```python
import torch

def _softmax(x, axis=-1):
    return torch.softmax(x, dim=axis)

def _gelu(x):
    return torch.nn.functional.gelu(x, approximate='tanh')

def _silu(x):
    return torch.nn.functional.silu(x)

def _sigmoid(x):
    return torch.sigmoid(x)

def _layernorm(x, axis=-1, eps=1e-05):
    m = x.mean(dim=axis, keepdim=True)
    v = x.var(dim=axis, keepdim=True, unbiased=False)
    return (x - m) / torch.sqrt(v + eps)

def _scatter_add(tgt, idx, src, axis=0):
    return tgt.clone().index_add_(axis, idx, src)

def _segment_sum(src, seg, n):
    out = torch.zeros((n,) + src.shape[1:], dtype=src.dtype)
    return out.index_add_(0, seg, src)

def _pad(x, pw):
    flat = tuple((v for pair in reversed(pw) for v in pair))
    return torch.nn.functional.pad(x, flat)
kernel_name = 'adaLN_cond__memory_aug_recurrent_mem_tr__mixer_token_mlp__prompt'

def setup_inputs():

    _w = lambda a: (lambda t: t.to(torch.bfloat16) if t.is_floating_point() else t)(torch.as_tensor(a))

    def _A_setup():
        B, S, Dm = (1, 2048, 1024)
        H, Dh = (32, 128)
        M, seg = (8, 32)
        seg = min(seg, S)
        S = S // seg * seg
        return {'x': _w((lambda *s: torch.randn(*s, dtype=torch.bfloat16) * 0.05)(B, S, Dm)), 'mem0': _w((lambda *s: torch.randn(*s, dtype=torch.bfloat16) * 0.8)(B, M, Dm)), 'Wq': _w((lambda *s: torch.randn(*s, dtype=torch.bfloat16) * 1.6)(Dm, H, Dh) * Dm ** (-0.5)), 'Wk': _w((lambda *s: torch.randn(*s, dtype=torch.bfloat16) * 1.6)(Dm, H, Dh) * Dm ** (-0.5)), 'Wv': _w((lambda *s: torch.randn(*s, dtype=torch.bfloat16) * 0.8)(Dm, H, Dh) * Dm ** (-0.5)), 'Wo': _w((lambda *s: torch.randn(*s, dtype=torch.bfloat16) * 0.8)(H, Dh, Dm) * (H * Dh) ** (-0.5)), 'seg_len': seg}
    _A_in = _A_setup()

    def _B_setup():
        B, S, D, F = (1, 2048, 1024, 3584)
        return {'x': _w((lambda *s: torch.randn(*s, dtype=torch.bfloat16) * 0.05)(B, S, D)), 'w1': _w((lambda *s: torch.randn(*s, dtype=torch.bfloat16) * 1.6)(S, F) * S ** (-0.5)), 'b1': _w((lambda *s: torch.randn(*s, dtype=torch.bfloat16) * 1.6)(F) * 0.02), 'w2': _w((lambda *s: torch.randn(*s, dtype=torch.bfloat16) * 0.2)(F, S) * F ** (-0.5)), 'b2': _w((lambda *s: torch.randn(*s, dtype=torch.bfloat16) * 0.2)(S) * 0.02)}
    _B_in = _B_setup()
    return {'A_x': _A_in['x'], 'A_mem0': _A_in['mem0'], 'A_Wq': _A_in['Wq'], 'A_Wk': _A_in['Wk'], 'A_Wv': _A_in['Wv'], 'A_Wo': _A_in['Wo'], 'A_seg_len': _A_in['seg_len'], 'B_x': _B_in['x'], 'B_w1': _B_in['w1'], 'B_b1': _B_in['b1'], 'B_w2': _B_in['w2'], 'B_b2': _B_in['b2'], 'c': _w((lambda *s: torch.randn(*s, dtype=torch.bfloat16) * 0.05)(1, 1024) * 8.0), 'w_mod': _w((lambda *s: torch.randn(*s, dtype=torch.bfloat16) * 0.05)(1024, 6 * 1024) * 1024 ** (-0.5) * 8.0)}

def reference(A_x, A_mem0, A_Wq, A_Wk, A_Wv, A_Wo, A_seg_len, B_x, B_w1, B_b1, B_w2, B_b2, c, w_mod):

    def _A_ref(x, mem0, Wq, Wk, Wv, Wo, seg_len):
        B, S, Dm = x.shape
        H, Dh = (Wq.shape[1], Wq.shape[2])
        M = mem0.shape[1]
        scale = Dh ** (-0.5)
        n_seg = S // seg_len
        L = M + seg_len
        idx = torch.arange(L)
        mask = (idx[:, None] < M) | (idx[:, None] >= idx[None, :])
        mem = mem0
        outs = []
        for s in range(n_seg):
            xs = x[:, s * seg_len:(s + 1) * seg_len, :].clone()
            h = torch.concatenate([mem, xs], axis=1)
            q = torch.einsum('btd,dhe->bhte', h, Wq)
            k = torch.einsum('btd,dhe->bhte', h, Wk)
            v = torch.einsum('btd,dhe->bhte', h, Wv)
            scores = torch.einsum('bhqe,bhke->bhqk', q, k) * scale
            scores = torch.where(mask[None, None], scores, -1000000000.0)
            p = _softmax(scores, axis=-1)
            o = torch.einsum('bhqk,bhke->bhqe', p, v)
            o = torch.einsum('bhte,hed->btd', o, Wo)
            mem = o[:, :M, :].clone()
            outs.append(o[:, M:, :])
        return torch.concatenate(outs, axis=1)

    def _B_ref(x, w1, b1, w2, b2):
        B, S, D = x.shape
        h = _layernorm(x, axis=-1)
        u = torch.einsum('bsd,sf->bdf', h, w1) + b1
        u = _gelu(u)
        y = torch.einsum('bdf,fs->bds', u, w2) + b2
        return (lambda x, *d: x.permute(*d))(y, 0, 2, 1)
    x = A_x
    mod = (_silu(c) @ w_mod).reshape(c.shape[0], 6, 1, -1)
    sa, ca, ga, sb, cb, gb = (mod[:, 0].clone(), mod[:, 1].clone(), mod[:, 2].clone(), mod[:, 3].clone(), mod[:, 4].clone(), mod[:, 5].clone())
    h = _layernorm(x, axis=-1) * (1 + ca) + sa
    x = x + ga * _A_ref(h, A_mem0, A_Wq, A_Wk, A_Wv, A_Wo, A_seg_len)
    h = _layernorm(x, axis=-1) * (1 + cb) + sb
    x = x + gb * _B_ref(h, B_w1, B_b1, B_w2, B_b2)
    return x
```

```asm
; @launch kernel=mega_kernel grid=(256,1,1) block=(256,1,1) lds=131072
; @launch kernel=tail_kernel grid=(256,1,1) block=(256,1,1) lds=131072
.amdgcn_target "amdgcn-amd-amdhsa--gfx950"
.text
.globl mega_kernel
.p2align 8
.type mega_kernel,@function
mega_kernel:
    s_cmp_ge_u32 s2, 256
    s_cbranch_scc1 M_end
    s_load_dwordx2 s[70:71], s[0:1], 120
    s_load_dwordx2 s[6:7], s[0:1], 128
    s_load_dwordx2 s[10:11], s[0:1], 8
    v_lshlrev_b32 v3, 4, v0
    v_lshrrev_b32 v1, 6, v0
    v_and_b32 v0, 63, v0
    v_readfirstlane_b32 s3, v1
    s_getreg_b32 s4, hwreg(HW_REG_XCC_ID, 0, 4)
    s_and_b32 s4, s4, 7
    v_mov_b32 v8, -1
    v_mov_b32 v9, -1
    v_mov_b32 v10, -1
    v_mov_b32 v11, -1
    s_waitcnt lgkmcnt(0)
    s_lshl_b32 s12, s2, 15
    s_add_u32 s12, s12, 117440512
    s_add_u32 s14, s6, s12
    s_addc_u32 s15, s7, 0
    global_store_dwordx4 v3, v[8:11], s[14:15] sc1
    s_add_u32 s14, s14, 4096
    s_addc_u32 s15, s15, 0
    global_store_dwordx4 v3, v[8:11], s[14:15] sc1
    s_add_u32 s14, s14, 4096
    s_addc_u32 s15, s15, 0
    global_store_dwordx4 v3, v[8:11], s[14:15] sc1
    s_add_u32 s14, s14, 4096
    s_addc_u32 s15, s15, 0
    global_store_dwordx4 v3, v[8:11], s[14:15] sc1
    s_add_u32 s14, s14, 4096
    s_addc_u32 s15, s15, 0
    global_store_dwordx4 v3, v[8:11], s[14:15] sc1
    s_add_u32 s14, s14, 4096
    s_addc_u32 s15, s15, 0
    global_store_dwordx4 v3, v[8:11], s[14:15] sc1
    s_add_u32 s14, s14, 4096
    s_addc_u32 s15, s15, 0
    global_store_dwordx4 v3, v[8:11], s[14:15] sc1
    s_add_u32 s14, s14, 4096
    s_addc_u32 s15, s15, 0
    global_store_dwordx4 v3, v[8:11], s[14:15] sc1
    s_add_u32 s14, s14, 4096
    s_addc_u32 s15, s15, 0
    s_cmp_ge_u32 s2, 128
    s_cbranch_scc1 M_f2
    s_lshl_b32 s12, s2, 12
    s_add_u32 s13, s12, 101711872
    s_add_u32 s14, s6, s13
    s_addc_u32 s15, s7, 0
    global_store_dwordx4 v3, v[8:11], s[14:15] sc1
    s_add_u32 s13, s12, 100663296
    s_add_u32 s14, s6, s13
    s_addc_u32 s15, s7, 0
    s_cmp_lt_u32 s2, 32
    s_cbranch_scc1 M_img
    global_store_dwordx4 v3, v[8:11], s[14:15] sc1
    s_branch M_f3
M_img:
    s_and_b32 s16, s2, 3
    s_lshl_b32 s16, s16, 2
    s_add_u32 s16, s16, s3
    s_lshl_b32 s16, s16, 7
    v_and_b32 v5, 7, v0
    v_lshlrev_b32 v5, 11, v5
    v_bfe_u32 v6, v0, 3, 1
    v_lshl_add_u32 v5, v6, 6, v5
    v_lshrrev_b32 v6, 4, v0
    v_lshl_add_u32 v5, v6, 4, v5
    v_add_u32 v5, s16, v5
    global_load_dwordx4 v[16:19], v5, s[10:11]
    s_waitcnt vmcnt(0)
    global_store_dwordx4 v3, v[16:19], s[14:15] sc1
    s_branch M_f3
M_f2:
    s_cmp_ge_u32 s2, 192
    s_cbranch_scc1 M_f4
    s_sub_u32 s12, s2, 128
    s_lshl_b32 s12, s12, 12
    s_add_u32 s13, s12, 102760448
    s_add_u32 s14, s6, s13
    s_addc_u32 s15, s7, 0
    global_store_dwordx4 v3, v[8:11], s[14:15] sc1
    s_branch M_f3
M_f4:
    s_cmp_ge_u32 s2, 240
    s_cbranch_scc1 M_f3
    s_sub_u32 s12, s2, 192
    s_lshl_b32 s12, s12, 12
    s_add_u32 s12, s12, 130023424
    s_add_u32 s14, s6, s12
    s_addc_u32 s15, s7, 0
    v_mov_b32 v8, 0
    v_mov_b32 v9, 0
    v_mov_b32 v10, 0
    v_mov_b32 v11, 0
    global_store_dwordx4 v3, v[8:11], s[14:15] sc1
M_f3:
    s_waitcnt vmcnt(0)
    s_barrier
    s_cmp_lg_u32 s3, 0
    s_cbranch_scc1 M_w
    s_and_b32 s12, s4, 3
    s_lshl_b32 s12, s12, 2
    s_lshr_b32 s13, s4, 2
    s_lshl_b32 s13, s13, 7
    s_add_u32 s12, s12, s13
    v_mov_b32 v1, s12
    v_mov_b32 v2, 1
    s_mov_b64 exec, 1
    global_atomic_add v3, v1, v2, s[70:71] sc0
    s_waitcnt vmcnt(0)
    v_mov_b32 v1, 0
    ds_write_b32 v1, v3
    s_waitcnt lgkmcnt(0)
    s_mov_b64 exec, -1
M_w:
    s_barrier
    v_mov_b32 v1, 0
    ds_read_b32 v6, v1
    s_waitcnt lgkmcnt(0)
    v_readfirstlane_b32 s5, v6
    s_barrier
    s_mov_b32 s65, 1
    s_cmp_lt_u32 s5, 16
    s_cbranch_scc1 M_rec_fast
    s_cmp_lt_u32 s5, 32
    s_cbranch_scc0 M_idle
    s_sub_u32 s5, s5, 16
    s_branch M_bulk
M_idle:
    s_cmp_lg_u32 s3, 0
    s_cbranch_scc1 L_fc_i_w
    s_mov_b64 exec, 0xff
    v_and_b32 v1, 3, v0
    v_lshlrev_b32 v1, 2, v1
    v_lshrrev_b32 v5, 2, v0
    v_lshl_add_u32 v1, v5, 7, v1
    s_mov_b32 s13, 0x200000
L_fc_i_p:
    global_load_dword v4, v1, s[70:71] sc1
    s_waitcnt vmcnt(0)
    v_mov_b32 v5, v4
    s_nop 1
    v_add_u32_dpp v5, v5, v5 quad_perm:[1,0,3,2] row_mask:0xf bank_mask:0xf
    s_nop 1
    v_add_u32_dpp v5, v5, v5 quad_perm:[2,3,0,1] row_mask:0xf bank_mask:0xf
    s_nop 1
    v_add_u32_dpp v5, v5, v5 row_half_mirror row_mask:0xf bank_mask:0xf
    s_nop 0
    v_readfirstlane_b32 s14, v5
    s_nop 0
    s_cmp_ge_u32 s14, 256
    s_cbranch_scc1 L_fc_i_a
    s_sleep 8
    s_sub_u32 s13, s13, 1
    s_cbranch_scc0 L_fc_i_p
L_fc_i_a:
    v_cmp_ne_u32 vcc, 32, v4
    s_nop 1
    s_cmp_eq_u64 vcc, 0
    s_cselect_b32 s15, 1, 0
    s_mov_b64 exec, 1
    v_mov_b32 v6, s15
    v_mov_b32 v1, 131008
    ds_write_b32 v1, v6
    s_waitcnt lgkmcnt(0)
    s_mov_b64 exec, -1
L_fc_i_w:
    s_barrier
    v_mov_b32 v1, 131008
    ds_read_b32 v6, v1
    s_waitcnt lgkmcnt(0)
    v_readfirstlane_b32 s15, v6
    s_barrier
M_slow:
    s_mov_b32 s65, 0
    s_lshr_b32 s4, s2, 4
    s_and_b32 s4, s4, 7
    s_and_b32 s5, s2, 15
    s_cmp_lt_u32 s2, 128
    s_cbranch_scc1 M_rec_slow
    s_branch M_bulk
M_end:
    s_endpgm
M_bulk:
    s_load_dwordx2 s[6:7], s[0:1], 128
    s_load_dwordx2 s[76:77], s[0:1], 104
    s_load_dwordx2 s[78:79], s[0:1], 0
    s_load_dwordx2 s[84:85], s[0:1], 96
    s_waitcnt lgkmcnt(0)
    s_add_u32 s60, s6, 130023424
    s_addc_u32 s61, s7, 0
    s_cmp_eq_u32 s65, 0
    s_cbranch_scc0 B_L_cb
    s_add_u32 s60, s60, 65536
    s_addc_u32 s61, s61, 0
B_L_cb:
    s_lshl_b32 s62, s4, 4
    s_add_u32 s62, s62, s5
    s_mov_b32 s66, 0x400000
    s_load_dwordx2 s[8:9], s[0:1], 96
    s_lshl_b32 s12, s3, 6
    v_add_u32 v4, s12, v0
    v_lshlrev_b32 v5, 3, v4
    s_waitcnt lgkmcnt(0)
    global_load_dwordx2 v[12:13], v5, s[8:9]
    s_waitcnt vmcnt(0)
    v_lshlrev_b32 v14, 16, v12
    v_and_b32 v15, 0xffff0000, v12
    v_lshlrev_b32 v16, 16, v13
    v_and_b32 v17, 0xffff0000, v13
    s_mov_b32 s12, 0xbfb8aa3b
    v_mul_f32 v20, s12, v14
    v_exp_f32 v20, v20
    s_nop 0
    v_add_f32 v20, 1.0, v20
    v_rcp_f32 v20, v20
    s_nop 0
    v_mul_f32 v20, v14, v20
    v_mul_f32 v21, s12, v15
    v_exp_f32 v21, v21
    s_nop 0
    v_add_f32 v21, 1.0, v21
    v_rcp_f32 v21, v21
    s_nop 0
    v_mul_f32 v21, v15, v21
    v_mul_f32 v22, s12, v16
    v_exp_f32 v22, v22
    s_nop 0
    v_add_f32 v22, 1.0, v22
    v_rcp_f32 v22, v22
    s_nop 0
    v_mul_f32 v22, v16, v22
    v_mul_f32 v23, s12, v17
    v_exp_f32 v23, v23
    s_nop 0
    v_add_f32 v23, 1.0, v23
    v_rcp_f32 v23, v23
    s_nop 0
    v_mul_f32 v23, v17, v23
    v_cvt_pk_bf16_f32 v24, v20, v21
    v_cvt_pk_bf16_f32 v25, v22, v23
    v_lshlrev_b32 v20, 16, v24
    v_and_b32 v21, 0xffff0000, v24
    v_lshlrev_b32 v22, 16, v25
    v_and_b32 v23, 0xffff0000, v25
    v_lshlrev_b32 v4, 4, v4
    ds_write_b128 v4, v[20:23]
    s_waitcnt lgkmcnt(0)
    s_barrier
    s_lshl_b32 s67, s62, 5
    s_load_dwordx2 s[8:9], s[0:1], 104
    v_lshrrev_b32 v5, 2, v0
    s_lshl_b32 s12, s3, 8
    v_add_u32 v5, s12, v5
    v_lshlrev_b32 v6, 2, v5
    s_mov_b32 s13, 12288
    v_mul_lo_u32 v7, v5, s13
    v_and_b32 v26, 3, v0
    v_lshl_add_u32 v7, v26, 4, v7
    s_lshl_b32 s12, s67, 1
    v_add_u32 v7, s12, v7
    s_waitcnt lgkmcnt(0)
    global_load_dwordx4 v[32:35], v7, s[8:9]
    v_add_u32 v7, 196608, v7
    ds_read_b32 v96, v6 offset:0
    global_load_dwordx4 v[36:39], v7, s[8:9]
    v_add_u32 v7, 196608, v7
    ds_read_b32 v97, v6 offset:64
    global_load_dwordx4 v[40:43], v7, s[8:9]
    v_add_u32 v7, 196608, v7
    ds_read_b32 v98, v6 offset:128
    global_load_dwordx4 v[44:47], v7, s[8:9]
    v_add_u32 v7, 196608, v7
    ds_read_b32 v99, v6 offset:192
    global_load_dwordx4 v[48:51], v7, s[8:9]
    v_add_u32 v7, 196608, v7
    ds_read_b32 v100, v6 offset:256
    global_load_dwordx4 v[52:55], v7, s[8:9]
    v_add_u32 v7, 196608, v7
    ds_read_b32 v101, v6 offset:320
    global_load_dwordx4 v[56:59], v7, s[8:9]
    v_add_u32 v7, 196608, v7
    ds_read_b32 v102, v6 offset:384
    global_load_dwordx4 v[60:63], v7, s[8:9]
    v_add_u32 v7, 196608, v7
    ds_read_b32 v103, v6 offset:448
    global_load_dwordx4 v[64:67], v7, s[8:9]
    v_add_u32 v7, 196608, v7
    ds_read_b32 v104, v6 offset:512
    global_load_dwordx4 v[68:71], v7, s[8:9]
    v_add_u32 v7, 196608, v7
    ds_read_b32 v105, v6 offset:576
    global_load_dwordx4 v[72:75], v7, s[8:9]
    v_add_u32 v7, 196608, v7
    ds_read_b32 v106, v6 offset:640
    global_load_dwordx4 v[76:79], v7, s[8:9]
    v_add_u32 v7, 196608, v7
    ds_read_b32 v107, v6 offset:704
    global_load_dwordx4 v[80:83], v7, s[8:9]
    v_add_u32 v7, 196608, v7
    ds_read_b32 v108, v6 offset:768
    global_load_dwordx4 v[84:87], v7, s[8:9]
    v_add_u32 v7, 196608, v7
    ds_read_b32 v109, v6 offset:832
    global_load_dwordx4 v[88:91], v7, s[8:9]
    v_add_u32 v7, 196608, v7
    ds_read_b32 v110, v6 offset:896
    global_load_dwordx4 v[92:95], v7, s[8:9]
    v_add_u32 v7, 196608, v7
    ds_read_b32 v111, v6 offset:960
    v_mov_b32 v112, 0
    v_mov_b32 v113, 0
    v_mov_b32 v114, 0
    v_mov_b32 v115, 0
    v_mov_b32 v116, 0
    v_mov_b32 v117, 0
    v_mov_b32 v118, 0
    v_mov_b32 v119, 0
    s_waitcnt lgkmcnt(0)
    s_waitcnt vmcnt(15)
    v_lshlrev_b32 v27, 16, v32
    v_and_b32 v28, 0xffff0000, v32
    v_fmac_f32 v112, v27, v96
    v_fmac_f32 v113, v28, v96
    v_lshlrev_b32 v27, 16, v33
    v_and_b32 v28, 0xffff0000, v33
    v_fmac_f32 v114, v27, v96
    v_fmac_f32 v115, v28, v96
    v_lshlrev_b32 v27, 16, v34
    v_and_b32 v28, 0xffff0000, v34
    v_fmac_f32 v116, v27, v96
    v_fmac_f32 v117, v28, v96
    v_lshlrev_b32 v27, 16, v35
    v_and_b32 v28, 0xffff0000, v35
    v_fmac_f32 v118, v27, v96
    v_fmac_f32 v119, v28, v96
    s_waitcnt vmcnt(14)
    v_lshlrev_b32 v27, 16, v36
    v_and_b32 v28, 0xffff0000, v36
    v_fmac_f32 v112, v27, v97
    v_fmac_f32 v113, v28, v97
    v_lshlrev_b32 v27, 16, v37
    v_and_b32 v28, 0xffff0000, v37
    v_fmac_f32 v114, v27, v97
    v_fmac_f32 v115, v28, v97
    v_lshlrev_b32 v27, 16, v38
    v_and_b32 v28, 0xffff0000, v38
    v_fmac_f32 v116, v27, v97
    v_fmac_f32 v117, v28, v97
    v_lshlrev_b32 v27, 16, v39
    v_and_b32 v28, 0xffff0000, v39
    v_fmac_f32 v118, v27, v97
    v_fmac_f32 v119, v28, v97
    s_waitcnt vmcnt(13)
    v_lshlrev_b32 v27, 16, v40
    v_and_b32 v28, 0xffff0000, v40
    v_fmac_f32 v112, v27, v98
    v_fmac_f32 v113, v28, v98
    v_lshlrev_b32 v27, 16, v41
    v_and_b32 v28, 0xffff0000, v41
    v_fmac_f32 v114, v27, v98
    v_fmac_f32 v115, v28, v98
    v_lshlrev_b32 v27, 16, v42
    v_and_b32 v28, 0xffff0000, v42
    v_fmac_f32 v116, v27, v98
    v_fmac_f32 v117, v28, v98
    v_lshlrev_b32 v27, 16, v43
    v_and_b32 v28, 0xffff0000, v43
    v_fmac_f32 v118, v27, v98
    v_fmac_f32 v119, v28, v98
    s_waitcnt vmcnt(12)
    v_lshlrev_b32 v27, 16, v44
    v_and_b32 v28, 0xffff0000, v44
    v_fmac_f32 v112, v27, v99
    v_fmac_f32 v113, v28, v99
    v_lshlrev_b32 v27, 16, v45
    v_and_b32 v28, 0xffff0000, v45
    v_fmac_f32 v114, v27, v99
    v_fmac_f32 v115, v28, v99
    v_lshlrev_b32 v27, 16, v46
    v_and_b32 v28, 0xffff0000, v46
    v_fmac_f32 v116, v27, v99
    v_fmac_f32 v117, v28, v99
    v_lshlrev_b32 v27, 16, v47
    v_and_b32 v28, 0xffff0000, v47
    v_fmac_f32 v118, v27, v99
    v_fmac_f32 v119, v28, v99
    s_waitcnt vmcnt(11)
    v_lshlrev_b32 v27, 16, v48
    v_and_b32 v28, 0xffff0000, v48
    v_fmac_f32 v112, v27, v100
    v_fmac_f32 v113, v28, v100
    v_lshlrev_b32 v27, 16, v49
    v_and_b32 v28, 0xffff0000, v49
    v_fmac_f32 v114, v27, v100
    v_fmac_f32 v115, v28, v100
    v_lshlrev_b32 v27, 16, v50
    v_and_b32 v28, 0xffff0000, v50
    v_fmac_f32 v116, v27, v100
    v_fmac_f32 v117, v28, v100
    v_lshlrev_b32 v27, 16, v51
    v_and_b32 v28, 0xffff0000, v51
    v_fmac_f32 v118, v27, v100
    v_fmac_f32 v119, v28, v100
    s_waitcnt vmcnt(10)
    v_lshlrev_b32 v27, 16, v52
    v_and_b32 v28, 0xffff0000, v52
    v_fmac_f32 v112, v27, v101
    v_fmac_f32 v113, v28, v101
    v_lshlrev_b32 v27, 16, v53
    v_and_b32 v28, 0xffff0000, v53
    v_fmac_f32 v114, v27, v101
    v_fmac_f32 v115, v28, v101
    v_lshlrev_b32 v27, 16, v54
    v_and_b32 v28, 0xffff0000, v54
    v_fmac_f32 v116, v27, v101
    v_fmac_f32 v117, v28, v101
    v_lshlrev_b32 v27, 16, v55
    v_and_b32 v28, 0xffff0000, v55
    v_fmac_f32 v118, v27, v101
    v_fmac_f32 v119, v28, v101
    s_waitcnt vmcnt(9)
    v_lshlrev_b32 v27, 16, v56
    v_and_b32 v28, 0xffff0000, v56
    v_fmac_f32 v112, v27, v102
    v_fmac_f32 v113, v28, v102
    v_lshlrev_b32 v27, 16, v57
    v_and_b32 v28, 0xffff0000, v57
    v_fmac_f32 v114, v27, v102
    v_fmac_f32 v115, v28, v102
    v_lshlrev_b32 v27, 16, v58
    v_and_b32 v28, 0xffff0000, v58
    v_fmac_f32 v116, v27, v102
    v_fmac_f32 v117, v28, v102
    v_lshlrev_b32 v27, 16, v59
    v_and_b32 v28, 0xffff0000, v59
    v_fmac_f32 v118, v27, v102
    v_fmac_f32 v119, v28, v102
    s_waitcnt vmcnt(8)
    v_lshlrev_b32 v27, 16, v60
    v_and_b32 v28, 0xffff0000, v60
    v_fmac_f32 v112, v27, v103
    v_fmac_f32 v113, v28, v103
    v_lshlrev_b32 v27, 16, v61
    v_and_b32 v28, 0xffff0000, v61
    v_fmac_f32 v114, v27, v103
    v_fmac_f32 v115, v28, v103
    v_lshlrev_b32 v27, 16, v62
    v_and_b32 v28, 0xffff0000, v62
    v_fmac_f32 v116, v27, v103
    v_fmac_f32 v117, v28, v103
    v_lshlrev_b32 v27, 16, v63
    v_and_b32 v28, 0xffff0000, v63
    v_fmac_f32 v118, v27, v103
    v_fmac_f32 v119, v28, v103
    s_waitcnt vmcnt(7)
    v_lshlrev_b32 v27, 16, v64
    v_and_b32 v28, 0xffff0000, v64
    v_fmac_f32 v112, v27, v104
    v_fmac_f32 v113, v28, v104
    v_lshlrev_b32 v27, 16, v65
    v_and_b32 v28, 0xffff0000, v65
    v_fmac_f32 v114, v27, v104
    v_fmac_f32 v115, v28, v104
    v_lshlrev_b32 v27, 16, v66
    v_and_b32 v28, 0xffff0000, v66
    v_fmac_f32 v116, v27, v104
    v_fmac_f32 v117, v28, v104
    v_lshlrev_b32 v27, 16, v67
    v_and_b32 v28, 0xffff0000, v67
    v_fmac_f32 v118, v27, v104
    v_fmac_f32 v119, v28, v104
    s_waitcnt vmcnt(6)
    v_lshlrev_b32 v27, 16, v68
    v_and_b32 v28, 0xffff0000, v68
    v_fmac_f32 v112, v27, v105
    v_fmac_f32 v113, v28, v105
    v_lshlrev_b32 v27, 16, v69
    v_and_b32 v28, 0xffff0000, v69
    v_fmac_f32 v114, v27, v105
    v_fmac_f32 v115, v28, v105
    v_lshlrev_b32 v27, 16, v70
    v_and_b32 v28, 0xffff0000, v70
    v_fmac_f32 v116, v27, v105
    v_fmac_f32 v117, v28, v105
    v_lshlrev_b32 v27, 16, v71
    v_and_b32 v28, 0xffff0000, v71
    v_fmac_f32 v118, v27, v105
    v_fmac_f32 v119, v28, v105
    s_waitcnt vmcnt(5)
    v_lshlrev_b32 v27, 16, v72
    v_and_b32 v28, 0xffff0000, v72
    v_fmac_f32 v112, v27, v106
    v_fmac_f32 v113, v28, v106
    v_lshlrev_b32 v27, 16, v73
    v_and_b32 v28, 0xffff0000, v73
    v_fmac_f32 v114, v27, v106
    v_fmac_f32 v115, v28, v106
    v_lshlrev_b32 v27, 16, v74
    v_and_b32 v28, 0xffff0000, v74
    v_fmac_f32 v116, v27, v106
    v_fmac_f32 v117, v28, v106
    v_lshlrev_b32 v27, 16, v75
    v_and_b32 v28, 0xffff0000, v75
    v_fmac_f32 v118, v27, v106
    v_fmac_f32 v119, v28, v106
    s_waitcnt vmcnt(4)
    v_lshlrev_b32 v27, 16, v76
    v_and_b32 v28, 0xffff0000, v76
    v_fmac_f32 v112, v27, v107
    v_fmac_f32 v113, v28, v107
    v_lshlrev_b32 v27, 16, v77
    v_and_b32 v28, 0xffff0000, v77
    v_fmac_f32 v114, v27, v107
    v_fmac_f32 v115, v28, v107
    v_lshlrev_b32 v27, 16, v78
    v_and_b32 v28, 0xffff0000, v78
    v_fmac_f32 v116, v27, v107
    v_fmac_f32 v117, v28, v107
    v_lshlrev_b32 v27, 16, v79
    v_and_b32 v28, 0xffff0000, v79
    v_fmac_f32 v118, v27, v107
    v_fmac_f32 v119, v28, v107
    s_waitcnt vmcnt(3)
    v_lshlrev_b32 v27, 16, v80
    v_and_b32 v28, 0xffff0000, v80
    v_fmac_f32 v112, v27, v108
    v_fmac_f32 v113, v28, v108
    v_lshlrev_b32 v27, 16, v81
    v_and_b32 v28, 0xffff0000, v81
    v_fmac_f32 v114, v27, v108
    v_fmac_f32 v115, v28, v108
    v_lshlrev_b32 v27, 16, v82
    v_and_b32 v28, 0xffff0000, v82
    v_fmac_f32 v116, v27, v108
    v_fmac_f32 v117, v28, v108
    v_lshlrev_b32 v27, 16, v83
    v_and_b32 v28, 0xffff0000, v83
    v_fmac_f32 v118, v27, v108
    v_fmac_f32 v119, v28, v108
    s_waitcnt vmcnt(2)
    v_lshlrev_b32 v27, 16, v84
    v_and_b32 v28, 0xffff0000, v84
    v_fmac_f32 v112, v27, v109
    v_fmac_f32 v113, v28, v109
    v_lshlrev_b32 v27, 16, v85
    v_and_b32 v28, 0xffff0000, v85
    v_fmac_f32 v114, v27, v109
    v_fmac_f32 v115, v28, v109
    v_lshlrev_b32 v27, 16, v86
    v_and_b32 v28, 0xffff0000, v86
    v_fmac_f32 v116, v27, v109
    v_fmac_f32 v117, v28, v109
    v_lshlrev_b32 v27, 16, v87
    v_and_b32 v28, 0xffff0000, v87
    v_fmac_f32 v118, v27, v109
    v_fmac_f32 v119, v28, v109
    s_waitcnt vmcnt(1)
    v_lshlrev_b32 v27, 16, v88
    v_and_b32 v28, 0xffff0000, v88
    v_fmac_f32 v112, v27, v110
    v_fmac_f32 v113, v28, v110
    v_lshlrev_b32 v27, 16, v89
    v_and_b32 v28, 0xffff0000, v89
    v_fmac_f32 v114, v27, v110
    v_fmac_f32 v115, v28, v110
    v_lshlrev_b32 v27, 16, v90
    v_and_b32 v28, 0xffff0000, v90
    v_fmac_f32 v116, v27, v110
    v_fmac_f32 v117, v28, v110
    v_lshlrev_b32 v27, 16, v91
    v_and_b32 v28, 0xffff0000, v91
    v_fmac_f32 v118, v27, v110
    v_fmac_f32 v119, v28, v110
    s_waitcnt vmcnt(0)
    v_lshlrev_b32 v27, 16, v92
    v_and_b32 v28, 0xffff0000, v92
    v_fmac_f32 v112, v27, v111
    v_fmac_f32 v113, v28, v111
    v_lshlrev_b32 v27, 16, v93
    v_and_b32 v28, 0xffff0000, v93
    v_fmac_f32 v114, v27, v111
    v_fmac_f32 v115, v28, v111
    v_lshlrev_b32 v27, 16, v94
    v_and_b32 v28, 0xffff0000, v94
    v_fmac_f32 v116, v27, v111
    v_fmac_f32 v117, v28, v111
    v_lshlrev_b32 v27, 16, v95
    v_and_b32 v28, 0xffff0000, v95
    v_fmac_f32 v118, v27, v111
    v_fmac_f32 v119, v28, v111
    v_add_f32_dpp v112, v112, v112 row_ror:4 row_mask:0xf bank_mask:0xf
    s_nop 1
    v_add_f32_dpp v112, v112, v112 row_ror:8 row_mask:0xf bank_mask:0xf
    v_mov_b32 v27, v112
    s_nop 1
    v_permlane16_swap_b32 v112, v27
    v_add_f32 v112, v112, v27
    v_mov_b32 v27, v112
    s_nop 1
    v_permlane32_swap_b32 v112, v27
    v_add_f32 v112, v112, v27
    v_add_f32_dpp v113, v113, v113 row_ror:4 row_mask:0xf bank_mask:0xf
    s_nop 1
    v_add_f32_dpp v113, v113, v113 row_ror:8 row_mask:0xf bank_mask:0xf
    v_mov_b32 v27, v113
    s_nop 1
    v_permlane16_swap_b32 v113, v27
    v_add_f32 v113, v113, v27
    v_mov_b32 v27, v113
    s_nop 1
    v_permlane32_swap_b32 v113, v27
    v_add_f32 v113, v113, v27
    v_add_f32_dpp v114, v114, v114 row_ror:4 row_mask:0xf bank_mask:0xf
    s_nop 1
    v_add_f32_dpp v114, v114, v114 row_ror:8 row_mask:0xf bank_mask:0xf
    v_mov_b32 v27, v114
    s_nop 1
    v_permlane16_swap_b32 v114, v27
    v_add_f32 v114, v114, v27
    v_mov_b32 v27, v114
    s_nop 1
    v_permlane32_swap_b32 v114, v27
    v_add_f32 v114, v114, v27
    v_add_f32_dpp v115, v115, v115 row_ror:4 row_mask:0xf bank_mask:0xf
    s_nop 1
    v_add_f32_dpp v115, v115, v115 row_ror:8 row_mask:0xf bank_mask:0xf
    v_mov_b32 v27, v115
    s_nop 1
    v_permlane16_swap_b32 v115, v27
    v_add_f32 v115, v115, v27
    v_mov_b32 v27, v115
    s_nop 1
    v_permlane32_swap_b32 v115, v27
    v_add_f32 v115, v115, v27
    v_add_f32_dpp v116, v116, v116 row_ror:4 row_mask:0xf bank_mask:0xf
    s_nop 1
    v_add_f32_dpp v116, v116, v116 row_ror:8 row_mask:0xf bank_mask:0xf
    v_mov_b32 v27, v116
    s_nop 1
    v_permlane16_swap_b32 v116, v27
    v_add_f32 v116, v116, v27
    v_mov_b32 v27, v116
    s_nop 1
    v_permlane32_swap_b32 v116, v27
    v_add_f32 v116, v116, v27
    v_add_f32_dpp v117, v117, v117 row_ror:4 row_mask:0xf bank_mask:0xf
    s_nop 1
    v_add_f32_dpp v117, v117, v117 row_ror:8 row_mask:0xf bank_mask:0xf
    v_mov_b32 v27, v117
    s_nop 1
    v_permlane16_swap_b32 v117, v27
    v_add_f32 v117, v117, v27
    v_mov_b32 v27, v117
    s_nop 1
    v_permlane32_swap_b32 v117, v27
    v_add_f32 v117, v117, v27
    v_add_f32_dpp v118, v118, v118 row_ror:4 row_mask:0xf bank_mask:0xf
    s_nop 1
    v_add_f32_dpp v118, v118, v118 row_ror:8 row_mask:0xf bank_mask:0xf
    v_mov_b32 v27, v118
    s_nop 1
    v_permlane16_swap_b32 v118, v27
    v_add_f32 v118, v118, v27
    v_mov_b32 v27, v118
    s_nop 1
    v_permlane32_swap_b32 v118, v27
    v_add_f32 v118, v118, v27
    v_add_f32_dpp v119, v119, v119 row_ror:4 row_mask:0xf bank_mask:0xf
    s_nop 1
    v_add_f32_dpp v119, v119, v119 row_ror:8 row_mask:0xf bank_mask:0xf
    v_mov_b32 v27, v119
    s_nop 1
    v_permlane16_swap_b32 v119, v27
    v_add_f32 v119, v119, v27
    v_mov_b32 v27, v119
    s_nop 1
    v_permlane32_swap_b32 v119, v27
    v_add_f32 v119, v119, v27
    s_lshl_b32 s12, s3, 7
    v_lshlrev_b32 v5, 5, v26
    v_add_u32 v5, s12, v5
    s_mov_b64 exec, 0xf
    ds_write_b128 v5, v[112:115] offset:4096
    ds_write_b128 v5, v[116:119] offset:4112
    s_mov_b64 exec, -1
    s_waitcnt lgkmcnt(0)
    s_barrier
    s_cmp_lg_u32 s3, 0
    s_cbranch_scc1 B_L_mod_a_d
    v_lshlrev_b32 v5, 2, v0
    s_mov_b64 exec, 0xffffffff
    ds_read_b32 v32, v5 offset:4096
    ds_read_b32 v33, v5 offset:4224
    ds_read_b32 v34, v5 offset:4352
    ds_read_b32 v35, v5 offset:4480
    s_waitcnt lgkmcnt(0)
    v_add_f32 v32, v32, v33
    v_add_f32 v34, v34, v35
    v_add_f32 v32, v32, v34
    v_cvt_pk_bf16_f32 v32, v32, v32
    v_lshlrev_b32 v32, 16, v32
    s_lshl_b32 s12, s67, 2
    s_add_u32 s12, s12, 0
    v_add_u32 v5, s12, v5
    global_store_dword v5, v32, s[6:7] sc1
    s_mov_b64 exec, -1
B_L_mod_a_d:
    s_cmp_eq_u32 s65, 0
    s_cbranch_scc1 B_L_nochk
    s_cmp_lg_u32 s3, 0
    s_cbranch_scc1 B_L_fc_b_w
    s_mov_b64 exec, 0xff
    v_and_b32 v1, 3, v0
    v_lshlrev_b32 v1, 2, v1
    v_lshrrev_b32 v5, 2, v0
    v_lshl_add_u32 v1, v5, 7, v1
    s_mov_b32 s13, 0x200000
B_L_fc_b_p:
    global_load_dword v4, v1, s[70:71] sc1
    s_waitcnt vmcnt(0)
    v_mov_b32 v5, v4
    s_nop 1
    v_add_u32_dpp v5, v5, v5 quad_perm:[1,0,3,2] row_mask:0xf bank_mask:0xf
    s_nop 1
    v_add_u32_dpp v5, v5, v5 quad_perm:[2,3,0,1] row_mask:0xf bank_mask:0xf
    s_nop 1
    v_add_u32_dpp v5, v5, v5 row_half_mirror row_mask:0xf bank_mask:0xf
    s_nop 0
    v_readfirstlane_b32 s14, v5
    s_nop 0
    s_cmp_ge_u32 s14, 256
    s_cbranch_scc1 B_L_fc_b_a
    s_sleep 8
    s_sub_u32 s13, s13, 1
    s_cbranch_scc0 B_L_fc_b_p
B_L_fc_b_a:
    v_cmp_ne_u32 vcc, 32, v4
    s_nop 1
    s_cmp_eq_u64 vcc, 0
    s_cselect_b32 s15, 1, 0
    s_mov_b64 exec, 1
    v_mov_b32 v6, s15
    v_mov_b32 v1, 131008
    ds_write_b32 v1, v6
    s_waitcnt lgkmcnt(0)
    s_mov_b64 exec, -1
B_L_fc_b_w:
    s_barrier
    v_mov_b32 v1, 131008
    ds_read_b32 v6, v1
    s_waitcnt lgkmcnt(0)
    v_readfirstlane_b32 s15, v6
    s_barrier
    s_cmp_eq_u32 s15, 0
    s_cbranch_scc1 M_slow
B_L_nochk:
    s_cmp_lt_u32 s62, 64
    s_cselect_b32 s69, 40960, s69
    s_mov_b32 s44, 41088
    s_cselect_b32 s69, s69, s44
    s_waitcnt vmcnt(0)
    s_barrier
    s_cmp_lg_u32 s3, 0
    s_cbranch_scc1 B_L_sg_m1
    s_add_u32 s44, s69, 0
    v_mov_b32 v2, s44
    v_mov_b32 v3, 1
    s_mov_b64 exec, 1
    global_atomic_add v2, v3, s[60:61]
    s_mov_b64 exec, -1
B_L_sg_m1:
    s_cmp_lg_u32 s3, 0
    s_cbranch_scc1 B_L_wc_ma_b
    v_mov_b32 v2, 40960
B_L_wc_ma:
    global_load_dword v3, v2, s[60:61] sc1
    s_waitcnt vmcnt(0)
    v_readfirstlane_b32 s44, v3
    s_nop 0
    s_cmp_ge_u32 s44, 64
    s_cbranch_scc1 B_L_wc_ma_b
    s_sleep 3
    s_sub_u32 s66, s66, 1
    s_cbranch_scc0 B_L_wc_ma
    s_mov_b32 s66, 0
B_L_wc_ma_b:
    s_barrier
    s_load_dwordx2 s[8:9], s[0:1], 0
    v_lshlrev_b32 v2, 4, v0
    v_lshlrev_b32 v3, 5, v0
    s_add_u32 s12, s6, 0
    s_addc_u32 s13, s7, 0
    global_load_dwordx4 v[64:67], v3, s[12:13] offset:0
    global_load_dwordx4 v[68:71], v3, s[12:13] offset:16
    global_load_dwordx4 v[72:75], v3, s[12:13] offset:2048
    global_load_dwordx4 v[76:79], v3, s[12:13] offset:2064
    s_add_u32 s12, s12, 4096
    s_addc_u32 s13, s13, 0
    global_load_dwordx4 v[80:83], v3, s[12:13] offset:0
    global_load_dwordx4 v[84:87], v3, s[12:13] offset:16
    global_load_dwordx4 v[88:91], v3, s[12:13] offset:2048
    global_load_dwordx4 v[92:95], v3, s[12:13] offset:2064
    s_lshl_b32 s14, s62, 4
    s_lshl_b32 s15, s3, 2
    s_add_u32 s14, s14, s15
    s_waitcnt lgkmcnt(0)
    s_lshl_b32 s15, s14, 11
    s_add_u32 s10, s8, s15
    s_addc_u32 s11, s9, 0
    global_load_dwordx4 v[96:99], v2, s[10:11] offset:0
    global_load_dwordx4 v[100:103], v2, s[10:11] offset:1024
    global_load_dwordx4 v[104:107], v2, s[10:11] offset:2048
    global_load_dwordx4 v[108:111], v2, s[10:11] offset:3072
    s_add_u32 s10, s10, 4096
    s_addc_u32 s11, s11, 0
    global_load_dwordx4 v[112:115], v2, s[10:11] offset:0
    global_load_dwordx4 v[116:119], v2, s[10:11] offset:1024
    global_load_dwordx4 v[120:123], v2, s[10:11] offset:2048
    global_load_dwordx4 v[124:127], v2, s[10:11] offset:3072
    s_waitcnt vmcnt(8)
    v_add_f32 v80, 1.0, v80
    v_add_f32 v81, 1.0, v81
    v_add_f32 v82, 1.0, v82
    v_add_f32 v83, 1.0, v83
    v_add_f32 v84, 1.0, v84
    v_add_f32 v85, 1.0, v85
    v_add_f32 v86, 1.0, v86
    v_add_f32 v87, 1.0, v87
    v_add_f32 v88, 1.0, v88
    v_add_f32 v89, 1.0, v89
    v_add_f32 v90, 1.0, v90
    v_add_f32 v91, 1.0, v91
    v_add_f32 v92, 1.0, v92
    v_add_f32 v93, 1.0, v93
    v_add_f32 v94, 1.0, v94
    v_add_f32 v95, 1.0, v95
    s_waitcnt vmcnt(4)
    v_lshlrev_b32 v32, 16, v96
    v_and_b32 v33, 0xffff0000, v96
    v_lshlrev_b32 v34, 16, v97
    v_and_b32 v35, 0xffff0000, v97
    v_lshlrev_b32 v36, 16, v98
    v_and_b32 v37, 0xffff0000, v98
    v_lshlrev_b32 v38, 16, v99
    v_and_b32 v39, 0xffff0000, v99
    v_lshlrev_b32 v40, 16, v100
    v_and_b32 v41, 0xffff0000, v100
    v_lshlrev_b32 v42, 16, v101
    v_and_b32 v43, 0xffff0000, v101
    v_lshlrev_b32 v44, 16, v102
    v_and_b32 v45, 0xffff0000, v102
    v_lshlrev_b32 v46, 16, v103
    v_and_b32 v47, 0xffff0000, v103
    v_lshlrev_b32 v48, 16, v104
    v_and_b32 v49, 0xffff0000, v104
    v_lshlrev_b32 v50, 16, v105
    v_and_b32 v51, 0xffff0000, v105
    v_lshlrev_b32 v52, 16, v106
    v_and_b32 v53, 0xffff0000, v106
    v_lshlrev_b32 v54, 16, v107
    v_and_b32 v55, 0xffff0000, v107
    v_lshlrev_b32 v56, 16, v108
    v_and_b32 v57, 0xffff0000, v108
    v_lshlrev_b32 v58, 16, v109
    v_and_b32 v59, 0xffff0000, v109
    v_lshlrev_b32 v60, 16, v110
    v_and_b32 v61, 0xffff0000, v110
    v_lshlrev_b32 v62, 16, v111
    v_and_b32 v63, 0xffff0000, v111
    v_add_f32 v4, v32, v33
    v_add_f32 v4, v4, v34
    v_add_f32 v4, v4, v35
    v_add_f32 v4, v4, v36
    v_add_f32 v4, v4, v37
    v_add_f32 v4, v4, v38
    v_add_f32 v4, v4, v39
    v_add_f32 v4, v4, v40
    v_add_f32 v4, v4, v41
    v_add_f32 v4, v4, v42
    v_add_f32 v4, v4, v43
    v_add_f32 v4, v4, v44
    v_add_f32 v4, v4, v45
    v_add_f32 v4, v4, v46
    v_add_f32 v4, v4, v47
    s_nop 1
    v_add_f32_dpp v4, v4, v4 quad_perm:[1,0,3,2] row_mask:0xf bank_mask:0xf
    s_nop 1
    v_add_f32_dpp v4, v4, v4 quad_perm:[2,3,0,1] row_mask:0xf bank_mask:0xf
    s_nop 1
    v_add_f32_dpp v4, v4, v4 row_half_mirror row_mask:0xf bank_mask:0xf
    s_nop 1
    v_add_f32_dpp v4, v4, v4 row_mirror row_mask:0xf bank_mask:0xf
    v_mov_b32 v5, v4
    s_nop 1
    v_permlane16_swap_b32 v4, v5
    v_add_f32 v4, v4, v5
    v_mov_b32 v5, v4
    s_nop 1
    v_permlane32_swap_b32 v4, v5
    v_add_f32 v4, v4, v5
    v_mul_f32 v4, 0x3a800000, v4
    v_sub_f32 v32, v32, v4
    v_sub_f32 v33, v33, v4
    v_sub_f32 v34, v34, v4
    v_sub_f32 v35, v35, v4
    v_sub_f32 v36, v36, v4
    v_sub_f32 v37, v37, v4
    v_sub_f32 v38, v38, v4
    v_sub_f32 v39, v39, v4
    v_sub_f32 v40, v40, v4
    v_sub_f32 v41, v41, v4
    v_sub_f32 v42, v42, v4
    v_sub_f32 v43, v43, v4
    v_sub_f32 v44, v44, v4
    v_sub_f32 v45, v45, v4
    v_sub_f32 v46, v46, v4
    v_sub_f32 v47, v47, v4
    v_mul_f32 v4, v32, v32
    v_fmac_f32 v4, v33, v33
    v_fmac_f32 v4, v34, v34
    v_fmac_f32 v4, v35, v35
    v_fmac_f32 v4, v36, v36
    v_fmac_f32 v4, v37, v37
    v_fmac_f32 v4, v38, v38
    v_fmac_f32 v4, v39, v39
    v_fmac_f32 v4, v40, v40
    v_fmac_f32 v4, v41, v41
    v_fmac_f32 v4, v42, v42
    v_fmac_f32 v4, v43, v43
    v_fmac_f32 v4, v44, v44
    v_fmac_f32 v4, v45, v45
    v_fmac_f32 v4, v46, v46
    v_fmac_f32 v4, v47, v47
    s_nop 1
    v_add_f32_dpp v4, v4, v4 quad_perm:[1,0,3,2] row_mask:0xf bank_mask:0xf
    s_nop 1
    v_add_f32_dpp v4, v4, v4 quad_perm:[2,3,0,1] row_mask:0xf bank_mask:0xf
    s_nop 1
    v_add_f32_dpp v4, v4, v4 row_half_mirror row_mask:0xf bank_mask:0xf
    s_nop 1
    v_add_f32_dpp v4, v4, v4 row_mirror row_mask:0xf bank_mask:0xf
    v_mov_b32 v5, v4
    s_nop 1
    v_permlane16_swap_b32 v4, v5
    v_add_f32 v4, v4, v5
    v_mov_b32 v5, v4
    s_nop 1
    v_permlane32_swap_b32 v4, v5
    v_add_f32 v4, v4, v5
    v_mov_b32 v5, 0x3727c5ac
    v_fmac_f32 v5, 0x3a800000, v4
    v_rsq_f32 v5, v5
    s_nop 0
    v_mul_f32 v32, v32, v5
    v_mul_f32 v33, v33, v5
    v_mul_f32 v34, v34, v5
    v_mul_f32 v35, v35, v5
    v_mul_f32 v36, v36, v5
    v_mul_f32 v37, v37, v5
    v_mul_f32 v38, v38, v5
    v_mul_f32 v39, v39, v5
    v_mul_f32 v40, v40, v5
    v_mul_f32 v41, v41, v5
    v_mul_f32 v42, v42, v5
    v_mul_f32 v43, v43, v5
    v_mul_f32 v44, v44, v5
    v_mul_f32 v45, v45, v5
    v_mul_f32 v46, v46, v5
    v_mul_f32 v47, v47, v5
    v_add_f32 v4, v48, v49
    v_add_f32 v4, v4, v50
    v_add_f32 v4, v4, v51
    v_add_f32 v4, v4, v52
    v_add_f32 v4, v4, v53
    v_add_f32 v4, v4, v54
    v_add_f32 v4, v4, v55
    v_add_f32 v4, v4, v56
    v_add_f32 v4, v4, v57
    v_add_f32 v4, v4, v58
    v_add_f32 v4, v4, v59
    v_add_f32 v4, v4, v60
    v_add_f32 v4, v4, v61
    v_add_f32 v4, v4, v62
    v_add_f32 v4, v4, v63
    s_nop 1
    v_add_f32_dpp v4, v4, v4 quad_perm:[1,0,3,2] row_mask:0xf bank_mask:0xf
    s_nop 1
    v_add_f32_dpp v4, v4, v4 quad_perm:[2,3,0,1] row_mask:0xf bank_mask:0xf
    s_nop 1
    v_add_f32_dpp v4, v4, v4 row_half_mirror row_mask:0xf bank_mask:0xf
    s_nop 1
    v_add_f32_dpp v4, v4, v4 row_mirror row_mask:0xf bank_mask:0xf
    v_mov_b32 v5, v4
    s_nop 1
    v_permlane16_swap_b32 v4, v5
    v_add_f32 v4, v4, v5
    v_mov_b32 v5, v4
    s_nop 1
    v_permlane32_swap_b32 v4, v5
    v_add_f32 v4, v4, v5
    v_mul_f32 v4, 0x3a800000, v4
    v_sub_f32 v48, v48, v4
    v_sub_f32 v49, v49, v4
    v_sub_f32 v50, v50, v4
    v_sub_f32 v51, v51, v4
    v_sub_f32 v52, v52, v4
    v_sub_f32 v53, v53, v4
    v_sub_f32 v54, v54, v4
    v_sub_f32 v55, v55, v4
    v_sub_f32 v56, v56, v4
    v_sub_f32 v57, v57, v4
    v_sub_f32 v58, v58, v4
    v_sub_f32 v59, v59, v4
    v_sub_f32 v60, v60, v4
    v_sub_f32 v61, v61, v4
    v_sub_f32 v62, v62, v4
    v_sub_f32 v63, v63, v4
    v_mul_f32 v4, v48, v48
    v_fmac_f32 v4, v49, v49
    v_fmac_f32 v4, v50, v50
    v_fmac_f32 v4, v51, v51
    v_fmac_f32 v4, v52, v52
    v_fmac_f32 v4, v53, v53
    v_fmac_f32 v4, v54, v54
    v_fmac_f32 v4, v55, v55
    v_fmac_f32 v4, v56, v56
    v_fmac_f32 v4, v57, v57
    v_fmac_f32 v4, v58, v58
    v_fmac_f32 v4, v59, v59
    v_fmac_f32 v4, v60, v60
    v_fmac_f32 v4, v61, v61
    v_fmac_f32 v4, v62, v62
    v_fmac_f32 v4, v63, v63
    s_nop 1
    v_add_f32_dpp v4, v4, v4 quad_perm:[1,0,3,2] row_mask:0xf bank_mask:0xf
    s_nop 1
    v_add_f32_dpp v4, v4, v4 quad_perm:[2,3,0,1] row_mask:0xf bank_mask:0xf
    s_nop 1
    v_add_f32_dpp v4, v4, v4 row_half_mirror row_mask:0xf bank_mask:0xf
    s_nop 1
    v_add_f32_dpp v4, v4, v4 row_mirror row_mask:0xf bank_mask:0xf
    v_mov_b32 v5, v4
    s_nop 1
    v_permlane16_swap_b32 v4, v5
    v_add_f32 v4, v4, v5
    v_mov_b32 v5, v4
    s_nop 1
    v_permlane32_swap_b32 v4, v5
    v_add_f32 v4, v4, v5
    v_mov_b32 v5, 0x3727c5ac
    v_fmac_f32 v5, 0x3a800000, v4
    v_rsq_f32 v5, v5
    s_nop 0
    v_mul_f32 v48, v48, v5
    v_mul_f32 v49, v49, v5
    v_mul_f32 v50, v50, v5
    v_mul_f32 v51, v51, v5
    v_mul_f32 v52, v52, v5
    v_mul_f32 v53, v53, v5
    v_mul_f32 v54, v54, v5
    v_mul_f32 v55, v55, v5
    v_mul_f32 v56, v56, v5
    v_mul_f32 v57, v57, v5
    v_mul_f32 v58, v58, v5
    v_mul_f32 v59, v59, v5
    v_mul_f32 v60, v60, v5
    v_mul_f32 v61, v61, v5
    v_mul_f32 v62, v62, v5
    v_mul_f32 v63, v63, v5
    v_fma_f32 v32, v32, v80, v64
    v_fma_f32 v33, v33, v81, v65
    v_fma_f32 v34, v34, v82, v66
    v_fma_f32 v35, v35, v83, v67
    v_fma_f32 v36, v36, v84, v68
    v_fma_f32 v37, v37, v85, v69
    v_fma_f32 v38, v38, v86, v70
    v_fma_f32 v39, v39, v87, v71
    v_fma_f32 v40, v40, v88, v72
    v_fma_f32 v41, v41, v89, v73
    v_fma_f32 v42, v42, v90, v74
    v_fma_f32 v43, v43, v91, v75
    v_fma_f32 v44, v44, v92, v76
    v_fma_f32 v45, v45, v93, v77
    v_fma_f32 v46, v46, v94, v78
    v_fma_f32 v47, v47, v95, v79
    v_cvt_pk_bf16_f32 v8, v32, v33
    v_cvt_pk_bf16_f32 v9, v34, v35
    v_cvt_pk_bf16_f32 v10, v36, v37
    v_cvt_pk_bf16_f32 v11, v38, v39
    v_cvt_pk_bf16_f32 v12, v40, v41
    v_cvt_pk_bf16_f32 v13, v42, v43
    v_cvt_pk_bf16_f32 v14, v44, v45
    v_cvt_pk_bf16_f32 v15, v46, v47
    s_add_u32 s16, s14, 0
    s_lshr_b32 s17, s16, 4
    s_and_b32 s16, s16, 15
    s_lshr_b32 s18, s16, 2
    s_lshr_b32 s19, s18, 1
    s_and_b32 s18, s18, 1
    s_xor_b32 s18, s18, s19
    s_lshl_b32 s18, s18, 1
    s_or_b32 s18, s18, s19
    v_and_b32 v4, 3, v0
    v_xor_b32 v4, s18, v4
    v_lshlrev_b32 v4, 4, v4
    v_lshrrev_b32 v5, 2, v0
    v_lshl_add_u32 v4, v5, 17, v4
    s_lshl_b32 s17, s17, 10
    s_lshl_b32 s16, s16, 6
    s_add_u32 s17, s17, s16
    s_add_u32 s17, s17, 1048576
    v_add_u32 v4, s17, v4
    global_store_dwordx4 v4, v[8:11], s[6:7] sc1
    v_add_u32 v4, 2097152, v4
    global_store_dwordx4 v4, v[12:15], s[6:7] sc1
    v_fma_f32 v48, v48, v80, v64
    v_fma_f32 v49, v49, v81, v65
    v_fma_f32 v50, v50, v82, v66
    v_fma_f32 v51, v51, v83, v67
    v_fma_f32 v52, v52, v84, v68
    v_fma_f32 v53, v53, v85, v69
    v_fma_f32 v54, v54, v86, v70
    v_fma_f32 v55, v55, v87, v71
    v_fma_f32 v56, v56, v88, v72
    v_fma_f32 v57, v57, v89, v73
    v_fma_f32 v58, v58, v90, v74
    v_fma_f32 v59, v59, v91, v75
    v_fma_f32 v60, v60, v92, v76
    v_fma_f32 v61, v61, v93, v77
    v_fma_f32 v62, v62, v94, v78
    v_fma_f32 v63, v63, v95, v79
    v_cvt_pk_bf16_f32 v16, v48, v49
    v_cvt_pk_bf16_f32 v17, v50, v51
    v_cvt_pk_bf16_f32 v18, v52, v53
    v_cvt_pk_bf16_f32 v19, v54, v55
    v_cvt_pk_bf16_f32 v20, v56, v57
    v_cvt_pk_bf16_f32 v21, v58, v59
    v_cvt_pk_bf16_f32 v22, v60, v61
    v_cvt_pk_bf16_f32 v23, v62, v63
    s_add_u32 s16, s14, 1
    s_lshr_b32 s17, s16, 4
    s_and_b32 s16, s16, 15
    s_lshr_b32 s18, s16, 2
    s_lshr_b32 s19, s18, 1
    s_and_b32 s18, s18, 1
    s_xor_b32 s18, s18, s19
    s_lshl_b32 s18, s18, 1
    s_or_b32 s18, s18, s19
    v_and_b32 v4, 3, v0
    v_xor_b32 v4, s18, v4
    v_lshlrev_b32 v4, 4, v4
    v_lshrrev_b32 v5, 2, v0
    v_lshl_add_u32 v4, v5, 17, v4
    s_lshl_b32 s17, s17, 10
    s_lshl_b32 s16, s16, 6
    s_add_u32 s17, s17, s16
    s_add_u32 s17, s17, 1048576
    v_add_u32 v4, s17, v4
    global_store_dwordx4 v4, v[16:19], s[6:7] sc1
    v_add_u32 v4, 2097152, v4
    global_store_dwordx4 v4, v[20:23], s[6:7] sc1
    s_nop 1
    s_waitcnt vmcnt(4)
    v_lshlrev_b32 v32, 16, v112
    v_and_b32 v33, 0xffff0000, v112
    v_lshlrev_b32 v34, 16, v113
    v_and_b32 v35, 0xffff0000, v113
    v_lshlrev_b32 v36, 16, v114
    v_and_b32 v37, 0xffff0000, v114
    v_lshlrev_b32 v38, 16, v115
    v_and_b32 v39, 0xffff0000, v115
    v_lshlrev_b32 v40, 16, v116
    v_and_b32 v41, 0xffff0000, v116
    v_lshlrev_b32 v42, 16, v117
    v_and_b32 v43, 0xffff0000, v117
    v_lshlrev_b32 v44, 16, v118
    v_and_b32 v45, 0xffff0000, v118
    v_lshlrev_b32 v46, 16, v119
    v_and_b32 v47, 0xffff0000, v119
    v_lshlrev_b32 v48, 16, v120
    v_and_b32 v49, 0xffff0000, v120
    v_lshlrev_b32 v50, 16, v121
    v_and_b32 v51, 0xffff0000, v121
    v_lshlrev_b32 v52, 16, v122
    v_and_b32 v53, 0xffff0000, v122
    v_lshlrev_b32 v54, 16, v123
    v_and_b32 v55, 0xffff0000, v123
    v_lshlrev_b32 v56, 16, v124
    v_and_b32 v57, 0xffff0000, v124
    v_lshlrev_b32 v58, 16, v125
    v_and_b32 v59, 0xffff0000, v125
    v_lshlrev_b32 v60, 16, v126
    v_and_b32 v61, 0xffff0000, v126
    v_lshlrev_b32 v62, 16, v127
    v_and_b32 v63, 0xffff0000, v127
    v_add_f32 v4, v32, v33
    v_add_f32 v4, v4, v34
    v_add_f32 v4, v4, v35
    v_add_f32 v4, v4, v36
    v_add_f32 v4, v4, v37
    v_add_f32 v4, v4, v38
    v_add_f32 v4, v4, v39
    v_add_f32 v4, v4, v40
    v_add_f32 v4, v4, v41
    v_add_f32 v4, v4, v42
    v_add_f32 v4, v4, v43
    v_add_f32 v4, v4, v44
    v_add_f32 v4, v4, v45
    v_add_f32 v4, v4, v46
    v_add_f32 v4, v4, v47
    s_nop 1
    v_add_f32_dpp v4, v4, v4 quad_perm:[1,0,3,2] row_mask:0xf bank_mask:0xf
    s_nop 1
    v_add_f32_dpp v4, v4, v4 quad_perm:[2,3,0,1] row_mask:0xf bank_mask:0xf
    s_nop 1
    v_add_f32_dpp v4, v4, v4 row_half_mirror row_mask:0xf bank_mask:0xf
    s_nop 1
    v_add_f32_dpp v4, v4, v4 row_mirror row_mask:0xf bank_mask:0xf
    v_mov_b32 v5, v4
    s_nop 1
    v_permlane16_swap_b32 v4, v5
    v_add_f32 v4, v4, v5
    v_mov_b32 v5, v4
    s_nop 1
    v_permlane32_swap_b32 v4, v5
    v_add_f32 v4, v4, v5
    v_mul_f32 v4, 0x3a800000, v4
    v_sub_f32 v32, v32, v4
    v_sub_f32 v33, v33, v4
    v_sub_f32 v34, v34, v4
    v_sub_f32 v35, v35, v4
    v_sub_f32 v36, v36, v4
    v_sub_f32 v37, v37, v4
    v_sub_f32 v38, v38, v4
    v_sub_f32 v39, v39, v4
    v_sub_f32 v40, v40, v4
    v_sub_f32 v41, v41, v4
    v_sub_f32 v42, v42, v4
    v_sub_f32 v43, v43, v4
    v_sub_f32 v44, v44, v4
    v_sub_f32 v45, v45, v4
    v_sub_f32 v46, v46, v4
    v_sub_f32 v47, v47, v4
    v_mul_f32 v4, v32, v32
    v_fmac_f32 v4, v33, v33
    v_fmac_f32 v4, v34, v34
    v_fmac_f32 v4, v35, v35
    v_fmac_f32 v4, v36, v36
    v_fmac_f32 v4, v37, v37
    v_fmac_f32 v4, v38, v38
    v_fmac_f32 v4, v39, v39
    v_fmac_f32 v4, v40, v40
    v_fmac_f32 v4, v41, v41
    v_fmac_f32 v4, v42, v42
    v_fmac_f32 v4, v43, v43
    v_fmac_f32 v4, v44, v44
    v_fmac_f32 v4, v45, v45
    v_fmac_f32 v4, v46, v46
    v_fmac_f32 v4, v47, v47
    s_nop 1
    v_add_f32_dpp v4, v4, v4 quad_perm:[1,0,3,2] row_mask:0xf bank_mask:0xf
    s_nop 1
    v_add_f32_dpp v4, v4, v4 quad_perm:[2,3,0,1] row_mask:0xf bank_mask:0xf
    s_nop 1
    v_add_f32_dpp v4, v4, v4 row_half_mirror row_mask:0xf bank_mask:0xf
    s_nop 1
    v_add_f32_dpp v4, v4, v4 row_mirror row_mask:0xf bank_mask:0xf
    v_mov_b32 v5, v4
    s_nop 1
    v_permlane16_swap_b32 v4, v5
    v_add_f32 v4, v4, v5
    v_mov_b32 v5, v4
    s_nop 1
    v_permlane32_swap_b32 v4, v5
    v_add_f32 v4, v4, v5
    v_mov_b32 v5, 0x3727c5ac
    v_fmac_f32 v5, 0x3a800000, v4
    v_rsq_f32 v5, v5
    s_nop 0
    v_mul_f32 v32, v32, v5
    v_mul_f32 v33, v33, v5
    v_mul_f32 v34, v34, v5
    v_mul_f32 v35, v35, v5
    v_mul_f32 v36, v36, v5
    v_mul_f32 v37, v37, v5
    v_mul_f32 v38, v38, v5
    v_mul_f32 v39, v39, v5
    v_mul_f32 v40, v40, v5
    v_mul_f32 v41, v41, v5
    v_mul_f32 v42, v42, v5
    v_mul_f32 v43, v43, v5
    v_mul_f32 v44, v44, v5
    v_mul_f32 v45, v45, v5
    v_mul_f32 v46, v46, v5
    v_mul_f32 v47, v47, v5
    v_add_f32 v4, v48, v49
    v_add_f32 v4, v4, v50
    v_add_f32 v4, v4, v51
    v_add_f32 v4, v4, v52
    v_add_f32 v4, v4, v53
    v_add_f32 v4, v4, v54
    v_add_f32 v4, v4, v55
    v_add_f32 v4, v4, v56
    v_add_f32 v4, v4, v57
    v_add_f32 v4, v4, v58
    v_add_f32 v4, v4, v59
    v_add_f32 v4, v4, v60
    v_add_f32 v4, v4, v61
    v_add_f32 v4, v4, v62
    v_add_f32 v4, v4, v63
    s_nop 1
    v_add_f32_dpp v4, v4, v4 quad_perm:[1,0,3,2] row_mask:0xf bank_mask:0xf
    s_nop 1
    v_add_f32_dpp v4, v4, v4 quad_perm:[2,3,0,1] row_mask:0xf bank_mask:0xf
    s_nop 1
    v_add_f32_dpp v4, v4, v4 row_half_mirror row_mask:0xf bank_mask:0xf
    s_nop 1
    v_add_f32_dpp v4, v4, v4 row_mirror row_mask:0xf bank_mask:0xf
    v_mov_b32 v5, v4
    s_nop 1
    v_permlane16_swap_b32 v4, v5
    v_add_f32 v4, v4, v5
    v_mov_b32 v5, v4
    s_nop 1
    v_permlane32_swap_b32 v4, v5
    v_add_f32 v4, v4, v5
    v_mul_f32 v4, 0x3a800000, v4
    v_sub_f32 v48, v48, v4
    v_sub_f32 v49, v49, v4
    v_sub_f32 v50, v50, v4
    v_sub_f32 v51, v51, v4
    v_sub_f32 v52, v52, v4
    v_sub_f32 v53, v53, v4
    v_sub_f32 v54, v54, v4
    v_sub_f32 v55, v55, v4
    v_sub_f32 v56, v56, v4
    v_sub_f32 v57, v57, v4
    v_sub_f32 v58, v58, v4
    v_sub_f32 v59, v59, v4
    v_sub_f32 v60, v60, v4
    v_sub_f32 v61, v61, v4
    v_sub_f32 v62, v62, v4
    v_sub_f32 v63, v63, v4
    v_mul_f32 v4, v48, v48
    v_fmac_f32 v4, v49, v49
    v_fmac_f32 v4, v50, v50
    v_fmac_f32 v4, v51, v51
    v_fmac_f32 v4, v52, v52
    v_fmac_f32 v4, v53, v53
    v_fmac_f32 v4, v54, v54
    v_fmac_f32 v4, v55, v55
    v_fmac_f32 v4, v56, v56
    v_fmac_f32 v4, v57, v57
    v_fmac_f32 v4, v58, v58
    v_fmac_f32 v4, v59, v59
    v_fmac_f32 v4, v60, v60
    v_fmac_f32 v4, v61, v61
    v_fmac_f32 v4, v62, v62
    v_fmac_f32 v4, v63, v63
    s_nop 1
    v_add_f32_dpp v4, v4, v4 quad_perm:[1,0,3,2] row_mask:0xf bank_mask:0xf
    s_nop 1
    v_add_f32_dpp v4, v4, v4 quad_perm:[2,3,0,1] row_mask:0xf bank_mask:0xf
    s_nop 1
    v_add_f32_dpp v4, v4, v4 row_half_mirror row_mask:0xf bank_mask:0xf
    s_nop 1
    v_add_f32_dpp v4, v4, v4 row_mirror row_mask:0xf bank_mask:0xf
    v_mov_b32 v5, v4
    s_nop 1
    v_permlane16_swap_b32 v4, v5
    v_add_f32 v4, v4, v5
    v_mov_b32 v5, v4
    s_nop 1
    v_permlane32_swap_b32 v4, v5
    v_add_f32 v4, v4, v5
    v_mov_b32 v5, 0x3727c5ac
    v_fmac_f32 v5, 0x3a800000, v4
    v_rsq_f32 v5, v5
    s_nop 0
    v_mul_f32 v48, v48, v5
    v_mul_f32 v49, v49, v5
    v_mul_f32 v50, v50, v5
    v_mul_f32 v51, v51, v5
    v_mul_f32 v52, v52, v5
    v_mul_f32 v53, v53, v5
    v_mul_f32 v54, v54, v5
    v_mul_f32 v55, v55, v5
    v_mul_f32 v56, v56, v5
    v_mul_f32 v57, v57, v5
    v_mul_f32 v58, v58, v5
    v_mul_f32 v59, v59, v5
    v_mul_f32 v60, v60, v5
    v_mul_f32 v61, v61, v5
    v_mul_f32 v62, v62, v5
    v_mul_f32 v63, v63, v5
    v_fma_f32 v32, v32, v80, v64
    v_fma_f32 v33, v33, v81, v65
    v_fma_f32 v34, v34, v82, v66
    v_fma_f32 v35, v35, v83, v67
    v_fma_f32 v36, v36, v84, v68
    v_fma_f32 v37, v37, v85, v69
    v_fma_f32 v38, v38, v86, v70
    v_fma_f32 v39, v39, v87, v71
    v_fma_f32 v40, v40, v88, v72
    v_fma_f32 v41, v41, v89, v73
    v_fma_f32 v42, v42, v90, v74
    v_fma_f32 v43, v43, v91, v75
    v_fma_f32 v44, v44, v92, v76
    v_fma_f32 v45, v45, v93, v77
    v_fma_f32 v46, v46, v94, v78
    v_fma_f32 v47, v47, v95, v79
    v_cvt_pk_bf16_f32 v8, v32, v33
    v_cvt_pk_bf16_f32 v9, v34, v35
    v_cvt_pk_bf16_f32 v10, v36, v37
    v_cvt_pk_bf16_f32 v11, v38, v39
    v_cvt_pk_bf16_f32 v12, v40, v41
    v_cvt_pk_bf16_f32 v13, v42, v43
    v_cvt_pk_bf16_f32 v14, v44, v45
    v_cvt_pk_bf16_f32 v15, v46, v47
    s_add_u32 s16, s14, 2
    s_lshr_b32 s17, s16, 4
    s_and_b32 s16, s16, 15
    s_lshr_b32 s18, s16, 2
    s_lshr_b32 s19, s18, 1
    s_and_b32 s18, s18, 1
    s_xor_b32 s18, s18, s19
    s_lshl_b32 s18, s18, 1
    s_or_b32 s18, s18, s19
    v_and_b32 v4, 3, v0
    v_xor_b32 v4, s18, v4
    v_lshlrev_b32 v4, 4, v4
    v_lshrrev_b32 v5, 2, v0
    v_lshl_add_u32 v4, v5, 17, v4
    s_lshl_b32 s17, s17, 10
    s_lshl_b32 s16, s16, 6
    s_add_u32 s17, s17, s16
    s_add_u32 s17, s17, 1048576
    v_add_u32 v4, s17, v4
    global_store_dwordx4 v4, v[8:11], s[6:7] sc1
    v_add_u32 v4, 2097152, v4
    global_store_dwordx4 v4, v[12:15], s[6:7] sc1
    v_fma_f32 v48, v48, v80, v64
    v_fma_f32 v49, v49, v81, v65
    v_fma_f32 v50, v50, v82, v66
    v_fma_f32 v51, v51, v83, v67
    v_fma_f32 v52, v52, v84, v68
    v_fma_f32 v53, v53, v85, v69
    v_fma_f32 v54, v54, v86, v70
    v_fma_f32 v55, v55, v87, v71
    v_fma_f32 v56, v56, v88, v72
    v_fma_f32 v57, v57, v89, v73
    v_fma_f32 v58, v58, v90, v74
    v_fma_f32 v59, v59, v91, v75
    v_fma_f32 v60, v60, v92, v76
    v_fma_f32 v61, v61, v93, v77
    v_fma_f32 v62, v62, v94, v78
    v_fma_f32 v63, v63, v95, v79
    v_cvt_pk_bf16_f32 v16, v48, v49
    v_cvt_pk_bf16_f32 v17, v50, v51
    v_cvt_pk_bf16_f32 v18, v52, v53
    v_cvt_pk_bf16_f32 v19, v54, v55
    v_cvt_pk_bf16_f32 v20, v56, v57
    v_cvt_pk_bf16_f32 v21, v58, v59
    v_cvt_pk_bf16_f32 v22, v60, v61
    v_cvt_pk_bf16_f32 v23, v62, v63
    s_add_u32 s16, s14, 3
    s_lshr_b32 s17, s16, 4
    s_and_b32 s16, s16, 15
    s_lshr_b32 s18, s16, 2
    s_lshr_b32 s19, s18, 1
    s_and_b32 s18, s18, 1
    s_xor_b32 s18, s18, s19
    s_lshl_b32 s18, s18, 1
    s_or_b32 s18, s18, s19
    v_and_b32 v4, 3, v0
    v_xor_b32 v4, s18, v4
    v_lshlrev_b32 v4, 4, v4
    v_lshrrev_b32 v5, 2, v0
    v_lshl_add_u32 v4, v5, 17, v4
    s_lshl_b32 s17, s17, 10
    s_lshl_b32 s16, s16, 6
    s_add_u32 s17, s17, s16
    s_add_u32 s17, s17, 1048576
    v_add_u32 v4, s17, v4
    global_store_dwordx4 v4, v[16:19], s[6:7] sc1
    v_add_u32 v4, 2097152, v4
    global_store_dwordx4 v4, v[20:23], s[6:7] sc1
    s_lshr_b32 s69, s62, 4
    s_lshl_b32 s69, s69, 7
    s_waitcnt vmcnt(0)
    s_barrier
    s_cmp_lg_u32 s3, 0
    s_cbranch_scc1 B_L_sg_l1
    s_add_u32 s44, s69, 41984
    v_mov_b32 v2, s44
    v_mov_b32 v3, 1
    s_mov_b64 exec, 1
    global_atomic_add v2, v3, s[60:61]
    s_mov_b64 exec, -1
B_L_sg_l1:
    s_mov_b32 s64, 0
B_L_task:
    s_lshl_b32 s44, s4, 2
    s_and_b32 s45, s5, 3
    s_add_u32 s44, s44, s45
    s_add_u32 s44, s44, 16
    s_lshl_b32 s45, s4, 1
    s_and_b32 s46, s5, 1
    s_add_u32 s45, s45, s46
    s_lshr_b32 s46, s5, 2
    s_cmp_eq_u32 s64, 0
    s_cbranch_scc0 B_L_r1
    s_mov_b32 s67, s44
    s_lshl_b32 s68, s46, 6
    s_branch B_L_dec
B_L_r1:
    s_cmp_ge_u32 s5, 8
    s_cbranch_scc1 B_L_phase3
    s_sub_u32 s44, s64, 1
    s_mul_i32 s44, s44, 64
    s_mul_i32 s45, s4, 8
    s_add_u32 s44, s44, s45
    s_add_u32 s44, s44, s5
    s_cmp_ge_u32 s44, 352
    s_cbranch_scc1 B_L_phase3
    s_cmp_lt_u32 s44, 224
    s_cbranch_scc0 B_L_thq
    s_and_b32 s67, s44, 31
    s_add_u32 s67, s67, 16
    s_lshr_b32 s68, s44, 5
    s_add_u32 s68, s68, 1
    s_lshl_b32 s68, s68, 8
    s_branch B_L_dec
B_L_thq:
    s_sub_u32 s44, s44, 224
    s_and_b32 s67, s44, 15
    s_lshr_b32 s68, s44, 4
    s_lshl_b32 s68, s68, 8
B_L_dec:
    s_lshr_b32 s69, s68, 8
    s_lshl_b32 s69, s69, 7
    s_mov_b32 s73, s69
    s_cmp_eq_u32 s64, 0
    s_cbranch_scc1 B_L_l1skip
    s_cmp_lg_u32 s3, 0
    s_cbranch_scc1 B_L_wc_l1_b
    s_add_u32 s44, s69, 41984
    v_mov_b32 v2, s44
B_L_wc_l1:
    global_load_dword v3, v2, s[60:61] sc1
    s_waitcnt vmcnt(0)
    v_readfirstlane_b32 s44, v3
    s_nop 0
    s_cmp_ge_u32 s44, 16
    s_cbranch_scc1 B_L_wc_l1_b
    s_sleep 3
    s_sub_u32 s66, s66, 1
    s_cbranch_scc0 B_L_wc_l1
    s_mov_b32 s66, 0
B_L_wc_l1_b:
    s_barrier
B_L_l1skip:
    s_lshr_b32 s44, s68, 8
    s_lshl_b32 s45, s44, 3
    s_and_b32 s46, s67, 15
    s_lshr_b32 s46, s46, 1
    s_add_u32 s45, s45, s46
    s_lshl_b32 s45, s45, 7
    s_lshl_b32 s44, s44, 7
    s_add_u32 s44, s44, 8192
    s_cmp_lt_u32 s67, 16
    s_cselect_b32 s69, s44, s45
    s_lshr_b32 s44, s67, 4
    s_lshl_b32 s45, s44, 3
    s_add_u32 s40, s0, s45
    s_addc_u32 s41, s1, 0
    s_load_dwordx2 s[40:41], s[40:41], 16
    s_lshl_b32 s45, s44, 24
    s_add_u32 s45, s45, 8388608
    s_add_u32 s16, s6, s45
    s_addc_u32 s17, s7, 0
    s_and_b32 s17, s17, 0xffff
    s_mov_b32 s18, 16777216
    s_mov_b32 s19, 0x00020000
    s_add_u32 s12, s6, 1048576
    s_addc_u32 s13, s7, 0
    s_and_b32 s13, s13, 0xffff
    s_mov_b32 s14, 4194304
    s_mov_b32 s15, 0x00020000
    s_waitcnt lgkmcnt(0)
    s_add_u32 s8, s40, 0
    s_addc_u32 s9, s41, 0
    s_and_b32 s9, s9, 0xffff
    s_mov_b32 s10, 8388608
    s_mov_b32 s11, 0x00020000
    s_cmp_eq_u32 s64, 0
    s_cbranch_scc1 B_L_small
    s_cmp_ge_u32 s67, 32
    s_cbranch_scc1 B_L_bigv
    s_and_b32 s26, s67, 15
    s_lshl_b32 s20, s26, 9
    s_lshl_b32 s21, s68, 6
    s_mul_i32 s22, s3, 4096
    s_mul_i32 s23, s3, 4096
    v_and_b32 v1, 15, v0
    v_lshrrev_b32 v2, 4, v0
    v_lshrrev_b32 v3, 2, v1
    v_and_b32 v4, 1, v2
    v_lshrrev_b32 v5, 1, v2
    v_lshlrev_b32 v6, 3, v3
    v_lshl_add_u32 v6, v5, 2, v6
    v_add_u32 v6, v6, v4
    v_lshl_or_b32 v3, v4, 2, v3
    v_lshlrev_b32 v6, 9, v6
    v_and_b32 v4, 3, v1
    v_lshl_add_u32 v6, v4, 3, v6
    s_and_b32 s25, s3, 1
    s_mul_i32 s25, s25, 8
    s_add_u32 s26, s25, 0
    v_xor_b32 v4, s26, v3
    v_lshl_add_u32 v8, v4, 5, v6
    s_add_u32 s26, s25, 1
    v_xor_b32 v4, s26, v3
    v_lshl_add_u32 v9, v4, 5, v6
    s_add_u32 s26, s25, 2
    v_xor_b32 v4, s26, v3
    v_lshl_add_u32 v10, v4, 5, v6
    s_add_u32 s26, s25, 3
    v_xor_b32 v4, s26, v3
    v_lshl_add_u32 v11, v4, 5, v6
    s_add_u32 s26, s25, 4
    v_xor_b32 v4, s26, v3
    v_lshl_add_u32 v12, v4, 5, v6
    s_add_u32 s26, s25, 5
    v_xor_b32 v4, s26, v3
    v_lshl_add_u32 v13, v4, 5, v6
    s_add_u32 s26, s25, 6
    v_xor_b32 v4, s26, v3
    v_lshl_add_u32 v14, v4, 5, v6
    s_add_u32 s26, s25, 7
    v_xor_b32 v4, s26, v3
    v_lshl_add_u32 v15, v4, 5, v6
    v_lshrrev_b32 v3, 2, v1
    v_lshrrev_b32 v4, 1, v3
    v_and_b32 v5, 1, v3
    v_xor_b32 v5, v5, v4
    v_lshl_or_b32 v5, v5, 1, v4
    v_xor_b32 v5, v5, v2
    v_lshlrev_b32 v5, 4, v5
    v_lshl_add_u32 v5, v1, 6, v5
    s_lshr_b32 s25, s3, 1
    s_mul_i32 s25, s25, 8192
    s_add_u32 s25, s25, 16384
    v_add_u32 v16, s25, v5
    v_lshrrev_b32 v3, 5, v0
    v_and_b32 v4, 31, v0
    v_lshlrev_b32 v5, 3, v3
    v_add_u32 v5, s3, v5
    v_lshlrev_b32 v6, 2, v3
    v_or_b32 v6, s3, v6
    v_lshrrev_b32 v1, 1, v4
    v_xor_b32 v1, v1, v6
    v_lshlrev_b32 v1, 5, v1
    v_and_b32 v4, 1, v4
    v_lshl_or_b32 v1, v4, 4, v1
    s_mov_b32 s25, 8192
    v_mul_lo_u32 v5, v5, s25
    v_add_u32 v17, v5, v1
    v_add_u32 v18, 32768, v17
    v_add_u32 v19, 131072, v17
    v_add_u32 v20, 163840, v17
    v_lshlrev_b32 v3, 4, v0
    s_mul_i32 s25, s3, 4096
    v_add_u32 v21, s25, v3
    v_add_u32 v22, 1024, v21
    v_add_u32 v23, 2048, v21
    v_add_u32 v24, 3072, v21
    s_add_u32 s23, s23, 16384
    s_mov_b32 s33, 0
    s_mov_b32 s32, 0
    s_add_u32 s34, s22, s33
    s_add_u32 s35, s23, s33
    s_add_u32 m0, s34, 0
    s_nop 0
    buffer_load_dwordx4 v17, s[8:11], s20 offen lds
    s_add_u32 m0, s34, 1024
    s_nop 0
    buffer_load_dwordx4 v18, s[8:11], s20 offen lds
    s_add_u32 m0, s34, 2048
    s_nop 0
    buffer_load_dwordx4 v19, s[8:11], s20 offen lds
    s_add_u32 m0, s34, 3072
    s_nop 0
    buffer_load_dwordx4 v20, s[8:11], s20 offen lds
    s_add_u32 m0, s35, 0
    s_nop 0
    buffer_load_dwordx4 v21, s[12:15], s21 offen lds
    s_add_u32 m0, s35, 1024
    s_nop 0
    buffer_load_dwordx4 v22, s[12:15], s21 offen lds
    s_add_u32 m0, s35, 2048
    s_nop 0
    buffer_load_dwordx4 v23, s[12:15], s21 offen lds
    s_add_u32 m0, s35, 3072
    s_nop 0
    buffer_load_dwordx4 v24, s[12:15], s21 offen lds
    s_add_u32 s20, s20, 262144
    s_add_u32 s21, s21, 131072
    s_add_u32 s33, s33, 32768
    s_cmp_eq_u32 s33, 131072
    s_cselect_b32 s33, 0, s33
    s_add_u32 s34, s22, s33
    s_add_u32 s35, s23, s33
    s_add_u32 m0, s34, 0
    s_nop 0
    buffer_load_dwordx4 v17, s[8:11], s20 offen lds
    s_add_u32 m0, s34, 1024
    s_nop 0
    buffer_load_dwordx4 v18, s[8:11], s20 offen lds
    s_add_u32 m0, s34, 2048
    s_nop 0
    buffer_load_dwordx4 v19, s[8:11], s20 offen lds
    s_add_u32 m0, s34, 3072
    s_nop 0
    buffer_load_dwordx4 v20, s[8:11], s20 offen lds
    s_add_u32 m0, s35, 0
    s_nop 0
    buffer_load_dwordx4 v21, s[12:15], s21 offen lds
    s_add_u32 m0, s35, 1024
    s_nop 0
    buffer_load_dwordx4 v22, s[12:15], s21 offen lds
    s_add_u32 m0, s35, 2048
    s_nop 0
    buffer_load_dwordx4 v23, s[12:15], s21 offen lds
    s_add_u32 m0, s35, 3072
    s_nop 0
    buffer_load_dwordx4 v24, s[12:15], s21 offen lds
    s_add_u32 s20, s20, 262144
    s_add_u32 s21, s21, 131072
    s_add_u32 s33, s33, 32768
    s_cmp_eq_u32 s33, 131072
    s_cselect_b32 s33, 0, s33
    s_add_u32 s34, s22, s33
    s_add_u32 s35, s23, s33
    s_add_u32 m0, s34, 0
    s_nop 0
    buffer_load_dwordx4 v17, s[8:11], s20 offen lds
    s_add_u32 m0, s34, 1024
    s_nop 0
    buffer_load_dwordx4 v18, s[8:11], s20 offen lds
    s_add_u32 m0, s34, 2048
    s_nop 0
    buffer_load_dwordx4 v19, s[8:11], s20 offen lds
    s_add_u32 m0, s34, 3072
    s_nop 0
    buffer_load_dwordx4 v20, s[8:11], s20 offen lds
    s_add_u32 m0, s35, 0
    s_nop 0
    buffer_load_dwordx4 v21, s[12:15], s21 offen lds
    s_add_u32 m0, s35, 1024
    s_nop 0
    buffer_load_dwordx4 v22, s[12:15], s21 offen lds
    s_add_u32 m0, s35, 2048
    s_nop 0
    buffer_load_dwordx4 v23, s[12:15], s21 offen lds
    s_add_u32 m0, s35, 3072
    s_nop 0
    buffer_load_dwordx4 v24, s[12:15], s21 offen lds
    s_add_u32 s20, s20, 262144
    s_add_u32 s21, s21, 131072
    s_add_u32 s33, s33, 32768
    s_cmp_eq_u32 s33, 131072
    s_cselect_b32 s33, 0, s33
    s_add_u32 s34, s22, s33
    s_add_u32 s35, s23, s33
    s_add_u32 m0, s34, 0
    s_nop 0
    buffer_load_dwordx4 v17, s[8:11], s20 offen lds
    s_add_u32 m0, s34, 1024
    s_nop 0
    buffer_load_dwordx4 v18, s[8:11], s20 offen lds
    s_add_u32 m0, s34, 2048
    s_nop 0
    buffer_load_dwordx4 v19, s[8:11], s20 offen lds
    s_add_u32 m0, s34, 3072
    s_nop 0
    buffer_load_dwordx4 v20, s[8:11], s20 offen lds
    s_add_u32 m0, s35, 0
    s_nop 0
    buffer_load_dwordx4 v21, s[12:15], s21 offen lds
    s_add_u32 m0, s35, 1024
    s_nop 0
    buffer_load_dwordx4 v22, s[12:15], s21 offen lds
    s_add_u32 m0, s35, 2048
    s_nop 0
    buffer_load_dwordx4 v23, s[12:15], s21 offen lds
    s_add_u32 m0, s35, 3072
    s_nop 0
    buffer_load_dwordx4 v24, s[12:15], s21 offen lds
    s_add_u32 s20, s20, 262144
    s_add_u32 s21, s21, 131072
    s_add_u32 s33, s33, 32768
    s_cmp_eq_u32 s33, 131072
    s_cselect_b32 s33, 0, s33
    v_add_u32 v156, s32, v8
    v_add_u32 v157, s32, v9
    v_add_u32 v158, s32, v10
    v_add_u32 v159, s32, v11
    v_add_u32 v160, s32, v12
    v_add_u32 v161, s32, v13
    v_add_u32 v162, s32, v14
    v_add_u32 v163, s32, v15
    v_add_u32 v164, s32, v16
    s_waitcnt vmcnt(24)
    s_barrier
    ds_read_b128 v[60:63], v164 offset:0
    ds_read_b64_tr_b16 v[28:29], v156
    ds_read_b64_tr_b16 v[30:31], v156 offset:1024
    ds_read_b128 v[64:67], v164 offset:1024
    ds_read_b64_tr_b16 v[32:33], v157
    ds_read_b64_tr_b16 v[34:35], v157 offset:1024
    ds_read_b128 v[68:71], v164 offset:2048
    ds_read_b64_tr_b16 v[36:37], v158
    ds_read_b64_tr_b16 v[38:39], v158 offset:1024
    ds_read_b128 v[72:75], v164 offset:3072
    ds_read_b64_tr_b16 v[40:41], v159
    ds_read_b64_tr_b16 v[42:43], v159 offset:1024
    ds_read_b128 v[76:79], v164 offset:4096
    ds_read_b64_tr_b16 v[44:45], v160
    ds_read_b64_tr_b16 v[46:47], v160 offset:1024
    ds_read_b128 v[80:83], v164 offset:5120
    ds_read_b64_tr_b16 v[48:49], v161
    ds_read_b64_tr_b16 v[50:51], v161 offset:1024
    ds_read_b128 v[84:87], v164 offset:6144
    ds_read_b64_tr_b16 v[52:53], v162
    ds_read_b64_tr_b16 v[54:55], v162 offset:1024
    ds_read_b128 v[88:91], v164 offset:7168
    ds_read_b64_tr_b16 v[56:57], v163
    ds_read_b64_tr_b16 v[58:59], v163 offset:1024
    s_add_u32 s32, s32, 32768
    s_cmp_eq_u32 s32, 131072
    s_cselect_b32 s32, 0, s32
    v_add_u32 v156, s32, v8
    v_add_u32 v157, s32, v9
    v_add_u32 v158, s32, v10
    v_add_u32 v159, s32, v11
    v_add_u32 v160, s32, v12
    v_add_u32 v161, s32, v13
    v_add_u32 v162, s32, v14
    v_add_u32 v163, s32, v15
    v_add_u32 v164, s32, v16
    s_add_u32 s34, s22, s33
    s_add_u32 s35, s23, s33
    s_waitcnt vmcnt(16) lgkmcnt(0)
    s_barrier
    v_mfma_f32_16x16x32_bf16 a[0:3], v[28:31], v[60:63], 0
    v_mfma_f32_16x16x32_bf16 a[32:35], v[32:35], v[60:63], 0
    ds_read_b128 v[124:127], v164 offset:0
    s_add_u32 m0, s34, 0
    v_mfma_f32_16x16x32_bf16 a[64:67], v[36:39], v[60:63], 0
    buffer_load_dwordx4 v17, s[8:11], s20 offen lds
    v_mfma_f32_16x16x32_bf16 a[96:99], v[40:43], v[60:63], 0
    ds_read_b64_tr_b16 v[92:93], v156
    v_mfma_f32_16x16x32_bf16 a[128:131], v[44:47], v[60:63], 0
    v_mfma_f32_16x16x32_bf16 a[160:163], v[48:51], v[60:63], 0
    ds_read_b64_tr_b16 v[94:95], v156 offset:1024
    v_mfma_f32_16x16x32_bf16 a[192:195], v[52:55], v[60:63], 0
    v_mfma_f32_16x16x32_bf16 a[224:227], v[56:59], v[60:63], 0
    ds_read_b128 v[128:131], v164 offset:1024
    v_mfma_f32_16x16x32_bf16 a[4:7], v[28:31], v[64:67], 0
    v_mfma_f32_16x16x32_bf16 a[36:39], v[32:35], v[64:67], 0
    ds_read_b64_tr_b16 v[96:97], v157
    s_add_u32 m0, s34, 1024
    v_mfma_f32_16x16x32_bf16 a[68:71], v[36:39], v[64:67], 0
    buffer_load_dwordx4 v18, s[8:11], s20 offen lds
    v_mfma_f32_16x16x32_bf16 a[100:103], v[40:43], v[64:67], 0
    ds_read_b64_tr_b16 v[98:99], v157 offset:1024
    v_mfma_f32_16x16x32_bf16 a[132:135], v[44:47], v[64:67], 0
    v_mfma_f32_16x16x32_bf16 a[164:167], v[48:51], v[64:67], 0
    ds_read_b128 v[132:135], v164 offset:2048
    v_mfma_f32_16x16x32_bf16 a[196:199], v[52:55], v[64:67], 0
    v_mfma_f32_16x16x32_bf16 a[228:231], v[56:59], v[64:67], 0
    ds_read_b64_tr_b16 v[100:101], v158
    v_mfma_f32_16x16x32_bf16 a[8:11], v[28:31], v[68:71], 0
    v_mfma_f32_16x16x32_bf16 a[40:43], v[32:35], v[68:71], 0
    ds_read_b64_tr_b16 v[102:103], v158 offset:1024
    s_add_u32 m0, s34, 2048
    v_mfma_f32_16x16x32_bf16 a[72:75], v[36:39], v[68:71], 0
    buffer_load_dwordx4 v19, s[8:11], s20 offen lds
    v_mfma_f32_16x16x32_bf16 a[104:107], v[40:43], v[68:71], 0
    ds_read_b128 v[136:139], v164 offset:3072
    v_mfma_f32_16x16x32_bf16 a[136:139], v[44:47], v[68:71], 0
    v_mfma_f32_16x16x32_bf16 a[168:171], v[48:51], v[68:71], 0
    ds_read_b64_tr_b16 v[104:105], v159
    v_mfma_f32_16x16x32_bf16 a[200:203], v[52:55], v[68:71], 0
    v_mfma_f32_16x16x32_bf16 a[232:235], v[56:59], v[68:71], 0
    ds_read_b64_tr_b16 v[106:107], v159 offset:1024
    v_mfma_f32_16x16x32_bf16 a[12:15], v[28:31], v[72:75], 0
    v_mfma_f32_16x16x32_bf16 a[44:47], v[32:35], v[72:75], 0
    ds_read_b128 v[140:143], v164 offset:4096
    s_add_u32 m0, s34, 3072
    v_mfma_f32_16x16x32_bf16 a[76:79], v[36:39], v[72:75], 0
    buffer_load_dwordx4 v20, s[8:11], s20 offen lds
    v_mfma_f32_16x16x32_bf16 a[108:111], v[40:43], v[72:75], 0
    ds_read_b64_tr_b16 v[108:109], v160
    v_mfma_f32_16x16x32_bf16 a[140:143], v[44:47], v[72:75], 0
    v_mfma_f32_16x16x32_bf16 a[172:175], v[48:51], v[72:75], 0
    ds_read_b64_tr_b16 v[110:111], v160 offset:1024
    v_mfma_f32_16x16x32_bf16 a[204:207], v[52:55], v[72:75], 0
    v_mfma_f32_16x16x32_bf16 a[236:239], v[56:59], v[72:75], 0
    ds_read_b128 v[144:147], v164 offset:5120
    v_mfma_f32_16x16x32_bf16 a[16:19], v[28:31], v[76:79], 0
    v_mfma_f32_16x16x32_bf16 a[48:51], v[32:35], v[76:79], 0
    ds_read_b64_tr_b16 v[112:113], v161
    s_add_u32 m0, s35, 0
    v_mfma_f32_16x16x32_bf16 a[80:83], v[36:39], v[76:79], 0
    buffer_load_dwordx4 v21, s[12:15], s21 offen lds
    v_mfma_f32_16x16x32_bf16 a[112:115], v[40:43], v[76:79], 0
    ds_read_b64_tr_b16 v[114:115], v161 offset:1024
    v_mfma_f32_16x16x32_bf16 a[144:147], v[44:47], v[76:79], 0
    v_mfma_f32_16x16x32_bf16 a[176:179], v[48:51], v[76:79], 0
    ds_read_b128 v[148:151], v164 offset:6144
    v_mfma_f32_16x16x32_bf16 a[208:211], v[52:55], v[76:79], 0
    v_mfma_f32_16x16x32_bf16 a[240:243], v[56:59], v[76:79], 0
    ds_read_b64_tr_b16 v[116:117], v162
    v_mfma_f32_16x16x32_bf16 a[20:23], v[28:31], v[80:83], 0
    v_mfma_f32_16x16x32_bf16 a[52:55], v[32:35], v[80:83], 0
    ds_read_b64_tr_b16 v[118:119], v162 offset:1024
    s_add_u32 m0, s35, 1024
    v_mfma_f32_16x16x32_bf16 a[84:87], v[36:39], v[80:83], 0
    buffer_load_dwordx4 v22, s[12:15], s21 offen lds
    v_mfma_f32_16x16x32_bf16 a[116:119], v[40:43], v[80:83], 0
    ds_read_b128 v[152:155], v164 offset:7168
    v_mfma_f32_16x16x32_bf16 a[148:151], v[44:47], v[80:83], 0
    v_mfma_f32_16x16x32_bf16 a[180:183], v[48:51], v[80:83], 0
    ds_read_b64_tr_b16 v[120:121], v163
    v_mfma_f32_16x16x32_bf16 a[212:215], v[52:55], v[80:83], 0
    v_mfma_f32_16x16x32_bf16 a[244:247], v[56:59], v[80:83], 0
    ds_read_b64_tr_b16 v[122:123], v163 offset:1024
    v_mfma_f32_16x16x32_bf16 a[24:27], v[28:31], v[84:87], 0
    s_add_u32 s32, s32, 32768
    s_cmp_eq_u32 s32, 131072
    s_cselect_b32 s32, 0, s32
    v_mfma_f32_16x16x32_bf16 a[56:59], v[32:35], v[84:87], 0
    v_add_u32 v156, s32, v8
    s_add_u32 m0, s35, 2048
    v_mfma_f32_16x16x32_bf16 a[88:91], v[36:39], v[84:87], 0
    buffer_load_dwordx4 v23, s[12:15], s21 offen lds
    v_add_u32 v157, s32, v9
    v_mfma_f32_16x16x32_bf16 a[120:123], v[40:43], v[84:87], 0
    v_add_u32 v158, s32, v10
    v_mfma_f32_16x16x32_bf16 a[152:155], v[44:47], v[84:87], 0
    v_add_u32 v159, s32, v11
    v_mfma_f32_16x16x32_bf16 a[184:187], v[48:51], v[84:87], 0
    v_add_u32 v160, s32, v12
    v_mfma_f32_16x16x32_bf16 a[216:219], v[52:55], v[84:87], 0
    v_add_u32 v161, s32, v13
    v_mfma_f32_16x16x32_bf16 a[248:251], v[56:59], v[84:87], 0
    v_add_u32 v162, s32, v14
    v_mfma_f32_16x16x32_bf16 a[28:31], v[28:31], v[88:91], 0
    v_add_u32 v163, s32, v15
    v_mfma_f32_16x16x32_bf16 a[60:63], v[32:35], v[88:91], 0
    v_add_u32 v164, s32, v16
    s_add_u32 m0, s35, 3072
    v_mfma_f32_16x16x32_bf16 a[92:95], v[36:39], v[88:91], 0
    buffer_load_dwordx4 v24, s[12:15], s21 offen lds
    v_mfma_f32_16x16x32_bf16 a[124:127], v[40:43], v[88:91], 0
    s_add_u32 s20, s20, 262144
    s_add_u32 s21, s21, 131072
    v_mfma_f32_16x16x32_bf16 a[156:159], v[44:47], v[88:91], 0
    s_add_u32 s33, s33, 32768
    s_cmp_eq_u32 s33, 131072
    s_cselect_b32 s33, 0, s33
    v_mfma_f32_16x16x32_bf16 a[188:191], v[48:51], v[88:91], 0
    s_add_u32 s34, s22, s33
    s_add_u32 s35, s23, s33
    v_mfma_f32_16x16x32_bf16 a[220:223], v[52:55], v[88:91], 0
    v_mfma_f32_16x16x32_bf16 a[252:255], v[56:59], v[88:91], 0
    s_waitcnt vmcnt(16) lgkmcnt(0)
    s_barrier
    v_mfma_f32_16x16x32_bf16 a[0:3], v[92:95], v[124:127], a[0:3]
    v_mfma_f32_16x16x32_bf16 a[32:35], v[96:99], v[124:127], a[32:35]
    ds_read_b128 v[60:63], v164 offset:0
    s_add_u32 m0, s34, 0
    v_mfma_f32_16x16x32_bf16 a[64:67], v[100:103], v[124:127], a[64:67]
    buffer_load_dwordx4 v17, s[8:11], s20 offen lds
    v_mfma_f32_16x16x32_bf16 a[96:99], v[104:107], v[124:127], a[96:99]
    ds_read_b64_tr_b16 v[28:29], v156
    v_mfma_f32_16x16x32_bf16 a[128:131], v[108:111], v[124:127], a[128:131]
    v_mfma_f32_16x16x32_bf16 a[160:163], v[112:115], v[124:127], a[160:163]
    ds_read_b64_tr_b16 v[30:31], v156 offset:1024
    v_mfma_f32_16x16x32_bf16 a[192:195], v[116:119], v[124:127], a[192:195]
    v_mfma_f32_16x16x32_bf16 a[224:227], v[120:123], v[124:127], a[224:227]
    ds_read_b128 v[64:67], v164 offset:1024
    v_mfma_f32_16x16x32_bf16 a[4:7], v[92:95], v[128:131], a[4:7]
    v_mfma_f32_16x16x32_bf16 a[36:39], v[96:99], v[128:131], a[36:39]
    ds_read_b64_tr_b16 v[32:33], v157
    s_add_u32 m0, s34, 1024
    v_mfma_f32_16x16x32_bf16 a[68:71], v[100:103], v[128:131], a[68:71]
    buffer_load_dwordx4 v18, s[8:11], s20 offen lds
    v_mfma_f32_16x16x32_bf16 a[100:103], v[104:107], v[128:131], a[100:103]
    ds_read_b64_tr_b16 v[34:35], v157 offset:1024
    v_mfma_f32_16x16x32_bf16 a[132:135], v[108:111], v[128:131], a[132:135]
    v_mfma_f32_16x16x32_bf16 a[164:167], v[112:115], v[128:131], a[164:167]
    ds_read_b128 v[68:71], v164 offset:2048
    v_mfma_f32_16x16x32_bf16 a[196:199], v[116:119], v[128:131], a[196:199]
    v_mfma_f32_16x16x32_bf16 a[228:231], v[120:123], v[128:131], a[228:231]
    ds_read_b64_tr_b16 v[36:37], v158
    v_mfma_f32_16x16x32_bf16 a[8:11], v[92:95], v[132:135], a[8:11]
    v_mfma_f32_16x16x32_bf16 a[40:43], v[96:99], v[132:135], a[40:43]
    ds_read_b64_tr_b16 v[38:39], v158 offset:1024
    s_add_u32 m0, s34, 2048
    v_mfma_f32_16x16x32_bf16 a[72:75], v[100:103], v[132:135], a[72:75]
    buffer_load_dwordx4 v19, s[8:11], s20 offen lds
    v_mfma_f32_16x16x32_bf16 a[104:107], v[104:107], v[132:135], a[104:107]
    ds_read_b128 v[72:75], v164 offset:3072
    v_mfma_f32_16x16x32_bf16 a[136:139], v[108:111], v[132:135], a[136:139]
    v_mfma_f32_16x16x32_bf16 a[168:171], v[112:115], v[132:135], a[168:171]
    ds_read_b64_tr_b16 v[40:41], v159
    v_mfma_f32_16x16x32_bf16 a[200:203], v[116:119], v[132:135], a[200:203]
    v_mfma_f32_16x16x32_bf16 a[232:235], v[120:123], v[132:135], a[232:235]
    ds_read_b64_tr_b16 v[42:43], v159 offset:1024
    v_mfma_f32_16x16x32_bf16 a[12:15], v[92:95], v[136:139], a[12:15]
    v_mfma_f32_16x16x32_bf16 a[44:47], v[96:99], v[136:139], a[44:47]
    ds_read_b128 v[76:79], v164 offset:4096
    s_add_u32 m0, s34, 3072
    v_mfma_f32_16x16x32_bf16 a[76:79], v[100:103], v[136:139], a[76:79]
    buffer_load_dwordx4 v20, s[8:11], s20 offen lds
    v_mfma_f32_16x16x32_bf16 a[108:111], v[104:107], v[136:139], a[108:111]
    ds_read_b64_tr_b16 v[44:45], v160
    v_mfma_f32_16x16x32_bf16 a[140:143], v[108:111], v[136:139], a[140:143]
    v_mfma_f32_16x16x32_bf16 a[172:175], v[112:115], v[136:139], a[172:175]
    ds_read_b64_tr_b16 v[46:47], v160 offset:1024
    v_mfma_f32_16x16x32_bf16 a[204:207], v[116:119], v[136:139], a[204:207]
    v_mfma_f32_16x16x32_bf16 a[236:239], v[120:123], v[136:139], a[236:239]
    ds_read_b128 v[80:83], v164 offset:5120
    v_mfma_f32_16x16x32_bf16 a[16:19], v[92:95], v[140:143], a[16:19]
    v_mfma_f32_16x16x32_bf16 a[48:51], v[96:99], v[140:143], a[48:51]
    ds_read_b64_tr_b16 v[48:49], v161
    s_add_u32 m0, s35, 0
    v_mfma_f32_16x16x32_bf16 a[80:83], v[100:103], v[140:143], a[80:83]
    buffer_load_dwordx4 v21, s[12:15], s21 offen lds
    v_mfma_f32_16x16x32_bf16 a[112:115], v[104:107], v[140:143], a[112:115]
    ds_read_b64_tr_b16 v[50:51], v161 offset:1024
    v_mfma_f32_16x16x32_bf16 a[144:147], v[108:111], v[140:143], a[144:147]
    v_mfma_f32_16x16x32_bf16 a[176:179], v[112:115], v[140:143], a[176:179]
    ds_read_b128 v[84:87], v164 offset:6144
    v_mfma_f32_16x16x32_bf16 a[208:211], v[116:119], v[140:143], a[208:211]
    v_mfma_f32_16x16x32_bf16 a[240:243], v[120:123], v[140:143], a[240:243]
    ds_read_b64_tr_b16 v[52:53], v162
    v_mfma_f32_16x16x32_bf16 a[20:23], v[92:95], v[144:147], a[20:23]
    v_mfma_f32_16x16x32_bf16 a[52:55], v[96:99], v[144:147], a[52:55]
    ds_read_b64_tr_b16 v[54:55], v162 offset:1024
    s_add_u32 m0, s35, 1024
    v_mfma_f32_16x16x32_bf16 a[84:87], v[100:103], v[144:147], a[84:87]
    buffer_load_dwordx4 v22, s[12:15], s21 offen lds
    v_mfma_f32_16x16x32_bf16 a[116:119], v[104:107], v[144:147], a[116:119]
    ds_read_b128 v[88:91], v164 offset:7168
    v_mfma_f32_16x16x32_bf16 a[148:151], v[108:111], v[144:147], a[148:151]
    v_mfma_f32_16x16x32_bf16 a[180:183], v[112:115], v[144:147], a[180:183]
    ds_read_b64_tr_b16 v[56:57], v163
    v_mfma_f32_16x16x32_bf16 a[212:215], v[116:119], v[144:147], a[212:215]
    v_mfma_f32_16x16x32_bf16 a[244:247], v[120:123], v[144:147], a[244:247]
    ds_read_b64_tr_b16 v[58:59], v163 offset:1024
    v_mfma_f32_16x16x32_bf16 a[24:27], v[92:95], v[148:151], a[24:27]
    s_add_u32 s32, s32, 32768
    s_cmp_eq_u32 s32, 131072
    s_cselect_b32 s32, 0, s32
    v_mfma_f32_16x16x32_bf16 a[56:59], v[96:99], v[148:151], a[56:59]
    v_add_u32 v156, s32, v8
    s_add_u32 m0, s35, 2048
    v_mfma_f32_16x16x32_bf16 a[88:91], v[100:103], v[148:151], a[88:91]
    buffer_load_dwordx4 v23, s[12:15], s21 offen lds
    v_add_u32 v157, s32, v9
    v_mfma_f32_16x16x32_bf16 a[120:123], v[104:107], v[148:151], a[120:123]
    v_add_u32 v158, s32, v10
    v_mfma_f32_16x16x32_bf16 a[152:155], v[108:111], v[148:151], a[152:155]
    v_add_u32 v159, s32, v11
    v_mfma_f32_16x16x32_bf16 a[184:187], v[112:115], v[148:151], a[184:187]
    v_add_u32 v160, s32, v12
    v_mfma_f32_16x16x32_bf16 a[216:219], v[116:119], v[148:151], a[216:219]
    v_add_u32 v161, s32, v13
    v_mfma_f32_16x16x32_bf16 a[248:251], v[120:123], v[148:151], a[248:251]
    v_add_u32 v162, s32, v14
    v_mfma_f32_16x16x32_bf16 a[28:31], v[92:95], v[152:155], a[28:31]
    v_add_u32 v163, s32, v15
    v_mfma_f32_16x16x32_bf16 a[60:63], v[96:99], v[152:155], a[60:63]
    v_add_u32 v164, s32, v16
    s_add_u32 m0, s35, 3072
    v_mfma_f32_16x16x32_bf16 a[92:95], v[100:103], v[152:155], a[92:95]
    buffer_load_dwordx4 v24, s[12:15], s21 offen lds
    v_mfma_f32_16x16x32_bf16 a[124:127], v[104:107], v[152:155], a[124:127]
    s_add_u32 s20, s20, 262144
    s_add_u32 s21, s21, 131072
    v_mfma_f32_16x16x32_bf16 a[156:159], v[108:111], v[152:155], a[156:159]
    s_add_u32 s33, s33, 32768
    s_cmp_eq_u32 s33, 131072
    s_cselect_b32 s33, 0, s33
    v_mfma_f32_16x16x32_bf16 a[188:191], v[112:115], v[152:155], a[188:191]
    s_add_u32 s34, s22, s33
    s_add_u32 s35, s23, s33
    v_mfma_f32_16x16x32_bf16 a[220:223], v[116:119], v[152:155], a[220:223]
    v_mfma_f32_16x16x32_bf16 a[252:255], v[120:123], v[152:155], a[252:255]
    s_waitcnt vmcnt(16) lgkmcnt(0)
    s_barrier
    s_mov_b32 s24, 15
B_L_gA_loop:
    v_mfma_f32_16x16x32_bf16 a[0:3], v[28:31], v[60:63], a[0:3]
    v_mfma_f32_16x16x32_bf16 a[32:35], v[32:35], v[60:63], a[32:35]
    ds_read_b128 v[124:127], v164 offset:0
    s_add_u32 m0, s34, 0
    v_mfma_f32_16x16x32_bf16 a[64:67], v[36:39], v[60:63], a[64:67]
    buffer_load_dwordx4 v17, s[8:11], s20 offen lds
    v_mfma_f32_16x16x32_bf16 a[96:99], v[40:43], v[60:63], a[96:99]
    ds_read_b64_tr_b16 v[92:93], v156
    v_mfma_f32_16x16x32_bf16 a[128:131], v[44:47], v[60:63], a[128:131]
    v_mfma_f32_16x16x32_bf16 a[160:163], v[48:51], v[60:63], a[160:163]
    ds_read_b64_tr_b16 v[94:95], v156 offset:1024
    v_mfma_f32_16x16x32_bf16 a[192:195], v[52:55], v[60:63], a[192:195]
    v_mfma_f32_16x16x32_bf16 a[224:227], v[56:59], v[60:63], a[224:227]
    ds_read_b128 v[128:131], v164 offset:1024
    v_mfma_f32_16x16x32_bf16 a[4:7], v[28:31], v[64:67], a[4:7]
    v_mfma_f32_16x16x32_bf16 a[36:39], v[32:35], v[64:67], a[36:39]
    ds_read_b64_tr_b16 v[96:97], v157
    s_add_u32 m0, s34, 1024
    v_mfma_f32_16x16x32_bf16 a[68:71], v[36:39], v[64:67], a[68:71]
    buffer_load_dwordx4 v18, s[8:11], s20 offen lds
    v_mfma_f32_16x16x32_bf16 a[100:103], v[40:43], v[64:67], a[100:103]
    ds_read_b64_tr_b16 v[98:99], v157 offset:1024
    v_mfma_f32_16x16x32_bf16 a[132:135], v[44:47], v[64:67], a[132:135]
    v_mfma_f32_16x16x32_bf16 a[164:167], v[48:51], v[64:67], a[164:167]
    ds_read_b128 v[132:135], v164 offset:2048
    v_mfma_f32_16x16x32_bf16 a[196:199], v[52:55], v[64:67], a[196:199]
    v_mfma_f32_16x16x32_bf16 a[228:231], v[56:59], v[64:67], a[228:231]
    ds_read_b64_tr_b16 v[100:101], v158
    v_mfma_f32_16x16x32_bf16 a[8:11], v[28:31], v[68:71], a[8:11]
    v_mfma_f32_16x16x32_bf16 a[40:43], v[32:35], v[68:71], a[40:43]
    ds_read_b64_tr_b16 v[102:103], v158 offset:1024
    s_add_u32 m0, s34, 2048
    v_mfma_f32_16x16x32_bf16 a[72:75], v[36:39], v[68:71], a[72:75]
    buffer_load_dwordx4 v19, s[8:11], s20 offen lds
    v_mfma_f32_16x16x32_bf16 a[104:107], v[40:43], v[68:71], a[104:107]
    ds_read_b128 v[136:139], v164 offset:3072
    v_mfma_f32_16x16x32_bf16 a[136:139], v[44:47], v[68:71], a[136:139]
    v_mfma_f32_16x16x32_bf16 a[168:171], v[48:51], v[68:71], a[168:171]
    ds_read_b64_tr_b16 v[104:105], v159
    v_mfma_f32_16x16x32_bf16 a[200:203], v[52:55], v[68:71], a[200:203]
    v_mfma_f32_16x16x32_bf16 a[232:235], v[56:59], v[68:71], a[232:235]
    ds_read_b64_tr_b16 v[106:107], v159 offset:1024
    v_mfma_f32_16x16x32_bf16 a[12:15], v[28:31], v[72:75], a[12:15]
    v_mfma_f32_16x16x32_bf16 a[44:47], v[32:35], v[72:75], a[44:47]
    ds_read_b128 v[140:143], v164 offset:4096
    s_add_u32 m0, s34, 3072
    v_mfma_f32_16x16x32_bf16 a[76:79], v[36:39], v[72:75], a[76:79]
    buffer_load_dwordx4 v20, s[8:11], s20 offen lds
    v_mfma_f32_16x16x32_bf16 a[108:111], v[40:43], v[72:75], a[108:111]
    ds_read_b64_tr_b16 v[108:109], v160
    v_mfma_f32_16x16x32_bf16 a[140:143], v[44:47], v[72:75], a[140:143]
    v_mfma_f32_16x16x32_bf16 a[172:175], v[48:51], v[72:75], a[172:175]
    ds_read_b64_tr_b16 v[110:111], v160 offset:1024
    v_mfma_f32_16x16x32_bf16 a[204:207], v[52:55], v[72:75], a[204:207]
    v_mfma_f32_16x16x32_bf16 a[236:239], v[56:59], v[72:75], a[236:239]
    ds_read_b128 v[144:147], v164 offset:5120
    v_mfma_f32_16x16x32_bf16 a[16:19], v[28:31], v[76:79], a[16:19]
    v_mfma_f32_16x16x32_bf16 a[48:51], v[32:35], v[76:79], a[48:51]
    ds_read_b64_tr_b16 v[112:113], v161
    s_add_u32 m0, s35, 0
    v_mfma_f32_16x16x32_bf16 a[80:83], v[36:39], v[76:79], a[80:83]
    buffer_load_dwordx4 v21, s[12:15], s21 offen lds
    v_mfma_f32_16x16x32_bf16 a[112:115], v[40:43], v[76:79], a[112:115]
    ds_read_b64_tr_b16 v[114:115], v161 offset:1024
    v_mfma_f32_16x16x32_bf16 a[144:147], v[44:47], v[76:79], a[144:147]
    v_mfma_f32_16x16x32_bf16 a[176:179], v[48:51], v[76:79], a[176:179]
    ds_read_b128 v[148:151], v164 offset:6144
    v_mfma_f32_16x16x32_bf16 a[208:211], v[52:55], v[76:79], a[208:211]
    v_mfma_f32_16x16x32_bf16 a[240:243], v[56:59], v[76:79], a[240:243]
    ds_read_b64_tr_b16 v[116:117], v162
    v_mfma_f32_16x16x32_bf16 a[20:23], v[28:31], v[80:83], a[20:23]
    v_mfma_f32_16x16x32_bf16 a[52:55], v[32:35], v[80:83], a[52:55]
    ds_read_b64_tr_b16 v[118:119], v162 offset:1024
    s_add_u32 m0, s35, 1024
    v_mfma_f32_16x16x32_bf16 a[84:87], v[36:39], v[80:83], a[84:87]
    buffer_load_dwordx4 v22, s[12:15], s21 offen lds
    v_mfma_f32_16x16x32_bf16 a[116:119], v[40:43], v[80:83], a[116:119]
    ds_read_b128 v[152:155], v164 offset:7168
    v_mfma_f32_16x16x32_bf16 a[148:151], v[44:47], v[80:83], a[148:151]
    v_mfma_f32_16x16x32_bf16 a[180:183], v[48:51], v[80:83], a[180:183]
    ds_read_b64_tr_b16 v[120:121], v163
    v_mfma_f32_16x16x32_bf16 a[212:215], v[52:55], v[80:83], a[212:215]
    v_mfma_f32_16x16x32_bf16 a[244:247], v[56:59], v[80:83], a[244:247]
    ds_read_b64_tr_b16 v[122:123], v163 offset:1024
    v_mfma_f32_16x16x32_bf16 a[24:27], v[28:31], v[84:87], a[24:27]
    s_add_u32 s32, s32, 32768
    s_cmp_eq_u32 s32, 131072
    s_cselect_b32 s32, 0, s32
    v_mfma_f32_16x16x32_bf16 a[56:59], v[32:35], v[84:87], a[56:59]
    v_add_u32 v156, s32, v8
    s_add_u32 m0, s35, 2048
    v_mfma_f32_16x16x32_bf16 a[88:91], v[36:39], v[84:87], a[88:91]
    buffer_load_dwordx4 v23, s[12:15], s21 offen lds
    v_add_u32 v157, s32, v9
    v_mfma_f32_16x16x32_bf16 a[120:123], v[40:43], v[84:87], a[120:123]
    v_add_u32 v158, s32, v10
    v_mfma_f32_16x16x32_bf16 a[152:155], v[44:47], v[84:87], a[152:155]
    v_add_u32 v159, s32, v11
    v_mfma_f32_16x16x32_bf16 a[184:187], v[48:51], v[84:87], a[184:187]
    v_add_u32 v160, s32, v12
    v_mfma_f32_16x16x32_bf16 a[216:219], v[52:55], v[84:87], a[216:219]
    v_add_u32 v161, s32, v13
    v_mfma_f32_16x16x32_bf16 a[248:251], v[56:59], v[84:87], a[248:251]
    v_add_u32 v162, s32, v14
    v_mfma_f32_16x16x32_bf16 a[28:31], v[28:31], v[88:91], a[28:31]
    v_add_u32 v163, s32, v15
    v_mfma_f32_16x16x32_bf16 a[60:63], v[32:35], v[88:91], a[60:63]
    v_add_u32 v164, s32, v16
    s_add_u32 m0, s35, 3072
    v_mfma_f32_16x16x32_bf16 a[92:95], v[36:39], v[88:91], a[92:95]
    buffer_load_dwordx4 v24, s[12:15], s21 offen lds
    v_mfma_f32_16x16x32_bf16 a[124:127], v[40:43], v[88:91], a[124:127]
    s_add_u32 s20, s20, 262144
    s_add_u32 s21, s21, 131072
    v_mfma_f32_16x16x32_bf16 a[156:159], v[44:47], v[88:91], a[156:159]
    s_add_u32 s33, s33, 32768
    s_cmp_eq_u32 s33, 131072
    s_cselect_b32 s33, 0, s33
    v_mfma_f32_16x16x32_bf16 a[188:191], v[48:51], v[88:91], a[188:191]
    s_add_u32 s34, s22, s33
    s_add_u32 s35, s23, s33
    v_mfma_f32_16x16x32_bf16 a[220:223], v[52:55], v[88:91], a[220:223]
    v_mfma_f32_16x16x32_bf16 a[252:255], v[56:59], v[88:91], a[252:255]
    s_waitcnt vmcnt(16) lgkmcnt(0)
    s_barrier
    v_mfma_f32_16x16x32_bf16 a[0:3], v[92:95], v[124:127], a[0:3]
    v_mfma_f32_16x16x32_bf16 a[32:35], v[96:99], v[124:127], a[32:35]
    ds_read_b128 v[60:63], v164 offset:0
    s_add_u32 m0, s34, 0
    v_mfma_f32_16x16x32_bf16 a[64:67], v[100:103], v[124:127], a[64:67]
    buffer_load_dwordx4 v17, s[8:11], s20 offen lds
    v_mfma_f32_16x16x32_bf16 a[96:99], v[104:107], v[124:127], a[96:99]
    ds_read_b64_tr_b16 v[28:29], v156
    v_mfma_f32_16x16x32_bf16 a[128:131], v[108:111], v[124:127], a[128:131]
    v_mfma_f32_16x16x32_bf16 a[160:163], v[112:115], v[124:127], a[160:163]
    ds_read_b64_tr_b16 v[30:31], v156 offset:1024
    v_mfma_f32_16x16x32_bf16 a[192:195], v[116:119], v[124:127], a[192:195]
    v_mfma_f32_16x16x32_bf16 a[224:227], v[120:123], v[124:127], a[224:227]
    ds_read_b128 v[64:67], v164 offset:1024
    v_mfma_f32_16x16x32_bf16 a[4:7], v[92:95], v[128:131], a[4:7]
    v_mfma_f32_16x16x32_bf16 a[36:39], v[96:99], v[128:131], a[36:39]
    ds_read_b64_tr_b16 v[32:33], v157
    s_add_u32 m0, s34, 1024
    v_mfma_f32_16x16x32_bf16 a[68:71], v[100:103], v[128:131], a[68:71]
    buffer_load_dwordx4 v18, s[8:11], s20 offen lds
    v_mfma_f32_16x16x32_bf16 a[100:103], v[104:107], v[128:131], a[100:103]
    ds_read_b64_tr_b16 v[34:35], v157 offset:1024
    v_mfma_f32_16x16x32_bf16 a[132:135], v[108:111], v[128:131], a[132:135]
    v_mfma_f32_16x16x32_bf16 a[164:167], v[112:115], v[128:131], a[164:167]
    ds_read_b128 v[68:71], v164 offset:2048
    v_mfma_f32_16x16x32_bf16 a[196:199], v[116:119], v[128:131], a[196:199]
    v_mfma_f32_16x16x32_bf16 a[228:231], v[120:123], v[128:131], a[228:231]
    ds_read_b64_tr_b16 v[36:37], v158
    v_mfma_f32_16x16x32_bf16 a[8:11], v[92:95], v[132:135], a[8:11]
    v_mfma_f32_16x16x32_bf16 a[40:43], v[96:99], v[132:135], a[40:43]
    ds_read_b64_tr_b16 v[38:39], v158 offset:1024
    s_add_u32 m0, s34, 2048
    v_mfma_f32_16x16x32_bf16 a[72:75], v[100:103], v[132:135], a[72:75]
    buffer_load_dwordx4 v19, s[8:11], s20 offen lds
    v_mfma_f32_16x16x32_bf16 a[104:107], v[104:107], v[132:135], a[104:107]
    ds_read_b128 v[72:75], v164 offset:3072
    v_mfma_f32_16x16x32_bf16 a[136:139], v[108:111], v[132:135], a[136:139]
    v_mfma_f32_16x16x32_bf16 a[168:171], v[112:115], v[132:135], a[168:171]
    ds_read_b64_tr_b16 v[40:41], v159
    v_mfma_f32_16x16x32_bf16 a[200:203], v[116:119], v[132:135], a[200:203]
    v_mfma_f32_16x16x32_bf16 a[232:235], v[120:123], v[132:135], a[232:235]
    ds_read_b64_tr_b16 v[42:43], v159 offset:1024
    v_mfma_f32_16x16x32_bf16 a[12:15], v[92:95], v[136:139], a[12:15]
    v_mfma_f32_16x16x32_bf16 a[44:47], v[96:99], v[136:139], a[44:47]
    ds_read_b128 v[76:79], v164 offset:4096
    s_add_u32 m0, s34, 3072
    v_mfma_f32_16x16x32_bf16 a[76:79], v[100:103], v[136:139], a[76:79]
    buffer_load_dwordx4 v20, s[8:11], s20 offen lds
    v_mfma_f32_16x16x32_bf16 a[108:111], v[104:107], v[136:139], a[108:111]
    ds_read_b64_tr_b16 v[44:45], v160
    v_mfma_f32_16x16x32_bf16 a[140:143], v[108:111], v[136:139], a[140:143]
    v_mfma_f32_16x16x32_bf16 a[172:175], v[112:115], v[136:139], a[172:175]
    ds_read_b64_tr_b16 v[46:47], v160 offset:1024
    v_mfma_f32_16x16x32_bf16 a[204:207], v[116:119], v[136:139], a[204:207]
    v_mfma_f32_16x16x32_bf16 a[236:239], v[120:123], v[136:139], a[236:239]
    ds_read_b128 v[80:83], v164 offset:5120
    v_mfma_f32_16x16x32_bf16 a[16:19], v[92:95], v[140:143], a[16:19]
    v_mfma_f32_16x16x32_bf16 a[48:51], v[96:99], v[140:143], a[48:51]
    ds_read_b64_tr_b16 v[48:49], v161
    s_add_u32 m0, s35, 0
    v_mfma_f32_16x16x32_bf16 a[80:83], v[100:103], v[140:143], a[80:83]
    buffer_load_dwordx4 v21, s[12:15], s21 offen lds
    v_mfma_f32_16x16x32_bf16 a[112:115], v[104:107], v[140:143], a[112:115]
    ds_read_b64_tr_b16 v[50:51], v161 offset:1024
    v_mfma_f32_16x16x32_bf16 a[144:147], v[108:111], v[140:143], a[144:147]
    v_mfma_f32_16x16x32_bf16 a[176:179], v[112:115], v[140:143], a[176:179]
    ds_read_b128 v[84:87], v164 offset:6144
    v_mfma_f32_16x16x32_bf16 a[208:211], v[116:119], v[140:143], a[208:211]
    v_mfma_f32_16x16x32_bf16 a[240:243], v[120:123], v[140:143], a[240:243]
    ds_read_b64_tr_b16 v[52:53], v162
    v_mfma_f32_16x16x32_bf16 a[20:23], v[92:95], v[144:147], a[20:23]
    v_mfma_f32_16x16x32_bf16 a[52:55], v[96:99], v[144:147], a[52:55]
    ds_read_b64_tr_b16 v[54:55], v162 offset:1024
    s_add_u32 m0, s35, 1024
    v_mfma_f32_16x16x32_bf16 a[84:87], v[100:103], v[144:147], a[84:87]
    buffer_load_dwordx4 v22, s[12:15], s21 offen lds
    v_mfma_f32_16x16x32_bf16 a[116:119], v[104:107], v[144:147], a[116:119]
    ds_read_b128 v[88:91], v164 offset:7168
    v_mfma_f32_16x16x32_bf16 a[148:151], v[108:111], v[144:147], a[148:151]
    v_mfma_f32_16x16x32_bf16 a[180:183], v[112:115], v[144:147], a[180:183]
    ds_read_b64_tr_b16 v[56:57], v163
    v_mfma_f32_16x16x32_bf16 a[212:215], v[116:119], v[144:147], a[212:215]
    v_mfma_f32_16x16x32_bf16 a[244:247], v[120:123], v[144:147], a[244:247]
    ds_read_b64_tr_b16 v[58:59], v163 offset:1024
    v_mfma_f32_16x16x32_bf16 a[24:27], v[92:95], v[148:151], a[24:27]
    s_add_u32 s32, s32, 32768
    s_cmp_eq_u32 s32, 131072
    s_cselect_b32 s32, 0, s32
    v_mfma_f32_16x16x32_bf16 a[56:59], v[96:99], v[148:151], a[56:59]
    v_add_u32 v156, s32, v8
    s_add_u32 m0, s35, 2048
    v_mfma_f32_16x16x32_bf16 a[88:91], v[100:103], v[148:151], a[88:91]
    buffer_load_dwordx4 v23, s[12:15], s21 offen lds
    v_add_u32 v157, s32, v9
    v_mfma_f32_16x16x32_bf16 a[120:123], v[104:107], v[148:151], a[120:123]
    v_add_u32 v158, s32, v10
    v_mfma_f32_16x16x32_bf16 a[152:155], v[108:111], v[148:151], a[152:155]
    v_add_u32 v159, s32, v11
    v_mfma_f32_16x16x32_bf16 a[184:187], v[112:115], v[148:151], a[184:187]
    v_add_u32 v160, s32, v12
    v_mfma_f32_16x16x32_bf16 a[216:219], v[116:119], v[148:151], a[216:219]
    v_add_u32 v161, s32, v13
    v_mfma_f32_16x16x32_bf16 a[248:251], v[120:123], v[148:151], a[248:251]
    v_add_u32 v162, s32, v14
    v_mfma_f32_16x16x32_bf16 a[28:31], v[92:95], v[152:155], a[28:31]
    v_add_u32 v163, s32, v15
    v_mfma_f32_16x16x32_bf16 a[60:63], v[96:99], v[152:155], a[60:63]
    v_add_u32 v164, s32, v16
    s_add_u32 m0, s35, 3072
    v_mfma_f32_16x16x32_bf16 a[92:95], v[100:103], v[152:155], a[92:95]
    buffer_load_dwordx4 v24, s[12:15], s21 offen lds
    v_mfma_f32_16x16x32_bf16 a[124:127], v[104:107], v[152:155], a[124:127]
    s_add_u32 s20, s20, 262144
    s_add_u32 s21, s21, 131072
    v_mfma_f32_16x16x32_bf16 a[156:159], v[108:111], v[152:155], a[156:159]
    s_add_u32 s33, s33, 32768
    s_cmp_eq_u32 s33, 131072
    s_cselect_b32 s33, 0, s33
    v_mfma_f32_16x16x32_bf16 a[188:191], v[112:115], v[152:155], a[188:191]
    s_add_u32 s34, s22, s33
    s_add_u32 s35, s23, s33
    v_mfma_f32_16x16x32_bf16 a[220:223], v[116:119], v[152:155], a[220:223]
    v_mfma_f32_16x16x32_bf16 a[252:255], v[120:123], v[152:155], a[252:255]
    s_waitcnt vmcnt(16) lgkmcnt(0)
    s_barrier
    s_sub_u32 s24, s24, 1
    s_cmp_lg_u32 s24, 0
    s_cbranch_scc1 B_L_gA_loop
    s_waitcnt vmcnt(0)
    s_and_b32 s25, s67, 15
    s_lshl_b32 s25, s25, 1
    s_and_b32 s26, s3, 1
    s_add_u32 s25, s25, s26
    s_lshr_b32 s26, s68, 5
    s_lshr_b32 s27, s3, 1
    s_mul_i32 s27, s27, 4
    s_add_u32 s26, s26, s27
    s_lshl_b32 s26, s26, 5
    s_add_u32 s25, s25, s26
    s_lshl_b32 s25, s25, 13
    v_lshrrev_b32 v2, 4, v0
    v_and_b32 v3, 1, v2
    v_lshrrev_b32 v2, 1, v2
    v_lshl_or_b32 v2, v3, 1, v2
    v_and_b32 v3, 15, v0
    v_lshl_or_b32 v2, v2, 4, v3
    v_lshlrev_b32 v1, 4, v2
    s_add_u32 s26, s25, 0
    v_accvgpr_read_b32 v32, a0
    v_accvgpr_read_b32 v33, a1
    v_accvgpr_read_b32 v34, a2
    v_accvgpr_read_b32 v35, a3
    v_accvgpr_read_b32 v36, a32
    v_accvgpr_read_b32 v37, a33
    v_accvgpr_read_b32 v38, a34
    v_accvgpr_read_b32 v39, a35
    v_cvt_pk_bf16_f32 v28, v32, v33
    v_cvt_pk_bf16_f32 v29, v34, v35
    v_cvt_pk_bf16_f32 v30, v36, v37
    v_cvt_pk_bf16_f32 v31, v38, v39
    s_nop 0
    v_permlane16_swap_b32 v28, v30
    v_permlane16_swap_b32 v29, v31
    buffer_store_dwordx4 v[28:31], v1, s[16:19], s26 offen offset:0 sc1
    v_accvgpr_read_b32 v44, a64
    v_accvgpr_read_b32 v45, a65
    v_accvgpr_read_b32 v46, a66
    v_accvgpr_read_b32 v47, a67
    v_accvgpr_read_b32 v48, a96
    v_accvgpr_read_b32 v49, a97
    v_accvgpr_read_b32 v50, a98
    v_accvgpr_read_b32 v51, a99
    v_cvt_pk_bf16_f32 v40, v44, v45
    v_cvt_pk_bf16_f32 v41, v46, v47
    v_cvt_pk_bf16_f32 v42, v48, v49
    v_cvt_pk_bf16_f32 v43, v50, v51
    s_nop 0
    v_permlane16_swap_b32 v40, v42
    v_permlane16_swap_b32 v41, v43
    buffer_store_dwordx4 v[40:43], v1, s[16:19], s26 offen offset:1024 sc1
    v_accvgpr_read_b32 v56, a128
    v_accvgpr_read_b32 v57, a129
    v_accvgpr_read_b32 v58, a130
    v_accvgpr_read_b32 v59, a131
    v_accvgpr_read_b32 v60, a160
    v_accvgpr_read_b32 v61, a161
    v_accvgpr_read_b32 v62, a162
    v_accvgpr_read_b32 v63, a163
    v_cvt_pk_bf16_f32 v52, v56, v57
    v_cvt_pk_bf16_f32 v53, v58, v59
    v_cvt_pk_bf16_f32 v54, v60, v61
    v_cvt_pk_bf16_f32 v55, v62, v63
    s_nop 0
    v_permlane16_swap_b32 v52, v54
    v_permlane16_swap_b32 v53, v55
    buffer_store_dwordx4 v[52:55], v1, s[16:19], s26 offen offset:2048 sc1
    v_accvgpr_read_b32 v68, a192
    v_accvgpr_read_b32 v69, a193
    v_accvgpr_read_b32 v70, a194
    v_accvgpr_read_b32 v71, a195
    v_accvgpr_read_b32 v72, a224
    v_accvgpr_read_b32 v73, a225
    v_accvgpr_read_b32 v74, a226
    v_accvgpr_read_b32 v75, a227
    v_cvt_pk_bf16_f32 v64, v68, v69
    v_cvt_pk_bf16_f32 v65, v70, v71
    v_cvt_pk_bf16_f32 v66, v72, v73
    v_cvt_pk_bf16_f32 v67, v74, v75
    s_nop 0
    v_permlane16_swap_b32 v64, v66
    v_permlane16_swap_b32 v65, v67
    buffer_store_dwordx4 v[64:67], v1, s[16:19], s26 offen offset:3072 sc1
    s_add_u32 s26, s25, 4096
    v_accvgpr_read_b32 v32, a4
    v_accvgpr_read_b32 v33, a5
    v_accvgpr_read_b32 v34, a6
    v_accvgpr_read_b32 v35, a7
    v_accvgpr_read_b32 v36, a36
    v_accvgpr_read_b32 v37, a37
    v_accvgpr_read_b32 v38, a38
    v_accvgpr_read_b32 v39, a39
    v_cvt_pk_bf16_f32 v28, v32, v33
    v_cvt_pk_bf16_f32 v29, v34, v35
    v_cvt_pk_bf16_f32 v30, v36, v37
    v_cvt_pk_bf16_f32 v31, v38, v39
    s_nop 0
    v_permlane16_swap_b32 v28, v30
    v_permlane16_swap_b32 v29, v31
    buffer_store_dwordx4 v[28:31], v1, s[16:19], s26 offen offset:0 sc1
    v_accvgpr_read_b32 v44, a68
    v_accvgpr_read_b32 v45, a69
    v_accvgpr_read_b32 v46, a70
    v_accvgpr_read_b32 v47, a71
    v_accvgpr_read_b32 v48, a100
    v_accvgpr_read_b32 v49, a101
    v_accvgpr_read_b32 v50, a102
    v_accvgpr_read_b32 v51, a103
    v_cvt_pk_bf16_f32 v40, v44, v45
    v_cvt_pk_bf16_f32 v41, v46, v47
    v_cvt_pk_bf16_f32 v42, v48, v49
    v_cvt_pk_bf16_f32 v43, v50, v51
    s_nop 0
    v_permlane16_swap_b32 v40, v42
    v_permlane16_swap_b32 v41, v43
    buffer_store_dwordx4 v[40:43], v1, s[16:19], s26 offen offset:1024 sc1
    v_accvgpr_read_b32 v56, a132
    v_accvgpr_read_b32 v57, a133
    v_accvgpr_read_b32 v58, a134
    v_accvgpr_read_b32 v59, a135
    v_accvgpr_read_b32 v60, a164
    v_accvgpr_read_b32 v61, a165
    v_accvgpr_read_b32 v62, a166
    v_accvgpr_read_b32 v63, a167
    v_cvt_pk_bf16_f32 v52, v56, v57
    v_cvt_pk_bf16_f32 v53, v58, v59
    v_cvt_pk_bf16_f32 v54, v60, v61
    v_cvt_pk_bf16_f32 v55, v62, v63
    s_nop 0
    v_permlane16_swap_b32 v52, v54
    v_permlane16_swap_b32 v53, v55
    buffer_store_dwordx4 v[52:55], v1, s[16:19], s26 offen offset:2048 sc1
    v_accvgpr_read_b32 v68, a196
    v_accvgpr_read_b32 v69, a197
    v_accvgpr_read_b32 v70, a198
    v_accvgpr_read_b32 v71, a199
    v_accvgpr_read_b32 v72, a228
    v_accvgpr_read_b32 v73, a229
    v_accvgpr_read_b32 v74, a230
    v_accvgpr_read_b32 v75, a231
    v_cvt_pk_bf16_f32 v64, v68, v69
    v_cvt_pk_bf16_f32 v65, v70, v71
    v_cvt_pk_bf16_f32 v66, v72, v73
    v_cvt_pk_bf16_f32 v67, v74, v75
    s_nop 0
    v_permlane16_swap_b32 v64, v66
    v_permlane16_swap_b32 v65, v67
    buffer_store_dwordx4 v[64:67], v1, s[16:19], s26 offen offset:3072 sc1
    s_add_u32 s26, s25, 262144
    v_accvgpr_read_b32 v32, a8
    v_accvgpr_read_b32 v33, a9
    v_accvgpr_read_b32 v34, a10
    v_accvgpr_read_b32 v35, a11
    v_accvgpr_read_b32 v36, a40
    v_accvgpr_read_b32 v37, a41
    v_accvgpr_read_b32 v38, a42
    v_accvgpr_read_b32 v39, a43
    v_cvt_pk_bf16_f32 v28, v32, v33
    v_cvt_pk_bf16_f32 v29, v34, v35
    v_cvt_pk_bf16_f32 v30, v36, v37
    v_cvt_pk_bf16_f32 v31, v38, v39
    s_nop 0
    v_permlane16_swap_b32 v28, v30
    v_permlane16_swap_b32 v29, v31
    buffer_store_dwordx4 v[28:31], v1, s[16:19], s26 offen offset:0 sc1
    v_accvgpr_read_b32 v44, a72
    v_accvgpr_read_b32 v45, a73
    v_accvgpr_read_b32 v46, a74
    v_accvgpr_read_b32 v47, a75
    v_accvgpr_read_b32 v48, a104
    v_accvgpr_read_b32 v49, a105
    v_accvgpr_read_b32 v50, a106
    v_accvgpr_read_b32 v51, a107
    v_cvt_pk_bf16_f32 v40, v44, v45
    v_cvt_pk_bf16_f32 v41, v46, v47
    v_cvt_pk_bf16_f32 v42, v48, v49
    v_cvt_pk_bf16_f32 v43, v50, v51
    s_nop 0
    v_permlane16_swap_b32 v40, v42
    v_permlane16_swap_b32 v41, v43
    buffer_store_dwordx4 v[40:43], v1, s[16:19], s26 offen offset:1024 sc1
    v_accvgpr_read_b32 v56, a136
    v_accvgpr_read_b32 v57, a137
    v_accvgpr_read_b32 v58, a138
    v_accvgpr_read_b32 v59, a139
    v_accvgpr_read_b32 v60, a168
    v_accvgpr_read_b32 v61, a169
    v_accvgpr_read_b32 v62, a170
    v_accvgpr_read_b32 v63, a171
    v_cvt_pk_bf16_f32 v52, v56, v57
    v_cvt_pk_bf16_f32 v53, v58, v59
    v_cvt_pk_bf16_f32 v54, v60, v61
    v_cvt_pk_bf16_f32 v55, v62, v63
    s_nop 0
    v_permlane16_swap_b32 v52, v54
    v_permlane16_swap_b32 v53, v55
    buffer_store_dwordx4 v[52:55], v1, s[16:19], s26 offen offset:2048 sc1
    v_accvgpr_read_b32 v68, a200
    v_accvgpr_read_b32 v69, a201
    v_accvgpr_read_b32 v70, a202
    v_accvgpr_read_b32 v71, a203
    v_accvgpr_read_b32 v72, a232
    v_accvgpr_read_b32 v73, a233
    v_accvgpr_read_b32 v74, a234
    v_accvgpr_read_b32 v75, a235
    v_cvt_pk_bf16_f32 v64, v68, v69
    v_cvt_pk_bf16_f32 v65, v70, v71
    v_cvt_pk_bf16_f32 v66, v72, v73
    v_cvt_pk_bf16_f32 v67, v74, v75
    s_nop 0
    v_permlane16_swap_b32 v64, v66
    v_permlane16_swap_b32 v65, v67
    buffer_store_dwordx4 v[64:67], v1, s[16:19], s26 offen offset:3072 sc1
    s_add_u32 s26, s25, 266240
    v_accvgpr_read_b32 v32, a12
    v_accvgpr_read_b32 v33, a13
    v_accvgpr_read_b32 v34, a14
    v_accvgpr_read_b32 v35, a15
    v_accvgpr_read_b32 v36, a44
    v_accvgpr_read_b32 v37, a45
    v_accvgpr_read_b32 v38, a46
    v_accvgpr_read_b32 v39, a47
    v_cvt_pk_bf16_f32 v28, v32, v33
    v_cvt_pk_bf16_f32 v29, v34, v35
    v_cvt_pk_bf16_f32 v30, v36, v37
    v_cvt_pk_bf16_f32 v31, v38, v39
    s_nop 0
    v_permlane16_swap_b32 v28, v30
    v_permlane16_swap_b32 v29, v31
    buffer_store_dwordx4 v[28:31], v1, s[16:19], s26 offen offset:0 sc1
    v_accvgpr_read_b32 v44, a76
    v_accvgpr_read_b32 v45, a77
    v_accvgpr_read_b32 v46, a78
    v_accvgpr_read_b32 v47, a79
    v_accvgpr_read_b32 v48, a108
    v_accvgpr_read_b32 v49, a109
    v_accvgpr_read_b32 v50, a110
    v_accvgpr_read_b32 v51, a111
    v_cvt_pk_bf16_f32 v40, v44, v45
    v_cvt_pk_bf16_f32 v41, v46, v47
    v_cvt_pk_bf16_f32 v42, v48, v49
    v_cvt_pk_bf16_f32 v43, v50, v51
    s_nop 0
    v_permlane16_swap_b32 v40, v42
    v_permlane16_swap_b32 v41, v43
    buffer_store_dwordx4 v[40:43], v1, s[16:19], s26 offen offset:1024 sc1
    v_accvgpr_read_b32 v56, a140
    v_accvgpr_read_b32 v57, a141
    v_accvgpr_read_b32 v58, a142
    v_accvgpr_read_b32 v59, a143
    v_accvgpr_read_b32 v60, a172
    v_accvgpr_read_b32 v61, a173
    v_accvgpr_read_b32 v62, a174
    v_accvgpr_read_b32 v63, a175
    v_cvt_pk_bf16_f32 v52, v56, v57
    v_cvt_pk_bf16_f32 v53, v58, v59
    v_cvt_pk_bf16_f32 v54, v60, v61
    v_cvt_pk_bf16_f32 v55, v62, v63
    s_nop 0
    v_permlane16_swap_b32 v52, v54
    v_permlane16_swap_b32 v53, v55
    buffer_store_dwordx4 v[52:55], v1, s[16:19], s26 offen offset:2048 sc1
    v_accvgpr_read_b32 v68, a204
    v_accvgpr_read_b32 v69, a205
    v_accvgpr_read_b32 v70, a206
    v_accvgpr_read_b32 v71, a207
    v_accvgpr_read_b32 v72, a236
    v_accvgpr_read_b32 v73, a237
    v_accvgpr_read_b32 v74, a238
    v_accvgpr_read_b32 v75, a239
    v_cvt_pk_bf16_f32 v64, v68, v69
    v_cvt_pk_bf16_f32 v65, v70, v71
    v_cvt_pk_bf16_f32 v66, v72, v73
    v_cvt_pk_bf16_f32 v67, v74, v75
    s_nop 0
    v_permlane16_swap_b32 v64, v66
    v_permlane16_swap_b32 v65, v67
    buffer_store_dwordx4 v[64:67], v1, s[16:19], s26 offen offset:3072 sc1
    s_add_u32 s26, s25, 524288
    v_accvgpr_read_b32 v32, a16
    v_accvgpr_read_b32 v33, a17
    v_accvgpr_read_b32 v34, a18
    v_accvgpr_read_b32 v35, a19
    v_accvgpr_read_b32 v36, a48
    v_accvgpr_read_b32 v37, a49
    v_accvgpr_read_b32 v38, a50
    v_accvgpr_read_b32 v39, a51
    v_cvt_pk_bf16_f32 v28, v32, v33
    v_cvt_pk_bf16_f32 v29, v34, v35
    v_cvt_pk_bf16_f32 v30, v36, v37
    v_cvt_pk_bf16_f32 v31, v38, v39
    s_nop 0
    v_permlane16_swap_b32 v28, v30
    v_permlane16_swap_b32 v29, v31
    buffer_store_dwordx4 v[28:31], v1, s[16:19], s26 offen offset:0 sc1
    v_accvgpr_read_b32 v44, a80
    v_accvgpr_read_b32 v45, a81
    v_accvgpr_read_b32 v46, a82
    v_accvgpr_read_b32 v47, a83
    v_accvgpr_read_b32 v48, a112
    v_accvgpr_read_b32 v49, a113
    v_accvgpr_read_b32 v50, a114
    v_accvgpr_read_b32 v51, a115
    v_cvt_pk_bf16_f32 v40, v44, v45
    v_cvt_pk_bf16_f32 v41, v46, v47
    v_cvt_pk_bf16_f32 v42, v48, v49
    v_cvt_pk_bf16_f32 v43, v50, v51
    s_nop 0
    v_permlane16_swap_b32 v40, v42
    v_permlane16_swap_b32 v41, v43
    buffer_store_dwordx4 v[40:43], v1, s[16:19], s26 offen offset:1024 sc1
    v_accvgpr_read_b32 v56, a144
    v_accvgpr_read_b32 v57, a145
    v_accvgpr_read_b32 v58, a146
    v_accvgpr_read_b32 v59, a147
    v_accvgpr_read_b32 v60, a176
    v_accvgpr_read_b32 v61, a177
    v_accvgpr_read_b32 v62, a178
    v_accvgpr_read_b32 v63, a179
    v_cvt_pk_bf16_f32 v52, v56, v57
    v_cvt_pk_bf16_f32 v53, v58, v59
    v_cvt_pk_bf16_f32 v54, v60, v61
    v_cvt_pk_bf16_f32 v55, v62, v63
    s_nop 0
    v_permlane16_swap_b32 v52, v54
    v_permlane16_swap_b32 v53, v55
    buffer_store_dwordx4 v[52:55], v1, s[16:19], s26 offen offset:2048 sc1
    v_accvgpr_read_b32 v68, a208
    v_accvgpr_read_b32 v69, a209
    v_accvgpr_read_b32 v70, a210
    v_accvgpr_read_b32 v71, a211
    v_accvgpr_read_b32 v72, a240
    v_accvgpr_read_b32 v73, a241
    v_accvgpr_read_b32 v74, a242
    v_accvgpr_read_b32 v75, a243
    v_cvt_pk_bf16_f32 v64, v68, v69
    v_cvt_pk_bf16_f32 v65, v70, v71
    v_cvt_pk_bf16_f32 v66, v72, v73
    v_cvt_pk_bf16_f32 v67, v74, v75
    s_nop 0
    v_permlane16_swap_b32 v64, v66
    v_permlane16_swap_b32 v65, v67
    buffer_store_dwordx4 v[64:67], v1, s[16:19], s26 offen offset:3072 sc1
    s_add_u32 s26, s25, 528384
    v_accvgpr_read_b32 v32, a20
    v_accvgpr_read_b32 v33, a21
    v_accvgpr_read_b32 v34, a22
    v_accvgpr_read_b32 v35, a23
    v_accvgpr_read_b32 v36, a52
    v_accvgpr_read_b32 v37, a53
    v_accvgpr_read_b32 v38, a54
    v_accvgpr_read_b32 v39, a55
    v_cvt_pk_bf16_f32 v28, v32, v33
    v_cvt_pk_bf16_f32 v29, v34, v35
    v_cvt_pk_bf16_f32 v30, v36, v37
    v_cvt_pk_bf16_f32 v31, v38, v39
    s_nop 0
    v_permlane16_swap_b32 v28, v30
    v_permlane16_swap_b32 v29, v31
    buffer_store_dwordx4 v[28:31], v1, s[16:19], s26 offen offset:0 sc1
    v_accvgpr_read_b32 v44, a84
    v_accvgpr_read_b32 v45, a85
    v_accvgpr_read_b32 v46, a86
    v_accvgpr_read_b32 v47, a87
    v_accvgpr_read_b32 v48, a116
    v_accvgpr_read_b32 v49, a117
    v_accvgpr_read_b32 v50, a118
    v_accvgpr_read_b32 v51, a119
    v_cvt_pk_bf16_f32 v40, v44, v45
    v_cvt_pk_bf16_f32 v41, v46, v47
    v_cvt_pk_bf16_f32 v42, v48, v49
    v_cvt_pk_bf16_f32 v43, v50, v51
    s_nop 0
    v_permlane16_swap_b32 v40, v42
    v_permlane16_swap_b32 v41, v43
    buffer_store_dwordx4 v[40:43], v1, s[16:19], s26 offen offset:1024 sc1
    v_accvgpr_read_b32 v56, a148
    v_accvgpr_read_b32 v57, a149
    v_accvgpr_read_b32 v58, a150
    v_accvgpr_read_b32 v59, a151
    v_accvgpr_read_b32 v60, a180
    v_accvgpr_read_b32 v61, a181
    v_accvgpr_read_b32 v62, a182
    v_accvgpr_read_b32 v63, a183
    v_cvt_pk_bf16_f32 v52, v56, v57
    v_cvt_pk_bf16_f32 v53, v58, v59
    v_cvt_pk_bf16_f32 v54, v60, v61
    v_cvt_pk_bf16_f32 v55, v62, v63
    s_nop 0
    v_permlane16_swap_b32 v52, v54
    v_permlane16_swap_b32 v53, v55
    buffer_store_dwordx4 v[52:55], v1, s[16:19], s26 offen offset:2048 sc1
    v_accvgpr_read_b32 v68, a212
    v_accvgpr_read_b32 v69, a213
    v_accvgpr_read_b32 v70, a214
    v_accvgpr_read_b32 v71, a215
    v_accvgpr_read_b32 v72, a244
    v_accvgpr_read_b32 v73, a245
    v_accvgpr_read_b32 v74, a246
    v_accvgpr_read_b32 v75, a247
    v_cvt_pk_bf16_f32 v64, v68, v69
    v_cvt_pk_bf16_f32 v65, v70, v71
    v_cvt_pk_bf16_f32 v66, v72, v73
    v_cvt_pk_bf16_f32 v67, v74, v75
    s_nop 0
    v_permlane16_swap_b32 v64, v66
    v_permlane16_swap_b32 v65, v67
    buffer_store_dwordx4 v[64:67], v1, s[16:19], s26 offen offset:3072 sc1
    s_add_u32 s26, s25, 786432
    v_accvgpr_read_b32 v32, a24
    v_accvgpr_read_b32 v33, a25
    v_accvgpr_read_b32 v34, a26
    v_accvgpr_read_b32 v35, a27
    v_accvgpr_read_b32 v36, a56
    v_accvgpr_read_b32 v37, a57
    v_accvgpr_read_b32 v38, a58
    v_accvgpr_read_b32 v39, a59
    v_cvt_pk_bf16_f32 v28, v32, v33
    v_cvt_pk_bf16_f32 v29, v34, v35
    v_cvt_pk_bf16_f32 v30, v36, v37
    v_cvt_pk_bf16_f32 v31, v38, v39
    s_nop 0
    v_permlane16_swap_b32 v28, v30
    v_permlane16_swap_b32 v29, v31
    buffer_store_dwordx4 v[28:31], v1, s[16:19], s26 offen offset:0 sc1
    v_accvgpr_read_b32 v44, a88
    v_accvgpr_read_b32 v45, a89
    v_accvgpr_read_b32 v46, a90
    v_accvgpr_read_b32 v47, a91
    v_accvgpr_read_b32 v48, a120
    v_accvgpr_read_b32 v49, a121
    v_accvgpr_read_b32 v50, a122
    v_accvgpr_read_b32 v51, a123
    v_cvt_pk_bf16_f32 v40, v44, v45
    v_cvt_pk_bf16_f32 v41, v46, v47
    v_cvt_pk_bf16_f32 v42, v48, v49
    v_cvt_pk_bf16_f32 v43, v50, v51
    s_nop 0
    v_permlane16_swap_b32 v40, v42
    v_permlane16_swap_b32 v41, v43
    buffer_store_dwordx4 v[40:43], v1, s[16:19], s26 offen offset:1024 sc1
    v_accvgpr_read_b32 v56, a152
    v_accvgpr_read_b32 v57, a153
    v_accvgpr_read_b32 v58, a154
    v_accvgpr_read_b32 v59, a155
    v_accvgpr_read_b32 v60, a184
    v_accvgpr_read_b32 v61, a185
    v_accvgpr_read_b32 v62, a186
    v_accvgpr_read_b32 v63, a187
    v_cvt_pk_bf16_f32 v52, v56, v57
    v_cvt_pk_bf16_f32 v53, v58, v59
    v_cvt_pk_bf16_f32 v54, v60, v61
    v_cvt_pk_bf16_f32 v55, v62, v63
    s_nop 0
    v_permlane16_swap_b32 v52, v54
    v_permlane16_swap_b32 v53, v55
    buffer_store_dwordx4 v[52:55], v1, s[16:19], s26 offen offset:2048 sc1
    v_accvgpr_read_b32 v68, a216
    v_accvgpr_read_b32 v69, a217
    v_accvgpr_read_b32 v70, a218
    v_accvgpr_read_b32 v71, a219
    v_accvgpr_read_b32 v72, a248
    v_accvgpr_read_b32 v73, a249
    v_accvgpr_read_b32 v74, a250
    v_accvgpr_read_b32 v75, a251
    v_cvt_pk_bf16_f32 v64, v68, v69
    v_cvt_pk_bf16_f32 v65, v70, v71
    v_cvt_pk_bf16_f32 v66, v72, v73
    v_cvt_pk_bf16_f32 v67, v74, v75
    s_nop 0
    v_permlane16_swap_b32 v64, v66
    v_permlane16_swap_b32 v65, v67
    buffer_store_dwordx4 v[64:67], v1, s[16:19], s26 offen offset:3072 sc1
    s_add_u32 s26, s25, 790528
    v_accvgpr_read_b32 v32, a28
    v_accvgpr_read_b32 v33, a29
    v_accvgpr_read_b32 v34, a30
    v_accvgpr_read_b32 v35, a31
    v_accvgpr_read_b32 v36, a60
    v_accvgpr_read_b32 v37, a61
    v_accvgpr_read_b32 v38, a62
    v_accvgpr_read_b32 v39, a63
    v_cvt_pk_bf16_f32 v28, v32, v33
    v_cvt_pk_bf16_f32 v29, v34, v35
    v_cvt_pk_bf16_f32 v30, v36, v37
    v_cvt_pk_bf16_f32 v31, v38, v39
    s_nop 0
    v_permlane16_swap_b32 v28, v30
    v_permlane16_swap_b32 v29, v31
    buffer_store_dwordx4 v[28:31], v1, s[16:19], s26 offen offset:0 sc1
    v_accvgpr_read_b32 v44, a92
    v_accvgpr_read_b32 v45, a93
    v_accvgpr_read_b32 v46, a94
    v_accvgpr_read_b32 v47, a95
    v_accvgpr_read_b32 v48, a124
    v_accvgpr_read_b32 v49, a125
    v_accvgpr_read_b32 v50, a126
    v_accvgpr_read_b32 v51, a127
    v_cvt_pk_bf16_f32 v40, v44, v45
    v_cvt_pk_bf16_f32 v41, v46, v47
    v_cvt_pk_bf16_f32 v42, v48, v49
    v_cvt_pk_bf16_f32 v43, v50, v51
    s_nop 0
    v_permlane16_swap_b32 v40, v42
    v_permlane16_swap_b32 v41, v43
    buffer_store_dwordx4 v[40:43], v1, s[16:19], s26 offen offset:1024 sc1
    v_accvgpr_read_b32 v56, a156
    v_accvgpr_read_b32 v57, a157
    v_accvgpr_read_b32 v58, a158
    v_accvgpr_read_b32 v59, a159
    v_accvgpr_read_b32 v60, a188
    v_accvgpr_read_b32 v61, a189
    v_accvgpr_read_b32 v62, a190
    v_accvgpr_read_b32 v63, a191
    v_cvt_pk_bf16_f32 v52, v56, v57
    v_cvt_pk_bf16_f32 v53, v58, v59
    v_cvt_pk_bf16_f32 v54, v60, v61
    v_cvt_pk_bf16_f32 v55, v62, v63
    s_nop 0
    v_permlane16_swap_b32 v52, v54
    v_permlane16_swap_b32 v53, v55
    buffer_store_dwordx4 v[52:55], v1, s[16:19], s26 offen offset:2048 sc1
    v_accvgpr_read_b32 v68, a220
    v_accvgpr_read_b32 v69, a221
    v_accvgpr_read_b32 v70, a222
    v_accvgpr_read_b32 v71, a223
    v_accvgpr_read_b32 v72, a252
    v_accvgpr_read_b32 v73, a253
    v_accvgpr_read_b32 v74, a254
    v_accvgpr_read_b32 v75, a255
    v_cvt_pk_bf16_f32 v64, v68, v69
    v_cvt_pk_bf16_f32 v65, v70, v71
    v_cvt_pk_bf16_f32 v66, v72, v73
    v_cvt_pk_bf16_f32 v67, v74, v75
    s_nop 0
    v_permlane16_swap_b32 v64, v66
    v_permlane16_swap_b32 v65, v67
    buffer_store_dwordx4 v[64:67], v1, s[16:19], s26 offen offset:3072 sc1
    s_waitcnt vmcnt(0)
    s_barrier
    s_branch B_L_sig
B_L_bigv:
    s_and_b32 s26, s67, 15
    s_lshl_b32 s20, s26, 9
    s_lshl_b32 s21, s68, 6
    s_mul_i32 s22, s3, 4096
    s_mul_i32 s23, s3, 4096
    v_and_b32 v1, 15, v0
    v_lshrrev_b32 v2, 4, v0
    v_lshrrev_b32 v3, 2, v1
    v_and_b32 v4, 1, v2
    v_lshrrev_b32 v5, 1, v2
    v_lshlrev_b32 v6, 3, v3
    v_lshl_add_u32 v6, v5, 2, v6
    v_add_u32 v6, v6, v4
    v_lshl_or_b32 v3, v4, 2, v3
    v_lshlrev_b32 v6, 9, v6
    v_and_b32 v4, 3, v1
    v_lshl_add_u32 v6, v4, 3, v6
    s_and_b32 s25, s3, 1
    s_mul_i32 s25, s25, 8
    s_add_u32 s26, s25, 0
    v_xor_b32 v4, s26, v3
    v_lshl_add_u32 v8, v4, 5, v6
    s_add_u32 s26, s25, 1
    v_xor_b32 v4, s26, v3
    v_lshl_add_u32 v9, v4, 5, v6
    s_add_u32 s26, s25, 2
    v_xor_b32 v4, s26, v3
    v_lshl_add_u32 v10, v4, 5, v6
    s_add_u32 s26, s25, 3
    v_xor_b32 v4, s26, v3
    v_lshl_add_u32 v11, v4, 5, v6
    s_add_u32 s26, s25, 4
    v_xor_b32 v4, s26, v3
    v_lshl_add_u32 v12, v4, 5, v6
    s_add_u32 s26, s25, 5
    v_xor_b32 v4, s26, v3
    v_lshl_add_u32 v13, v4, 5, v6
    s_add_u32 s26, s25, 6
    v_xor_b32 v4, s26, v3
    v_lshl_add_u32 v14, v4, 5, v6
    s_add_u32 s26, s25, 7
    v_xor_b32 v4, s26, v3
    v_lshl_add_u32 v15, v4, 5, v6
    v_lshrrev_b32 v3, 2, v1
    v_lshrrev_b32 v4, 1, v3
    v_and_b32 v5, 1, v3
    v_xor_b32 v5, v5, v4
    v_lshl_or_b32 v5, v5, 1, v4
    v_xor_b32 v5, v5, v2
    v_lshlrev_b32 v5, 4, v5
    v_lshl_add_u32 v5, v1, 6, v5
    s_lshr_b32 s25, s3, 1
    s_mul_i32 s25, s25, 8192
    s_add_u32 s25, s25, 16384
    v_add_u32 v16, s25, v5
    v_lshrrev_b32 v3, 5, v0
    v_and_b32 v4, 31, v0
    v_lshlrev_b32 v5, 3, v3
    v_add_u32 v5, s3, v5
    v_lshlrev_b32 v6, 2, v3
    v_or_b32 v6, s3, v6
    v_lshrrev_b32 v1, 1, v4
    v_xor_b32 v1, v1, v6
    v_lshlrev_b32 v1, 5, v1
    v_and_b32 v4, 1, v4
    v_lshl_or_b32 v1, v4, 4, v1
    s_mov_b32 s25, 8192
    v_mul_lo_u32 v5, v5, s25
    v_add_u32 v17, v5, v1
    v_add_u32 v18, 32768, v17
    v_add_u32 v19, 131072, v17
    v_add_u32 v20, 163840, v17
    v_lshlrev_b32 v3, 4, v0
    s_mul_i32 s25, s3, 4096
    v_add_u32 v21, s25, v3
    v_add_u32 v22, 1024, v21
    v_add_u32 v23, 2048, v21
    v_add_u32 v24, 3072, v21
    s_add_u32 s23, s23, 16384
    s_mov_b32 s33, 0
    s_mov_b32 s32, 0
    s_add_u32 s34, s22, s33
    s_add_u32 s35, s23, s33
    s_add_u32 m0, s34, 0
    s_nop 0
    buffer_load_dwordx4 v17, s[8:11], s20 offen lds
    s_add_u32 m0, s34, 1024
    s_nop 0
    buffer_load_dwordx4 v18, s[8:11], s20 offen lds
    s_add_u32 m0, s34, 2048
    s_nop 0
    buffer_load_dwordx4 v19, s[8:11], s20 offen lds
    s_add_u32 m0, s34, 3072
    s_nop 0
    buffer_load_dwordx4 v20, s[8:11], s20 offen lds
    s_add_u32 m0, s35, 0
    s_nop 0
    buffer_load_dwordx4 v21, s[12:15], s21 offen lds
    s_add_u32 m0, s35, 1024
    s_nop 0
    buffer_load_dwordx4 v22, s[12:15], s21 offen lds
    s_add_u32 m0, s35, 2048
    s_nop 0
    buffer_load_dwordx4 v23, s[12:15], s21 offen lds
    s_add_u32 m0, s35, 3072
    s_nop 0
    buffer_load_dwordx4 v24, s[12:15], s21 offen lds
    s_add_u32 s20, s20, 262144
    s_add_u32 s21, s21, 131072
    s_add_u32 s33, s33, 32768
    s_cmp_eq_u32 s33, 131072
    s_cselect_b32 s33, 0, s33
    s_add_u32 s34, s22, s33
    s_add_u32 s35, s23, s33
    s_add_u32 m0, s34, 0
    s_nop 0
    buffer_load_dwordx4 v17, s[8:11], s20 offen lds
    s_add_u32 m0, s34, 1024
    s_nop 0
    buffer_load_dwordx4 v18, s[8:11], s20 offen lds
    s_add_u32 m0, s34, 2048
    s_nop 0
    buffer_load_dwordx4 v19, s[8:11], s20 offen lds
    s_add_u32 m0, s34, 3072
    s_nop 0
    buffer_load_dwordx4 v20, s[8:11], s20 offen lds
    s_add_u32 m0, s35, 0
    s_nop 0
    buffer_load_dwordx4 v21, s[12:15], s21 offen lds
    s_add_u32 m0, s35, 1024
    s_nop 0
    buffer_load_dwordx4 v22, s[12:15], s21 offen lds
    s_add_u32 m0, s35, 2048
    s_nop 0
    buffer_load_dwordx4 v23, s[12:15], s21 offen lds
    s_add_u32 m0, s35, 3072
    s_nop 0
    buffer_load_dwordx4 v24, s[12:15], s21 offen lds
    s_add_u32 s20, s20, 262144
    s_add_u32 s21, s21, 131072
    s_add_u32 s33, s33, 32768
    s_cmp_eq_u32 s33, 131072
    s_cselect_b32 s33, 0, s33
    s_add_u32 s34, s22, s33
    s_add_u32 s35, s23, s33
    s_add_u32 m0, s34, 0
    s_nop 0
    buffer_load_dwordx4 v17, s[8:11], s20 offen lds
    s_add_u32 m0, s34, 1024
    s_nop 0
    buffer_load_dwordx4 v18, s[8:11], s20 offen lds
    s_add_u32 m0, s34, 2048
    s_nop 0
    buffer_load_dwordx4 v19, s[8:11], s20 offen lds
    s_add_u32 m0, s34, 3072
    s_nop 0
    buffer_load_dwordx4 v20, s[8:11], s20 offen lds
    s_add_u32 m0, s35, 0
    s_nop 0
    buffer_load_dwordx4 v21, s[12:15], s21 offen lds
    s_add_u32 m0, s35, 1024
    s_nop 0
    buffer_load_dwordx4 v22, s[12:15], s21 offen lds
    s_add_u32 m0, s35, 2048
    s_nop 0
    buffer_load_dwordx4 v23, s[12:15], s21 offen lds
    s_add_u32 m0, s35, 3072
    s_nop 0
    buffer_load_dwordx4 v24, s[12:15], s21 offen lds
    s_add_u32 s20, s20, 262144
    s_add_u32 s21, s21, 131072
    s_add_u32 s33, s33, 32768
    s_cmp_eq_u32 s33, 131072
    s_cselect_b32 s33, 0, s33
    s_add_u32 s34, s22, s33
    s_add_u32 s35, s23, s33
    s_add_u32 m0, s34, 0
    s_nop 0
    buffer_load_dwordx4 v17, s[8:11], s20 offen lds
    s_add_u32 m0, s34, 1024
    s_nop 0
    buffer_load_dwordx4 v18, s[8:11], s20 offen lds
    s_add_u32 m0, s34, 2048
    s_nop 0
    buffer_load_dwordx4 v19, s[8:11], s20 offen lds
    s_add_u32 m0, s34, 3072
    s_nop 0
    buffer_load_dwordx4 v20, s[8:11], s20 offen lds
    s_add_u32 m0, s35, 0
    s_nop 0
    buffer_load_dwordx4 v21, s[12:15], s21 offen lds
    s_add_u32 m0, s35, 1024
    s_nop 0
    buffer_load_dwordx4 v22, s[12:15], s21 offen lds
    s_add_u32 m0, s35, 2048
    s_nop 0
    buffer_load_dwordx4 v23, s[12:15], s21 offen lds
    s_add_u32 m0, s35, 3072
    s_nop 0
    buffer_load_dwordx4 v24, s[12:15], s21 offen lds
    s_add_u32 s20, s20, 262144
    s_add_u32 s21, s21, 131072
    s_add_u32 s33, s33, 32768
    s_cmp_eq_u32 s33, 131072
    s_cselect_b32 s33, 0, s33
    v_add_u32 v156, s32, v8
    v_add_u32 v157, s32, v9
    v_add_u32 v158, s32, v10
    v_add_u32 v159, s32, v11
    v_add_u32 v160, s32, v12
    v_add_u32 v161, s32, v13
    v_add_u32 v162, s32, v14
    v_add_u32 v163, s32, v15
    v_add_u32 v164, s32, v16
    s_waitcnt vmcnt(24)
    s_barrier
    ds_read_b128 v[60:63], v164 offset:0
    ds_read_b64_tr_b16 v[28:29], v156
    ds_read_b64_tr_b16 v[30:31], v156 offset:1024
    ds_read_b128 v[64:67], v164 offset:1024
    ds_read_b64_tr_b16 v[32:33], v157
    ds_read_b64_tr_b16 v[34:35], v157 offset:1024
    ds_read_b128 v[68:71], v164 offset:2048
    ds_read_b64_tr_b16 v[36:37], v158
    ds_read_b64_tr_b16 v[38:39], v158 offset:1024
    ds_read_b128 v[72:75], v164 offset:3072
    ds_read_b64_tr_b16 v[40:41], v159
    ds_read_b64_tr_b16 v[42:43], v159 offset:1024
    ds_read_b128 v[76:79], v164 offset:4096
    ds_read_b64_tr_b16 v[44:45], v160
    ds_read_b64_tr_b16 v[46:47], v160 offset:1024
    ds_read_b128 v[80:83], v164 offset:5120
    ds_read_b64_tr_b16 v[48:49], v161
    ds_read_b64_tr_b16 v[50:51], v161 offset:1024
    ds_read_b128 v[84:87], v164 offset:6144
    ds_read_b64_tr_b16 v[52:53], v162
    ds_read_b64_tr_b16 v[54:55], v162 offset:1024
    ds_read_b128 v[88:91], v164 offset:7168
    ds_read_b64_tr_b16 v[56:57], v163
    ds_read_b64_tr_b16 v[58:59], v163 offset:1024
    s_add_u32 s32, s32, 32768
    s_cmp_eq_u32 s32, 131072
    s_cselect_b32 s32, 0, s32
    v_add_u32 v156, s32, v8
    v_add_u32 v157, s32, v9
    v_add_u32 v158, s32, v10
    v_add_u32 v159, s32, v11
    v_add_u32 v160, s32, v12
    v_add_u32 v161, s32, v13
    v_add_u32 v162, s32, v14
    v_add_u32 v163, s32, v15
    v_add_u32 v164, s32, v16
    s_add_u32 s34, s22, s33
    s_add_u32 s35, s23, s33
    s_waitcnt vmcnt(16) lgkmcnt(0)
    s_barrier
    v_mfma_f32_16x16x32_bf16 a[0:3], v[60:63], v[28:31], 0
    v_mfma_f32_16x16x32_bf16 a[32:35], v[60:63], v[32:35], 0
    ds_read_b128 v[124:127], v164 offset:0
    s_add_u32 m0, s34, 0
    v_mfma_f32_16x16x32_bf16 a[64:67], v[60:63], v[36:39], 0
    buffer_load_dwordx4 v17, s[8:11], s20 offen lds
    v_mfma_f32_16x16x32_bf16 a[96:99], v[60:63], v[40:43], 0
    ds_read_b64_tr_b16 v[92:93], v156
    v_mfma_f32_16x16x32_bf16 a[128:131], v[60:63], v[44:47], 0
    v_mfma_f32_16x16x32_bf16 a[160:163], v[60:63], v[48:51], 0
    ds_read_b64_tr_b16 v[94:95], v156 offset:1024
    v_mfma_f32_16x16x32_bf16 a[192:195], v[60:63], v[52:55], 0
    v_mfma_f32_16x16x32_bf16 a[224:227], v[60:63], v[56:59], 0
    ds_read_b128 v[128:131], v164 offset:1024
    v_mfma_f32_16x16x32_bf16 a[4:7], v[64:67], v[28:31], 0
    v_mfma_f32_16x16x32_bf16 a[36:39], v[64:67], v[32:35], 0
    ds_read_b64_tr_b16 v[96:97], v157
    s_add_u32 m0, s34, 1024
    v_mfma_f32_16x16x32_bf16 a[68:71], v[64:67], v[36:39], 0
    buffer_load_dwordx4 v18, s[8:11], s20 offen lds
    v_mfma_f32_16x16x32_bf16 a[100:103], v[64:67], v[40:43], 0
    ds_read_b64_tr_b16 v[98:99], v157 offset:1024
    v_mfma_f32_16x16x32_bf16 a[132:135], v[64:67], v[44:47], 0
    v_mfma_f32_16x16x32_bf16 a[164:167], v[64:67], v[48:51], 0
    ds_read_b128 v[132:135], v164 offset:2048
    v_mfma_f32_16x16x32_bf16 a[196:199], v[64:67], v[52:55], 0
    v_mfma_f32_16x16x32_bf16 a[228:231], v[64:67], v[56:59], 0
    ds_read_b64_tr_b16 v[100:101], v158
    v_mfma_f32_16x16x32_bf16 a[8:11], v[68:71], v[28:31], 0
    v_mfma_f32_16x16x32_bf16 a[40:43], v[68:71], v[32:35], 0
    ds_read_b64_tr_b16 v[102:103], v158 offset:1024
    s_add_u32 m0, s34, 2048
    v_mfma_f32_16x16x32_bf16 a[72:75], v[68:71], v[36:39], 0
    buffer_load_dwordx4 v19, s[8:11], s20 offen lds
    v_mfma_f32_16x16x32_bf16 a[104:107], v[68:71], v[40:43], 0
    ds_read_b128 v[136:139], v164 offset:3072
    v_mfma_f32_16x16x32_bf16 a[136:139], v[68:71], v[44:47], 0
    v_mfma_f32_16x16x32_bf16 a[168:171], v[68:71], v[48:51], 0
    ds_read_b64_tr_b16 v[104:105], v159
    v_mfma_f32_16x16x32_bf16 a[200:203], v[68:71], v[52:55], 0
    v_mfma_f32_16x16x32_bf16 a[232:235], v[68:71], v[56:59], 0
    ds_read_b64_tr_b16 v[106:107], v159 offset:1024
    v_mfma_f32_16x16x32_bf16 a[12:15], v[72:75], v[28:31], 0
    v_mfma_f32_16x16x32_bf16 a[44:47], v[72:75], v[32:35], 0
    ds_read_b128 v[140:143], v164 offset:4096
    s_add_u32 m0, s34, 3072
    v_mfma_f32_16x16x32_bf16 a[76:79], v[72:75], v[36:39], 0
    buffer_load_dwordx4 v20, s[8:11], s20 offen lds
    v_mfma_f32_16x16x32_bf16 a[108:111], v[72:75], v[40:43], 0
    ds_read_b64_tr_b16 v[108:109], v160
    v_mfma_f32_16x16x32_bf16 a[140:143], v[72:75], v[44:47], 0
    v_mfma_f32_16x16x32_bf16 a[172:175], v[72:75], v[48:51], 0
    ds_read_b64_tr_b16 v[110:111], v160 offset:1024
    v_mfma_f32_16x16x32_bf16 a[204:207], v[72:75], v[52:55], 0
    v_mfma_f32_16x16x32_bf16 a[236:239], v[72:75], v[56:59], 0
    ds_read_b128 v[144:147], v164 offset:5120
    v_mfma_f32_16x16x32_bf16 a[16:19], v[76:79], v[28:31], 0
    v_mfma_f32_16x16x32_bf16 a[48:51], v[76:79], v[32:35], 0
    ds_read_b64_tr_b16 v[112:113], v161
    s_add_u32 m0, s35, 0
    v_mfma_f32_16x16x32_bf16 a[80:83], v[76:79], v[36:39], 0
    buffer_load_dwordx4 v21, s[12:15], s21 offen lds
    v_mfma_f32_16x16x32_bf16 a[112:115], v[76:79], v[40:43], 0
    ds_read_b64_tr_b16 v[114:115], v161 offset:1024
    v_mfma_f32_16x16x32_bf16 a[144:147], v[76:79], v[44:47], 0
    v_mfma_f32_16x16x32_bf16 a[176:179], v[76:79], v[48:51], 0
    ds_read_b128 v[148:151], v164 offset:6144
    v_mfma_f32_16x16x32_bf16 a[208:211], v[76:79], v[52:55], 0
    v_mfma_f32_16x16x32_bf16 a[240:243], v[76:79], v[56:59], 0
    ds_read_b64_tr_b16 v[116:117], v162
    v_mfma_f32_16x16x32_bf16 a[20:23], v[80:83], v[28:31], 0
    v_mfma_f32_16x16x32_bf16 a[52:55], v[80:83], v[32:35], 0
    ds_read_b64_tr_b16 v[118:119], v162 offset:1024
    s_add_u32 m0, s35, 1024
    v_mfma_f32_16x16x32_bf16 a[84:87], v[80:83], v[36:39], 0
    buffer_load_dwordx4 v22, s[12:15], s21 offen lds
    v_mfma_f32_16x16x32_bf16 a[116:119], v[80:83], v[40:43], 0
    ds_read_b128 v[152:155], v164 offset:7168
    v_mfma_f32_16x16x32_bf16 a[148:151], v[80:83], v[44:47], 0
    v_mfma_f32_16x16x32_bf16 a[180:183], v[80:83], v[48:51], 0
    ds_read_b64_tr_b16 v[120:121], v163
    v_mfma_f32_16x16x32_bf16 a[212:215], v[80:83], v[52:55], 0
    v_mfma_f32_16x16x32_bf16 a[244:247], v[80:83], v[56:59], 0
    ds_read_b64_tr_b16 v[122:123], v163 offset:1024
    v_mfma_f32_16x16x32_bf16 a[24:27], v[84:87], v[28:31], 0
    s_add_u32 s32, s32, 32768
    s_cmp_eq_u32 s32, 131072
    s_cselect_b32 s32, 0, s32
    v_mfma_f32_16x16x32_bf16 a[56:59], v[84:87], v[32:35], 0
    v_add_u32 v156, s32, v8
    s_add_u32 m0, s35, 2048
    v_mfma_f32_16x16x32_bf16 a[88:91], v[84:87], v[36:39], 0
    buffer_load_dwordx4 v23, s[12:15], s21 offen lds
    v_add_u32 v157, s32, v9
    v_mfma_f32_16x16x32_bf16 a[120:123], v[84:87], v[40:43], 0
    v_add_u32 v158, s32, v10
    v_mfma_f32_16x16x32_bf16 a[152:155], v[84:87], v[44:47], 0
    v_add_u32 v159, s32, v11
    v_mfma_f32_16x16x32_bf16 a[184:187], v[84:87], v[48:51], 0
    v_add_u32 v160, s32, v12
    v_mfma_f32_16x16x32_bf16 a[216:219], v[84:87], v[52:55], 0
    v_add_u32 v161, s32, v13
    v_mfma_f32_16x16x32_bf16 a[248:251], v[84:87], v[56:59], 0
    v_add_u32 v162, s32, v14
    v_mfma_f32_16x16x32_bf16 a[28:31], v[88:91], v[28:31], 0
    v_add_u32 v163, s32, v15
    v_mfma_f32_16x16x32_bf16 a[60:63], v[88:91], v[32:35], 0
    v_add_u32 v164, s32, v16
    s_add_u32 m0, s35, 3072
    v_mfma_f32_16x16x32_bf16 a[92:95], v[88:91], v[36:39], 0
    buffer_load_dwordx4 v24, s[12:15], s21 offen lds
    v_mfma_f32_16x16x32_bf16 a[124:127], v[88:91], v[40:43], 0
    s_add_u32 s20, s20, 262144
    s_add_u32 s21, s21, 131072
    v_mfma_f32_16x16x32_bf16 a[156:159], v[88:91], v[44:47], 0
    s_add_u32 s33, s33, 32768
    s_cmp_eq_u32 s33, 131072
    s_cselect_b32 s33, 0, s33
    v_mfma_f32_16x16x32_bf16 a[188:191], v[88:91], v[48:51], 0
    s_add_u32 s34, s22, s33
    s_add_u32 s35, s23, s33
    v_mfma_f32_16x16x32_bf16 a[220:223], v[88:91], v[52:55], 0
    v_mfma_f32_16x16x32_bf16 a[252:255], v[88:91], v[56:59], 0
    s_waitcnt vmcnt(16) lgkmcnt(0)
    s_barrier
    v_mfma_f32_16x16x32_bf16 a[0:3], v[124:127], v[92:95], a[0:3]
    v_mfma_f32_16x16x32_bf16 a[32:35], v[124:127], v[96:99], a[32:35]
    ds_read_b128 v[60:63], v164 offset:0
    s_add_u32 m0, s34, 0
    v_mfma_f32_16x16x32_bf16 a[64:67], v[124:127], v[100:103], a[64:67]
    buffer_load_dwordx4 v17, s[8:11], s20 offen lds
    v_mfma_f32_16x16x32_bf16 a[96:99], v[124:127], v[104:107], a[96:99]
    ds_read_b64_tr_b16 v[28:29], v156
    v_mfma_f32_16x16x32_bf16 a[128:131], v[124:127], v[108:111], a[128:131]
    v_mfma_f32_16x16x32_bf16 a[160:163], v[124:127], v[112:115], a[160:163]
    ds_read_b64_tr_b16 v[30:31], v156 offset:1024
    v_mfma_f32_16x16x32_bf16 a[192:195], v[124:127], v[116:119], a[192:195]
    v_mfma_f32_16x16x32_bf16 a[224:227], v[124:127], v[120:123], a[224:227]
    ds_read_b128 v[64:67], v164 offset:1024
    v_mfma_f32_16x16x32_bf16 a[4:7], v[128:131], v[92:95], a[4:7]
    v_mfma_f32_16x16x32_bf16 a[36:39], v[128:131], v[96:99], a[36:39]
    ds_read_b64_tr_b16 v[32:33], v157
    s_add_u32 m0, s34, 1024
    v_mfma_f32_16x16x32_bf16 a[68:71], v[128:131], v[100:103], a[68:71]
    buffer_load_dwordx4 v18, s[8:11], s20 offen lds
    v_mfma_f32_16x16x32_bf16 a[100:103], v[128:131], v[104:107], a[100:103]
    ds_read_b64_tr_b16 v[34:35], v157 offset:1024
    v_mfma_f32_16x16x32_bf16 a[132:135], v[128:131], v[108:111], a[132:135]
    v_mfma_f32_16x16x32_bf16 a[164:167], v[128:131], v[112:115], a[164:167]
    ds_read_b128 v[68:71], v164 offset:2048
    v_mfma_f32_16x16x32_bf16 a[196:199], v[128:131], v[116:119], a[196:199]
    v_mfma_f32_16x16x32_bf16 a[228:231], v[128:131], v[120:123], a[228:231]
    ds_read_b64_tr_b16 v[36:37], v158
    v_mfma_f32_16x16x32_bf16 a[8:11], v[132:135], v[92:95], a[8:11]
    v_mfma_f32_16x16x32_bf16 a[40:43], v[132:135], v[96:99], a[40:43]
    ds_read_b64_tr_b16 v[38:39], v158 offset:1024
    s_add_u32 m0, s34, 2048
    v_mfma_f32_16x16x32_bf16 a[72:75], v[132:135], v[100:103], a[72:75]
    buffer_load_dwordx4 v19, s[8:11], s20 offen lds
    v_mfma_f32_16x16x32_bf16 a[104:107], v[132:135], v[104:107], a[104:107]
    ds_read_b128 v[72:75], v164 offset:3072
    v_mfma_f32_16x16x32_bf16 a[136:139], v[132:135], v[108:111], a[136:139]
    v_mfma_f32_16x16x32_bf16 a[168:171], v[132:135], v[112:115], a[168:171]
    ds_read_b64_tr_b16 v[40:41], v159
    v_mfma_f32_16x16x32_bf16 a[200:203], v[132:135], v[116:119], a[200:203]
    v_mfma_f32_16x16x32_bf16 a[232:235], v[132:135], v[120:123], a[232:235]
    ds_read_b64_tr_b16 v[42:43], v159 offset:1024
    v_mfma_f32_16x16x32_bf16 a[12:15], v[136:139], v[92:95], a[12:15]
    v_mfma_f32_16x16x32_bf16 a[44:47], v[136:139], v[96:99], a[44:47]
    ds_read_b128 v[76:79], v164 offset:4096
    s_add_u32 m0, s34, 3072
    v_mfma_f32_16x16x32_bf16 a[76:79], v[136:139], v[100:103], a[76:79]
    buffer_load_dwordx4 v20, s[8:11], s20 offen lds
    v_mfma_f32_16x16x32_bf16 a[108:111], v[136:139], v[104:107], a[108:111]
    ds_read_b64_tr_b16 v[44:45], v160
    v_mfma_f32_16x16x32_bf16 a[140:143], v[136:139], v[108:111], a[140:143]
    v_mfma_f32_16x16x32_bf16 a[172:175], v[136:139], v[112:115], a[172:175]
    ds_read_b64_tr_b16 v[46:47], v160 offset:1024
    v_mfma_f32_16x16x32_bf16 a[204:207], v[136:139], v[116:119], a[204:207]
    v_mfma_f32_16x16x32_bf16 a[236:239], v[136:139], v[120:123], a[236:239]
    ds_read_b128 v[80:83], v164 offset:5120
    v_mfma_f32_16x16x32_bf16 a[16:19], v[140:143], v[92:95], a[16:19]
    v_mfma_f32_16x16x32_bf16 a[48:51], v[140:143], v[96:99], a[48:51]
    ds_read_b64_tr_b16 v[48:49], v161
    s_add_u32 m0, s35, 0
    v_mfma_f32_16x16x32_bf16 a[80:83], v[140:143], v[100:103], a[80:83]
    buffer_load_dwordx4 v21, s[12:15], s21 offen lds
    v_mfma_f32_16x16x32_bf16 a[112:115], v[140:143], v[104:107], a[112:115]
    ds_read_b64_tr_b16 v[50:51], v161 offset:1024
    v_mfma_f32_16x16x32_bf16 a[144:147], v[140:143], v[108:111], a[144:147]
    v_mfma_f32_16x16x32_bf16 a[176:179], v[140:143], v[112:115], a[176:179]
    ds_read_b128 v[84:87], v164 offset:6144
    v_mfma_f32_16x16x32_bf16 a[208:211], v[140:143], v[116:119], a[208:211]
    v_mfma_f32_16x16x32_bf16 a[240:243], v[140:143], v[120:123], a[240:243]
    ds_read_b64_tr_b16 v[52:53], v162
    v_mfma_f32_16x16x32_bf16 a[20:23], v[144:147], v[92:95], a[20:23]
    v_mfma_f32_16x16x32_bf16 a[52:55], v[144:147], v[96:99], a[52:55]
    ds_read_b64_tr_b16 v[54:55], v162 offset:1024
    s_add_u32 m0, s35, 1024
    v_mfma_f32_16x16x32_bf16 a[84:87], v[144:147], v[100:103], a[84:87]
    buffer_load_dwordx4 v22, s[12:15], s21 offen lds
    v_mfma_f32_16x16x32_bf16 a[116:119], v[144:147], v[104:107], a[116:119]
    ds_read_b128 v[88:91], v164 offset:7168
    v_mfma_f32_16x16x32_bf16 a[148:151], v[144:147], v[108:111], a[148:151]
    v_mfma_f32_16x16x32_bf16 a[180:183], v[144:147], v[112:115], a[180:183]
    ds_read_b64_tr_b16 v[56:57], v163
    v_mfma_f32_16x16x32_bf16 a[212:215], v[144:147], v[116:119], a[212:215]
    v_mfma_f32_16x16x32_bf16 a[244:247], v[144:147], v[120:123], a[244:247]
    ds_read_b64_tr_b16 v[58:59], v163 offset:1024
    v_mfma_f32_16x16x32_bf16 a[24:27], v[148:151], v[92:95], a[24:27]
    s_add_u32 s32, s32, 32768
    s_cmp_eq_u32 s32, 131072
    s_cselect_b32 s32, 0, s32
    v_mfma_f32_16x16x32_bf16 a[56:59], v[148:151], v[96:99], a[56:59]
    v_add_u32 v156, s32, v8
    s_add_u32 m0, s35, 2048
    v_mfma_f32_16x16x32_bf16 a[88:91], v[148:151], v[100:103], a[88:91]
    buffer_load_dwordx4 v23, s[12:15], s21 offen lds
    v_add_u32 v157, s32, v9
    v_mfma_f32_16x16x32_bf16 a[120:123], v[148:151], v[104:107], a[120:123]
    v_add_u32 v158, s32, v10
    v_mfma_f32_16x16x32_bf16 a[152:155], v[148:151], v[108:111], a[152:155]
    v_add_u32 v159, s32, v11
    v_mfma_f32_16x16x32_bf16 a[184:187], v[148:151], v[112:115], a[184:187]
    v_add_u32 v160, s32, v12
    v_mfma_f32_16x16x32_bf16 a[216:219], v[148:151], v[116:119], a[216:219]
    v_add_u32 v161, s32, v13
    v_mfma_f32_16x16x32_bf16 a[248:251], v[148:151], v[120:123], a[248:251]
    v_add_u32 v162, s32, v14
    v_mfma_f32_16x16x32_bf16 a[28:31], v[152:155], v[92:95], a[28:31]
    v_add_u32 v163, s32, v15
    v_mfma_f32_16x16x32_bf16 a[60:63], v[152:155], v[96:99], a[60:63]
    v_add_u32 v164, s32, v16
    s_add_u32 m0, s35, 3072
    v_mfma_f32_16x16x32_bf16 a[92:95], v[152:155], v[100:103], a[92:95]
    buffer_load_dwordx4 v24, s[12:15], s21 offen lds
    v_mfma_f32_16x16x32_bf16 a[124:127], v[152:155], v[104:107], a[124:127]
    s_add_u32 s20, s20, 262144
    s_add_u32 s21, s21, 131072
    v_mfma_f32_16x16x32_bf16 a[156:159], v[152:155], v[108:111], a[156:159]
    s_add_u32 s33, s33, 32768
    s_cmp_eq_u32 s33, 131072
    s_cselect_b32 s33, 0, s33
    v_mfma_f32_16x16x32_bf16 a[188:191], v[152:155], v[112:115], a[188:191]
    s_add_u32 s34, s22, s33
    s_add_u32 s35, s23, s33
    v_mfma_f32_16x16x32_bf16 a[220:223], v[152:155], v[116:119], a[220:223]
    v_mfma_f32_16x16x32_bf16 a[252:255], v[152:155], v[120:123], a[252:255]
    s_waitcnt vmcnt(16) lgkmcnt(0)
    s_barrier
    s_mov_b32 s24, 15
B_L_gB_loop:
    v_mfma_f32_16x16x32_bf16 a[0:3], v[60:63], v[28:31], a[0:3]
    v_mfma_f32_16x16x32_bf16 a[32:35], v[60:63], v[32:35], a[32:35]
    ds_read_b128 v[124:127], v164 offset:0
    s_add_u32 m0, s34, 0
    v_mfma_f32_16x16x32_bf16 a[64:67], v[60:63], v[36:39], a[64:67]
    buffer_load_dwordx4 v17, s[8:11], s20 offen lds
    v_mfma_f32_16x16x32_bf16 a[96:99], v[60:63], v[40:43], a[96:99]
    ds_read_b64_tr_b16 v[92:93], v156
    v_mfma_f32_16x16x32_bf16 a[128:131], v[60:63], v[44:47], a[128:131]
    v_mfma_f32_16x16x32_bf16 a[160:163], v[60:63], v[48:51], a[160:163]
    ds_read_b64_tr_b16 v[94:95], v156 offset:1024
    v_mfma_f32_16x16x32_bf16 a[192:195], v[60:63], v[52:55], a[192:195]
    v_mfma_f32_16x16x32_bf16 a[224:227], v[60:63], v[56:59], a[224:227]
    ds_read_b128 v[128:131], v164 offset:1024
    v_mfma_f32_16x16x32_bf16 a[4:7], v[64:67], v[28:31], a[4:7]
    v_mfma_f32_16x16x32_bf16 a[36:39], v[64:67], v[32:35], a[36:39]
    ds_read_b64_tr_b16 v[96:97], v157
    s_add_u32 m0, s34, 1024
    v_mfma_f32_16x16x32_bf16 a[68:71], v[64:67], v[36:39], a[68:71]
    buffer_load_dwordx4 v18, s[8:11], s20 offen lds
    v_mfma_f32_16x16x32_bf16 a[100:103], v[64:67], v[40:43], a[100:103]
    ds_read_b64_tr_b16 v[98:99], v157 offset:1024
    v_mfma_f32_16x16x32_bf16 a[132:135], v[64:67], v[44:47], a[132:135]
    v_mfma_f32_16x16x32_bf16 a[164:167], v[64:67], v[48:51], a[164:167]
    ds_read_b128 v[132:135], v164 offset:2048
    v_mfma_f32_16x16x32_bf16 a[196:199], v[64:67], v[52:55], a[196:199]
    v_mfma_f32_16x16x32_bf16 a[228:231], v[64:67], v[56:59], a[228:231]
    ds_read_b64_tr_b16 v[100:101], v158
    v_mfma_f32_16x16x32_bf16 a[8:11], v[68:71], v[28:31], a[8:11]
    v_mfma_f32_16x16x32_bf16 a[40:43], v[68:71], v[32:35], a[40:43]
    ds_read_b64_tr_b16 v[102:103], v158 offset:1024
    s_add_u32 m0, s34, 2048
    v_mfma_f32_16x16x32_bf16 a[72:75], v[68:71], v[36:39], a[72:75]
    buffer_load_dwordx4 v19, s[8:11], s20 offen lds
    v_mfma_f32_16x16x32_bf16 a[104:107], v[68:71], v[40:43], a[104:107]
    ds_read_b128 v[136:139], v164 offset:3072
    v_mfma_f32_16x16x32_bf16 a[136:139], v[68:71], v[44:47], a[136:139]
    v_mfma_f32_16x16x32_bf16 a[168:171], v[68:71], v[48:51], a[168:171]
    ds_read_b64_tr_b16 v[104:105], v159
    v_mfma_f32_16x16x32_bf16 a[200:203], v[68:71], v[52:55], a[200:203]
    v_mfma_f32_16x16x32_bf16 a[232:235], v[68:71], v[56:59], a[232:235]
    ds_read_b64_tr_b16 v[106:107], v159 offset:1024
    v_mfma_f32_16x16x32_bf16 a[12:15], v[72:75], v[28:31], a[12:15]
    v_mfma_f32_16x16x32_bf16 a[44:47], v[72:75], v[32:35], a[44:47]
    ds_read_b128 v[140:143], v164 offset:4096
    s_add_u32 m0, s34, 3072
    v_mfma_f32_16x16x32_bf16 a[76:79], v[72:75], v[36:39], a[76:79]
    buffer_load_dwordx4 v20, s[8:11], s20 offen lds
    v_mfma_f32_16x16x32_bf16 a[108:111], v[72:75], v[40:43], a[108:111]
    ds_read_b64_tr_b16 v[108:109], v160
    v_mfma_f32_16x16x32_bf16 a[140:143], v[72:75], v[44:47], a[140:143]
    v_mfma_f32_16x16x32_bf16 a[172:175], v[72:75], v[48:51], a[172:175]
    ds_read_b64_tr_b16 v[110:111], v160 offset:1024
    v_mfma_f32_16x16x32_bf16 a[204:207], v[72:75], v[52:55], a[204:207]
    v_mfma_f32_16x16x32_bf16 a[236:239], v[72:75], v[56:59], a[236:239]
    ds_read_b128 v[144:147], v164 offset:5120
    v_mfma_f32_16x16x32_bf16 a[16:19], v[76:79], v[28:31], a[16:19]
    v_mfma_f32_16x16x32_bf16 a[48:51], v[76:79], v[32:35], a[48:51]
    ds_read_b64_tr_b16 v[112:113], v161
    s_add_u32 m0, s35, 0
    v_mfma_f32_16x16x32_bf16 a[80:83], v[76:79], v[36:39], a[80:83]
    buffer_load_dwordx4 v21, s[12:15], s21 offen lds
    v_mfma_f32_16x16x32_bf16 a[112:115], v[76:79], v[40:43], a[112:115]
    ds_read_b64_tr_b16 v[114:115], v161 offset:1024
    v_mfma_f32_16x16x32_bf16 a[144:147], v[76:79], v[44:47], a[144:147]
    v_mfma_f32_16x16x32_bf16 a[176:179], v[76:79], v[48:51], a[176:179]
    ds_read_b128 v[148:151], v164 offset:6144
    v_mfma_f32_16x16x32_bf16 a[208:211], v[76:79], v[52:55], a[208:211]
    v_mfma_f32_16x16x32_bf16 a[240:243], v[76:79], v[56:59], a[240:243]
    ds_read_b64_tr_b16 v[116:117], v162
    v_mfma_f32_16x16x32_bf16 a[20:23], v[80:83], v[28:31], a[20:23]
    v_mfma_f32_16x16x32_bf16 a[52:55], v[80:83], v[32:35], a[52:55]
    ds_read_b64_tr_b16 v[118:119], v162 offset:1024
    s_add_u32 m0, s35, 1024
    v_mfma_f32_16x16x32_bf16 a[84:87], v[80:83], v[36:39], a[84:87]
    buffer_load_dwordx4 v22, s[12:15], s21 offen lds
    v_mfma_f32_16x16x32_bf16 a[116:119], v[80:83], v[40:43], a[116:119]
    ds_read_b128 v[152:155], v164 offset:7168
    v_mfma_f32_16x16x32_bf16 a[148:151], v[80:83], v[44:47], a[148:151]
    v_mfma_f32_16x16x32_bf16 a[180:183], v[80:83], v[48:51], a[180:183]
    ds_read_b64_tr_b16 v[120:121], v163
    v_mfma_f32_16x16x32_bf16 a[212:215], v[80:83], v[52:55], a[212:215]
    v_mfma_f32_16x16x32_bf16 a[244:247], v[80:83], v[56:59], a[244:247]
    ds_read_b64_tr_b16 v[122:123], v163 offset:1024
    v_mfma_f32_16x16x32_bf16 a[24:27], v[84:87], v[28:31], a[24:27]
    s_add_u32 s32, s32, 32768
    s_cmp_eq_u32 s32, 131072
    s_cselect_b32 s32, 0, s32
    v_mfma_f32_16x16x32_bf16 a[56:59], v[84:87], v[32:35], a[56:59]
    v_add_u32 v156, s32, v8
    s_add_u32 m0, s35, 2048
    v_mfma_f32_16x16x32_bf16 a[88:91], v[84:87], v[36:39], a[88:91]
    buffer_load_dwordx4 v23, s[12:15], s21 offen lds
    v_add_u32 v157, s32, v9
    v_mfma_f32_16x16x32_bf16 a[120:123], v[84:87], v[40:43], a[120:123]
    v_add_u32 v158, s32, v10
    v_mfma_f32_16x16x32_bf16 a[152:155], v[84:87], v[44:47], a[152:155]
    v_add_u32 v159, s32, v11
    v_mfma_f32_16x16x32_bf16 a[184:187], v[84:87], v[48:51], a[184:187]
    v_add_u32 v160, s32, v12
    v_mfma_f32_16x16x32_bf16 a[216:219], v[84:87], v[52:55], a[216:219]
    v_add_u32 v161, s32, v13
    v_mfma_f32_16x16x32_bf16 a[248:251], v[84:87], v[56:59], a[248:251]
    v_add_u32 v162, s32, v14
    v_mfma_f32_16x16x32_bf16 a[28:31], v[88:91], v[28:31], a[28:31]
    v_add_u32 v163, s32, v15
    v_mfma_f32_16x16x32_bf16 a[60:63], v[88:91], v[32:35], a[60:63]
    v_add_u32 v164, s32, v16
    s_add_u32 m0, s35, 3072
    v_mfma_f32_16x16x32_bf16 a[92:95], v[88:91], v[36:39], a[92:95]
    buffer_load_dwordx4 v24, s[12:15], s21 offen lds
    v_mfma_f32_16x16x32_bf16 a[124:127], v[88:91], v[40:43], a[124:127]
    s_add_u32 s20, s20, 262144
    s_add_u32 s21, s21, 131072
    v_mfma_f32_16x16x32_bf16 a[156:159], v[88:91], v[44:47], a[156:159]
    s_add_u32 s33, s33, 32768
    s_cmp_eq_u32 s33, 131072
    s_cselect_b32 s33, 0, s33
    v_mfma_f32_16x16x32_bf16 a[188:191], v[88:91], v[48:51], a[188:191]
    s_add_u32 s34, s22, s33
    s_add_u32 s35, s23, s33
    v_mfma_f32_16x16x32_bf16 a[220:223], v[88:91], v[52:55], a[220:223]
    v_mfma_f32_16x16x32_bf16 a[252:255], v[88:91], v[56:59], a[252:255]
    s_waitcnt vmcnt(16) lgkmcnt(0)
    s_barrier
    v_mfma_f32_16x16x32_bf16 a[0:3], v[124:127], v[92:95], a[0:3]
    v_mfma_f32_16x16x32_bf16 a[32:35], v[124:127], v[96:99], a[32:35]
    ds_read_b128 v[60:63], v164 offset:0
    s_add_u32 m0, s34, 0
    v_mfma_f32_16x16x32_bf16 a[64:67], v[124:127], v[100:103], a[64:67]
    buffer_load_dwordx4 v17, s[8:11], s20 offen lds
    v_mfma_f32_16x16x32_bf16 a[96:99], v[124:127], v[104:107], a[96:99]
    ds_read_b64_tr_b16 v[28:29], v156
    v_mfma_f32_16x16x32_bf16 a[128:131], v[124:127], v[108:111], a[128:131]
    v_mfma_f32_16x16x32_bf16 a[160:163], v[124:127], v[112:115], a[160:163]
    ds_read_b64_tr_b16 v[30:31], v156 offset:1024
    v_mfma_f32_16x16x32_bf16 a[192:195], v[124:127], v[116:119], a[192:195]
    v_mfma_f32_16x16x32_bf16 a[224:227], v[124:127], v[120:123], a[224:227]
    ds_read_b128 v[64:67], v164 offset:1024
    v_mfma_f32_16x16x32_bf16 a[4:7], v[128:131], v[92:95], a[4:7]
    v_mfma_f32_16x16x32_bf16 a[36:39], v[128:131], v[96:99], a[36:39]
    ds_read_b64_tr_b16 v[32:33], v157
    s_add_u32 m0, s34, 1024
    v_mfma_f32_16x16x32_bf16 a[68:71], v[128:131], v[100:103], a[68:71]
    buffer_load_dwordx4 v18, s[8:11], s20 offen lds
    v_mfma_f32_16x16x32_bf16 a[100:103], v[128:131], v[104:107], a[100:103]
    ds_read_b64_tr_b16 v[34:35], v157 offset:1024
    v_mfma_f32_16x16x32_bf16 a[132:135], v[128:131], v[108:111], a[132:135]
    v_mfma_f32_16x16x32_bf16 a[164:167], v[128:131], v[112:115], a[164:167]
    ds_read_b128 v[68:71], v164 offset:2048
    v_mfma_f32_16x16x32_bf16 a[196:199], v[128:131], v[116:119], a[196:199]
    v_mfma_f32_16x16x32_bf16 a[228:231], v[128:131], v[120:123], a[228:231]
    ds_read_b64_tr_b16 v[36:37], v158
    v_mfma_f32_16x16x32_bf16 a[8:11], v[132:135], v[92:95], a[8:11]
    v_mfma_f32_16x16x32_bf16 a[40:43], v[132:135], v[96:99], a[40:43]
    ds_read_b64_tr_b16 v[38:39], v158 offset:1024
    s_add_u32 m0, s34, 2048
    v_mfma_f32_16x16x32_bf16 a[72:75], v[132:135], v[100:103], a[72:75]
    buffer_load_dwordx4 v19, s[8:11], s20 offen lds
    v_mfma_f32_16x16x32_bf16 a[104:107], v[132:135], v[104:107], a[104:107]
    ds_read_b128 v[72:75], v164 offset:3072
    v_mfma_f32_16x16x32_bf16 a[136:139], v[132:135], v[108:111], a[136:139]
    v_mfma_f32_16x16x32_bf16 a[168:171], v[132:135], v[112:115], a[168:171]
    ds_read_b64_tr_b16 v[40:41], v159
    v_mfma_f32_16x16x32_bf16 a[200:203], v[132:135], v[116:119], a[200:203]
    v_mfma_f32_16x16x32_bf16 a[232:235], v[132:135], v[120:123], a[232:235]
    ds_read_b64_tr_b16 v[42:43], v159 offset:1024
    v_mfma_f32_16x16x32_bf16 a[12:15], v[136:139], v[92:95], a[12:15]
    v_mfma_f32_16x16x32_bf16 a[44:47], v[136:139], v[96:99], a[44:47]
    ds_read_b128 v[76:79], v164 offset:4096
    s_add_u32 m0, s34, 3072
    v_mfma_f32_16x16x32_bf16 a[76:79], v[136:139], v[100:103], a[76:79]
    buffer_load_dwordx4 v20, s[8:11], s20 offen lds
    v_mfma_f32_16x16x32_bf16 a[108:111], v[136:139], v[104:107], a[108:111]
    ds_read_b64_tr_b16 v[44:45], v160
    v_mfma_f32_16x16x32_bf16 a[140:143], v[136:139], v[108:111], a[140:143]
    v_mfma_f32_16x16x32_bf16 a[172:175], v[136:139], v[112:115], a[172:175]
    ds_read_b64_tr_b16 v[46:47], v160 offset:1024
    v_mfma_f32_16x16x32_bf16 a[204:207], v[136:139], v[116:119], a[204:207]
    v_mfma_f32_16x16x32_bf16 a[236:239], v[136:139], v[120:123], a[236:239]
    ds_read_b128 v[80:83], v164 offset:5120
    v_mfma_f32_16x16x32_bf16 a[16:19], v[140:143], v[92:95], a[16:19]
    v_mfma_f32_16x16x32_bf16 a[48:51], v[140:143], v[96:99], a[48:51]
    ds_read_b64_tr_b16 v[48:49], v161
    s_add_u32 m0, s35, 0
    v_mfma_f32_16x16x32_bf16 a[80:83], v[140:143], v[100:103], a[80:83]
    buffer_load_dwordx4 v21, s[12:15], s21 offen lds
    v_mfma_f32_16x16x32_bf16 a[112:115], v[140:143], v[104:107], a[112:115]
    ds_read_b64_tr_b16 v[50:51], v161 offset:1024
    v_mfma_f32_16x16x32_bf16 a[144:147], v[140:143], v[108:111], a[144:147]
    v_mfma_f32_16x16x32_bf16 a[176:179], v[140:143], v[112:115], a[176:179]
    ds_read_b128 v[84:87], v164 offset:6144
    v_mfma_f32_16x16x32_bf16 a[208:211], v[140:143], v[116:119], a[208:211]
    v_mfma_f32_16x16x32_bf16 a[240:243], v[140:143], v[120:123], a[240:243]
    ds_read_b64_tr_b16 v[52:53], v162
    v_mfma_f32_16x16x32_bf16 a[20:23], v[144:147], v[92:95], a[20:23]
    v_mfma_f32_16x16x32_bf16 a[52:55], v[144:147], v[96:99], a[52:55]
    ds_read_b64_tr_b16 v[54:55], v162 offset:1024
    s_add_u32 m0, s35, 1024
    v_mfma_f32_16x16x32_bf16 a[84:87], v[144:147], v[100:103], a[84:87]
    buffer_load_dwordx4 v22, s[12:15], s21 offen lds
    v_mfma_f32_16x16x32_bf16 a[116:119], v[144:147], v[104:107], a[116:119]
    ds_read_b128 v[88:91], v164 offset:7168
    v_mfma_f32_16x16x32_bf16 a[148:151], v[144:147], v[108:111], a[148:151]
    v_mfma_f32_16x16x32_bf16 a[180:183], v[144:147], v[112:115], a[180:183]
    ds_read_b64_tr_b16 v[56:57], v163
    v_mfma_f32_16x16x32_bf16 a[212:215], v[144:147], v[116:119], a[212:215]
    v_mfma_f32_16x16x32_bf16 a[244:247], v[144:147], v[120:123], a[244:247]
    ds_read_b64_tr_b16 v[58:59], v163 offset:1024
    v_mfma_f32_16x16x32_bf16 a[24:27], v[148:151], v[92:95], a[24:27]
    s_add_u32 s32, s32, 32768
    s_cmp_eq_u32 s32, 131072
    s_cselect_b32 s32, 0, s32
    v_mfma_f32_16x16x32_bf16 a[56:59], v[148:151], v[96:99], a[56:59]
    v_add_u32 v156, s32, v8
    s_add_u32 m0, s35, 2048
    v_mfma_f32_16x16x32_bf16 a[88:91], v[148:151], v[100:103], a[88:91]
    buffer_load_dwordx4 v23, s[12:15], s21 offen lds
    v_add_u32 v157, s32, v9
    v_mfma_f32_16x16x32_bf16 a[120:123], v[148:151], v[104:107], a[120:123]
    v_add_u32 v158, s32, v10
    v_mfma_f32_16x16x32_bf16 a[152:155], v[148:151], v[108:111], a[152:155]
    v_add_u32 v159, s32, v11
    v_mfma_f32_16x16x32_bf16 a[184:187], v[148:151], v[112:115], a[184:187]
    v_add_u32 v160, s32, v12
    v_mfma_f32_16x16x32_bf16 a[216:219], v[148:151], v[116:119], a[216:219]
    v_add_u32 v161, s32, v13
    v_mfma_f32_16x16x32_bf16 a[248:251], v[148:151], v[120:123], a[248:251]
    v_add_u32 v162, s32, v14
    v_mfma_f32_16x16x32_bf16 a[28:31], v[152:155], v[92:95], a[28:31]
    v_add_u32 v163, s32, v15
    v_mfma_f32_16x16x32_bf16 a[60:63], v[152:155], v[96:99], a[60:63]
    v_add_u32 v164, s32, v16
    s_add_u32 m0, s35, 3072
    v_mfma_f32_16x16x32_bf16 a[92:95], v[152:155], v[100:103], a[92:95]
    buffer_load_dwordx4 v24, s[12:15], s21 offen lds
    v_mfma_f32_16x16x32_bf16 a[124:127], v[152:155], v[104:107], a[124:127]
    s_add_u32 s20, s20, 262144
    s_add_u32 s21, s21, 131072
    v_mfma_f32_16x16x32_bf16 a[156:159], v[152:155], v[108:111], a[156:159]
    s_add_u32 s33, s33, 32768
    s_cmp_eq_u32 s33, 131072
    s_cselect_b32 s33, 0, s33
    v_mfma_f32_16x16x32_bf16 a[188:191], v[152:155], v[112:115], a[188:191]
    s_add_u32 s34, s22, s33
    s_add_u32 s35, s23, s33
    v_mfma_f32_16x16x32_bf16 a[220:223], v[152:155], v[116:119], a[220:223]
    v_mfma_f32_16x16x32_bf16 a[252:255], v[152:155], v[120:123], a[252:255]
    s_waitcnt vmcnt(16) lgkmcnt(0)
    s_barrier
    s_sub_u32 s24, s24, 1
    s_cmp_lg_u32 s24, 0
    s_cbranch_scc1 B_L_gB_loop
    s_waitcnt vmcnt(0)
    s_and_b32 s25, s67, 15
    s_lshl_b32 s25, s25, 1
    s_and_b32 s26, s3, 1
    s_add_u32 s25, s25, s26
    s_lshr_b32 s26, s68, 5
    s_lshr_b32 s27, s3, 1
    s_mul_i32 s27, s27, 4
    s_add_u32 s26, s26, s27
    s_lshl_b32 s26, s26, 5
    s_add_u32 s25, s25, s26
    s_lshl_b32 s25, s25, 13
    v_lshlrev_b32 v1, 4, v0
    s_add_u32 s26, s25, 0
    v_accvgpr_read_b32 v32, a0
    v_accvgpr_read_b32 v33, a1
    v_accvgpr_read_b32 v34, a2
    v_accvgpr_read_b32 v35, a3
    v_accvgpr_read_b32 v36, a4
    v_accvgpr_read_b32 v37, a5
    v_accvgpr_read_b32 v38, a6
    v_accvgpr_read_b32 v39, a7
    v_cvt_pk_bf16_f32 v28, v32, v33
    v_cvt_pk_bf16_f32 v29, v34, v35
    v_cvt_pk_bf16_f32 v30, v36, v37
    v_cvt_pk_bf16_f32 v31, v38, v39
    buffer_store_dwordx4 v[28:31], v1, s[16:19], s26 offen offset:0 sc1
    v_accvgpr_read_b32 v44, a32
    v_accvgpr_read_b32 v45, a33
    v_accvgpr_read_b32 v46, a34
    v_accvgpr_read_b32 v47, a35
    v_accvgpr_read_b32 v48, a36
    v_accvgpr_read_b32 v49, a37
    v_accvgpr_read_b32 v50, a38
    v_accvgpr_read_b32 v51, a39
    v_cvt_pk_bf16_f32 v40, v44, v45
    v_cvt_pk_bf16_f32 v41, v46, v47
    v_cvt_pk_bf16_f32 v42, v48, v49
    v_cvt_pk_bf16_f32 v43, v50, v51
    buffer_store_dwordx4 v[40:43], v1, s[16:19], s26 offen offset:1024 sc1
    v_accvgpr_read_b32 v56, a64
    v_accvgpr_read_b32 v57, a65
    v_accvgpr_read_b32 v58, a66
    v_accvgpr_read_b32 v59, a67
    v_accvgpr_read_b32 v60, a68
    v_accvgpr_read_b32 v61, a69
    v_accvgpr_read_b32 v62, a70
    v_accvgpr_read_b32 v63, a71
    v_cvt_pk_bf16_f32 v52, v56, v57
    v_cvt_pk_bf16_f32 v53, v58, v59
    v_cvt_pk_bf16_f32 v54, v60, v61
    v_cvt_pk_bf16_f32 v55, v62, v63
    buffer_store_dwordx4 v[52:55], v1, s[16:19], s26 offen offset:2048 sc1
    v_accvgpr_read_b32 v68, a96
    v_accvgpr_read_b32 v69, a97
    v_accvgpr_read_b32 v70, a98
    v_accvgpr_read_b32 v71, a99
    v_accvgpr_read_b32 v72, a100
    v_accvgpr_read_b32 v73, a101
    v_accvgpr_read_b32 v74, a102
    v_accvgpr_read_b32 v75, a103
    v_cvt_pk_bf16_f32 v64, v68, v69
    v_cvt_pk_bf16_f32 v65, v70, v71
    v_cvt_pk_bf16_f32 v66, v72, v73
    v_cvt_pk_bf16_f32 v67, v74, v75
    buffer_store_dwordx4 v[64:67], v1, s[16:19], s26 offen offset:3072 sc1
    s_add_u32 s26, s25, 4096
    v_accvgpr_read_b32 v32, a128
    v_accvgpr_read_b32 v33, a129
    v_accvgpr_read_b32 v34, a130
    v_accvgpr_read_b32 v35, a131
    v_accvgpr_read_b32 v36, a132
    v_accvgpr_read_b32 v37, a133
    v_accvgpr_read_b32 v38, a134
    v_accvgpr_read_b32 v39, a135
    v_cvt_pk_bf16_f32 v28, v32, v33
    v_cvt_pk_bf16_f32 v29, v34, v35
    v_cvt_pk_bf16_f32 v30, v36, v37
    v_cvt_pk_bf16_f32 v31, v38, v39
    buffer_store_dwordx4 v[28:31], v1, s[16:19], s26 offen offset:0 sc1
    v_accvgpr_read_b32 v44, a160
    v_accvgpr_read_b32 v45, a161
    v_accvgpr_read_b32 v46, a162
    v_accvgpr_read_b32 v47, a163
    v_accvgpr_read_b32 v48, a164
    v_accvgpr_read_b32 v49, a165
    v_accvgpr_read_b32 v50, a166
    v_accvgpr_read_b32 v51, a167
    v_cvt_pk_bf16_f32 v40, v44, v45
    v_cvt_pk_bf16_f32 v41, v46, v47
    v_cvt_pk_bf16_f32 v42, v48, v49
    v_cvt_pk_bf16_f32 v43, v50, v51
    buffer_store_dwordx4 v[40:43], v1, s[16:19], s26 offen offset:1024 sc1
    v_accvgpr_read_b32 v56, a192
    v_accvgpr_read_b32 v57, a193
    v_accvgpr_read_b32 v58, a194
    v_accvgpr_read_b32 v59, a195
    v_accvgpr_read_b32 v60, a196
    v_accvgpr_read_b32 v61, a197
    v_accvgpr_read_b32 v62, a198
    v_accvgpr_read_b32 v63, a199
    v_cvt_pk_bf16_f32 v52, v56, v57
    v_cvt_pk_bf16_f32 v53, v58, v59
    v_cvt_pk_bf16_f32 v54, v60, v61
    v_cvt_pk_bf16_f32 v55, v62, v63
    buffer_store_dwordx4 v[52:55], v1, s[16:19], s26 offen offset:2048 sc1
    v_accvgpr_read_b32 v68, a224
    v_accvgpr_read_b32 v69, a225
    v_accvgpr_read_b32 v70, a226
    v_accvgpr_read_b32 v71, a227
    v_accvgpr_read_b32 v72, a228
    v_accvgpr_read_b32 v73, a229
    v_accvgpr_read_b32 v74, a230
    v_accvgpr_read_b32 v75, a231
    v_cvt_pk_bf16_f32 v64, v68, v69
    v_cvt_pk_bf16_f32 v65, v70, v71
    v_cvt_pk_bf16_f32 v66, v72, v73
    v_cvt_pk_bf16_f32 v67, v74, v75
    buffer_store_dwordx4 v[64:67], v1, s[16:19], s26 offen offset:3072 sc1
    s_add_u32 s26, s25, 262144
    v_accvgpr_read_b32 v32, a8
    v_accvgpr_read_b32 v33, a9
    v_accvgpr_read_b32 v34, a10
    v_accvgpr_read_b32 v35, a11
    v_accvgpr_read_b32 v36, a12
    v_accvgpr_read_b32 v37, a13
    v_accvgpr_read_b32 v38, a14
    v_accvgpr_read_b32 v39, a15
    v_cvt_pk_bf16_f32 v28, v32, v33
    v_cvt_pk_bf16_f32 v29, v34, v35
    v_cvt_pk_bf16_f32 v30, v36, v37
    v_cvt_pk_bf16_f32 v31, v38, v39
    buffer_store_dwordx4 v[28:31], v1, s[16:19], s26 offen offset:0 sc1
    v_accvgpr_read_b32 v44, a40
    v_accvgpr_read_b32 v45, a41
    v_accvgpr_read_b32 v46, a42
    v_accvgpr_read_b32 v47, a43
    v_accvgpr_read_b32 v48, a44
    v_accvgpr_read_b32 v49, a45
    v_accvgpr_read_b32 v50, a46
    v_accvgpr_read_b32 v51, a47
    v_cvt_pk_bf16_f32 v40, v44, v45
    v_cvt_pk_bf16_f32 v41, v46, v47
    v_cvt_pk_bf16_f32 v42, v48, v49
    v_cvt_pk_bf16_f32 v43, v50, v51
    buffer_store_dwordx4 v[40:43], v1, s[16:19], s26 offen offset:1024 sc1
    v_accvgpr_read_b32 v56, a72
    v_accvgpr_read_b32 v57, a73
    v_accvgpr_read_b32 v58, a74
    v_accvgpr_read_b32 v59, a75
    v_accvgpr_read_b32 v60, a76
    v_accvgpr_read_b32 v61, a77
    v_accvgpr_read_b32 v62, a78
    v_accvgpr_read_b32 v63, a79
    v_cvt_pk_bf16_f32 v52, v56, v57
    v_cvt_pk_bf16_f32 v53, v58, v59
    v_cvt_pk_bf16_f32 v54, v60, v61
    v_cvt_pk_bf16_f32 v55, v62, v63
    buffer_store_dwordx4 v[52:55], v1, s[16:19], s26 offen offset:2048 sc1
    v_accvgpr_read_b32 v68, a104
    v_accvgpr_read_b32 v69, a105
    v_accvgpr_read_b32 v70, a106
    v_accvgpr_read_b32 v71, a107
    v_accvgpr_read_b32 v72, a108
    v_accvgpr_read_b32 v73, a109
    v_accvgpr_read_b32 v74, a110
    v_accvgpr_read_b32 v75, a111
    v_cvt_pk_bf16_f32 v64, v68, v69
    v_cvt_pk_bf16_f32 v65, v70, v71
    v_cvt_pk_bf16_f32 v66, v72, v73
    v_cvt_pk_bf16_f32 v67, v74, v75
    buffer_store_dwordx4 v[64:67], v1, s[16:19], s26 offen offset:3072 sc1
    s_add_u32 s26, s25, 266240
    v_accvgpr_read_b32 v32, a136
    v_accvgpr_read_b32 v33, a137
    v_accvgpr_read_b32 v34, a138
    v_accvgpr_read_b32 v35, a139
    v_accvgpr_read_b32 v36, a140
    v_accvgpr_read_b32 v37, a141
    v_accvgpr_read_b32 v38, a142
    v_accvgpr_read_b32 v39, a143
    v_cvt_pk_bf16_f32 v28, v32, v33
    v_cvt_pk_bf16_f32 v29, v34, v35
    v_cvt_pk_bf16_f32 v30, v36, v37
    v_cvt_pk_bf16_f32 v31, v38, v39
    buffer_store_dwordx4 v[28:31], v1, s[16:19], s26 offen offset:0 sc1
    v_accvgpr_read_b32 v44, a168
    v_accvgpr_read_b32 v45, a169
    v_accvgpr_read_b32 v46, a170
    v_accvgpr_read_b32 v47, a171
    v_accvgpr_read_b32 v48, a172
    v_accvgpr_read_b32 v49, a173
    v_accvgpr_read_b32 v50, a174
    v_accvgpr_read_b32 v51, a175
    v_cvt_pk_bf16_f32 v40, v44, v45
    v_cvt_pk_bf16_f32 v41, v46, v47
    v_cvt_pk_bf16_f32 v42, v48, v49
    v_cvt_pk_bf16_f32 v43, v50, v51
    buffer_store_dwordx4 v[40:43], v1, s[16:19], s26 offen offset:1024 sc1
    v_accvgpr_read_b32 v56, a200
    v_accvgpr_read_b32 v57, a201
    v_accvgpr_read_b32 v58, a202
    v_accvgpr_read_b32 v59, a203
    v_accvgpr_read_b32 v60, a204
    v_accvgpr_read_b32 v61, a205
    v_accvgpr_read_b32 v62, a206
    v_accvgpr_read_b32 v63, a207
    v_cvt_pk_bf16_f32 v52, v56, v57
    v_cvt_pk_bf16_f32 v53, v58, v59
    v_cvt_pk_bf16_f32 v54, v60, v61
    v_cvt_pk_bf16_f32 v55, v62, v63
    buffer_store_dwordx4 v[52:55], v1, s[16:19], s26 offen offset:2048 sc1
    v_accvgpr_read_b32 v68, a232
    v_accvgpr_read_b32 v69, a233
    v_accvgpr_read_b32 v70, a234
    v_accvgpr_read_b32 v71, a235
    v_accvgpr_read_b32 v72, a236
    v_accvgpr_read_b32 v73, a237
    v_accvgpr_read_b32 v74, a238
    v_accvgpr_read_b32 v75, a239
    v_cvt_pk_bf16_f32 v64, v68, v69
    v_cvt_pk_bf16_f32 v65, v70, v71
    v_cvt_pk_bf16_f32 v66, v72, v73
    v_cvt_pk_bf16_f32 v67, v74, v75
    buffer_store_dwordx4 v[64:67], v1, s[16:19], s26 offen offset:3072 sc1
    s_add_u32 s26, s25, 524288
    v_accvgpr_read_b32 v32, a16
    v_accvgpr_read_b32 v33, a17
    v_accvgpr_read_b32 v34, a18
    v_accvgpr_read_b32 v35, a19
    v_accvgpr_read_b32 v36, a20
    v_accvgpr_read_b32 v37, a21
    v_accvgpr_read_b32 v38, a22
    v_accvgpr_read_b32 v39, a23
    v_cvt_pk_bf16_f32 v28, v32, v33
    v_cvt_pk_bf16_f32 v29, v34, v35
    v_cvt_pk_bf16_f32 v30, v36, v37
    v_cvt_pk_bf16_f32 v31, v38, v39
    buffer_store_dwordx4 v[28:31], v1, s[16:19], s26 offen offset:0 sc1
    v_accvgpr_read_b32 v44, a48
    v_accvgpr_read_b32 v45, a49
    v_accvgpr_read_b32 v46, a50
    v_accvgpr_read_b32 v47, a51
    v_accvgpr_read_b32 v48, a52
    v_accvgpr_read_b32 v49, a53
    v_accvgpr_read_b32 v50, a54
    v_accvgpr_read_b32 v51, a55
    v_cvt_pk_bf16_f32 v40, v44, v45
    v_cvt_pk_bf16_f32 v41, v46, v47
    v_cvt_pk_bf16_f32 v42, v48, v49
    v_cvt_pk_bf16_f32 v43, v50, v51
    buffer_store_dwordx4 v[40:43], v1, s[16:19], s26 offen offset:1024 sc1
    v_accvgpr_read_b32 v56, a80
    v_accvgpr_read_b32 v57, a81
    v_accvgpr_read_b32 v58, a82
    v_accvgpr_read_b32 v59, a83
    v_accvgpr_read_b32 v60, a84
    v_accvgpr_read_b32 v61, a85
    v_accvgpr_read_b32 v62, a86
    v_accvgpr_read_b32 v63, a87
    v_cvt_pk_bf16_f32 v52, v56, v57
    v_cvt_pk_bf16_f32 v53, v58, v59
    v_cvt_pk_bf16_f32 v54, v60, v61
    v_cvt_pk_bf16_f32 v55, v62, v63
    buffer_store_dwordx4 v[52:55], v1, s[16:19], s26 offen offset:2048 sc1
    v_accvgpr_read_b32 v68, a112
    v_accvgpr_read_b32 v69, a113
    v_accvgpr_read_b32 v70, a114
    v_accvgpr_read_b32 v71, a115
    v_accvgpr_read_b32 v72, a116
    v_accvgpr_read_b32 v73, a117
    v_accvgpr_read_b32 v74, a118
    v_accvgpr_read_b32 v75, a119
    v_cvt_pk_bf16_f32 v64, v68, v69
    v_cvt_pk_bf16_f32 v65, v70, v71
    v_cvt_pk_bf16_f32 v66, v72, v73
    v_cvt_pk_bf16_f32 v67, v74, v75
    buffer_store_dwordx4 v[64:67], v1, s[16:19], s26 offen offset:3072 sc1
    s_add_u32 s26, s25, 528384
    v_accvgpr_read_b32 v32, a144
    v_accvgpr_read_b32 v33, a145
    v_accvgpr_read_b32 v34, a146
    v_accvgpr_read_b32 v35, a147
    v_accvgpr_read_b32 v36, a148
    v_accvgpr_read_b32 v37, a149
    v_accvgpr_read_b32 v38, a150
    v_accvgpr_read_b32 v39, a151
    v_cvt_pk_bf16_f32 v28, v32, v33
    v_cvt_pk_bf16_f32 v29, v34, v35
    v_cvt_pk_bf16_f32 v30, v36, v37
    v_cvt_pk_bf16_f32 v31, v38, v39
    buffer_store_dwordx4 v[28:31], v1, s[16:19], s26 offen offset:0 sc1
    v_accvgpr_read_b32 v44, a176
    v_accvgpr_read_b32 v45, a177
    v_accvgpr_read_b32 v46, a178
    v_accvgpr_read_b32 v47, a179
    v_accvgpr_read_b32 v48, a180
    v_accvgpr_read_b32 v49, a181
    v_accvgpr_read_b32 v50, a182
    v_accvgpr_read_b32 v51, a183
    v_cvt_pk_bf16_f32 v40, v44, v45
    v_cvt_pk_bf16_f32 v41, v46, v47
    v_cvt_pk_bf16_f32 v42, v48, v49
    v_cvt_pk_bf16_f32 v43, v50, v51
    buffer_store_dwordx4 v[40:43], v1, s[16:19], s26 offen offset:1024 sc1
    v_accvgpr_read_b32 v56, a208
    v_accvgpr_read_b32 v57, a209
    v_accvgpr_read_b32 v58, a210
    v_accvgpr_read_b32 v59, a211
    v_accvgpr_read_b32 v60, a212
    v_accvgpr_read_b32 v61, a213
    v_accvgpr_read_b32 v62, a214
    v_accvgpr_read_b32 v63, a215
    v_cvt_pk_bf16_f32 v52, v56, v57
    v_cvt_pk_bf16_f32 v53, v58, v59
    v_cvt_pk_bf16_f32 v54, v60, v61
    v_cvt_pk_bf16_f32 v55, v62, v63
    buffer_store_dwordx4 v[52:55], v1, s[16:19], s26 offen offset:2048 sc1
    v_accvgpr_read_b32 v68, a240
    v_accvgpr_read_b32 v69, a241
    v_accvgpr_read_b32 v70, a242
    v_accvgpr_read_b32 v71, a243
    v_accvgpr_read_b32 v72, a244
    v_accvgpr_read_b32 v73, a245
    v_accvgpr_read_b32 v74, a246
    v_accvgpr_read_b32 v75, a247
    v_cvt_pk_bf16_f32 v64, v68, v69
    v_cvt_pk_bf16_f32 v65, v70, v71
    v_cvt_pk_bf16_f32 v66, v72, v73
    v_cvt_pk_bf16_f32 v67, v74, v75
    buffer_store_dwordx4 v[64:67], v1, s[16:19], s26 offen offset:3072 sc1
    s_add_u32 s26, s25, 786432
    v_accvgpr_read_b32 v32, a24
    v_accvgpr_read_b32 v33, a25
    v_accvgpr_read_b32 v34, a26
    v_accvgpr_read_b32 v35, a27
    v_accvgpr_read_b32 v36, a28
    v_accvgpr_read_b32 v37, a29
    v_accvgpr_read_b32 v38, a30
    v_accvgpr_read_b32 v39, a31
    v_cvt_pk_bf16_f32 v28, v32, v33
    v_cvt_pk_bf16_f32 v29, v34, v35
    v_cvt_pk_bf16_f32 v30, v36, v37
    v_cvt_pk_bf16_f32 v31, v38, v39
    buffer_store_dwordx4 v[28:31], v1, s[16:19], s26 offen offset:0 sc1
    v_accvgpr_read_b32 v44, a56
    v_accvgpr_read_b32 v45, a57
    v_accvgpr_read_b32 v46, a58
    v_accvgpr_read_b32 v47, a59
    v_accvgpr_read_b32 v48, a60
    v_accvgpr_read_b32 v49, a61
    v_accvgpr_read_b32 v50, a62
    v_accvgpr_read_b32 v51, a63
    v_cvt_pk_bf16_f32 v40, v44, v45
    v_cvt_pk_bf16_f32 v41, v46, v47
    v_cvt_pk_bf16_f32 v42, v48, v49
    v_cvt_pk_bf16_f32 v43, v50, v51
    buffer_store_dwordx4 v[40:43], v1, s[16:19], s26 offen offset:1024 sc1
    v_accvgpr_read_b32 v56, a88
    v_accvgpr_read_b32 v57, a89
    v_accvgpr_read_b32 v58, a90
    v_accvgpr_read_b32 v59, a91
    v_accvgpr_read_b32 v60, a92
    v_accvgpr_read_b32 v61, a93
    v_accvgpr_read_b32 v62, a94
    v_accvgpr_read_b32 v63, a95
    v_cvt_pk_bf16_f32 v52, v56, v57
    v_cvt_pk_bf16_f32 v53, v58, v59
    v_cvt_pk_bf16_f32 v54, v60, v61
    v_cvt_pk_bf16_f32 v55, v62, v63
    buffer_store_dwordx4 v[52:55], v1, s[16:19], s26 offen offset:2048 sc1
    v_accvgpr_read_b32 v68, a120
    v_accvgpr_read_b32 v69, a121
    v_accvgpr_read_b32 v70, a122
    v_accvgpr_read_b32 v71, a123
    v_accvgpr_read_b32 v72, a124
    v_accvgpr_read_b32 v73, a125
    v_accvgpr_read_b32 v74, a126
    v_accvgpr_read_b32 v75, a127
    v_cvt_pk_bf16_f32 v64, v68, v69
    v_cvt_pk_bf16_f32 v65, v70, v71
    v_cvt_pk_bf16_f32 v66, v72, v73
    v_cvt_pk_bf16_f32 v67, v74, v75
    buffer_store_dwordx4 v[64:67], v1, s[16:19], s26 offen offset:3072 sc1
    s_add_u32 s26, s25, 790528
    v_accvgpr_read_b32 v32, a152
    v_accvgpr_read_b32 v33, a153
    v_accvgpr_read_b32 v34, a154
    v_accvgpr_read_b32 v35, a155
    v_accvgpr_read_b32 v36, a156
    v_accvgpr_read_b32 v37, a157
    v_accvgpr_read_b32 v38, a158
    v_accvgpr_read_b32 v39, a159
    v_cvt_pk_bf16_f32 v28, v32, v33
    v_cvt_pk_bf16_f32 v29, v34, v35
    v_cvt_pk_bf16_f32 v30, v36, v37
    v_cvt_pk_bf16_f32 v31, v38, v39
    buffer_store_dwordx4 v[28:31], v1, s[16:19], s26 offen offset:0 sc1
    v_accvgpr_read_b32 v44, a184
    v_accvgpr_read_b32 v45, a185
    v_accvgpr_read_b32 v46, a186
    v_accvgpr_read_b32 v47, a187
    v_accvgpr_read_b32 v48, a188
    v_accvgpr_read_b32 v49, a189
    v_accvgpr_read_b32 v50, a190
    v_accvgpr_read_b32 v51, a191
    v_cvt_pk_bf16_f32 v40, v44, v45
    v_cvt_pk_bf16_f32 v41, v46, v47
    v_cvt_pk_bf16_f32 v42, v48, v49
    v_cvt_pk_bf16_f32 v43, v50, v51
    buffer_store_dwordx4 v[40:43], v1, s[16:19], s26 offen offset:1024 sc1
    v_accvgpr_read_b32 v56, a216
    v_accvgpr_read_b32 v57, a217
    v_accvgpr_read_b32 v58, a218
    v_accvgpr_read_b32 v59, a219
    v_accvgpr_read_b32 v60, a220
    v_accvgpr_read_b32 v61, a221
    v_accvgpr_read_b32 v62, a222
    v_accvgpr_read_b32 v63, a223
    v_cvt_pk_bf16_f32 v52, v56, v57
    v_cvt_pk_bf16_f32 v53, v58, v59
    v_cvt_pk_bf16_f32 v54, v60, v61
    v_cvt_pk_bf16_f32 v55, v62, v63
    buffer_store_dwordx4 v[52:55], v1, s[16:19], s26 offen offset:2048 sc1
    v_accvgpr_read_b32 v68, a248
    v_accvgpr_read_b32 v69, a249
    v_accvgpr_read_b32 v70, a250
    v_accvgpr_read_b32 v71, a251
    v_accvgpr_read_b32 v72, a252
    v_accvgpr_read_b32 v73, a253
    v_accvgpr_read_b32 v74, a254
    v_accvgpr_read_b32 v75, a255
    v_cvt_pk_bf16_f32 v64, v68, v69
    v_cvt_pk_bf16_f32 v65, v70, v71
    v_cvt_pk_bf16_f32 v66, v72, v73
    v_cvt_pk_bf16_f32 v67, v74, v75
    buffer_store_dwordx4 v[64:67], v1, s[16:19], s26 offen offset:3072 sc1
    s_waitcnt vmcnt(0)
    s_barrier
    s_branch B_L_sig
B_L_small:
    s_cmp_ge_u32 s67, 32
    s_cbranch_scc1 B_L_smallv
    s_and_b32 s26, s67, 15
    s_lshl_b32 s20, s26, 9
    s_lshl_b32 s21, s68, 6
    s_mul_i32 s22, s3, 4096
    s_mul_i32 s23, s3, 1024
    v_and_b32 v1, 15, v0
    v_lshrrev_b32 v2, 4, v0
    v_lshrrev_b32 v3, 2, v1
    v_and_b32 v4, 1, v2
    v_lshrrev_b32 v5, 1, v2
    v_lshlrev_b32 v6, 3, v3
    v_lshl_add_u32 v6, v5, 2, v6
    v_add_u32 v6, v6, v4
    v_lshl_or_b32 v3, v4, 2, v3
    v_lshlrev_b32 v6, 9, v6
    v_and_b32 v4, 3, v1
    v_lshl_add_u32 v6, v4, 3, v6
    s_and_b32 s25, s3, 1
    s_mul_i32 s25, s25, 8
    s_add_u32 s26, s25, 0
    v_xor_b32 v4, s26, v3
    v_lshl_add_u32 v8, v4, 5, v6
    s_add_u32 s26, s25, 1
    v_xor_b32 v4, s26, v3
    v_lshl_add_u32 v9, v4, 5, v6
    s_add_u32 s26, s25, 2
    v_xor_b32 v4, s26, v3
    v_lshl_add_u32 v10, v4, 5, v6
    s_add_u32 s26, s25, 3
    v_xor_b32 v4, s26, v3
    v_lshl_add_u32 v11, v4, 5, v6
    s_add_u32 s26, s25, 4
    v_xor_b32 v4, s26, v3
    v_lshl_add_u32 v12, v4, 5, v6
    s_add_u32 s26, s25, 5
    v_xor_b32 v4, s26, v3
    v_lshl_add_u32 v13, v4, 5, v6
    s_add_u32 s26, s25, 6
    v_xor_b32 v4, s26, v3
    v_lshl_add_u32 v14, v4, 5, v6
    s_add_u32 s26, s25, 7
    v_xor_b32 v4, s26, v3
    v_lshl_add_u32 v15, v4, 5, v6
    v_lshrrev_b32 v3, 2, v1
    v_lshrrev_b32 v4, 1, v3
    v_and_b32 v5, 1, v3
    v_xor_b32 v5, v5, v4
    v_lshl_or_b32 v5, v5, 1, v4
    v_xor_b32 v5, v5, v2
    v_lshlrev_b32 v5, 4, v5
    v_lshl_add_u32 v5, v1, 6, v5
    s_lshr_b32 s25, s3, 1
    s_mul_i32 s25, s25, 2048
    s_add_u32 s25, s25, 16384
    v_add_u32 v16, s25, v5
    v_lshrrev_b32 v3, 5, v0
    v_and_b32 v4, 31, v0
    v_lshlrev_b32 v5, 3, v3
    v_add_u32 v5, s3, v5
    v_lshlrev_b32 v6, 2, v3
    v_or_b32 v6, s3, v6
    v_lshrrev_b32 v1, 1, v4
    v_xor_b32 v1, v1, v6
    v_lshlrev_b32 v1, 5, v1
    v_and_b32 v4, 1, v4
    v_lshl_or_b32 v1, v4, 4, v1
    s_mov_b32 s25, 8192
    v_mul_lo_u32 v5, v5, s25
    v_add_u32 v17, v5, v1
    v_add_u32 v18, 32768, v17
    v_add_u32 v19, 131072, v17
    v_add_u32 v20, 163840, v17
    v_lshlrev_b32 v3, 4, v0
    s_mul_i32 s25, s3, 1024
    v_add_u32 v21, s25, v3
    s_add_u32 s23, s23, 16384
    s_mov_b32 s33, 0
    s_mov_b32 s32, 0
    s_add_u32 s34, s22, s33
    s_add_u32 s35, s23, s33
    s_add_u32 m0, s34, 0
    s_nop 0
    buffer_load_dwordx4 v17, s[8:11], s20 offen lds
    s_add_u32 m0, s34, 1024
    s_nop 0
    buffer_load_dwordx4 v18, s[8:11], s20 offen lds
    s_add_u32 m0, s34, 2048
    s_nop 0
    buffer_load_dwordx4 v19, s[8:11], s20 offen lds
    s_add_u32 m0, s34, 3072
    s_nop 0
    buffer_load_dwordx4 v20, s[8:11], s20 offen lds
    s_add_u32 s20, s20, 262144
    s_add_u32 s33, s33, 20480
    s_cmp_eq_u32 s33, 122880
    s_cselect_b32 s33, 0, s33
    s_add_u32 s34, s22, s33
    s_add_u32 s35, s23, s33
    s_add_u32 m0, s34, 0
    s_nop 0
    buffer_load_dwordx4 v17, s[8:11], s20 offen lds
    s_add_u32 m0, s34, 1024
    s_nop 0
    buffer_load_dwordx4 v18, s[8:11], s20 offen lds
    s_add_u32 m0, s34, 2048
    s_nop 0
    buffer_load_dwordx4 v19, s[8:11], s20 offen lds
    s_add_u32 m0, s34, 3072
    s_nop 0
    buffer_load_dwordx4 v20, s[8:11], s20 offen lds
    s_add_u32 s20, s20, 262144
    s_add_u32 s33, s33, 20480
    s_cmp_eq_u32 s33, 122880
    s_cselect_b32 s33, 0, s33
    s_add_u32 s34, s22, s33
    s_add_u32 s35, s23, s33
    s_add_u32 m0, s34, 0
    s_nop 0
    buffer_load_dwordx4 v17, s[8:11], s20 offen lds
    s_add_u32 m0, s34, 1024
    s_nop 0
    buffer_load_dwordx4 v18, s[8:11], s20 offen lds
    s_add_u32 m0, s34, 2048
    s_nop 0
    buffer_load_dwordx4 v19, s[8:11], s20 offen lds
    s_add_u32 m0, s34, 3072
    s_nop 0
    buffer_load_dwordx4 v20, s[8:11], s20 offen lds
    s_add_u32 s20, s20, 262144
    s_add_u32 s33, s33, 20480
    s_cmp_eq_u32 s33, 122880
    s_cselect_b32 s33, 0, s33
    s_add_u32 s34, s22, s33
    s_add_u32 s35, s23, s33
    s_add_u32 m0, s34, 0
    s_nop 0
    buffer_load_dwordx4 v17, s[8:11], s20 offen lds
    s_add_u32 m0, s34, 1024
    s_nop 0
    buffer_load_dwordx4 v18, s[8:11], s20 offen lds
    s_add_u32 m0, s34, 2048
    s_nop 0
    buffer_load_dwordx4 v19, s[8:11], s20 offen lds
    s_add_u32 m0, s34, 3072
    s_nop 0
    buffer_load_dwordx4 v20, s[8:11], s20 offen lds
    s_add_u32 s20, s20, 262144
    s_add_u32 s33, s33, 20480
    s_cmp_eq_u32 s33, 122880
    s_cselect_b32 s33, 0, s33
    s_add_u32 s34, s22, s33
    s_add_u32 s35, s23, s33
    s_add_u32 m0, s34, 0
    s_nop 0
    buffer_load_dwordx4 v17, s[8:11], s20 offen lds
    s_add_u32 m0, s34, 1024
    s_nop 0
    buffer_load_dwordx4 v18, s[8:11], s20 offen lds
    s_add_u32 m0, s34, 2048
    s_nop 0
    buffer_load_dwordx4 v19, s[8:11], s20 offen lds
    s_add_u32 m0, s34, 3072
    s_nop 0
    buffer_load_dwordx4 v20, s[8:11], s20 offen lds
    s_add_u32 s20, s20, 262144
    s_add_u32 s33, s33, 20480
    s_cmp_eq_u32 s33, 122880
    s_cselect_b32 s33, 0, s33
    s_add_u32 s34, s22, s33
    s_add_u32 s35, s23, s33
    s_add_u32 m0, s34, 0
    s_nop 0
    buffer_load_dwordx4 v17, s[8:11], s20 offen lds
    s_add_u32 m0, s34, 1024
    s_nop 0
    buffer_load_dwordx4 v18, s[8:11], s20 offen lds
    s_add_u32 m0, s34, 2048
    s_nop 0
    buffer_load_dwordx4 v19, s[8:11], s20 offen lds
    s_add_u32 m0, s34, 3072
    s_nop 0
    buffer_load_dwordx4 v20, s[8:11], s20 offen lds
    s_add_u32 s20, s20, 262144
    s_add_u32 s33, s33, 20480
    s_cmp_eq_u32 s33, 122880
    s_cselect_b32 s33, 0, s33
    s_cmp_lg_u32 s3, 0
    s_cbranch_scc1 B_L_wc_l1c_b
    s_add_u32 s44, s73, 41984
    v_mov_b32 v2, s44
B_L_wc_l1c:
    global_load_dword v3, v2, s[60:61] sc1
    s_waitcnt vmcnt(0)
    v_readfirstlane_b32 s44, v3
    s_nop 0
    s_cmp_ge_u32 s44, 16
    s_cbranch_scc1 B_L_wc_l1c_b
    s_sleep 3
    s_sub_u32 s66, s66, 1
    s_cbranch_scc0 B_L_wc_l1c
    s_mov_b32 s66, 0
B_L_wc_l1c_b:
    s_barrier
    s_add_u32 s34, s22, s33
    s_add_u32 s35, s23, s33
    s_add_u32 m0, s35, 0
    s_nop 0
    buffer_load_dwordx4 v21, s[12:15], s21 offen lds
    s_add_u32 s21, s21, 131072
    s_add_u32 s33, s33, 20480
    s_cmp_eq_u32 s33, 122880
    s_cselect_b32 s33, 0, s33
    s_add_u32 s34, s22, s33
    s_add_u32 s35, s23, s33
    s_add_u32 m0, s35, 0
    s_nop 0
    buffer_load_dwordx4 v21, s[12:15], s21 offen lds
    s_add_u32 s21, s21, 131072
    s_add_u32 s33, s33, 20480
    s_cmp_eq_u32 s33, 122880
    s_cselect_b32 s33, 0, s33
    s_add_u32 s34, s22, s33
    s_add_u32 s35, s23, s33
    s_add_u32 m0, s35, 0
    s_nop 0
    buffer_load_dwordx4 v21, s[12:15], s21 offen lds
    s_add_u32 s21, s21, 131072
    s_add_u32 s33, s33, 20480
    s_cmp_eq_u32 s33, 122880
    s_cselect_b32 s33, 0, s33
    s_add_u32 s34, s22, s33
    s_add_u32 s35, s23, s33
    s_add_u32 m0, s35, 0
    s_nop 0
    buffer_load_dwordx4 v21, s[12:15], s21 offen lds
    s_add_u32 s21, s21, 131072
    s_add_u32 s33, s33, 20480
    s_cmp_eq_u32 s33, 122880
    s_cselect_b32 s33, 0, s33
    s_add_u32 s34, s22, s33
    s_add_u32 s35, s23, s33
    s_add_u32 m0, s35, 0
    s_nop 0
    buffer_load_dwordx4 v21, s[12:15], s21 offen lds
    s_add_u32 s21, s21, 131072
    s_add_u32 s33, s33, 20480
    s_cmp_eq_u32 s33, 122880
    s_cselect_b32 s33, 0, s33
    s_add_u32 s34, s22, s33
    s_add_u32 s35, s23, s33
    s_add_u32 m0, s35, 0
    s_nop 0
    buffer_load_dwordx4 v21, s[12:15], s21 offen lds
    s_add_u32 s21, s21, 131072
    s_add_u32 s33, s33, 20480
    s_cmp_eq_u32 s33, 122880
    s_cselect_b32 s33, 0, s33
    v_add_u32 v104, s32, v8
    v_add_u32 v105, s32, v9
    v_add_u32 v106, s32, v10
    v_add_u32 v107, s32, v11
    v_add_u32 v108, s32, v12
    v_add_u32 v109, s32, v13
    v_add_u32 v110, s32, v14
    v_add_u32 v111, s32, v15
    v_add_u32 v112, s32, v16
    s_waitcnt vmcnt(5)
    s_barrier
    ds_read_b128 v[56:59], v112 offset:0
    ds_read_b64_tr_b16 v[24:25], v104
    ds_read_b64_tr_b16 v[26:27], v104 offset:1024
    ds_read_b128 v[60:63], v112 offset:1024
    ds_read_b64_tr_b16 v[28:29], v105
    ds_read_b64_tr_b16 v[30:31], v105 offset:1024
    ds_read_b64_tr_b16 v[32:33], v106
    ds_read_b64_tr_b16 v[34:35], v106 offset:1024
    ds_read_b64_tr_b16 v[36:37], v107
    ds_read_b64_tr_b16 v[38:39], v107 offset:1024
    ds_read_b64_tr_b16 v[40:41], v108
    ds_read_b64_tr_b16 v[42:43], v108 offset:1024
    ds_read_b64_tr_b16 v[44:45], v109
    ds_read_b64_tr_b16 v[46:47], v109 offset:1024
    ds_read_b64_tr_b16 v[48:49], v110
    ds_read_b64_tr_b16 v[50:51], v110 offset:1024
    ds_read_b64_tr_b16 v[52:53], v111
    ds_read_b64_tr_b16 v[54:55], v111 offset:1024
    s_add_u32 s32, s32, 20480
    s_cmp_eq_u32 s32, 122880
    s_cselect_b32 s32, 0, s32
    v_add_u32 v104, s32, v8
    v_add_u32 v105, s32, v9
    v_add_u32 v106, s32, v10
    v_add_u32 v107, s32, v11
    v_add_u32 v108, s32, v12
    v_add_u32 v109, s32, v13
    v_add_u32 v110, s32, v14
    v_add_u32 v111, s32, v15
    v_add_u32 v112, s32, v16
    s_add_u32 s34, s22, s33
    s_add_u32 s35, s23, s33
    s_waitcnt vmcnt(4) lgkmcnt(0)
    s_barrier
    v_mfma_f32_16x16x32_bf16 a[0:3], v[24:27], v[56:59], 0
    v_mfma_f32_16x16x32_bf16 a[8:11], v[28:31], v[56:59], 0
    ds_read_b128 v[96:99], v112 offset:0
    ds_read_b64_tr_b16 v[64:65], v104
    s_add_u32 m0, s34, 0
    v_mfma_f32_16x16x32_bf16 a[16:19], v[32:35], v[56:59], 0
    buffer_load_dwordx4 v17, s[8:11], s20 offen lds
    v_mfma_f32_16x16x32_bf16 a[24:27], v[36:39], v[56:59], 0
    ds_read_b64_tr_b16 v[66:67], v104 offset:1024
    ds_read_b128 v[100:103], v112 offset:1024
    ds_read_b64_tr_b16 v[68:69], v105
    v_mfma_f32_16x16x32_bf16 a[32:35], v[40:43], v[56:59], 0
    ds_read_b64_tr_b16 v[70:71], v105 offset:1024
    s_add_u32 m0, s34, 1024
    v_mfma_f32_16x16x32_bf16 a[40:43], v[44:47], v[56:59], 0
    buffer_load_dwordx4 v18, s[8:11], s20 offen lds
    v_mfma_f32_16x16x32_bf16 a[48:51], v[48:51], v[56:59], 0
    ds_read_b64_tr_b16 v[72:73], v106
    ds_read_b64_tr_b16 v[74:75], v106 offset:1024
    ds_read_b64_tr_b16 v[76:77], v107
    v_mfma_f32_16x16x32_bf16 a[56:59], v[52:55], v[56:59], 0
    ds_read_b64_tr_b16 v[78:79], v107 offset:1024
    ds_read_b64_tr_b16 v[80:81], v108
    s_add_u32 m0, s34, 2048
    v_mfma_f32_16x16x32_bf16 a[4:7], v[24:27], v[60:63], 0
    buffer_load_dwordx4 v19, s[8:11], s20 offen lds
    v_mfma_f32_16x16x32_bf16 a[12:15], v[28:31], v[60:63], 0
    ds_read_b64_tr_b16 v[82:83], v108 offset:1024
    ds_read_b64_tr_b16 v[84:85], v109
    ds_read_b64_tr_b16 v[86:87], v109 offset:1024
    v_mfma_f32_16x16x32_bf16 a[20:23], v[32:35], v[60:63], 0
    ds_read_b64_tr_b16 v[88:89], v110
    s_add_u32 m0, s34, 3072
    v_mfma_f32_16x16x32_bf16 a[28:31], v[36:39], v[60:63], 0
    buffer_load_dwordx4 v20, s[8:11], s20 offen lds
    v_mfma_f32_16x16x32_bf16 a[36:39], v[40:43], v[60:63], 0
    ds_read_b64_tr_b16 v[90:91], v110 offset:1024
    ds_read_b64_tr_b16 v[92:93], v111
    ds_read_b64_tr_b16 v[94:95], v111 offset:1024
    v_mfma_f32_16x16x32_bf16 a[44:47], v[44:47], v[60:63], 0
    s_add_u32 s32, s32, 20480
    s_cmp_eq_u32 s32, 122880
    s_cselect_b32 s32, 0, s32
    s_add_u32 m0, s35, 0
    v_mfma_f32_16x16x32_bf16 a[52:55], v[48:51], v[60:63], 0
    buffer_load_dwordx4 v21, s[12:15], s21 offen lds
    v_add_u32 v104, s32, v8
    v_mfma_f32_16x16x32_bf16 a[60:63], v[52:55], v[60:63], 0
    v_add_u32 v105, s32, v9
    v_add_u32 v106, s32, v10
    v_add_u32 v107, s32, v11
    v_add_u32 v108, s32, v12
    v_add_u32 v109, s32, v13
    v_add_u32 v110, s32, v14
    v_add_u32 v111, s32, v15
    v_add_u32 v112, s32, v16
    s_add_u32 s20, s20, 262144
    s_add_u32 s21, s21, 131072
    s_add_u32 s33, s33, 20480
    s_cmp_eq_u32 s33, 122880
    s_cselect_b32 s33, 0, s33
    s_add_u32 s34, s22, s33
    s_add_u32 s35, s23, s33
    s_waitcnt vmcnt(8) lgkmcnt(0)
    s_barrier
    v_mfma_f32_16x16x32_bf16 a[0:3], v[64:67], v[96:99], a[0:3]
    v_mfma_f32_16x16x32_bf16 a[8:11], v[68:71], v[96:99], a[8:11]
    ds_read_b128 v[56:59], v112 offset:0
    ds_read_b64_tr_b16 v[24:25], v104
    s_add_u32 m0, s34, 0
    v_mfma_f32_16x16x32_bf16 a[16:19], v[72:75], v[96:99], a[16:19]
    buffer_load_dwordx4 v17, s[8:11], s20 offen lds
    v_mfma_f32_16x16x32_bf16 a[24:27], v[76:79], v[96:99], a[24:27]
    ds_read_b64_tr_b16 v[26:27], v104 offset:1024
    ds_read_b128 v[60:63], v112 offset:1024
    ds_read_b64_tr_b16 v[28:29], v105
    v_mfma_f32_16x16x32_bf16 a[32:35], v[80:83], v[96:99], a[32:35]
    ds_read_b64_tr_b16 v[30:31], v105 offset:1024
    s_add_u32 m0, s34, 1024
    v_mfma_f32_16x16x32_bf16 a[40:43], v[84:87], v[96:99], a[40:43]
    buffer_load_dwordx4 v18, s[8:11], s20 offen lds
    v_mfma_f32_16x16x32_bf16 a[48:51], v[88:91], v[96:99], a[48:51]
    ds_read_b64_tr_b16 v[32:33], v106
    ds_read_b64_tr_b16 v[34:35], v106 offset:1024
    ds_read_b64_tr_b16 v[36:37], v107
    v_mfma_f32_16x16x32_bf16 a[56:59], v[92:95], v[96:99], a[56:59]
    ds_read_b64_tr_b16 v[38:39], v107 offset:1024
    ds_read_b64_tr_b16 v[40:41], v108
    s_add_u32 m0, s34, 2048
    v_mfma_f32_16x16x32_bf16 a[4:7], v[64:67], v[100:103], a[4:7]
    buffer_load_dwordx4 v19, s[8:11], s20 offen lds
    v_mfma_f32_16x16x32_bf16 a[12:15], v[68:71], v[100:103], a[12:15]
    ds_read_b64_tr_b16 v[42:43], v108 offset:1024
    ds_read_b64_tr_b16 v[44:45], v109
    ds_read_b64_tr_b16 v[46:47], v109 offset:1024
    v_mfma_f32_16x16x32_bf16 a[20:23], v[72:75], v[100:103], a[20:23]
    ds_read_b64_tr_b16 v[48:49], v110
    s_add_u32 m0, s34, 3072
    v_mfma_f32_16x16x32_bf16 a[28:31], v[76:79], v[100:103], a[28:31]
    buffer_load_dwordx4 v20, s[8:11], s20 offen lds
    v_mfma_f32_16x16x32_bf16 a[36:39], v[80:83], v[100:103], a[36:39]
    ds_read_b64_tr_b16 v[50:51], v110 offset:1024
    ds_read_b64_tr_b16 v[52:53], v111
    ds_read_b64_tr_b16 v[54:55], v111 offset:1024
    v_mfma_f32_16x16x32_bf16 a[44:47], v[84:87], v[100:103], a[44:47]
    s_add_u32 s32, s32, 20480
    s_cmp_eq_u32 s32, 122880
    s_cselect_b32 s32, 0, s32
    s_add_u32 m0, s35, 0
    v_mfma_f32_16x16x32_bf16 a[52:55], v[88:91], v[100:103], a[52:55]
    buffer_load_dwordx4 v21, s[12:15], s21 offen lds
    v_add_u32 v104, s32, v8
    v_mfma_f32_16x16x32_bf16 a[60:63], v[92:95], v[100:103], a[60:63]
    v_add_u32 v105, s32, v9
    v_add_u32 v106, s32, v10
    v_add_u32 v107, s32, v11
    v_add_u32 v108, s32, v12
    v_add_u32 v109, s32, v13
    v_add_u32 v110, s32, v14
    v_add_u32 v111, s32, v15
    v_add_u32 v112, s32, v16
    s_add_u32 s20, s20, 262144
    s_add_u32 s21, s21, 131072
    s_add_u32 s33, s33, 20480
    s_cmp_eq_u32 s33, 122880
    s_cselect_b32 s33, 0, s33
    s_add_u32 s34, s22, s33
    s_add_u32 s35, s23, s33
    s_waitcnt vmcnt(12) lgkmcnt(0)
    s_barrier
    s_mov_b32 s24, 15
B_L_gC_loop:
    v_mfma_f32_16x16x32_bf16 a[0:3], v[24:27], v[56:59], a[0:3]
    v_mfma_f32_16x16x32_bf16 a[8:11], v[28:31], v[56:59], a[8:11]
    ds_read_b128 v[96:99], v112 offset:0
    ds_read_b64_tr_b16 v[64:65], v104
    s_add_u32 m0, s34, 0
    v_mfma_f32_16x16x32_bf16 a[16:19], v[32:35], v[56:59], a[16:19]
    buffer_load_dwordx4 v17, s[8:11], s20 offen lds
    v_mfma_f32_16x16x32_bf16 a[24:27], v[36:39], v[56:59], a[24:27]
    ds_read_b64_tr_b16 v[66:67], v104 offset:1024
    ds_read_b128 v[100:103], v112 offset:1024
    ds_read_b64_tr_b16 v[68:69], v105
    v_mfma_f32_16x16x32_bf16 a[32:35], v[40:43], v[56:59], a[32:35]
    ds_read_b64_tr_b16 v[70:71], v105 offset:1024
    s_add_u32 m0, s34, 1024
    v_mfma_f32_16x16x32_bf16 a[40:43], v[44:47], v[56:59], a[40:43]
    buffer_load_dwordx4 v18, s[8:11], s20 offen lds
    v_mfma_f32_16x16x32_bf16 a[48:51], v[48:51], v[56:59], a[48:51]
    ds_read_b64_tr_b16 v[72:73], v106
    ds_read_b64_tr_b16 v[74:75], v106 offset:1024
    ds_read_b64_tr_b16 v[76:77], v107
    v_mfma_f32_16x16x32_bf16 a[56:59], v[52:55], v[56:59], a[56:59]
    ds_read_b64_tr_b16 v[78:79], v107 offset:1024
    ds_read_b64_tr_b16 v[80:81], v108
    s_add_u32 m0, s34, 2048
    v_mfma_f32_16x16x32_bf16 a[4:7], v[24:27], v[60:63], a[4:7]
    buffer_load_dwordx4 v19, s[8:11], s20 offen lds
    v_mfma_f32_16x16x32_bf16 a[12:15], v[28:31], v[60:63], a[12:15]
    ds_read_b64_tr_b16 v[82:83], v108 offset:1024
    ds_read_b64_tr_b16 v[84:85], v109
    ds_read_b64_tr_b16 v[86:87], v109 offset:1024
    v_mfma_f32_16x16x32_bf16 a[20:23], v[32:35], v[60:63], a[20:23]
    ds_read_b64_tr_b16 v[88:89], v110
    s_add_u32 m0, s34, 3072
    v_mfma_f32_16x16x32_bf16 a[28:31], v[36:39], v[60:63], a[28:31]
    buffer_load_dwordx4 v20, s[8:11], s20 offen lds
    v_mfma_f32_16x16x32_bf16 a[36:39], v[40:43], v[60:63], a[36:39]
    ds_read_b64_tr_b16 v[90:91], v110 offset:1024
    ds_read_b64_tr_b16 v[92:93], v111
    ds_read_b64_tr_b16 v[94:95], v111 offset:1024
    v_mfma_f32_16x16x32_bf16 a[44:47], v[44:47], v[60:63], a[44:47]
    s_add_u32 s32, s32, 20480
    s_cmp_eq_u32 s32, 122880
    s_cselect_b32 s32, 0, s32
    s_add_u32 m0, s35, 0
    v_mfma_f32_16x16x32_bf16 a[52:55], v[48:51], v[60:63], a[52:55]
    buffer_load_dwordx4 v21, s[12:15], s21 offen lds
    v_add_u32 v104, s32, v8
    v_mfma_f32_16x16x32_bf16 a[60:63], v[52:55], v[60:63], a[60:63]
    v_add_u32 v105, s32, v9
    v_add_u32 v106, s32, v10
    v_add_u32 v107, s32, v11
    v_add_u32 v108, s32, v12
    v_add_u32 v109, s32, v13
    v_add_u32 v110, s32, v14
    v_add_u32 v111, s32, v15
    v_add_u32 v112, s32, v16
    s_add_u32 s20, s20, 262144
    s_add_u32 s21, s21, 131072
    s_add_u32 s33, s33, 20480
    s_cmp_eq_u32 s33, 122880
    s_cselect_b32 s33, 0, s33
    s_add_u32 s34, s22, s33
    s_add_u32 s35, s23, s33
    s_waitcnt vmcnt(16) lgkmcnt(0)
    s_barrier
    v_mfma_f32_16x16x32_bf16 a[0:3], v[64:67], v[96:99], a[0:3]
    v_mfma_f32_16x16x32_bf16 a[8:11], v[68:71], v[96:99], a[8:11]
    ds_read_b128 v[56:59], v112 offset:0
    ds_read_b64_tr_b16 v[24:25], v104
    s_add_u32 m0, s34, 0
    v_mfma_f32_16x16x32_bf16 a[16:19], v[72:75], v[96:99], a[16:19]
    buffer_load_dwordx4 v17, s[8:11], s20 offen lds
    v_mfma_f32_16x16x32_bf16 a[24:27], v[76:79], v[96:99], a[24:27]
    ds_read_b64_tr_b16 v[26:27], v104 offset:1024
    ds_read_b128 v[60:63], v112 offset:1024
    ds_read_b64_tr_b16 v[28:29], v105
    v_mfma_f32_16x16x32_bf16 a[32:35], v[80:83], v[96:99], a[32:35]
    ds_read_b64_tr_b16 v[30:31], v105 offset:1024
    s_add_u32 m0, s34, 1024
    v_mfma_f32_16x16x32_bf16 a[40:43], v[84:87], v[96:99], a[40:43]
    buffer_load_dwordx4 v18, s[8:11], s20 offen lds
    v_mfma_f32_16x16x32_bf16 a[48:51], v[88:91], v[96:99], a[48:51]
    ds_read_b64_tr_b16 v[32:33], v106
    ds_read_b64_tr_b16 v[34:35], v106 offset:1024
    ds_read_b64_tr_b16 v[36:37], v107
    v_mfma_f32_16x16x32_bf16 a[56:59], v[92:95], v[96:99], a[56:59]
    ds_read_b64_tr_b16 v[38:39], v107 offset:1024
    ds_read_b64_tr_b16 v[40:41], v108
    s_add_u32 m0, s34, 2048
    v_mfma_f32_16x16x32_bf16 a[4:7], v[64:67], v[100:103], a[4:7]
    buffer_load_dwordx4 v19, s[8:11], s20 offen lds
    v_mfma_f32_16x16x32_bf16 a[12:15], v[68:71], v[100:103], a[12:15]
    ds_read_b64_tr_b16 v[42:43], v108 offset:1024
    ds_read_b64_tr_b16 v[44:45], v109
    ds_read_b64_tr_b16 v[46:47], v109 offset:1024
    v_mfma_f32_16x16x32_bf16 a[20:23], v[72:75], v[100:103], a[20:23]
    ds_read_b64_tr_b16 v[48:49], v110
    s_add_u32 m0, s34, 3072
    v_mfma_f32_16x16x32_bf16 a[28:31], v[76:79], v[100:103], a[28:31]
    buffer_load_dwordx4 v20, s[8:11], s20 offen lds
    v_mfma_f32_16x16x32_bf16 a[36:39], v[80:83], v[100:103], a[36:39]
    ds_read_b64_tr_b16 v[50:51], v110 offset:1024
    ds_read_b64_tr_b16 v[52:53], v111
    ds_read_b64_tr_b16 v[54:55], v111 offset:1024
    v_mfma_f32_16x16x32_bf16 a[44:47], v[84:87], v[100:103], a[44:47]
    s_add_u32 s32, s32, 20480
    s_cmp_eq_u32 s32, 122880
    s_cselect_b32 s32, 0, s32
    s_add_u32 m0, s35, 0
    v_mfma_f32_16x16x32_bf16 a[52:55], v[88:91], v[100:103], a[52:55]
    buffer_load_dwordx4 v21, s[12:15], s21 offen lds
    v_add_u32 v104, s32, v8
    v_mfma_f32_16x16x32_bf16 a[60:63], v[92:95], v[100:103], a[60:63]
    v_add_u32 v105, s32, v9
    v_add_u32 v106, s32, v10
    v_add_u32 v107, s32, v11
    v_add_u32 v108, s32, v12
    v_add_u32 v109, s32, v13
    v_add_u32 v110, s32, v14
    v_add_u32 v111, s32, v15
    v_add_u32 v112, s32, v16
    s_add_u32 s20, s20, 262144
    s_add_u32 s21, s21, 131072
    s_add_u32 s33, s33, 20480
    s_cmp_eq_u32 s33, 122880
    s_cselect_b32 s33, 0, s33
    s_add_u32 s34, s22, s33
    s_add_u32 s35, s23, s33
    s_waitcnt vmcnt(16) lgkmcnt(0)
    s_barrier
    s_sub_u32 s24, s24, 1
    s_cmp_lg_u32 s24, 0
    s_cbranch_scc1 B_L_gC_loop
    s_waitcnt vmcnt(0)
    s_and_b32 s25, s67, 15
    s_lshl_b32 s25, s25, 1
    s_and_b32 s26, s3, 1
    s_add_u32 s25, s25, s26
    s_lshr_b32 s26, s68, 5
    s_lshr_b32 s27, s3, 1
    s_mul_i32 s27, s27, 1
    s_add_u32 s26, s26, s27
    s_lshl_b32 s26, s26, 5
    s_add_u32 s25, s25, s26
    s_lshl_b32 s25, s25, 13
    v_lshrrev_b32 v2, 4, v0
    v_and_b32 v3, 1, v2
    v_lshrrev_b32 v2, 1, v2
    v_lshl_or_b32 v2, v3, 1, v2
    v_and_b32 v3, 15, v0
    v_lshl_or_b32 v2, v2, 4, v3
    v_lshlrev_b32 v1, 4, v2
    s_add_u32 s26, s25, 0
    v_accvgpr_read_b32 v28, a0
    v_accvgpr_read_b32 v29, a1
    v_accvgpr_read_b32 v30, a2
    v_accvgpr_read_b32 v31, a3
    v_accvgpr_read_b32 v32, a8
    v_accvgpr_read_b32 v33, a9
    v_accvgpr_read_b32 v34, a10
    v_accvgpr_read_b32 v35, a11
    v_cvt_pk_bf16_f32 v24, v28, v29
    v_cvt_pk_bf16_f32 v25, v30, v31
    v_cvt_pk_bf16_f32 v26, v32, v33
    v_cvt_pk_bf16_f32 v27, v34, v35
    s_nop 0
    v_permlane16_swap_b32 v24, v26
    v_permlane16_swap_b32 v25, v27
    buffer_store_dwordx4 v[24:27], v1, s[16:19], s26 offen offset:0 sc1
    v_accvgpr_read_b32 v40, a16
    v_accvgpr_read_b32 v41, a17
    v_accvgpr_read_b32 v42, a18
    v_accvgpr_read_b32 v43, a19
    v_accvgpr_read_b32 v44, a24
    v_accvgpr_read_b32 v45, a25
    v_accvgpr_read_b32 v46, a26
    v_accvgpr_read_b32 v47, a27
    v_cvt_pk_bf16_f32 v36, v40, v41
    v_cvt_pk_bf16_f32 v37, v42, v43
    v_cvt_pk_bf16_f32 v38, v44, v45
    v_cvt_pk_bf16_f32 v39, v46, v47
    s_nop 0
    v_permlane16_swap_b32 v36, v38
    v_permlane16_swap_b32 v37, v39
    buffer_store_dwordx4 v[36:39], v1, s[16:19], s26 offen offset:1024 sc1
    v_accvgpr_read_b32 v52, a32
    v_accvgpr_read_b32 v53, a33
    v_accvgpr_read_b32 v54, a34
    v_accvgpr_read_b32 v55, a35
    v_accvgpr_read_b32 v56, a40
    v_accvgpr_read_b32 v57, a41
    v_accvgpr_read_b32 v58, a42
    v_accvgpr_read_b32 v59, a43
    v_cvt_pk_bf16_f32 v48, v52, v53
    v_cvt_pk_bf16_f32 v49, v54, v55
    v_cvt_pk_bf16_f32 v50, v56, v57
    v_cvt_pk_bf16_f32 v51, v58, v59
    s_nop 0
    v_permlane16_swap_b32 v48, v50
    v_permlane16_swap_b32 v49, v51
    buffer_store_dwordx4 v[48:51], v1, s[16:19], s26 offen offset:2048 sc1
    v_accvgpr_read_b32 v64, a48
    v_accvgpr_read_b32 v65, a49
    v_accvgpr_read_b32 v66, a50
    v_accvgpr_read_b32 v67, a51
    v_accvgpr_read_b32 v68, a56
    v_accvgpr_read_b32 v69, a57
    v_accvgpr_read_b32 v70, a58
    v_accvgpr_read_b32 v71, a59
    v_cvt_pk_bf16_f32 v60, v64, v65
    v_cvt_pk_bf16_f32 v61, v66, v67
    v_cvt_pk_bf16_f32 v62, v68, v69
    v_cvt_pk_bf16_f32 v63, v70, v71
    s_nop 0
    v_permlane16_swap_b32 v60, v62
    v_permlane16_swap_b32 v61, v63
    buffer_store_dwordx4 v[60:63], v1, s[16:19], s26 offen offset:3072 sc1
    s_add_u32 s26, s25, 4096
    v_accvgpr_read_b32 v28, a4
    v_accvgpr_read_b32 v29, a5
    v_accvgpr_read_b32 v30, a6
    v_accvgpr_read_b32 v31, a7
    v_accvgpr_read_b32 v32, a12
    v_accvgpr_read_b32 v33, a13
    v_accvgpr_read_b32 v34, a14
    v_accvgpr_read_b32 v35, a15
    v_cvt_pk_bf16_f32 v24, v28, v29
    v_cvt_pk_bf16_f32 v25, v30, v31
    v_cvt_pk_bf16_f32 v26, v32, v33
    v_cvt_pk_bf16_f32 v27, v34, v35
    s_nop 0
    v_permlane16_swap_b32 v24, v26
    v_permlane16_swap_b32 v25, v27
    buffer_store_dwordx4 v[24:27], v1, s[16:19], s26 offen offset:0 sc1
    v_accvgpr_read_b32 v40, a20
    v_accvgpr_read_b32 v41, a21
    v_accvgpr_read_b32 v42, a22
    v_accvgpr_read_b32 v43, a23
    v_accvgpr_read_b32 v44, a28
    v_accvgpr_read_b32 v45, a29
    v_accvgpr_read_b32 v46, a30
    v_accvgpr_read_b32 v47, a31
    v_cvt_pk_bf16_f32 v36, v40, v41
    v_cvt_pk_bf16_f32 v37, v42, v43
    v_cvt_pk_bf16_f32 v38, v44, v45
    v_cvt_pk_bf16_f32 v39, v46, v47
    s_nop 0
    v_permlane16_swap_b32 v36, v38
    v_permlane16_swap_b32 v37, v39
    buffer_store_dwordx4 v[36:39], v1, s[16:19], s26 offen offset:1024 sc1
    v_accvgpr_read_b32 v52, a36
    v_accvgpr_read_b32 v53, a37
    v_accvgpr_read_b32 v54, a38
    v_accvgpr_read_b32 v55, a39
    v_accvgpr_read_b32 v56, a44
    v_accvgpr_read_b32 v57, a45
    v_accvgpr_read_b32 v58, a46
    v_accvgpr_read_b32 v59, a47
    v_cvt_pk_bf16_f32 v48, v52, v53
    v_cvt_pk_bf16_f32 v49, v54, v55
    v_cvt_pk_bf16_f32 v50, v56, v57
    v_cvt_pk_bf16_f32 v51, v58, v59
    s_nop 0
    v_permlane16_swap_b32 v48, v50
    v_permlane16_swap_b32 v49, v51
    buffer_store_dwordx4 v[48:51], v1, s[16:19], s26 offen offset:2048 sc1
    v_accvgpr_read_b32 v64, a52
    v_accvgpr_read_b32 v65, a53
    v_accvgpr_read_b32 v66, a54
    v_accvgpr_read_b32 v67, a55
    v_accvgpr_read_b32 v68, a60
    v_accvgpr_read_b32 v69, a61
    v_accvgpr_read_b32 v70, a62
    v_accvgpr_read_b32 v71, a63
    v_cvt_pk_bf16_f32 v60, v64, v65
    v_cvt_pk_bf16_f32 v61, v66, v67
    v_cvt_pk_bf16_f32 v62, v68, v69
    v_cvt_pk_bf16_f32 v63, v70, v71
    s_nop 0
    v_permlane16_swap_b32 v60, v62
    v_permlane16_swap_b32 v61, v63
    buffer_store_dwordx4 v[60:63], v1, s[16:19], s26 offen offset:3072 sc1
    s_waitcnt vmcnt(0)
    s_barrier
    s_branch B_L_sig
B_L_smallv:
    s_and_b32 s26, s67, 15
    s_lshl_b32 s20, s26, 9
    s_lshl_b32 s21, s68, 6
    s_mul_i32 s22, s3, 4096
    s_mul_i32 s23, s3, 1024
    v_and_b32 v1, 15, v0
    v_lshrrev_b32 v2, 4, v0
    v_lshrrev_b32 v3, 2, v1
    v_and_b32 v4, 1, v2
    v_lshrrev_b32 v5, 1, v2
    v_lshlrev_b32 v6, 3, v3
    v_lshl_add_u32 v6, v5, 2, v6
    v_add_u32 v6, v6, v4
    v_lshl_or_b32 v3, v4, 2, v3
    v_lshlrev_b32 v6, 9, v6
    v_and_b32 v4, 3, v1
    v_lshl_add_u32 v6, v4, 3, v6
    s_and_b32 s25, s3, 1
    s_mul_i32 s25, s25, 8
    s_add_u32 s26, s25, 0
    v_xor_b32 v4, s26, v3
    v_lshl_add_u32 v8, v4, 5, v6
    s_add_u32 s26, s25, 1
    v_xor_b32 v4, s26, v3
    v_lshl_add_u32 v9, v4, 5, v6
    s_add_u32 s26, s25, 2
    v_xor_b32 v4, s26, v3
    v_lshl_add_u32 v10, v4, 5, v6
    s_add_u32 s26, s25, 3
    v_xor_b32 v4, s26, v3
    v_lshl_add_u32 v11, v4, 5, v6
    s_add_u32 s26, s25, 4
    v_xor_b32 v4, s26, v3
    v_lshl_add_u32 v12, v4, 5, v6
    s_add_u32 s26, s25, 5
    v_xor_b32 v4, s26, v3
    v_lshl_add_u32 v13, v4, 5, v6
    s_add_u32 s26, s25, 6
    v_xor_b32 v4, s26, v3
    v_lshl_add_u32 v14, v4, 5, v6
    s_add_u32 s26, s25, 7
    v_xor_b32 v4, s26, v3
    v_lshl_add_u32 v15, v4, 5, v6
    v_lshrrev_b32 v3, 2, v1
    v_lshrrev_b32 v4, 1, v3
    v_and_b32 v5, 1, v3
    v_xor_b32 v5, v5, v4
    v_lshl_or_b32 v5, v5, 1, v4
    v_xor_b32 v5, v5, v2
    v_lshlrev_b32 v5, 4, v5
    v_lshl_add_u32 v5, v1, 6, v5
    s_lshr_b32 s25, s3, 1
    s_mul_i32 s25, s25, 2048
    s_add_u32 s25, s25, 16384
    v_add_u32 v16, s25, v5
    v_lshrrev_b32 v3, 5, v0
    v_and_b32 v4, 31, v0
    v_lshlrev_b32 v5, 3, v3
    v_add_u32 v5, s3, v5
    v_lshlrev_b32 v6, 2, v3
    v_or_b32 v6, s3, v6
    v_lshrrev_b32 v1, 1, v4
    v_xor_b32 v1, v1, v6
    v_lshlrev_b32 v1, 5, v1
    v_and_b32 v4, 1, v4
    v_lshl_or_b32 v1, v4, 4, v1
    s_mov_b32 s25, 8192
    v_mul_lo_u32 v5, v5, s25
    v_add_u32 v17, v5, v1
    v_add_u32 v18, 32768, v17
    v_add_u32 v19, 131072, v17
    v_add_u32 v20, 163840, v17
    v_lshlrev_b32 v3, 4, v0
    s_mul_i32 s25, s3, 1024
    v_add_u32 v21, s25, v3
    s_add_u32 s23, s23, 16384
    s_mov_b32 s33, 0
    s_mov_b32 s32, 0
    s_add_u32 s34, s22, s33
    s_add_u32 s35, s23, s33
    s_add_u32 m0, s34, 0
    s_nop 0
    buffer_load_dwordx4 v17, s[8:11], s20 offen lds
    s_add_u32 m0, s34, 1024
    s_nop 0
    buffer_load_dwordx4 v18, s[8:11], s20 offen lds
    s_add_u32 m0, s34, 2048
    s_nop 0
    buffer_load_dwordx4 v19, s[8:11], s20 offen lds
    s_add_u32 m0, s34, 3072
    s_nop 0
    buffer_load_dwordx4 v20, s[8:11], s20 offen lds
    s_add_u32 s20, s20, 262144
    s_add_u32 s33, s33, 20480
    s_cmp_eq_u32 s33, 122880
    s_cselect_b32 s33, 0, s33
    s_add_u32 s34, s22, s33
    s_add_u32 s35, s23, s33
    s_add_u32 m0, s34, 0
    s_nop 0
    buffer_load_dwordx4 v17, s[8:11], s20 offen lds
    s_add_u32 m0, s34, 1024
    s_nop 0
    buffer_load_dwordx4 v18, s[8:11], s20 offen lds
    s_add_u32 m0, s34, 2048
    s_nop 0
    buffer_load_dwordx4 v19, s[8:11], s20 offen lds
    s_add_u32 m0, s34, 3072
    s_nop 0
    buffer_load_dwordx4 v20, s[8:11], s20 offen lds
    s_add_u32 s20, s20, 262144
    s_add_u32 s33, s33, 20480
    s_cmp_eq_u32 s33, 122880
    s_cselect_b32 s33, 0, s33
    s_add_u32 s34, s22, s33
    s_add_u32 s35, s23, s33
    s_add_u32 m0, s34, 0
    s_nop 0
    buffer_load_dwordx4 v17, s[8:11], s20 offen lds
    s_add_u32 m0, s34, 1024
    s_nop 0
    buffer_load_dwordx4 v18, s[8:11], s20 offen lds
    s_add_u32 m0, s34, 2048
    s_nop 0
    buffer_load_dwordx4 v19, s[8:11], s20 offen lds
    s_add_u32 m0, s34, 3072
    s_nop 0
    buffer_load_dwordx4 v20, s[8:11], s20 offen lds
    s_add_u32 s20, s20, 262144
    s_add_u32 s33, s33, 20480
    s_cmp_eq_u32 s33, 122880
    s_cselect_b32 s33, 0, s33
    s_add_u32 s34, s22, s33
    s_add_u32 s35, s23, s33
    s_add_u32 m0, s34, 0
    s_nop 0
    buffer_load_dwordx4 v17, s[8:11], s20 offen lds
    s_add_u32 m0, s34, 1024
    s_nop 0
    buffer_load_dwordx4 v18, s[8:11], s20 offen lds
    s_add_u32 m0, s34, 2048
    s_nop 0
    buffer_load_dwordx4 v19, s[8:11], s20 offen lds
    s_add_u32 m0, s34, 3072
    s_nop 0
    buffer_load_dwordx4 v20, s[8:11], s20 offen lds
    s_add_u32 s20, s20, 262144
    s_add_u32 s33, s33, 20480
    s_cmp_eq_u32 s33, 122880
    s_cselect_b32 s33, 0, s33
    s_add_u32 s34, s22, s33
    s_add_u32 s35, s23, s33
    s_add_u32 m0, s34, 0
    s_nop 0
    buffer_load_dwordx4 v17, s[8:11], s20 offen lds
    s_add_u32 m0, s34, 1024
    s_nop 0
    buffer_load_dwordx4 v18, s[8:11], s20 offen lds
    s_add_u32 m0, s34, 2048
    s_nop 0
    buffer_load_dwordx4 v19, s[8:11], s20 offen lds
    s_add_u32 m0, s34, 3072
    s_nop 0
    buffer_load_dwordx4 v20, s[8:11], s20 offen lds
    s_add_u32 s20, s20, 262144
    s_add_u32 s33, s33, 20480
    s_cmp_eq_u32 s33, 122880
    s_cselect_b32 s33, 0, s33
    s_add_u32 s34, s22, s33
    s_add_u32 s35, s23, s33
    s_add_u32 m0, s34, 0
    s_nop 0
    buffer_load_dwordx4 v17, s[8:11], s20 offen lds
    s_add_u32 m0, s34, 1024
    s_nop 0
    buffer_load_dwordx4 v18, s[8:11], s20 offen lds
    s_add_u32 m0, s34, 2048
    s_nop 0
    buffer_load_dwordx4 v19, s[8:11], s20 offen lds
    s_add_u32 m0, s34, 3072
    s_nop 0
    buffer_load_dwordx4 v20, s[8:11], s20 offen lds
    s_add_u32 s20, s20, 262144
    s_add_u32 s33, s33, 20480
    s_cmp_eq_u32 s33, 122880
    s_cselect_b32 s33, 0, s33
    s_cmp_lg_u32 s3, 0
    s_cbranch_scc1 B_L_wc_l1d_b
    s_add_u32 s44, s73, 41984
    v_mov_b32 v2, s44
B_L_wc_l1d:
    global_load_dword v3, v2, s[60:61] sc1
    s_waitcnt vmcnt(0)
    v_readfirstlane_b32 s44, v3
    s_nop 0
    s_cmp_ge_u32 s44, 16
    s_cbranch_scc1 B_L_wc_l1d_b
    s_sleep 3
    s_sub_u32 s66, s66, 1
    s_cbranch_scc0 B_L_wc_l1d
    s_mov_b32 s66, 0
B_L_wc_l1d_b:
    s_barrier
    s_add_u32 s34, s22, s33
    s_add_u32 s35, s23, s33
    s_add_u32 m0, s35, 0
    s_nop 0
    buffer_load_dwordx4 v21, s[12:15], s21 offen lds
    s_add_u32 s21, s21, 131072
    s_add_u32 s33, s33, 20480
    s_cmp_eq_u32 s33, 122880
    s_cselect_b32 s33, 0, s33
    s_add_u32 s34, s22, s33
    s_add_u32 s35, s23, s33
    s_add_u32 m0, s35, 0
    s_nop 0
    buffer_load_dwordx4 v21, s[12:15], s21 offen lds
    s_add_u32 s21, s21, 131072
    s_add_u32 s33, s33, 20480
    s_cmp_eq_u32 s33, 122880
    s_cselect_b32 s33, 0, s33
    s_add_u32 s34, s22, s33
    s_add_u32 s35, s23, s33
    s_add_u32 m0, s35, 0
    s_nop 0
    buffer_load_dwordx4 v21, s[12:15], s21 offen lds
    s_add_u32 s21, s21, 131072
    s_add_u32 s33, s33, 20480
    s_cmp_eq_u32 s33, 122880
    s_cselect_b32 s33, 0, s33
    s_add_u32 s34, s22, s33
    s_add_u32 s35, s23, s33
    s_add_u32 m0, s35, 0
    s_nop 0
    buffer_load_dwordx4 v21, s[12:15], s21 offen lds
    s_add_u32 s21, s21, 131072
    s_add_u32 s33, s33, 20480
    s_cmp_eq_u32 s33, 122880
    s_cselect_b32 s33, 0, s33
    s_add_u32 s34, s22, s33
    s_add_u32 s35, s23, s33
    s_add_u32 m0, s35, 0
    s_nop 0
    buffer_load_dwordx4 v21, s[12:15], s21 offen lds
    s_add_u32 s21, s21, 131072
    s_add_u32 s33, s33, 20480
    s_cmp_eq_u32 s33, 122880
    s_cselect_b32 s33, 0, s33
    s_add_u32 s34, s22, s33
    s_add_u32 s35, s23, s33
    s_add_u32 m0, s35, 0
    s_nop 0
    buffer_load_dwordx4 v21, s[12:15], s21 offen lds
    s_add_u32 s21, s21, 131072
    s_add_u32 s33, s33, 20480
    s_cmp_eq_u32 s33, 122880
    s_cselect_b32 s33, 0, s33
    v_add_u32 v104, s32, v8
    v_add_u32 v105, s32, v9
    v_add_u32 v106, s32, v10
    v_add_u32 v107, s32, v11
    v_add_u32 v108, s32, v12
    v_add_u32 v109, s32, v13
    v_add_u32 v110, s32, v14
    v_add_u32 v111, s32, v15
    v_add_u32 v112, s32, v16
    s_waitcnt vmcnt(5)
    s_barrier
    ds_read_b128 v[56:59], v112 offset:0
    ds_read_b64_tr_b16 v[24:25], v104
    ds_read_b64_tr_b16 v[26:27], v104 offset:1024
    ds_read_b128 v[60:63], v112 offset:1024
    ds_read_b64_tr_b16 v[28:29], v105
    ds_read_b64_tr_b16 v[30:31], v105 offset:1024
    ds_read_b64_tr_b16 v[32:33], v106
    ds_read_b64_tr_b16 v[34:35], v106 offset:1024
    ds_read_b64_tr_b16 v[36:37], v107
    ds_read_b64_tr_b16 v[38:39], v107 offset:1024
    ds_read_b64_tr_b16 v[40:41], v108
    ds_read_b64_tr_b16 v[42:43], v108 offset:1024
    ds_read_b64_tr_b16 v[44:45], v109
    ds_read_b64_tr_b16 v[46:47], v109 offset:1024
    ds_read_b64_tr_b16 v[48:49], v110
    ds_read_b64_tr_b16 v[50:51], v110 offset:1024
    ds_read_b64_tr_b16 v[52:53], v111
    ds_read_b64_tr_b16 v[54:55], v111 offset:1024
    s_add_u32 s32, s32, 20480
    s_cmp_eq_u32 s32, 122880
    s_cselect_b32 s32, 0, s32
    v_add_u32 v104, s32, v8
    v_add_u32 v105, s32, v9
    v_add_u32 v106, s32, v10
    v_add_u32 v107, s32, v11
    v_add_u32 v108, s32, v12
    v_add_u32 v109, s32, v13
    v_add_u32 v110, s32, v14
    v_add_u32 v111, s32, v15
    v_add_u32 v112, s32, v16
    s_add_u32 s34, s22, s33
    s_add_u32 s35, s23, s33
    s_waitcnt vmcnt(4) lgkmcnt(0)
    s_barrier
    v_mfma_f32_16x16x32_bf16 a[0:3], v[56:59], v[24:27], 0
    v_mfma_f32_16x16x32_bf16 a[8:11], v[56:59], v[28:31], 0
    ds_read_b128 v[96:99], v112 offset:0
    ds_read_b64_tr_b16 v[64:65], v104
    s_add_u32 m0, s34, 0
    v_mfma_f32_16x16x32_bf16 a[16:19], v[56:59], v[32:35], 0
    buffer_load_dwordx4 v17, s[8:11], s20 offen lds
    v_mfma_f32_16x16x32_bf16 a[24:27], v[56:59], v[36:39], 0
    ds_read_b64_tr_b16 v[66:67], v104 offset:1024
    ds_read_b128 v[100:103], v112 offset:1024
    ds_read_b64_tr_b16 v[68:69], v105
    v_mfma_f32_16x16x32_bf16 a[32:35], v[56:59], v[40:43], 0
    ds_read_b64_tr_b16 v[70:71], v105 offset:1024
    s_add_u32 m0, s34, 1024
    v_mfma_f32_16x16x32_bf16 a[40:43], v[56:59], v[44:47], 0
    buffer_load_dwordx4 v18, s[8:11], s20 offen lds
    v_mfma_f32_16x16x32_bf16 a[48:51], v[56:59], v[48:51], 0
    ds_read_b64_tr_b16 v[72:73], v106
    ds_read_b64_tr_b16 v[74:75], v106 offset:1024
    ds_read_b64_tr_b16 v[76:77], v107
    v_mfma_f32_16x16x32_bf16 a[56:59], v[56:59], v[52:55], 0
    ds_read_b64_tr_b16 v[78:79], v107 offset:1024
    ds_read_b64_tr_b16 v[80:81], v108
    s_add_u32 m0, s34, 2048
    v_mfma_f32_16x16x32_bf16 a[4:7], v[60:63], v[24:27], 0
    buffer_load_dwordx4 v19, s[8:11], s20 offen lds
    v_mfma_f32_16x16x32_bf16 a[12:15], v[60:63], v[28:31], 0
    ds_read_b64_tr_b16 v[82:83], v108 offset:1024
    ds_read_b64_tr_b16 v[84:85], v109
    ds_read_b64_tr_b16 v[86:87], v109 offset:1024
    v_mfma_f32_16x16x32_bf16 a[20:23], v[60:63], v[32:35], 0
    ds_read_b64_tr_b16 v[88:89], v110
    s_add_u32 m0, s34, 3072
    v_mfma_f32_16x16x32_bf16 a[28:31], v[60:63], v[36:39], 0
    buffer_load_dwordx4 v20, s[8:11], s20 offen lds
    v_mfma_f32_16x16x32_bf16 a[36:39], v[60:63], v[40:43], 0
    ds_read_b64_tr_b16 v[90:91], v110 offset:1024
    ds_read_b64_tr_b16 v[92:93], v111
    ds_read_b64_tr_b16 v[94:95], v111 offset:1024
    v_mfma_f32_16x16x32_bf16 a[44:47], v[60:63], v[44:47], 0
    s_add_u32 s32, s32, 20480
    s_cmp_eq_u32 s32, 122880
    s_cselect_b32 s32, 0, s32
    s_add_u32 m0, s35, 0
    v_mfma_f32_16x16x32_bf16 a[52:55], v[60:63], v[48:51], 0
    buffer_load_dwordx4 v21, s[12:15], s21 offen lds
    v_add_u32 v104, s32, v8
    v_mfma_f32_16x16x32_bf16 a[60:63], v[60:63], v[52:55], 0
    v_add_u32 v105, s32, v9
    v_add_u32 v106, s32, v10
    v_add_u32 v107, s32, v11
    v_add_u32 v108, s32, v12
    v_add_u32 v109, s32, v13
    v_add_u32 v110, s32, v14
    v_add_u32 v111, s32, v15
    v_add_u32 v112, s32, v16
    s_add_u32 s20, s20, 262144
    s_add_u32 s21, s21, 131072
    s_add_u32 s33, s33, 20480
    s_cmp_eq_u32 s33, 122880
    s_cselect_b32 s33, 0, s33
    s_add_u32 s34, s22, s33
    s_add_u32 s35, s23, s33
    s_waitcnt vmcnt(8) lgkmcnt(0)
    s_barrier
    v_mfma_f32_16x16x32_bf16 a[0:3], v[96:99], v[64:67], a[0:3]
    v_mfma_f32_16x16x32_bf16 a[8:11], v[96:99], v[68:71], a[8:11]
    ds_read_b128 v[56:59], v112 offset:0
    ds_read_b64_tr_b16 v[24:25], v104
    s_add_u32 m0, s34, 0
    v_mfma_f32_16x16x32_bf16 a[16:19], v[96:99], v[72:75], a[16:19]
    buffer_load_dwordx4 v17, s[8:11], s20 offen lds
    v_mfma_f32_16x16x32_bf16 a[24:27], v[96:99], v[76:79], a[24:27]
    ds_read_b64_tr_b16 v[26:27], v104 offset:1024
    ds_read_b128 v[60:63], v112 offset:1024
    ds_read_b64_tr_b16 v[28:29], v105
    v_mfma_f32_16x16x32_bf16 a[32:35], v[96:99], v[80:83], a[32:35]
    ds_read_b64_tr_b16 v[30:31], v105 offset:1024
    s_add_u32 m0, s34, 1024
    v_mfma_f32_16x16x32_bf16 a[40:43], v[96:99], v[84:87], a[40:43]
    buffer_load_dwordx4 v18, s[8:11], s20 offen lds
    v_mfma_f32_16x16x32_bf16 a[48:51], v[96:99], v[88:91], a[48:51]
    ds_read_b64_tr_b16 v[32:33], v106
    ds_read_b64_tr_b16 v[34:35], v106 offset:1024
    ds_read_b64_tr_b16 v[36:37], v107
    v_mfma_f32_16x16x32_bf16 a[56:59], v[96:99], v[92:95], a[56:59]
    ds_read_b64_tr_b16 v[38:39], v107 offset:1024
    ds_read_b64_tr_b16 v[40:41], v108
    s_add_u32 m0, s34, 2048
    v_mfma_f32_16x16x32_bf16 a[4:7], v[100:103], v[64:67], a[4:7]
    buffer_load_dwordx4 v19, s[8:11], s20 offen lds
    v_mfma_f32_16x16x32_bf16 a[12:15], v[100:103], v[68:71], a[12:15]
    ds_read_b64_tr_b16 v[42:43], v108 offset:1024
    ds_read_b64_tr_b16 v[44:45], v109
    ds_read_b64_tr_b16 v[46:47], v109 offset:1024
    v_mfma_f32_16x16x32_bf16 a[20:23], v[100:103], v[72:75], a[20:23]
    ds_read_b64_tr_b16 v[48:49], v110
    s_add_u32 m0, s34, 3072
    v_mfma_f32_16x16x32_bf16 a[28:31], v[100:103], v[76:79], a[28:31]
    buffer_load_dwordx4 v20, s[8:11], s20 offen lds
    v_mfma_f32_16x16x32_bf16 a[36:39], v[100:103], v[80:83], a[36:39]
    ds_read_b64_tr_b16 v[50:51], v110 offset:1024
    ds_read_b64_tr_b16 v[52:53], v111
    ds_read_b64_tr_b16 v[54:55], v111 offset:1024
    v_mfma_f32_16x16x32_bf16 a[44:47], v[100:103], v[84:87], a[44:47]
    s_add_u32 s32, s32, 20480
    s_cmp_eq_u32 s32, 122880
    s_cselect_b32 s32, 0, s32
    s_add_u32 m0, s35, 0
    v_mfma_f32_16x16x32_bf16 a[52:55], v[100:103], v[88:91], a[52:55]
    buffer_load_dwordx4 v21, s[12:15], s21 offen lds
    v_add_u32 v104, s32, v8
    v_mfma_f32_16x16x32_bf16 a[60:63], v[100:103], v[92:95], a[60:63]
    v_add_u32 v105, s32, v9
    v_add_u32 v106, s32, v10
    v_add_u32 v107, s32, v11
    v_add_u32 v108, s32, v12
    v_add_u32 v109, s32, v13
    v_add_u32 v110, s32, v14
    v_add_u32 v111, s32, v15
    v_add_u32 v112, s32, v16
    s_add_u32 s20, s20, 262144
    s_add_u32 s21, s21, 131072
    s_add_u32 s33, s33, 20480
    s_cmp_eq_u32 s33, 122880
    s_cselect_b32 s33, 0, s33
    s_add_u32 s34, s22, s33
    s_add_u32 s35, s23, s33
    s_waitcnt vmcnt(12) lgkmcnt(0)
    s_barrier
    s_mov_b32 s24, 15
B_L_gD_loop:
    v_mfma_f32_16x16x32_bf16 a[0:3], v[56:59], v[24:27], a[0:3]
    v_mfma_f32_16x16x32_bf16 a[8:11], v[56:59], v[28:31], a[8:11]
    ds_read_b128 v[96:99], v112 offset:0
    ds_read_b64_tr_b16 v[64:65], v104
    s_add_u32 m0, s34, 0
    v_mfma_f32_16x16x32_bf16 a[16:19], v[56:59], v[32:35], a[16:19]
    buffer_load_dwordx4 v17, s[8:11], s20 offen lds
    v_mfma_f32_16x16x32_bf16 a[24:27], v[56:59], v[36:39], a[24:27]
    ds_read_b64_tr_b16 v[66:67], v104 offset:1024
    ds_read_b128 v[100:103], v112 offset:1024
    ds_read_b64_tr_b16 v[68:69], v105
    v_mfma_f32_16x16x32_bf16 a[32:35], v[56:59], v[40:43], a[32:35]
    ds_read_b64_tr_b16 v[70:71], v105 offset:1024
    s_add_u32 m0, s34, 1024
    v_mfma_f32_16x16x32_bf16 a[40:43], v[56:59], v[44:47], a[40:43]
    buffer_load_dwordx4 v18, s[8:11], s20 offen lds
    v_mfma_f32_16x16x32_bf16 a[48:51], v[56:59], v[48:51], a[48:51]
    ds_read_b64_tr_b16 v[72:73], v106
    ds_read_b64_tr_b16 v[74:75], v106 offset:1024
    ds_read_b64_tr_b16 v[76:77], v107
    v_mfma_f32_16x16x32_bf16 a[56:59], v[56:59], v[52:55], a[56:59]
    ds_read_b64_tr_b16 v[78:79], v107 offset:1024
    ds_read_b64_tr_b16 v[80:81], v108
    s_add_u32 m0, s34, 2048
    v_mfma_f32_16x16x32_bf16 a[4:7], v[60:63], v[24:27], a[4:7]
    buffer_load_dwordx4 v19, s[8:11], s20 offen lds
    v_mfma_f32_16x16x32_bf16 a[12:15], v[60:63], v[28:31], a[12:15]
    ds_read_b64_tr_b16 v[82:83], v108 offset:1024
    ds_read_b64_tr_b16 v[84:85], v109
    ds_read_b64_tr_b16 v[86:87], v109 offset:1024
    v_mfma_f32_16x16x32_bf16 a[20:23], v[60:63], v[32:35], a[20:23]
    ds_read_b64_tr_b16 v[88:89], v110
    s_add_u32 m0, s34, 3072
    v_mfma_f32_16x16x32_bf16 a[28:31], v[60:63], v[36:39], a[28:31]
    buffer_load_dwordx4 v20, s[8:11], s20 offen lds
    v_mfma_f32_16x16x32_bf16 a[36:39], v[60:63], v[40:43], a[36:39]
    ds_read_b64_tr_b16 v[90:91], v110 offset:1024
    ds_read_b64_tr_b16 v[92:93], v111
    ds_read_b64_tr_b16 v[94:95], v111 offset:1024
    v_mfma_f32_16x16x32_bf16 a[44:47], v[60:63], v[44:47], a[44:47]
    s_add_u32 s32, s32, 20480
    s_cmp_eq_u32 s32, 122880
    s_cselect_b32 s32, 0, s32
    s_add_u32 m0, s35, 0
    v_mfma_f32_16x16x32_bf16 a[52:55], v[60:63], v[48:51], a[52:55]
    buffer_load_dwordx4 v21, s[12:15], s21 offen lds
    v_add_u32 v104, s32, v8
    v_mfma_f32_16x16x32_bf16 a[60:63], v[60:63], v[52:55], a[60:63]
    v_add_u32 v105, s32, v9
    v_add_u32 v106, s32, v10
    v_add_u32 v107, s32, v11
    v_add_u32 v108, s32, v12
    v_add_u32 v109, s32, v13
    v_add_u32 v110, s32, v14
    v_add_u32 v111, s32, v15
    v_add_u32 v112, s32, v16
    s_add_u32 s20, s20, 262144
    s_add_u32 s21, s21, 131072
    s_add_u32 s33, s33, 20480
    s_cmp_eq_u32 s33, 122880
    s_cselect_b32 s33, 0, s33
    s_add_u32 s34, s22, s33
    s_add_u32 s35, s23, s33
    s_waitcnt vmcnt(16) lgkmcnt(0)
    s_barrier
    v_mfma_f32_16x16x32_bf16 a[0:3], v[96:99], v[64:67], a[0:3]
    v_mfma_f32_16x16x32_bf16 a[8:11], v[96:99], v[68:71], a[8:11]
    ds_read_b128 v[56:59], v112 offset:0
    ds_read_b64_tr_b16 v[24:25], v104
    s_add_u32 m0, s34, 0
    v_mfma_f32_16x16x32_bf16 a[16:19], v[96:99], v[72:75], a[16:19]
    buffer_load_dwordx4 v17, s[8:11], s20 offen lds
    v_mfma_f32_16x16x32_bf16 a[24:27], v[96:99], v[76:79], a[24:27]
    ds_read_b64_tr_b16 v[26:27], v104 offset:1024
    ds_read_b128 v[60:63], v112 offset:1024
    ds_read_b64_tr_b16 v[28:29], v105
    v_mfma_f32_16x16x32_bf16 a[32:35], v[96:99], v[80:83], a[32:35]
    ds_read_b64_tr_b16 v[30:31], v105 offset:1024
    s_add_u32 m0, s34, 1024
    v_mfma_f32_16x16x32_bf16 a[40:43], v[96:99], v[84:87], a[40:43]
    buffer_load_dwordx4 v18, s[8:11], s20 offen lds
    v_mfma_f32_16x16x32_bf16 a[48:51], v[96:99], v[88:91], a[48:51]
    ds_read_b64_tr_b16 v[32:33], v106
    ds_read_b64_tr_b16 v[34:35], v106 offset:1024
    ds_read_b64_tr_b16 v[36:37], v107
    v_mfma_f32_16x16x32_bf16 a[56:59], v[96:99], v[92:95], a[56:59]
    ds_read_b64_tr_b16 v[38:39], v107 offset:1024
    ds_read_b64_tr_b16 v[40:41], v108
    s_add_u32 m0, s34, 2048
    v_mfma_f32_16x16x32_bf16 a[4:7], v[100:103], v[64:67], a[4:7]
    buffer_load_dwordx4 v19, s[8:11], s20 offen lds
    v_mfma_f32_16x16x32_bf16 a[12:15], v[100:103], v[68:71], a[12:15]
    ds_read_b64_tr_b16 v[42:43], v108 offset:1024
    ds_read_b64_tr_b16 v[44:45], v109
    ds_read_b64_tr_b16 v[46:47], v109 offset:1024
    v_mfma_f32_16x16x32_bf16 a[20:23], v[100:103], v[72:75], a[20:23]
    ds_read_b64_tr_b16 v[48:49], v110
    s_add_u32 m0, s34, 3072
    v_mfma_f32_16x16x32_bf16 a[28:31], v[100:103], v[76:79], a[28:31]
    buffer_load_dwordx4 v20, s[8:11], s20 offen lds
    v_mfma_f32_16x16x32_bf16 a[36:39], v[100:103], v[80:83], a[36:39]
    ds_read_b64_tr_b16 v[50:51], v110 offset:1024
    ds_read_b64_tr_b16 v[52:53], v111
    ds_read_b64_tr_b16 v[54:55], v111 offset:1024
    v_mfma_f32_16x16x32_bf16 a[44:47], v[100:103], v[84:87], a[44:47]
    s_add_u32 s32, s32, 20480
    s_cmp_eq_u32 s32, 122880
    s_cselect_b32 s32, 0, s32
    s_add_u32 m0, s35, 0
    v_mfma_f32_16x16x32_bf16 a[52:55], v[100:103], v[88:91], a[52:55]
    buffer_load_dwordx4 v21, s[12:15], s21 offen lds
    v_add_u32 v104, s32, v8
    v_mfma_f32_16x16x32_bf16 a[60:63], v[100:103], v[92:95], a[60:63]
    v_add_u32 v105, s32, v9
    v_add_u32 v106, s32, v10
    v_add_u32 v107, s32, v11
    v_add_u32 v108, s32, v12
    v_add_u32 v109, s32, v13
    v_add_u32 v110, s32, v14
    v_add_u32 v111, s32, v15
    v_add_u32 v112, s32, v16
    s_add_u32 s20, s20, 262144
    s_add_u32 s21, s21, 131072
    s_add_u32 s33, s33, 20480
    s_cmp_eq_u32 s33, 122880
    s_cselect_b32 s33, 0, s33
    s_add_u32 s34, s22, s33
    s_add_u32 s35, s23, s33
    s_waitcnt vmcnt(16) lgkmcnt(0)
    s_barrier
    s_sub_u32 s24, s24, 1
    s_cmp_lg_u32 s24, 0
    s_cbranch_scc1 B_L_gD_loop
    s_waitcnt vmcnt(0)
    s_and_b32 s25, s67, 15
    s_lshl_b32 s25, s25, 1
    s_and_b32 s26, s3, 1
    s_add_u32 s25, s25, s26
    s_lshr_b32 s26, s68, 5
    s_lshr_b32 s27, s3, 1
    s_mul_i32 s27, s27, 1
    s_add_u32 s26, s26, s27
    s_lshl_b32 s26, s26, 5
    s_add_u32 s25, s25, s26
    s_lshl_b32 s25, s25, 13
    v_lshlrev_b32 v1, 4, v0
    s_add_u32 s26, s25, 0
    v_accvgpr_read_b32 v28, a0
    v_accvgpr_read_b32 v29, a1
    v_accvgpr_read_b32 v30, a2
    v_accvgpr_read_b32 v31, a3
    v_accvgpr_read_b32 v32, a4
    v_accvgpr_read_b32 v33, a5
    v_accvgpr_read_b32 v34, a6
    v_accvgpr_read_b32 v35, a7
    v_cvt_pk_bf16_f32 v24, v28, v29
    v_cvt_pk_bf16_f32 v25, v30, v31
    v_cvt_pk_bf16_f32 v26, v32, v33
    v_cvt_pk_bf16_f32 v27, v34, v35
    buffer_store_dwordx4 v[24:27], v1, s[16:19], s26 offen offset:0 sc1
    v_accvgpr_read_b32 v40, a8
    v_accvgpr_read_b32 v41, a9
    v_accvgpr_read_b32 v42, a10
    v_accvgpr_read_b32 v43, a11
    v_accvgpr_read_b32 v44, a12
    v_accvgpr_read_b32 v45, a13
    v_accvgpr_read_b32 v46, a14
    v_accvgpr_read_b32 v47, a15
    v_cvt_pk_bf16_f32 v36, v40, v41
    v_cvt_pk_bf16_f32 v37, v42, v43
    v_cvt_pk_bf16_f32 v38, v44, v45
    v_cvt_pk_bf16_f32 v39, v46, v47
    buffer_store_dwordx4 v[36:39], v1, s[16:19], s26 offen offset:1024 sc1
    v_accvgpr_read_b32 v52, a16
    v_accvgpr_read_b32 v53, a17
    v_accvgpr_read_b32 v54, a18
    v_accvgpr_read_b32 v55, a19
    v_accvgpr_read_b32 v56, a20
    v_accvgpr_read_b32 v57, a21
    v_accvgpr_read_b32 v58, a22
    v_accvgpr_read_b32 v59, a23
    v_cvt_pk_bf16_f32 v48, v52, v53
    v_cvt_pk_bf16_f32 v49, v54, v55
    v_cvt_pk_bf16_f32 v50, v56, v57
    v_cvt_pk_bf16_f32 v51, v58, v59
    buffer_store_dwordx4 v[48:51], v1, s[16:19], s26 offen offset:2048 sc1
    v_accvgpr_read_b32 v64, a24
    v_accvgpr_read_b32 v65, a25
    v_accvgpr_read_b32 v66, a26
    v_accvgpr_read_b32 v67, a27
    v_accvgpr_read_b32 v68, a28
    v_accvgpr_read_b32 v69, a29
    v_accvgpr_read_b32 v70, a30
    v_accvgpr_read_b32 v71, a31
    v_cvt_pk_bf16_f32 v60, v64, v65
    v_cvt_pk_bf16_f32 v61, v66, v67
    v_cvt_pk_bf16_f32 v62, v68, v69
    v_cvt_pk_bf16_f32 v63, v70, v71
    buffer_store_dwordx4 v[60:63], v1, s[16:19], s26 offen offset:3072 sc1
    s_add_u32 s26, s25, 4096
    v_accvgpr_read_b32 v28, a32
    v_accvgpr_read_b32 v29, a33
    v_accvgpr_read_b32 v30, a34
    v_accvgpr_read_b32 v31, a35
    v_accvgpr_read_b32 v32, a36
    v_accvgpr_read_b32 v33, a37
    v_accvgpr_read_b32 v34, a38
    v_accvgpr_read_b32 v35, a39
    v_cvt_pk_bf16_f32 v24, v28, v29
    v_cvt_pk_bf16_f32 v25, v30, v31
    v_cvt_pk_bf16_f32 v26, v32, v33
    v_cvt_pk_bf16_f32 v27, v34, v35
    buffer_store_dwordx4 v[24:27], v1, s[16:19], s26 offen offset:0 sc1
    v_accvgpr_read_b32 v40, a40
    v_accvgpr_read_b32 v41, a41
    v_accvgpr_read_b32 v42, a42
    v_accvgpr_read_b32 v43, a43
    v_accvgpr_read_b32 v44, a44
    v_accvgpr_read_b32 v45, a45
    v_accvgpr_read_b32 v46, a46
    v_accvgpr_read_b32 v47, a47
    v_cvt_pk_bf16_f32 v36, v40, v41
    v_cvt_pk_bf16_f32 v37, v42, v43
    v_cvt_pk_bf16_f32 v38, v44, v45
    v_cvt_pk_bf16_f32 v39, v46, v47
    buffer_store_dwordx4 v[36:39], v1, s[16:19], s26 offen offset:1024 sc1
    v_accvgpr_read_b32 v52, a48
    v_accvgpr_read_b32 v53, a49
    v_accvgpr_read_b32 v54, a50
    v_accvgpr_read_b32 v55, a51
    v_accvgpr_read_b32 v56, a52
    v_accvgpr_read_b32 v57, a53
    v_accvgpr_read_b32 v58, a54
    v_accvgpr_read_b32 v59, a55
    v_cvt_pk_bf16_f32 v48, v52, v53
    v_cvt_pk_bf16_f32 v49, v54, v55
    v_cvt_pk_bf16_f32 v50, v56, v57
    v_cvt_pk_bf16_f32 v51, v58, v59
    buffer_store_dwordx4 v[48:51], v1, s[16:19], s26 offen offset:2048 sc1
    v_accvgpr_read_b32 v64, a56
    v_accvgpr_read_b32 v65, a57
    v_accvgpr_read_b32 v66, a58
    v_accvgpr_read_b32 v67, a59
    v_accvgpr_read_b32 v68, a60
    v_accvgpr_read_b32 v69, a61
    v_accvgpr_read_b32 v70, a62
    v_accvgpr_read_b32 v71, a63
    v_cvt_pk_bf16_f32 v60, v64, v65
    v_cvt_pk_bf16_f32 v61, v66, v67
    v_cvt_pk_bf16_f32 v62, v68, v69
    v_cvt_pk_bf16_f32 v63, v70, v71
    buffer_store_dwordx4 v[60:63], v1, s[16:19], s26 offen offset:3072 sc1
    s_waitcnt vmcnt(0)
    s_barrier
B_L_sig:
    s_waitcnt vmcnt(0)
    s_barrier
    s_cmp_lg_u32 s3, 0
    s_cbranch_scc1 B_L_sg_t
    s_add_u32 s44, s69, 0
    v_mov_b32 v2, s44
    v_mov_b32 v3, 1
    s_mov_b64 exec, 1
    global_atomic_add v2, v3, s[60:61]
    s_mov_b64 exec, -1
B_L_sg_t:
    s_add_u32 s64, s64, 1
    s_branch B_L_task
B_L_phase3:
    s_cmp_ge_u32 s62, 64
    s_cbranch_scc1 B_L_nomod2
    s_load_dwordx2 s[8:9], s[0:1], 96
    s_lshl_b32 s12, s3, 6
    v_add_u32 v4, s12, v0
    v_lshlrev_b32 v5, 3, v4
    s_waitcnt lgkmcnt(0)
    global_load_dwordx2 v[12:13], v5, s[8:9]
    s_waitcnt vmcnt(0)
    v_lshlrev_b32 v14, 16, v12
    v_and_b32 v15, 0xffff0000, v12
    v_lshlrev_b32 v16, 16, v13
    v_and_b32 v17, 0xffff0000, v13
    s_mov_b32 s12, 0xbfb8aa3b
    v_mul_f32 v20, s12, v14
    v_exp_f32 v20, v20
    s_nop 0
    v_add_f32 v20, 1.0, v20
    v_rcp_f32 v20, v20
    s_nop 0
    v_mul_f32 v20, v14, v20
    v_mul_f32 v21, s12, v15
    v_exp_f32 v21, v21
    s_nop 0
    v_add_f32 v21, 1.0, v21
    v_rcp_f32 v21, v21
    s_nop 0
    v_mul_f32 v21, v15, v21
    v_mul_f32 v22, s12, v16
    v_exp_f32 v22, v22
    s_nop 0
    v_add_f32 v22, 1.0, v22
    v_rcp_f32 v22, v22
    s_nop 0
    v_mul_f32 v22, v16, v22
    v_mul_f32 v23, s12, v17
    v_exp_f32 v23, v23
    s_nop 0
    v_add_f32 v23, 1.0, v23
    v_rcp_f32 v23, v23
    s_nop 0
    v_mul_f32 v23, v17, v23
    v_cvt_pk_bf16_f32 v24, v20, v21
    v_cvt_pk_bf16_f32 v25, v22, v23
    v_lshlrev_b32 v20, 16, v24
    v_and_b32 v21, 0xffff0000, v24
    v_lshlrev_b32 v22, 16, v25
    v_and_b32 v23, 0xffff0000, v25
    v_lshlrev_b32 v4, 4, v4
    ds_write_b128 v4, v[20:23]
    s_waitcnt lgkmcnt(0)
    s_barrier
    s_lshl_b32 s67, s62, 5
    s_add_u32 s67, s67, 4096
    s_load_dwordx2 s[8:9], s[0:1], 104
    v_lshrrev_b32 v5, 2, v0
    s_lshl_b32 s12, s3, 8
    v_add_u32 v5, s12, v5
    v_lshlrev_b32 v6, 2, v5
    s_mov_b32 s13, 12288
    v_mul_lo_u32 v7, v5, s13
    v_and_b32 v26, 3, v0
    v_lshl_add_u32 v7, v26, 4, v7
    s_lshl_b32 s12, s67, 1
    v_add_u32 v7, s12, v7
    s_waitcnt lgkmcnt(0)
    global_load_dwordx4 v[32:35], v7, s[8:9]
    v_add_u32 v7, 196608, v7
    ds_read_b32 v96, v6 offset:0
    global_load_dwordx4 v[36:39], v7, s[8:9]
    v_add_u32 v7, 196608, v7
    ds_read_b32 v97, v6 offset:64
    global_load_dwordx4 v[40:43], v7, s[8:9]
    v_add_u32 v7, 196608, v7
    ds_read_b32 v98, v6 offset:128
    global_load_dwordx4 v[44:47], v7, s[8:9]
    v_add_u32 v7, 196608, v7
    ds_read_b32 v99, v6 offset:192
    global_load_dwordx4 v[48:51], v7, s[8:9]
    v_add_u32 v7, 196608, v7
    ds_read_b32 v100, v6 offset:256
    global_load_dwordx4 v[52:55], v7, s[8:9]
    v_add_u32 v7, 196608, v7
    ds_read_b32 v101, v6 offset:320
    global_load_dwordx4 v[56:59], v7, s[8:9]
    v_add_u32 v7, 196608, v7
    ds_read_b32 v102, v6 offset:384
    global_load_dwordx4 v[60:63], v7, s[8:9]
    v_add_u32 v7, 196608, v7
    ds_read_b32 v103, v6 offset:448
    global_load_dwordx4 v[64:67], v7, s[8:9]
    v_add_u32 v7, 196608, v7
    ds_read_b32 v104, v6 offset:512
    global_load_dwordx4 v[68:71], v7, s[8:9]
    v_add_u32 v7, 196608, v7
    ds_read_b32 v105, v6 offset:576
    global_load_dwordx4 v[72:75], v7, s[8:9]
    v_add_u32 v7, 196608, v7
    ds_read_b32 v106, v6 offset:640
    global_load_dwordx4 v[76:79], v7, s[8:9]
    v_add_u32 v7, 196608, v7
    ds_read_b32 v107, v6 offset:704
    global_load_dwordx4 v[80:83], v7, s[8:9]
    v_add_u32 v7, 196608, v7
    ds_read_b32 v108, v6 offset:768
    global_load_dwordx4 v[84:87], v7, s[8:9]
    v_add_u32 v7, 196608, v7
    ds_read_b32 v109, v6 offset:832
    global_load_dwordx4 v[88:91], v7, s[8:9]
    v_add_u32 v7, 196608, v7
    ds_read_b32 v110, v6 offset:896
    global_load_dwordx4 v[92:95], v7, s[8:9]
    v_add_u32 v7, 196608, v7
    ds_read_b32 v111, v6 offset:960
    v_mov_b32 v112, 0
    v_mov_b32 v113, 0
    v_mov_b32 v114, 0
    v_mov_b32 v115, 0
    v_mov_b32 v116, 0
    v_mov_b32 v117, 0
    v_mov_b32 v118, 0
    v_mov_b32 v119, 0
    s_waitcnt lgkmcnt(0)
    s_waitcnt vmcnt(15)
    v_lshlrev_b32 v27, 16, v32
    v_and_b32 v28, 0xffff0000, v32
    v_fmac_f32 v112, v27, v96
    v_fmac_f32 v113, v28, v96
    v_lshlrev_b32 v27, 16, v33
    v_and_b32 v28, 0xffff0000, v33
    v_fmac_f32 v114, v27, v96
    v_fmac_f32 v115, v28, v96
    v_lshlrev_b32 v27, 16, v34
    v_and_b32 v28, 0xffff0000, v34
    v_fmac_f32 v116, v27, v96
    v_fmac_f32 v117, v28, v96
    v_lshlrev_b32 v27, 16, v35
    v_and_b32 v28, 0xffff0000, v35
    v_fmac_f32 v118, v27, v96
    v_fmac_f32 v119, v28, v96
    s_waitcnt vmcnt(14)
    v_lshlrev_b32 v27, 16, v36
    v_and_b32 v28, 0xffff0000, v36
    v_fmac_f32 v112, v27, v97
    v_fmac_f32 v113, v28, v97
    v_lshlrev_b32 v27, 16, v37
    v_and_b32 v28, 0xffff0000, v37
    v_fmac_f32 v114, v27, v97
    v_fmac_f32 v115, v28, v97
    v_lshlrev_b32 v27, 16, v38
    v_and_b32 v28, 0xffff0000, v38
    v_fmac_f32 v116, v27, v97
    v_fmac_f32 v117, v28, v97
    v_lshlrev_b32 v27, 16, v39
    v_and_b32 v28, 0xffff0000, v39
    v_fmac_f32 v118, v27, v97
    v_fmac_f32 v119, v28, v97
    s_waitcnt vmcnt(13)
    v_lshlrev_b32 v27, 16, v40
    v_and_b32 v28, 0xffff0000, v40
    v_fmac_f32 v112, v27, v98
    v_fmac_f32 v113, v28, v98
    v_lshlrev_b32 v27, 16, v41
    v_and_b32 v28, 0xffff0000, v41
    v_fmac_f32 v114, v27, v98
    v_fmac_f32 v115, v28, v98
    v_lshlrev_b32 v27, 16, v42
    v_and_b32 v28, 0xffff0000, v42
    v_fmac_f32 v116, v27, v98
    v_fmac_f32 v117, v28, v98
    v_lshlrev_b32 v27, 16, v43
    v_and_b32 v28, 0xffff0000, v43
    v_fmac_f32 v118, v27, v98
    v_fmac_f32 v119, v28, v98
    s_waitcnt vmcnt(12)
    v_lshlrev_b32 v27, 16, v44
    v_and_b32 v28, 0xffff0000, v44
    v_fmac_f32 v112, v27, v99
    v_fmac_f32 v113, v28, v99
    v_lshlrev_b32 v27, 16, v45
    v_and_b32 v28, 0xffff0000, v45
    v_fmac_f32 v114, v27, v99
    v_fmac_f32 v115, v28, v99
    v_lshlrev_b32 v27, 16, v46
    v_and_b32 v28, 0xffff0000, v46
    v_fmac_f32 v116, v27, v99
    v_fmac_f32 v117, v28, v99
    v_lshlrev_b32 v27, 16, v47
    v_and_b32 v28, 0xffff0000, v47
    v_fmac_f32 v118, v27, v99
    v_fmac_f32 v119, v28, v99
    s_waitcnt vmcnt(11)
    v_lshlrev_b32 v27, 16, v48
    v_and_b32 v28, 0xffff0000, v48
    v_fmac_f32 v112, v27, v100
    v_fmac_f32 v113, v28, v100
    v_lshlrev_b32 v27, 16, v49
    v_and_b32 v28, 0xffff0000, v49
    v_fmac_f32 v114, v27, v100
    v_fmac_f32 v115, v28, v100
    v_lshlrev_b32 v27, 16, v50
    v_and_b32 v28, 0xffff0000, v50
    v_fmac_f32 v116, v27, v100
    v_fmac_f32 v117, v28, v100
    v_lshlrev_b32 v27, 16, v51
    v_and_b32 v28, 0xffff0000, v51
    v_fmac_f32 v118, v27, v100
    v_fmac_f32 v119, v28, v100
    s_waitcnt vmcnt(10)
    v_lshlrev_b32 v27, 16, v52
    v_and_b32 v28, 0xffff0000, v52
    v_fmac_f32 v112, v27, v101
    v_fmac_f32 v113, v28, v101
    v_lshlrev_b32 v27, 16, v53
    v_and_b32 v28, 0xffff0000, v53
    v_fmac_f32 v114, v27, v101
    v_fmac_f32 v115, v28, v101
    v_lshlrev_b32 v27, 16, v54
    v_and_b32 v28, 0xffff0000, v54
    v_fmac_f32 v116, v27, v101
    v_fmac_f32 v117, v28, v101
    v_lshlrev_b32 v27, 16, v55
    v_and_b32 v28, 0xffff0000, v55
    v_fmac_f32 v118, v27, v101
    v_fmac_f32 v119, v28, v101
    s_waitcnt vmcnt(9)
    v_lshlrev_b32 v27, 16, v56
    v_and_b32 v28, 0xffff0000, v56
    v_fmac_f32 v112, v27, v102
    v_fmac_f32 v113, v28, v102
    v_lshlrev_b32 v27, 16, v57
    v_and_b32 v28, 0xffff0000, v57
    v_fmac_f32 v114, v27, v102
    v_fmac_f32 v115, v28, v102
    v_lshlrev_b32 v27, 16, v58
    v_and_b32 v28, 0xffff0000, v58
    v_fmac_f32 v116, v27, v102
    v_fmac_f32 v117, v28, v102
    v_lshlrev_b32 v27, 16, v59
    v_and_b32 v28, 0xffff0000, v59
    v_fmac_f32 v118, v27, v102
    v_fmac_f32 v119, v28, v102
    s_waitcnt vmcnt(8)
    v_lshlrev_b32 v27, 16, v60
    v_and_b32 v28, 0xffff0000, v60
    v_fmac_f32 v112, v27, v103
    v_fmac_f32 v113, v28, v103
    v_lshlrev_b32 v27, 16, v61
    v_and_b32 v28, 0xffff0000, v61
    v_fmac_f32 v114, v27, v103
    v_fmac_f32 v115, v28, v103
    v_lshlrev_b32 v27, 16, v62
    v_and_b32 v28, 0xffff0000, v62
    v_fmac_f32 v116, v27, v103
    v_fmac_f32 v117, v28, v103
    v_lshlrev_b32 v27, 16, v63
    v_and_b32 v28, 0xffff0000, v63
    v_fmac_f32 v118, v27, v103
    v_fmac_f32 v119, v28, v103
    s_waitcnt vmcnt(7)
    v_lshlrev_b32 v27, 16, v64
    v_and_b32 v28, 0xffff0000, v64
    v_fmac_f32 v112, v27, v104
    v_fmac_f32 v113, v28, v104
    v_lshlrev_b32 v27, 16, v65
    v_and_b32 v28, 0xffff0000, v65
    v_fmac_f32 v114, v27, v104
    v_fmac_f32 v115, v28, v104
    v_lshlrev_b32 v27, 16, v66
    v_and_b32 v28, 0xffff0000, v66
    v_fmac_f32 v116, v27, v104
    v_fmac_f32 v117, v28, v104
    v_lshlrev_b32 v27, 16, v67
    v_and_b32 v28, 0xffff0000, v67
    v_fmac_f32 v118, v27, v104
    v_fmac_f32 v119, v28, v104
    s_waitcnt vmcnt(6)
    v_lshlrev_b32 v27, 16, v68
    v_and_b32 v28, 0xffff0000, v68
    v_fmac_f32 v112, v27, v105
    v_fmac_f32 v113, v28, v105
    v_lshlrev_b32 v27, 16, v69
    v_and_b32 v28, 0xffff0000, v69
    v_fmac_f32 v114, v27, v105
    v_fmac_f32 v115, v28, v105
    v_lshlrev_b32 v27, 16, v70
    v_and_b32 v28, 0xffff0000, v70
    v_fmac_f32 v116, v27, v105
    v_fmac_f32 v117, v28, v105
    v_lshlrev_b32 v27, 16, v71
    v_and_b32 v28, 0xffff0000, v71
    v_fmac_f32 v118, v27, v105
    v_fmac_f32 v119, v28, v105
    s_waitcnt vmcnt(5)
    v_lshlrev_b32 v27, 16, v72
    v_and_b32 v28, 0xffff0000, v72
    v_fmac_f32 v112, v27, v106
    v_fmac_f32 v113, v28, v106
    v_lshlrev_b32 v27, 16, v73
    v_and_b32 v28, 0xffff0000, v73
    v_fmac_f32 v114, v27, v106
    v_fmac_f32 v115, v28, v106
    v_lshlrev_b32 v27, 16, v74
    v_and_b32 v28, 0xffff0000, v74
    v_fmac_f32 v116, v27, v106
    v_fmac_f32 v117, v28, v106
    v_lshlrev_b32 v27, 16, v75
    v_and_b32 v28, 0xffff0000, v75
    v_fmac_f32 v118, v27, v106
    v_fmac_f32 v119, v28, v106
    s_waitcnt vmcnt(4)
    v_lshlrev_b32 v27, 16, v76
    v_and_b32 v28, 0xffff0000, v76
    v_fmac_f32 v112, v27, v107
    v_fmac_f32 v113, v28, v107
    v_lshlrev_b32 v27, 16, v77
    v_and_b32 v28, 0xffff0000, v77
    v_fmac_f32 v114, v27, v107
    v_fmac_f32 v115, v28, v107
    v_lshlrev_b32 v27, 16, v78
    v_and_b32 v28, 0xffff0000, v78
    v_fmac_f32 v116, v27, v107
    v_fmac_f32 v117, v28, v107
    v_lshlrev_b32 v27, 16, v79
    v_and_b32 v28, 0xffff0000, v79
    v_fmac_f32 v118, v27, v107
    v_fmac_f32 v119, v28, v107
    s_waitcnt vmcnt(3)
    v_lshlrev_b32 v27, 16, v80
    v_and_b32 v28, 0xffff0000, v80
    v_fmac_f32 v112, v27, v108
    v_fmac_f32 v113, v28, v108
    v_lshlrev_b32 v27, 16, v81
    v_and_b32 v28, 0xffff0000, v81
    v_fmac_f32 v114, v27, v108
    v_fmac_f32 v115, v28, v108
    v_lshlrev_b32 v27, 16, v82
    v_and_b32 v28, 0xffff0000, v82
    v_fmac_f32 v116, v27, v108
    v_fmac_f32 v117, v28, v108
    v_lshlrev_b32 v27, 16, v83
    v_and_b32 v28, 0xffff0000, v83
    v_fmac_f32 v118, v27, v108
    v_fmac_f32 v119, v28, v108
    s_waitcnt vmcnt(2)
    v_lshlrev_b32 v27, 16, v84
    v_and_b32 v28, 0xffff0000, v84
    v_fmac_f32 v112, v27, v109
    v_fmac_f32 v113, v28, v109
    v_lshlrev_b32 v27, 16, v85
    v_and_b32 v28, 0xffff0000, v85
    v_fmac_f32 v114, v27, v109
    v_fmac_f32 v115, v28, v109
    v_lshlrev_b32 v27, 16, v86
    v_and_b32 v28, 0xffff0000, v86
    v_fmac_f32 v116, v27, v109
    v_fmac_f32 v117, v28, v109
    v_lshlrev_b32 v27, 16, v87
    v_and_b32 v28, 0xffff0000, v87
    v_fmac_f32 v118, v27, v109
    v_fmac_f32 v119, v28, v109
    s_waitcnt vmcnt(1)
    v_lshlrev_b32 v27, 16, v88
    v_and_b32 v28, 0xffff0000, v88
    v_fmac_f32 v112, v27, v110
    v_fmac_f32 v113, v28, v110
    v_lshlrev_b32 v27, 16, v89
    v_and_b32 v28, 0xffff0000, v89
    v_fmac_f32 v114, v27, v110
    v_fmac_f32 v115, v28, v110
    v_lshlrev_b32 v27, 16, v90
    v_and_b32 v28, 0xffff0000, v90
    v_fmac_f32 v116, v27, v110
    v_fmac_f32 v117, v28, v110
    v_lshlrev_b32 v27, 16, v91
    v_and_b32 v28, 0xffff0000, v91
    v_fmac_f32 v118, v27, v110
    v_fmac_f32 v119, v28, v110
    s_waitcnt vmcnt(0)
    v_lshlrev_b32 v27, 16, v92
    v_and_b32 v28, 0xffff0000, v92
    v_fmac_f32 v112, v27, v111
    v_fmac_f32 v113, v28, v111
    v_lshlrev_b32 v27, 16, v93
    v_and_b32 v28, 0xffff0000, v93
    v_fmac_f32 v114, v27, v111
    v_fmac_f32 v115, v28, v111
    v_lshlrev_b32 v27, 16, v94
    v_and_b32 v28, 0xffff0000, v94
    v_fmac_f32 v116, v27, v111
    v_fmac_f32 v117, v28, v111
    v_lshlrev_b32 v27, 16, v95
    v_and_b32 v28, 0xffff0000, v95
    v_fmac_f32 v118, v27, v111
    v_fmac_f32 v119, v28, v111
    v_add_f32_dpp v112, v112, v112 row_ror:4 row_mask:0xf bank_mask:0xf
    s_nop 1
    v_add_f32_dpp v112, v112, v112 row_ror:8 row_mask:0xf bank_mask:0xf
    v_mov_b32 v27, v112
    s_nop 1
    v_permlane16_swap_b32 v112, v27
    v_add_f32 v112, v112, v27
    v_mov_b32 v27, v112
    s_nop 1
    v_permlane32_swap_b32 v112, v27
    v_add_f32 v112, v112, v27
    v_add_f32_dpp v113, v113, v113 row_ror:4 row_mask:0xf bank_mask:0xf
    s_nop 1
    v_add_f32_dpp v113, v113, v113 row_ror:8 row_mask:0xf bank_mask:0xf
    v_mov_b32 v27, v113
    s_nop 1
    v_permlane16_swap_b32 v113, v27
    v_add_f32 v113, v113, v27
    v_mov_b32 v27, v113
    s_nop 1
    v_permlane32_swap_b32 v113, v27
    v_add_f32 v113, v113, v27
    v_add_f32_dpp v114, v114, v114 row_ror:4 row_mask:0xf bank_mask:0xf
    s_nop 1
    v_add_f32_dpp v114, v114, v114 row_ror:8 row_mask:0xf bank_mask:0xf
    v_mov_b32 v27, v114
    s_nop 1
    v_permlane16_swap_b32 v114, v27
    v_add_f32 v114, v114, v27
    v_mov_b32 v27, v114
    s_nop 1
    v_permlane32_swap_b32 v114, v27
    v_add_f32 v114, v114, v27
    v_add_f32_dpp v115, v115, v115 row_ror:4 row_mask:0xf bank_mask:0xf
    s_nop 1
    v_add_f32_dpp v115, v115, v115 row_ror:8 row_mask:0xf bank_mask:0xf
    v_mov_b32 v27, v115
    s_nop 1
    v_permlane16_swap_b32 v115, v27
    v_add_f32 v115, v115, v27
    v_mov_b32 v27, v115
    s_nop 1
    v_permlane32_swap_b32 v115, v27
    v_add_f32 v115, v115, v27
    v_add_f32_dpp v116, v116, v116 row_ror:4 row_mask:0xf bank_mask:0xf
    s_nop 1
    v_add_f32_dpp v116, v116, v116 row_ror:8 row_mask:0xf bank_mask:0xf
    v_mov_b32 v27, v116
    s_nop 1
    v_permlane16_swap_b32 v116, v27
    v_add_f32 v116, v116, v27
    v_mov_b32 v27, v116
    s_nop 1
    v_permlane32_swap_b32 v116, v27
    v_add_f32 v116, v116, v27
    v_add_f32_dpp v117, v117, v117 row_ror:4 row_mask:0xf bank_mask:0xf
    s_nop 1
    v_add_f32_dpp v117, v117, v117 row_ror:8 row_mask:0xf bank_mask:0xf
    v_mov_b32 v27, v117
    s_nop 1
    v_permlane16_swap_b32 v117, v27
    v_add_f32 v117, v117, v27
    v_mov_b32 v27, v117
    s_nop 1
    v_permlane32_swap_b32 v117, v27
    v_add_f32 v117, v117, v27
    v_add_f32_dpp v118, v118, v118 row_ror:4 row_mask:0xf bank_mask:0xf
    s_nop 1
    v_add_f32_dpp v118, v118, v118 row_ror:8 row_mask:0xf bank_mask:0xf
    v_mov_b32 v27, v118
    s_nop 1
    v_permlane16_swap_b32 v118, v27
    v_add_f32 v118, v118, v27
    v_mov_b32 v27, v118
    s_nop 1
    v_permlane32_swap_b32 v118, v27
    v_add_f32 v118, v118, v27
    v_add_f32_dpp v119, v119, v119 row_ror:4 row_mask:0xf bank_mask:0xf
    s_nop 1
    v_add_f32_dpp v119, v119, v119 row_ror:8 row_mask:0xf bank_mask:0xf
    v_mov_b32 v27, v119
    s_nop 1
    v_permlane16_swap_b32 v119, v27
    v_add_f32 v119, v119, v27
    v_mov_b32 v27, v119
    s_nop 1
    v_permlane32_swap_b32 v119, v27
    v_add_f32 v119, v119, v27
    s_lshl_b32 s12, s3, 7
    v_lshlrev_b32 v5, 5, v26
    v_add_u32 v5, s12, v5
    s_mov_b64 exec, 0xf
    ds_write_b128 v5, v[112:115] offset:4096
    ds_write_b128 v5, v[116:119] offset:4112
    s_mov_b64 exec, -1
    s_waitcnt lgkmcnt(0)
    s_barrier
    s_cmp_lg_u32 s3, 0
    s_cbranch_scc1 B_L_mod_b_d
    v_lshlrev_b32 v5, 2, v0
    s_mov_b64 exec, 0xffffffff
    ds_read_b32 v32, v5 offset:4096
    ds_read_b32 v33, v5 offset:4224
    ds_read_b32 v34, v5 offset:4352
    ds_read_b32 v35, v5 offset:4480
    s_waitcnt lgkmcnt(0)
    v_add_f32 v32, v32, v33
    v_add_f32 v34, v34, v35
    v_add_f32 v32, v32, v34
    v_cvt_pk_bf16_f32 v32, v32, v32
    v_lshlrev_b32 v32, 16, v32
    s_lshl_b32 s12, s67, 2
    s_add_u32 s12, s12, 0
    v_add_u32 v5, s12, v5
    global_store_dword v5, v32, s[6:7] sc1
    s_mov_b64 exec, -1
B_L_mod_b_d:
    s_waitcnt vmcnt(0)
    s_barrier
    s_cmp_lg_u32 s3, 0
    s_cbranch_scc1 B_L_sg_m2
    v_mov_b32 v2, 41216
    v_mov_b32 v3, 1
    s_mov_b64 exec, 1
    global_atomic_add v2, v3, s[60:61]
    s_mov_b64 exec, -1
B_L_sg_m2:
B_L_nomod2:
    s_load_dwordx2 s[40:41], s[0:1], 40
    s_waitcnt lgkmcnt(0)
    s_add_u32 s8, s40, 0
    s_addc_u32 s9, s41, 0
    s_and_b32 s9, s9, 0xffff
    s_mov_b32 s10, 8388608
    s_mov_b32 s11, 0x00020000
    s_mul_i32 s20, s62, 65536
    s_lshl_b32 s21, s3, 10
    s_add_u32 s20, s20, s21
    v_lshlrev_b32 v2, 4, v0
    s_mov_b32 s22, 16
B_L_pf_wo:
    buffer_load_dwordx4 v[8:11], v2, s[8:11], s20 offen
    s_add_u32 s20, s20, 4096
    s_sub_u32 s22, s22, 1
    s_cmp_lg_u32 s22, 0
    s_cbranch_scc0 B_L_pf_wo_d
    buffer_load_dwordx4 v[12:15], v2, s[8:11], s20 offen
    s_add_u32 s20, s20, 4096
    s_sub_u32 s22, s22, 1
    s_cmp_lg_u32 s22, 0
    s_waitcnt vmcnt(24)
    s_cbranch_scc1 B_L_pf_wo
B_L_pf_wo_d:
    s_waitcnt vmcnt(0)
    s_load_dwordx2 s[40:41], s[0:1], 64
    s_waitcnt lgkmcnt(0)
    s_add_u32 s8, s40, 0
    s_addc_u32 s9, s41, 0
    s_and_b32 s9, s9, 0xffff
    s_mov_b32 s10, 14680064
    s_mov_b32 s11, 0x00020000
    s_mul_i32 s20, s62, 114688
    s_lshl_b32 s21, s3, 10
    s_add_u32 s20, s20, s21
    v_lshlrev_b32 v2, 4, v0
    s_mov_b32 s22, 28
B_L_pf_w1:
    buffer_load_dwordx4 v[8:11], v2, s[8:11], s20 offen
    s_add_u32 s20, s20, 4096
    s_sub_u32 s22, s22, 1
    s_cmp_lg_u32 s22, 0
    s_cbranch_scc0 B_L_pf_w1_d
    buffer_load_dwordx4 v[12:15], v2, s[8:11], s20 offen
    s_add_u32 s20, s20, 4096
    s_sub_u32 s22, s22, 1
    s_cmp_lg_u32 s22, 0
    s_waitcnt vmcnt(24)
    s_cbranch_scc1 B_L_pf_w1
B_L_pf_w1_d:
    s_waitcnt vmcnt(0)
    s_load_dwordx2 s[40:41], s[0:1], 80
    s_waitcnt lgkmcnt(0)
    s_add_u32 s8, s40, 0
    s_addc_u32 s9, s41, 0
    s_and_b32 s9, s9, 0xffff
    s_mov_b32 s10, 14680064
    s_mov_b32 s11, 0x00020000
    s_mul_i32 s20, s62, 114688
    s_lshl_b32 s21, s3, 10
    s_add_u32 s20, s20, s21
    v_lshlrev_b32 v2, 4, v0
    s_mov_b32 s22, 28
B_L_pf_w2:
    buffer_load_dwordx4 v[8:11], v2, s[8:11], s20 offen
    s_add_u32 s20, s20, 4096
    s_sub_u32 s22, s22, 1
    s_cmp_lg_u32 s22, 0
    s_cbranch_scc0 B_L_pf_w2_d
    buffer_load_dwordx4 v[12:15], v2, s[8:11], s20 offen
    s_add_u32 s20, s20, 4096
    s_sub_u32 s22, s22, 1
    s_cmp_lg_u32 s22, 0
    s_waitcnt vmcnt(24)
    s_cbranch_scc1 B_L_pf_w2
B_L_pf_w2_d:
    s_waitcnt vmcnt(0)
    s_lshl_b32 s12, s3, 10
    v_lshlrev_b32 v3, 4, v0
    v_add_u32 v3, s12, v3
    v_mov_b32 v8, -1
    v_mov_b32 v9, -1
    v_mov_b32 v10, -1
    v_mov_b32 v11, -1
    s_lshl_b32 s12, s62, 17
    s_add_u32 s12, s12, 134217728
    s_add_u32 s14, s6, s12
    s_addc_u32 s15, s7, 0
    s_mov_b32 s16, 32
B_L_sfill:
    global_store_dwordx4 v3, v[8:11], s[14:15]
    s_add_u32 s14, s14, 4096
    s_addc_u32 s15, s15, 0
    s_sub_u32 s16, s16, 1
    s_cmp_lg_u32 s16, 0
    s_cbranch_scc1 B_L_sfill
    s_cmp_ge_u32 s62, 64
    s_cbranch_scc1 B_L_sfill2
    s_lshl_b32 s12, s62, 12
    s_add_u32 s12, s12, 150994944
    s_add_u32 s14, s6, s12
    s_addc_u32 s15, s7, 0
    global_store_dwordx4 v3, v[8:11], s[14:15]
B_L_sfill2:
    s_waitcnt vmcnt(0)
    s_branch B_L_bulk_done
B_L_bulk_done:
    s_waitcnt vmcnt(0)
    s_endpgm
M_rec_fast:
    s_load_dwordx2 s[62:63], s[0:1], 16
    s_load_dwordx2 s[64:65], s[0:1], 24
    s_load_dwordx2 s[66:67], s[0:1], 32
    s_load_dwordx2 s[68:69], s[0:1], 40
    s_load_dwordx2 s[10:11], s[0:1], 128
    s_waitcnt lgkmcnt(0)
    s_lshr_b32 s6, s5, 2
    s_and_b32 s7, s5, 3
    s_lshl_b32 s8, s4, 2
    s_add_u32 s8, s8, s3
    v_and_b32 v1, 15, v0
    v_lshrrev_b32 v2, 4, v0
    v_and_b32 v3, 7, v0
    v_lshlrev_b32 v56, 4, v0
    s_lshl_b32 s12, s4, 2
    s_add_u32 s12, s12, s6
    s_lshl_b32 s12, s12, 8
    s_lshl_b32 s13, s7, 6
    s_add_u32 s12, s12, s13
    v_lshrrev_b32 v4, 2, v0
    v_lshlrev_b32 v4, 13, v4
    v_and_b32 v5, 3, v0
    v_lshl_add_u32 v4, v5, 4, v4
    v_add_u32 v4, s12, v4
    s_lshl_b32 s13, s3, 21
    v_add_u32 v4, s13, v4
    v_mov_b32 v5, v4
    s_lshl_b32 s14, s3, 14
    s_add_u32 s14, s14, 0
    s_mov_b32 m0, s14
    s_add_u32 s14, s14, 1024
    global_load_lds_dwordx4 v5, s[62:63]
    v_add_u32 v5, 131072, v5
    s_mov_b32 m0, s14
    s_add_u32 s14, s14, 1024
    global_load_lds_dwordx4 v5, s[62:63]
    v_add_u32 v5, 131072, v5
    s_mov_b32 m0, s14
    s_add_u32 s14, s14, 1024
    global_load_lds_dwordx4 v5, s[62:63]
    v_add_u32 v5, 131072, v5
    s_mov_b32 m0, s14
    s_add_u32 s14, s14, 1024
    global_load_lds_dwordx4 v5, s[62:63]
    v_add_u32 v5, 131072, v5
    s_mov_b32 m0, s14
    s_add_u32 s14, s14, 1024
    global_load_lds_dwordx4 v5, s[62:63]
    v_add_u32 v5, 131072, v5
    s_mov_b32 m0, s14
    s_add_u32 s14, s14, 1024
    global_load_lds_dwordx4 v5, s[62:63]
    v_add_u32 v5, 131072, v5
    s_mov_b32 m0, s14
    s_add_u32 s14, s14, 1024
    global_load_lds_dwordx4 v5, s[62:63]
    v_add_u32 v5, 131072, v5
    s_mov_b32 m0, s14
    s_add_u32 s14, s14, 1024
    global_load_lds_dwordx4 v5, s[62:63]
    v_add_u32 v5, 131072, v5
    s_mov_b32 m0, s14
    s_add_u32 s14, s14, 1024
    global_load_lds_dwordx4 v5, s[62:63]
    v_add_u32 v5, 131072, v5
    s_mov_b32 m0, s14
    s_add_u32 s14, s14, 1024
    global_load_lds_dwordx4 v5, s[62:63]
    v_add_u32 v5, 131072, v5
    s_mov_b32 m0, s14
    s_add_u32 s14, s14, 1024
    global_load_lds_dwordx4 v5, s[62:63]
    v_add_u32 v5, 131072, v5
    s_mov_b32 m0, s14
    s_add_u32 s14, s14, 1024
    global_load_lds_dwordx4 v5, s[62:63]
    v_add_u32 v5, 131072, v5
    s_mov_b32 m0, s14
    s_add_u32 s14, s14, 1024
    global_load_lds_dwordx4 v5, s[62:63]
    v_add_u32 v5, 131072, v5
    s_mov_b32 m0, s14
    s_add_u32 s14, s14, 1024
    global_load_lds_dwordx4 v5, s[62:63]
    v_add_u32 v5, 131072, v5
    s_mov_b32 m0, s14
    s_add_u32 s14, s14, 1024
    global_load_lds_dwordx4 v5, s[62:63]
    v_add_u32 v5, 131072, v5
    s_mov_b32 m0, s14
    s_add_u32 s14, s14, 1024
    global_load_lds_dwordx4 v5, s[62:63]
    v_mov_b32 v5, v4
    s_lshl_b32 s14, s3, 14
    s_add_u32 s14, s14, 65536
    s_mov_b32 m0, s14
    s_add_u32 s14, s14, 1024
    global_load_lds_dwordx4 v5, s[64:65]
    v_add_u32 v5, 131072, v5
    s_mov_b32 m0, s14
    s_add_u32 s14, s14, 1024
    global_load_lds_dwordx4 v5, s[64:65]
    v_add_u32 v5, 131072, v5
    s_mov_b32 m0, s14
    s_add_u32 s14, s14, 1024
    global_load_lds_dwordx4 v5, s[64:65]
    v_add_u32 v5, 131072, v5
    s_mov_b32 m0, s14
    s_add_u32 s14, s14, 1024
    global_load_lds_dwordx4 v5, s[64:65]
    v_add_u32 v5, 131072, v5
    s_mov_b32 m0, s14
    s_add_u32 s14, s14, 1024
    global_load_lds_dwordx4 v5, s[64:65]
    v_add_u32 v5, 131072, v5
    s_mov_b32 m0, s14
    s_add_u32 s14, s14, 1024
    global_load_lds_dwordx4 v5, s[64:65]
    v_add_u32 v5, 131072, v5
    s_mov_b32 m0, s14
    s_add_u32 s14, s14, 1024
    global_load_lds_dwordx4 v5, s[64:65]
    v_add_u32 v5, 131072, v5
    s_mov_b32 m0, s14
    s_add_u32 s14, s14, 1024
    global_load_lds_dwordx4 v5, s[64:65]
    v_add_u32 v5, 131072, v5
    s_mov_b32 m0, s14
    s_add_u32 s14, s14, 1024
    global_load_lds_dwordx4 v5, s[64:65]
    v_add_u32 v5, 131072, v5
    s_mov_b32 m0, s14
    s_add_u32 s14, s14, 1024
    global_load_lds_dwordx4 v5, s[64:65]
    v_add_u32 v5, 131072, v5
    s_mov_b32 m0, s14
    s_add_u32 s14, s14, 1024
    global_load_lds_dwordx4 v5, s[64:65]
    v_add_u32 v5, 131072, v5
    s_mov_b32 m0, s14
    s_add_u32 s14, s14, 1024
    global_load_lds_dwordx4 v5, s[64:65]
    v_add_u32 v5, 131072, v5
    s_mov_b32 m0, s14
    s_add_u32 s14, s14, 1024
    global_load_lds_dwordx4 v5, s[64:65]
    v_add_u32 v5, 131072, v5
    s_mov_b32 m0, s14
    s_add_u32 s14, s14, 1024
    global_load_lds_dwordx4 v5, s[64:65]
    v_add_u32 v5, 131072, v5
    s_mov_b32 m0, s14
    s_add_u32 s14, s14, 1024
    global_load_lds_dwordx4 v5, s[64:65]
    v_add_u32 v5, 131072, v5
    s_mov_b32 m0, s14
    s_add_u32 s14, s14, 1024
    global_load_lds_dwordx4 v5, s[64:65]
    v_lshrrev_b32 v6, 2, v1
    v_lshl_add_u32 v6, v2, 3, v6
    v_lshlrev_b32 v6, 6, v6
    v_and_b32 v7, 3, v1
    v_lshl_add_u32 v6, v7, 3, v6
    s_waitcnt vmcnt(0)
    s_barrier
    s_lshr_b32 s12, s3, 1
    s_lshl_b32 s12, s12, 16
    s_and_b32 s13, s3, 1
    s_lshl_b32 s13, s13, 5
    s_add_u32 s12, s12, s13
    s_lshl_b32 s14, s3, 2
    s_add_u32 s14, s14, 0
    s_and_b32 s14, s14, 15
    s_lshl_b32 s14, s14, 12
    s_add_u32 s14, s14, s12
    v_add_u32 v7, s14, v6
    ds_read_b64_tr_b16 a[0:1], v7 offset:0
    ds_read_b64_tr_b16 a[2:3], v7 offset:256
    ds_read_b64_tr_b16 a[4:5], v7 offset:2048
    ds_read_b64_tr_b16 a[6:7], v7 offset:2304
    s_lshl_b32 s14, s3, 2
    s_add_u32 s14, s14, 1
    s_and_b32 s14, s14, 15
    s_lshl_b32 s14, s14, 12
    s_add_u32 s14, s14, s12
    v_add_u32 v7, s14, v6
    ds_read_b64_tr_b16 a[8:9], v7 offset:0
    ds_read_b64_tr_b16 a[10:11], v7 offset:256
    ds_read_b64_tr_b16 a[12:13], v7 offset:2048
    ds_read_b64_tr_b16 a[14:15], v7 offset:2304
    s_lshl_b32 s14, s3, 2
    s_add_u32 s14, s14, 2
    s_and_b32 s14, s14, 15
    s_lshl_b32 s14, s14, 12
    s_add_u32 s14, s14, s12
    v_add_u32 v7, s14, v6
    ds_read_b64_tr_b16 a[16:17], v7 offset:0
    ds_read_b64_tr_b16 a[18:19], v7 offset:256
    ds_read_b64_tr_b16 a[20:21], v7 offset:2048
    ds_read_b64_tr_b16 a[22:23], v7 offset:2304
    s_lshl_b32 s14, s3, 2
    s_add_u32 s14, s14, 3
    s_and_b32 s14, s14, 15
    s_lshl_b32 s14, s14, 12
    s_add_u32 s14, s14, s12
    v_add_u32 v7, s14, v6
    ds_read_b64_tr_b16 a[24:25], v7 offset:0
    ds_read_b64_tr_b16 a[26:27], v7 offset:256
    ds_read_b64_tr_b16 a[28:29], v7 offset:2048
    ds_read_b64_tr_b16 a[30:31], v7 offset:2304
    s_waitcnt lgkmcnt(0)
    s_lshl_b32 s14, s3, 2
    s_add_u32 s14, s14, 4
    s_and_b32 s14, s14, 15
    s_lshl_b32 s14, s14, 12
    s_add_u32 s14, s14, s12
    v_add_u32 v7, s14, v6
    ds_read_b64_tr_b16 a[32:33], v7 offset:0
    ds_read_b64_tr_b16 a[34:35], v7 offset:256
    ds_read_b64_tr_b16 a[36:37], v7 offset:2048
    ds_read_b64_tr_b16 a[38:39], v7 offset:2304
    s_lshl_b32 s14, s3, 2
    s_add_u32 s14, s14, 5
    s_and_b32 s14, s14, 15
    s_lshl_b32 s14, s14, 12
    s_add_u32 s14, s14, s12
    v_add_u32 v7, s14, v6
    ds_read_b64_tr_b16 a[40:41], v7 offset:0
    ds_read_b64_tr_b16 a[42:43], v7 offset:256
    ds_read_b64_tr_b16 a[44:45], v7 offset:2048
    ds_read_b64_tr_b16 a[46:47], v7 offset:2304
    s_lshl_b32 s14, s3, 2
    s_add_u32 s14, s14, 6
    s_and_b32 s14, s14, 15
    s_lshl_b32 s14, s14, 12
    s_add_u32 s14, s14, s12
    v_add_u32 v7, s14, v6
    ds_read_b64_tr_b16 a[48:49], v7 offset:0
    ds_read_b64_tr_b16 a[50:51], v7 offset:256
    ds_read_b64_tr_b16 a[52:53], v7 offset:2048
    ds_read_b64_tr_b16 a[54:55], v7 offset:2304
    s_lshl_b32 s14, s3, 2
    s_add_u32 s14, s14, 7
    s_and_b32 s14, s14, 15
    s_lshl_b32 s14, s14, 12
    s_add_u32 s14, s14, s12
    v_add_u32 v7, s14, v6
    ds_read_b64_tr_b16 a[56:57], v7 offset:0
    ds_read_b64_tr_b16 a[58:59], v7 offset:256
    ds_read_b64_tr_b16 a[60:61], v7 offset:2048
    ds_read_b64_tr_b16 a[62:63], v7 offset:2304
    s_waitcnt lgkmcnt(0)
    s_lshl_b32 s14, s3, 2
    s_add_u32 s14, s14, 8
    s_and_b32 s14, s14, 15
    s_lshl_b32 s14, s14, 12
    s_add_u32 s14, s14, s12
    v_add_u32 v7, s14, v6
    ds_read_b64_tr_b16 a[64:65], v7 offset:0
    ds_read_b64_tr_b16 a[66:67], v7 offset:256
    ds_read_b64_tr_b16 a[68:69], v7 offset:2048
    ds_read_b64_tr_b16 a[70:71], v7 offset:2304
    s_lshl_b32 s14, s3, 2
    s_add_u32 s14, s14, 9
    s_and_b32 s14, s14, 15
    s_lshl_b32 s14, s14, 12
    s_add_u32 s14, s14, s12
    v_add_u32 v7, s14, v6
    ds_read_b64_tr_b16 a[72:73], v7 offset:0
    ds_read_b64_tr_b16 a[74:75], v7 offset:256
    ds_read_b64_tr_b16 a[76:77], v7 offset:2048
    ds_read_b64_tr_b16 a[78:79], v7 offset:2304
    s_lshl_b32 s14, s3, 2
    s_add_u32 s14, s14, 10
    s_and_b32 s14, s14, 15
    s_lshl_b32 s14, s14, 12
    s_add_u32 s14, s14, s12
    v_add_u32 v7, s14, v6
    ds_read_b64_tr_b16 a[80:81], v7 offset:0
    ds_read_b64_tr_b16 a[82:83], v7 offset:256
    ds_read_b64_tr_b16 a[84:85], v7 offset:2048
    ds_read_b64_tr_b16 a[86:87], v7 offset:2304
    s_lshl_b32 s14, s3, 2
    s_add_u32 s14, s14, 11
    s_and_b32 s14, s14, 15
    s_lshl_b32 s14, s14, 12
    s_add_u32 s14, s14, s12
    v_add_u32 v7, s14, v6
    ds_read_b64_tr_b16 a[88:89], v7 offset:0
    ds_read_b64_tr_b16 a[90:91], v7 offset:256
    ds_read_b64_tr_b16 a[92:93], v7 offset:2048
    ds_read_b64_tr_b16 a[94:95], v7 offset:2304
    s_waitcnt lgkmcnt(0)
    s_lshl_b32 s14, s3, 2
    s_add_u32 s14, s14, 12
    s_and_b32 s14, s14, 15
    s_lshl_b32 s14, s14, 12
    s_add_u32 s14, s14, s12
    v_add_u32 v7, s14, v6
    ds_read_b64_tr_b16 a[96:97], v7 offset:0
    ds_read_b64_tr_b16 a[98:99], v7 offset:256
    ds_read_b64_tr_b16 a[100:101], v7 offset:2048
    ds_read_b64_tr_b16 a[102:103], v7 offset:2304
    s_lshl_b32 s14, s3, 2
    s_add_u32 s14, s14, 13
    s_and_b32 s14, s14, 15
    s_lshl_b32 s14, s14, 12
    s_add_u32 s14, s14, s12
    v_add_u32 v7, s14, v6
    ds_read_b64_tr_b16 a[104:105], v7 offset:0
    ds_read_b64_tr_b16 a[106:107], v7 offset:256
    ds_read_b64_tr_b16 a[108:109], v7 offset:2048
    ds_read_b64_tr_b16 a[110:111], v7 offset:2304
    s_lshl_b32 s14, s3, 2
    s_add_u32 s14, s14, 14
    s_and_b32 s14, s14, 15
    s_lshl_b32 s14, s14, 12
    s_add_u32 s14, s14, s12
    v_add_u32 v7, s14, v6
    ds_read_b64_tr_b16 a[112:113], v7 offset:0
    ds_read_b64_tr_b16 a[114:115], v7 offset:256
    ds_read_b64_tr_b16 a[116:117], v7 offset:2048
    ds_read_b64_tr_b16 a[118:119], v7 offset:2304
    s_lshl_b32 s14, s3, 2
    s_add_u32 s14, s14, 15
    s_and_b32 s14, s14, 15
    s_lshl_b32 s14, s14, 12
    s_add_u32 s14, s14, s12
    v_add_u32 v7, s14, v6
    ds_read_b64_tr_b16 a[120:121], v7 offset:0
    ds_read_b64_tr_b16 a[122:123], v7 offset:256
    ds_read_b64_tr_b16 a[124:125], v7 offset:2048
    ds_read_b64_tr_b16 a[126:127], v7 offset:2304
    s_waitcnt lgkmcnt(0)
    s_barrier
    v_mov_b32 v5, v4
    s_lshl_b32 s14, s3, 14
    s_add_u32 s14, s14, 0
    s_mov_b32 m0, s14
    s_add_u32 s14, s14, 1024
    global_load_lds_dwordx4 v5, s[66:67]
    v_add_u32 v5, 131072, v5
    s_mov_b32 m0, s14
    s_add_u32 s14, s14, 1024
    global_load_lds_dwordx4 v5, s[66:67]
    v_add_u32 v5, 131072, v5
    s_mov_b32 m0, s14
    s_add_u32 s14, s14, 1024
    global_load_lds_dwordx4 v5, s[66:67]
    v_add_u32 v5, 131072, v5
    s_mov_b32 m0, s14
    s_add_u32 s14, s14, 1024
    global_load_lds_dwordx4 v5, s[66:67]
    v_add_u32 v5, 131072, v5
    s_mov_b32 m0, s14
    s_add_u32 s14, s14, 1024
    global_load_lds_dwordx4 v5, s[66:67]
    v_add_u32 v5, 131072, v5
    s_mov_b32 m0, s14
    s_add_u32 s14, s14, 1024
    global_load_lds_dwordx4 v5, s[66:67]
    v_add_u32 v5, 131072, v5
    s_mov_b32 m0, s14
    s_add_u32 s14, s14, 1024
    global_load_lds_dwordx4 v5, s[66:67]
    v_add_u32 v5, 131072, v5
    s_mov_b32 m0, s14
    s_add_u32 s14, s14, 1024
    global_load_lds_dwordx4 v5, s[66:67]
    v_add_u32 v5, 131072, v5
    s_mov_b32 m0, s14
    s_add_u32 s14, s14, 1024
    global_load_lds_dwordx4 v5, s[66:67]
    v_add_u32 v5, 131072, v5
    s_mov_b32 m0, s14
    s_add_u32 s14, s14, 1024
    global_load_lds_dwordx4 v5, s[66:67]
    v_add_u32 v5, 131072, v5
    s_mov_b32 m0, s14
    s_add_u32 s14, s14, 1024
    global_load_lds_dwordx4 v5, s[66:67]
    v_add_u32 v5, 131072, v5
    s_mov_b32 m0, s14
    s_add_u32 s14, s14, 1024
    global_load_lds_dwordx4 v5, s[66:67]
    v_add_u32 v5, 131072, v5
    s_mov_b32 m0, s14
    s_add_u32 s14, s14, 1024
    global_load_lds_dwordx4 v5, s[66:67]
    v_add_u32 v5, 131072, v5
    s_mov_b32 m0, s14
    s_add_u32 s14, s14, 1024
    global_load_lds_dwordx4 v5, s[66:67]
    v_add_u32 v5, 131072, v5
    s_mov_b32 m0, s14
    s_add_u32 s14, s14, 1024
    global_load_lds_dwordx4 v5, s[66:67]
    v_add_u32 v5, 131072, v5
    s_mov_b32 m0, s14
    s_add_u32 s14, s14, 1024
    global_load_lds_dwordx4 v5, s[66:67]
    v_lshrrev_b32 v4, 3, v0
    v_lshlrev_b32 v4, 11, v4
    v_and_b32 v5, 7, v0
    v_lshl_add_u32 v4, v5, 4, v4
    s_lshl_b32 s12, s4, 20
    s_lshl_b32 s13, s5, 7
    s_add_u32 s12, s12, s13
    s_lshl_b32 s13, s3, 18
    s_add_u32 s12, s12, s13
    v_add_u32 v4, s12, v4
    v_mov_b32 v5, v4
    s_lshl_b32 s14, s3, 14
    s_add_u32 s14, s14, 65536
    s_mov_b32 m0, s14
    s_add_u32 s14, s14, 1024
    global_load_lds_dwordx4 v5, s[68:69]
    v_add_u32 v5, 16384, v5
    s_mov_b32 m0, s14
    s_add_u32 s14, s14, 1024
    global_load_lds_dwordx4 v5, s[68:69]
    v_add_u32 v5, 16384, v5
    s_mov_b32 m0, s14
    s_add_u32 s14, s14, 1024
    global_load_lds_dwordx4 v5, s[68:69]
    v_add_u32 v5, 16384, v5
    s_mov_b32 m0, s14
    s_add_u32 s14, s14, 1024
    global_load_lds_dwordx4 v5, s[68:69]
    v_add_u32 v5, 16384, v5
    s_mov_b32 m0, s14
    s_add_u32 s14, s14, 1024
    global_load_lds_dwordx4 v5, s[68:69]
    v_add_u32 v5, 16384, v5
    s_mov_b32 m0, s14
    s_add_u32 s14, s14, 1024
    global_load_lds_dwordx4 v5, s[68:69]
    v_add_u32 v5, 16384, v5
    s_mov_b32 m0, s14
    s_add_u32 s14, s14, 1024
    global_load_lds_dwordx4 v5, s[68:69]
    v_add_u32 v5, 16384, v5
    s_mov_b32 m0, s14
    s_add_u32 s14, s14, 1024
    global_load_lds_dwordx4 v5, s[68:69]
    v_add_u32 v5, 16384, v5
    s_mov_b32 m0, s14
    s_add_u32 s14, s14, 1024
    global_load_lds_dwordx4 v5, s[68:69]
    v_add_u32 v5, 16384, v5
    s_mov_b32 m0, s14
    s_add_u32 s14, s14, 1024
    global_load_lds_dwordx4 v5, s[68:69]
    v_add_u32 v5, 16384, v5
    s_mov_b32 m0, s14
    s_add_u32 s14, s14, 1024
    global_load_lds_dwordx4 v5, s[68:69]
    v_add_u32 v5, 16384, v5
    s_mov_b32 m0, s14
    s_add_u32 s14, s14, 1024
    global_load_lds_dwordx4 v5, s[68:69]
    v_add_u32 v5, 16384, v5
    s_mov_b32 m0, s14
    s_add_u32 s14, s14, 1024
    global_load_lds_dwordx4 v5, s[68:69]
    v_add_u32 v5, 16384, v5
    s_mov_b32 m0, s14
    s_add_u32 s14, s14, 1024
    global_load_lds_dwordx4 v5, s[68:69]
    v_add_u32 v5, 16384, v5
    s_mov_b32 m0, s14
    s_add_u32 s14, s14, 1024
    global_load_lds_dwordx4 v5, s[68:69]
    v_add_u32 v5, 16384, v5
    s_mov_b32 m0, s14
    s_add_u32 s14, s14, 1024
    global_load_lds_dwordx4 v5, s[68:69]
    s_waitcnt vmcnt(0)
    s_barrier
    s_and_b32 s12, s3, 1
    s_lshl_b32 s12, s12, 5
    s_lshl_b32 s14, s3, 2
    s_add_u32 s14, s14, 0
    s_and_b32 s14, s14, 15
    s_lshl_b32 s14, s14, 12
    s_add_u32 s14, s14, s12
    v_add_u32 v7, s14, v6
    ds_read_b64_tr_b16 a[128:129], v7 offset:0
    ds_read_b64_tr_b16 a[130:131], v7 offset:256
    ds_read_b64_tr_b16 a[132:133], v7 offset:2048
    ds_read_b64_tr_b16 a[134:135], v7 offset:2304
    s_lshl_b32 s14, s3, 2
    s_add_u32 s14, s14, 1
    s_and_b32 s14, s14, 15
    s_lshl_b32 s14, s14, 12
    s_add_u32 s14, s14, s12
    v_add_u32 v7, s14, v6
    ds_read_b64_tr_b16 a[136:137], v7 offset:0
    ds_read_b64_tr_b16 a[138:139], v7 offset:256
    ds_read_b64_tr_b16 a[140:141], v7 offset:2048
    ds_read_b64_tr_b16 a[142:143], v7 offset:2304
    s_lshl_b32 s14, s3, 2
    s_add_u32 s14, s14, 2
    s_and_b32 s14, s14, 15
    s_lshl_b32 s14, s14, 12
    s_add_u32 s14, s14, s12
    v_add_u32 v7, s14, v6
    ds_read_b64_tr_b16 a[144:145], v7 offset:0
    ds_read_b64_tr_b16 a[146:147], v7 offset:256
    ds_read_b64_tr_b16 a[148:149], v7 offset:2048
    ds_read_b64_tr_b16 a[150:151], v7 offset:2304
    s_lshl_b32 s14, s3, 2
    s_add_u32 s14, s14, 3
    s_and_b32 s14, s14, 15
    s_lshl_b32 s14, s14, 12
    s_add_u32 s14, s14, s12
    v_add_u32 v7, s14, v6
    ds_read_b64_tr_b16 a[152:153], v7 offset:0
    ds_read_b64_tr_b16 a[154:155], v7 offset:256
    ds_read_b64_tr_b16 a[156:157], v7 offset:2048
    ds_read_b64_tr_b16 a[158:159], v7 offset:2304
    s_waitcnt lgkmcnt(0)
    s_lshl_b32 s14, s3, 2
    s_add_u32 s14, s14, 4
    s_and_b32 s14, s14, 15
    s_lshl_b32 s14, s14, 12
    s_add_u32 s14, s14, s12
    v_add_u32 v7, s14, v6
    ds_read_b64_tr_b16 a[160:161], v7 offset:0
    ds_read_b64_tr_b16 a[162:163], v7 offset:256
    ds_read_b64_tr_b16 a[164:165], v7 offset:2048
    ds_read_b64_tr_b16 a[166:167], v7 offset:2304
    s_lshl_b32 s14, s3, 2
    s_add_u32 s14, s14, 5
    s_and_b32 s14, s14, 15
    s_lshl_b32 s14, s14, 12
    s_add_u32 s14, s14, s12
    v_add_u32 v7, s14, v6
    ds_read_b64_tr_b16 a[168:169], v7 offset:0
    ds_read_b64_tr_b16 a[170:171], v7 offset:256
    ds_read_b64_tr_b16 a[172:173], v7 offset:2048
    ds_read_b64_tr_b16 a[174:175], v7 offset:2304
    s_lshl_b32 s14, s3, 2
    s_add_u32 s14, s14, 6
    s_and_b32 s14, s14, 15
    s_lshl_b32 s14, s14, 12
    s_add_u32 s14, s14, s12
    v_add_u32 v7, s14, v6
    ds_read_b64_tr_b16 a[176:177], v7 offset:0
    ds_read_b64_tr_b16 a[178:179], v7 offset:256
    ds_read_b64_tr_b16 a[180:181], v7 offset:2048
    ds_read_b64_tr_b16 a[182:183], v7 offset:2304
    s_lshl_b32 s14, s3, 2
    s_add_u32 s14, s14, 7
    s_and_b32 s14, s14, 15
    s_lshl_b32 s14, s14, 12
    s_add_u32 s14, s14, s12
    v_add_u32 v7, s14, v6
    ds_read_b64_tr_b16 a[184:185], v7 offset:0
    ds_read_b64_tr_b16 a[186:187], v7 offset:256
    ds_read_b64_tr_b16 a[188:189], v7 offset:2048
    ds_read_b64_tr_b16 a[190:191], v7 offset:2304
    s_waitcnt lgkmcnt(0)
    v_lshrrev_b32 v6, 2, v1
    v_lshl_add_u32 v6, v2, 2, v6
    v_lshlrev_b32 v6, 7, v6
    v_and_b32 v7, 3, v1
    v_lshl_add_u32 v6, v7, 3, v6
    s_lshl_b32 s12, s3, 14
    s_add_u32 s12, s12, 65536
    v_add_u32 v7, s12, v6
    ds_read_b64_tr_b16 a[192:193], v7 offset:0
    ds_read_b64_tr_b16 a[194:195], v7 offset:2048
    ds_read_b64_tr_b16 a[196:197], v7 offset:4096
    ds_read_b64_tr_b16 a[198:199], v7 offset:6144
    ds_read_b64_tr_b16 a[200:201], v7 offset:8192
    ds_read_b64_tr_b16 a[202:203], v7 offset:10240
    ds_read_b64_tr_b16 a[204:205], v7 offset:12288
    ds_read_b64_tr_b16 a[206:207], v7 offset:14336
    s_waitcnt lgkmcnt(0)
    ds_read_b64_tr_b16 a[208:209], v7 offset:32
    ds_read_b64_tr_b16 a[210:211], v7 offset:2080
    ds_read_b64_tr_b16 a[212:213], v7 offset:4128
    ds_read_b64_tr_b16 a[214:215], v7 offset:6176
    ds_read_b64_tr_b16 a[216:217], v7 offset:8224
    ds_read_b64_tr_b16 a[218:219], v7 offset:10272
    ds_read_b64_tr_b16 a[220:221], v7 offset:12320
    ds_read_b64_tr_b16 a[222:223], v7 offset:14368
    s_waitcnt lgkmcnt(0)
    ds_read_b64_tr_b16 a[224:225], v7 offset:64
    ds_read_b64_tr_b16 a[226:227], v7 offset:2112
    ds_read_b64_tr_b16 a[228:229], v7 offset:4160
    ds_read_b64_tr_b16 a[230:231], v7 offset:6208
    ds_read_b64_tr_b16 a[232:233], v7 offset:8256
    ds_read_b64_tr_b16 a[234:235], v7 offset:10304
    ds_read_b64_tr_b16 a[236:237], v7 offset:12352
    ds_read_b64_tr_b16 a[238:239], v7 offset:14400
    s_waitcnt lgkmcnt(0)
    ds_read_b64_tr_b16 a[240:241], v7 offset:96
    ds_read_b64_tr_b16 a[242:243], v7 offset:2144
    ds_read_b64_tr_b16 a[244:245], v7 offset:4192
    ds_read_b64_tr_b16 a[246:247], v7 offset:6240
    ds_read_b64_tr_b16 a[248:249], v7 offset:8288
    ds_read_b64_tr_b16 a[250:251], v7 offset:10336
    ds_read_b64_tr_b16 a[252:253], v7 offset:12384
    ds_read_b64_tr_b16 a[254:255], v7 offset:14432
    s_waitcnt lgkmcnt(0)
    s_barrier
    s_cmp_lg_u32 s3, 0
    s_cbranch_scc1 RF_L_fc_r_w
    s_mov_b64 exec, 0xff
    v_and_b32 v1, 3, v0
    v_lshlrev_b32 v1, 2, v1
    v_lshrrev_b32 v5, 2, v0
    v_lshl_add_u32 v1, v5, 7, v1
    s_mov_b32 s13, 0x200000
RF_L_fc_r_p:
    global_load_dword v4, v1, s[70:71] sc1
    s_waitcnt vmcnt(0)
    v_mov_b32 v5, v4
    s_nop 1
    v_add_u32_dpp v5, v5, v5 quad_perm:[1,0,3,2] row_mask:0xf bank_mask:0xf
    s_nop 1
    v_add_u32_dpp v5, v5, v5 quad_perm:[2,3,0,1] row_mask:0xf bank_mask:0xf
    s_nop 1
    v_add_u32_dpp v5, v5, v5 row_half_mirror row_mask:0xf bank_mask:0xf
    s_nop 0
    v_readfirstlane_b32 s14, v5
    s_nop 0
    s_cmp_ge_u32 s14, 256
    s_cbranch_scc1 RF_L_fc_r_a
    s_sleep 8
    s_sub_u32 s13, s13, 1
    s_cbranch_scc0 RF_L_fc_r_p
RF_L_fc_r_a:
    v_cmp_ne_u32 vcc, 32, v4
    s_nop 1
    s_cmp_eq_u64 vcc, 0
    s_cselect_b32 s15, 1, 0
    s_mov_b64 exec, 1
    v_mov_b32 v6, s15
    v_mov_b32 v1, 131008
    ds_write_b32 v1, v6
    s_waitcnt lgkmcnt(0)
    s_mov_b64 exec, -1
RF_L_fc_r_w:
    s_barrier
    v_mov_b32 v1, 131008
    ds_read_b32 v6, v1
    s_waitcnt lgkmcnt(0)
    v_readfirstlane_b32 s15, v6
    s_barrier
    s_cmp_eq_u32 s15, 0
    s_cbranch_scc1 M_slow
    v_and_b32 v1, 15, v0
    v_lshrrev_b32 v2, 4, v0
    v_and_b32 v3, 7, v0
    s_lshl_b32 s12, s3, 12
    v_add_u32 v8, s12, v56
    v_lshrrev_b32 v4, 1, v2
    v_lshlrev_b32 v4, 8, v4
    v_lshl_add_u32 v4, v3, 4, v4
    s_lshr_b32 s12, s7, 1
    s_lshl_b32 s12, s12, 10
    s_and_b32 s13, s3, 1
    s_lshl_b32 s13, s13, 9
    s_add_u32 s12, s12, s13
    s_and_b32 s13, s7, 1
    s_lshl_b32 s13, s13, 7
    s_add_u32 s12, s12, s13
    v_add_u32 v57, s12, v4
    s_lshl_b32 s12, s6, 12
    s_lshr_b32 s13, s3, 1
    s_lshl_b32 s13, s13, 11
    s_add_u32 s12, s12, s13
    v_add_u32 v9, s12, v57
    s_lshl_b32 s12, s6, 11
    s_lshl_b32 s13, s7, 9
    s_add_u32 s12, s12, s13
    v_add_u32 v10, s12, v56
    s_lshl_b32 s12, s3, 11
    v_add_u32 v11, s12, v56
    s_lshl_b32 s12, s4, 4
    s_add_u32 s12, s12, s5
    s_lshl_b32 s12, s12, 10
    s_and_b32 s13, s3, 1
    s_lshl_b32 s13, s13, 9
    s_add_u32 s12, s12, s13
    s_lshr_b32 s13, s3, 1
    s_lshl_b32 s13, s13, 7
    s_add_u32 s12, s12, s13
    v_add_u32 v12, s12, v4
    v_lshlrev_b32 v13, 14, v2
    v_lshl_add_u32 v13, v1, 4, v13
    s_lshl_b32 s12, s5, 10
    s_lshl_b32 s13, s3, 8
    s_add_u32 s12, s12, s13
    v_add_u32 v13, s12, v13
    v_add_u32 v14, s12, v56
    v_lshlrev_b32 v15, 13, v1
    v_lshl_add_u32 v15, v2, 4, v15
    s_lshl_b32 s12, s8, 8
    v_add_u32 v15, s12, v15
    v_mov_b32 v232, v56
    v_mov_b32 v52, 0
    v_mov_b32 v4, 0x3f80
    v_cmp_eq_u32 vcc, 0, v1
    s_nop 1
    v_cndmask_b32 v52, v52, v4, vcc
    v_mov_b32 v4, 0x3f800000
    v_cmp_eq_u32 vcc, 1, v1
    s_nop 1
    v_cndmask_b32 v52, v52, v4, vcc
    v_mov_b32 v53, 0
    v_mov_b32 v4, 0x3f80
    v_cmp_eq_u32 vcc, 2, v1
    s_nop 1
    v_cndmask_b32 v53, v53, v4, vcc
    v_mov_b32 v4, 0x3f800000
    v_cmp_eq_u32 vcc, 3, v1
    s_nop 1
    v_cndmask_b32 v53, v53, v4, vcc
    v_mov_b32 v54, 0
    v_mov_b32 v4, 0x3f80
    v_cmp_eq_u32 vcc, 4, v1
    s_nop 1
    v_cndmask_b32 v54, v54, v4, vcc
    v_mov_b32 v4, 0x3f800000
    v_cmp_eq_u32 vcc, 5, v1
    s_nop 1
    v_cndmask_b32 v54, v54, v4, vcc
    v_mov_b32 v55, 0
    v_mov_b32 v4, 0x3f80
    v_cmp_eq_u32 vcc, 6, v1
    s_nop 1
    v_cndmask_b32 v55, v55, v4, vcc
    v_mov_b32 v4, 0x3f800000
    v_cmp_eq_u32 vcc, 7, v1
    s_nop 1
    v_cndmask_b32 v55, v55, v4, vcc
    v_mov_b32 v4, 0xff800000
    v_cmp_lt_u32 vcc, 31, v0
    s_nop 1
    v_cndmask_b32 v60, 0, v4, vcc
    v_mov_b32 v61, v60
    v_mov_b32 v62, v60
    v_mov_b32 v63, v60
    v_mov_b32 v236, -1
    v_mov_b32 v237, -1
    v_mov_b32 v238, -1
    v_mov_b32 v239, -1
    s_mov_b32 s54, 0xff
    s_mov_b32 s55, 0xff
    s_mov_b32 s58, -1
    s_mov_b32 s59, 0
    s_mov_b32 s60, 0x3e0293ee
    s_mov_b32 s61, s60
    s_mov_b32 s52, 0x400000
    s_mov_b32 s50, 0
    s_lshl_b32 s12, s8, 13
    s_add_u32 s12, s12, 4096
    s_add_u32 s32, s10, 25165824
    s_addc_u32 s33, s11, 0
    s_add_u32 s32, s32, s12
    s_addc_u32 s33, s33, 0
    s_lshl_b32 s12, s8, 13
    s_add_u32 s12, s12, 4096
    s_add_u32 s36, s10, 41943040
    s_addc_u32 s37, s11, 0
    s_add_u32 s36, s36, s12
    s_addc_u32 s37, s37, 0
    s_lshl_b32 s12, s8, 11
    s_add_u32 s38, s10, 58720256
    s_addc_u32 s39, s11, 0
    s_add_u32 s38, s38, s12
    s_addc_u32 s39, s39, 0
    s_add_u32 s40, s10, 62914560
    s_addc_u32 s41, s11, 0
    s_add_u32 s40, s40, s12
    s_addc_u32 s41, s41, 0
    s_add_u32 s16, s10, 130023424
    s_addc_u32 s17, s11, 0
    s_lshl_b32 s12, s4, 7
    s_mov_b32 s14, 16
    s_cmp_lg_u32 s3, 0
    s_cbranch_scc1 RF_L_gp_k0_ok
    v_mov_b32 v242, s12
RF_L_gp_k0:
    global_load_dword v243, v242, s[16:17] sc1
    s_waitcnt vmcnt(0)
    v_readfirstlane_b32 s13, v243
    s_nop 0
    s_cmp_ge_u32 s13, s14
    s_cbranch_scc1 RF_L_gp_k0_ok
    s_sleep 6
    s_sub_u32 s52, s52, 1
    s_cbranch_scc0 RF_L_gp_k0
    s_mov_b32 s52, 0
RF_L_gp_k0_ok:
    s_barrier
    global_load_dwordx4 v[128:131], v56, s[32:33] offset:-4096
    global_load_dwordx4 v[132:135], v56, s[32:33] offset:-3072
    global_load_dwordx4 v[136:139], v56, s[32:33] offset:-2048
    global_load_dwordx4 v[140:143], v56, s[32:33] offset:-1024
    global_load_dwordx4 v[144:147], v56, s[32:33] offset:0
    global_load_dwordx4 v[148:151], v56, s[32:33] offset:1024
    global_load_dwordx4 v[152:155], v56, s[32:33] offset:2048
    global_load_dwordx4 v[156:159], v56, s[32:33] offset:3072
    s_lshl_b32 s13, s4, 2
    s_add_u32 s13, s13, s6
    s_lshl_b32 s13, s13, 13
    s_lshl_b32 s14, s7, 11
    s_add_u32 s13, s13, s14
    s_and_b32 s14, s3, 1
    s_lshl_b32 s14, s14, 10
    s_add_u32 s13, s13, s14
    v_add_u32 v58, s13, v56
    s_cmp_lt_u32 s3, 2
    s_mov_b32 s12, 25690112
    s_mov_b32 s13, 42467328
    s_cselect_b32 s12, s12, s13
    s_add_u32 s18, s10, s12
    s_addc_u32 s19, s11, 0
    v_add_u32 v232, 4096, v8
    v_and_b32 v232, 0x3fff, v232
    v_add_u32 v233, 8192, v8
    v_and_b32 v233, 0x3fff, v233
    v_add_u32 v234, 12288, v8
    v_and_b32 v234, 0x3fff, v234
    s_lshl_b32 s12, s3, 10
    v_add_u32 v235, s12, v56
    v_and_b32 v59, 31, v0
    v_lshlrev_b32 v59, 4, v59
    v_lshrrev_b32 v242, 5, v0
    v_lshl_add_u32 v59, v242, 10, v59
    v_lshlrev_b32 v243, 2, v0
    s_lshl_b32 s12, s3, 8
    v_add_u32 v15, s12, v243
    s_add_u32 s12, s3, 1
    s_and_b32 s12, s12, 3
    s_lshl_b32 s12, s12, 8
    v_add_u32 v1, s12, v243
    s_add_u32 s12, s3, 2
    s_and_b32 s12, s12, 3
    s_lshl_b32 s12, s12, 8
    v_add_u32 v2, s12, v243
    s_add_u32 s12, s3, 3
    s_and_b32 s12, s12, 3
    s_lshl_b32 s12, s12, 8
    v_add_u32 v3, s12, v243
    v_mov_b32 v4, 0x3f803f80
    v_mov_b32 v5, 0x3f803f80
    v_mov_b32 v6, 0x3f803f80
    v_mov_b32 v7, 0x3f803f80
RF_L_step:
    s_add_u32 s12, s50, 2
    s_and_b32 s13, s12, 7
    s_cmp_lg_u32 s13, 0
    s_cbranch_scc1 RF_L_kvskip
    s_cmp_ge_u32 s12, 64
    s_cbranch_scc1 RF_L_kvskip
    s_lshr_b32 s12, s12, 3
    s_mov_b32 s14, 4
    v_readfirstlane_b32 s13, v57
    s_nop 0
    s_cmp_ge_u32 s13, s14
    s_cbranch_scc1 RF_L_kvskip
    s_lshl_b32 s12, s12, 3
    s_add_u32 s12, s12, s4
    s_lshl_b32 s12, s12, 7
    v_mov_b32 v242, s12
RF_L_gp_n:
    global_load_dword v243, v242, s[16:17] sc1
    s_waitcnt vmcnt(0)
    v_readfirstlane_b32 s13, v243
    s_nop 0
    s_cmp_ge_u32 s13, s14
    s_cbranch_scc1 RF_L_gp_n_ok
    s_sleep 4
    s_sub_u32 s52, s52, 1
    s_cbranch_scc0 RF_L_gp_n
    s_mov_b32 s52, 0
RF_L_gp_n_ok:
RF_L_kvskip:
    s_and_b32 s51, s50, 3
    s_lshl_b32 s12, s51, 17
    s_lshl_b32 s13, s4, 14
    s_add_u32 s14, s12, s13
    s_add_u32 s20, s10, 100663296
    s_addc_u32 s21, s11, 0
    s_add_u32 s20, s20, s14
    s_addc_u32 s21, s21, 0
    s_add_u32 s24, s10, 101711872
    s_addc_u32 s25, s11, 0
    s_add_u32 s24, s24, s14
    s_addc_u32 s25, s25, 0
    s_lshl_b32 s15, s50, 17
    s_add_u32 s28, s10, 117440512
    s_addc_u32 s29, s11, 0
    s_add_u32 s28, s28, s15
    s_addc_u32 s29, s29, 0
    s_add_u32 s30, s28, 65536
    s_addc_u32 s31, s29, 0
    s_lshr_b32 s15, s14, 1
    s_add_u32 s26, s10, 102760448
    s_addc_u32 s27, s11, 0
    s_add_u32 s26, s26, s15
    s_addc_u32 s27, s27, 0
    s_add_u32 s15, s50, 1
    s_and_b32 s15, s15, 3
    s_lshl_b32 s15, s15, 17
    s_add_u32 s15, s15, s13
    s_add_u32 s22, s10, 100663296
    s_addc_u32 s23, s11, 0
    s_add_u32 s22, s22, s15
    s_addc_u32 s23, s23, 0
    s_xor_b32 s15, s12, 262144
    s_add_u32 s15, s15, s13
    s_add_u32 s42, s10, 101711872
    s_addc_u32 s43, s11, 0
    s_add_u32 s42, s42, s15
    s_addc_u32 s43, s43, 0
    s_lshr_b32 s15, s15, 1
    s_add_u32 s44, s10, 102760448
    s_addc_u32 s45, s11, 0
    s_add_u32 s44, s44, s15
    s_addc_u32 s45, s45, 0
    s_add_u32 s15, s50, 3
    s_and_b32 s15, s15, 3
    s_lshl_b32 s15, s15, 17
    s_add_u32 s15, s15, s13
    s_add_u32 s48, s10, 100663296
    s_addc_u32 s49, s11, 0
    s_add_u32 s48, s48, s15
    s_addc_u32 s49, s49, 0
    global_load_dwordx4 v[64:67], v8, s[20:21] offset:0 sc1
    global_load_dwordx4 v[68:71], v8, s[20:21] offset:1024 sc1
    global_load_dwordx4 v[72:75], v8, s[20:21] offset:2048 sc1
    global_load_dwordx4 v[76:79], v8, s[20:21] offset:3072 sc1
    s_waitcnt vmcnt(0)
    s_branch RF_L_e3_c
RF_L_e3_r:
    global_load_dwordx4 v[64:67], v8, s[20:21] offset:0 sc1
    global_load_dwordx4 v[68:71], v8, s[20:21] offset:1024 sc1
    global_load_dwordx4 v[72:75], v8, s[20:21] offset:2048 sc1
    global_load_dwordx4 v[76:79], v8, s[20:21] offset:3072 sc1
    s_waitcnt vmcnt(0)
RF_L_e3_c:
    v_max3_u32 v240, v64, v65, v66
    v_max3_u32 v240, v240, v67, v68
    v_max3_u32 v240, v240, v69, v70
    v_max3_u32 v240, v240, v71, v72
    v_max3_u32 v240, v240, v73, v74
    v_max3_u32 v240, v240, v75, v76
    v_max3_u32 v240, v240, v77, v78
    v_max_u32 v240, v240, v79
    v_cmp_eq_u32 vcc, -1, v240
    s_cbranch_vccz RF_L_e3_ok
    s_sub_u32 s52, s52, 1
    s_cbranch_scc0 RF_L_e3_r
    s_mov_b32 s52, 0
RF_L_e3_ok:
    ds_write_b128 v8, v[64:67] offset:0
    v_mfma_f32_16x16x32_bf16 v[16:19], a[0:3], v[64:67], 0
    ds_write_b128 v8, v[68:71] offset:1024
    v_mfma_f32_16x16x32_bf16 v[20:23], a[4:7], v[64:67], 0
    ds_write_b128 v8, v[72:75] offset:2048
    v_mfma_f32_16x16x32_bf16 v[16:19], a[8:11], v[68:71], v[16:19]
    ds_write_b128 v8, v[76:79] offset:3072
    v_mfma_f32_16x16x32_bf16 v[20:23], a[12:15], v[68:71], v[20:23]
    s_waitcnt lgkmcnt(0)
    s_barrier
    ds_read_b128 v[80:83], v232 offset:0
    ds_read_b128 v[84:87], v232 offset:1024
    ds_read_b128 v[88:91], v232 offset:2048
    ds_read_b128 v[92:95], v232 offset:3072
    ds_read_b128 v[96:99], v233 offset:0
    ds_read_b128 v[100:103], v233 offset:1024
    ds_read_b128 v[104:107], v233 offset:2048
    ds_read_b128 v[108:111], v233 offset:3072
    ds_read_b128 v[112:115], v234 offset:0
    ds_read_b128 v[116:119], v234 offset:1024
    ds_read_b128 v[120:123], v234 offset:2048
    ds_read_b128 v[124:127], v234 offset:3072
    v_mfma_f32_16x16x32_bf16 v[16:19], a[16:19], v[72:75], v[16:19]
    v_mfma_f32_16x16x32_bf16 v[20:23], a[20:23], v[72:75], v[20:23]
    v_mfma_f32_16x16x32_bf16 v[16:19], a[24:27], v[76:79], v[16:19]
    v_mfma_f32_16x16x32_bf16 v[20:23], a[28:31], v[76:79], v[20:23]
    s_waitcnt lgkmcnt(11)
    v_mfma_f32_16x16x32_bf16 v[16:19], a[32:35], v[80:83], v[16:19]
    v_mfma_f32_16x16x32_bf16 v[20:23], a[36:39], v[80:83], v[20:23]
    s_waitcnt lgkmcnt(10)
    v_mfma_f32_16x16x32_bf16 v[16:19], a[40:43], v[84:87], v[16:19]
    v_mfma_f32_16x16x32_bf16 v[20:23], a[44:47], v[84:87], v[20:23]
    global_load_dwordx4 v[160:163], v56, s[36:37] offset:-4096
    s_waitcnt lgkmcnt(9)
    v_mfma_f32_16x16x32_bf16 v[16:19], a[48:51], v[88:91], v[16:19]
    v_mfma_f32_16x16x32_bf16 v[20:23], a[52:55], v[88:91], v[20:23]
    s_waitcnt lgkmcnt(8)
    v_mfma_f32_16x16x32_bf16 v[16:19], a[56:59], v[92:95], v[16:19]
    v_mfma_f32_16x16x32_bf16 v[20:23], a[60:63], v[92:95], v[20:23]
    global_load_dwordx4 v[164:167], v56, s[36:37] offset:-3072
    s_waitcnt lgkmcnt(7)
    v_mfma_f32_16x16x32_bf16 v[16:19], a[64:67], v[96:99], v[16:19]
    v_mfma_f32_16x16x32_bf16 v[20:23], a[68:71], v[96:99], v[20:23]
    s_waitcnt lgkmcnt(6)
    v_mfma_f32_16x16x32_bf16 v[16:19], a[72:75], v[100:103], v[16:19]
    v_mfma_f32_16x16x32_bf16 v[20:23], a[76:79], v[100:103], v[20:23]
    global_load_dwordx4 v[168:171], v56, s[36:37] offset:-2048
    s_waitcnt lgkmcnt(5)
    v_mfma_f32_16x16x32_bf16 v[16:19], a[80:83], v[104:107], v[16:19]
    v_mfma_f32_16x16x32_bf16 v[20:23], a[84:87], v[104:107], v[20:23]
    s_waitcnt lgkmcnt(4)
    v_mfma_f32_16x16x32_bf16 v[16:19], a[88:91], v[108:111], v[16:19]
    v_mfma_f32_16x16x32_bf16 v[20:23], a[92:95], v[108:111], v[20:23]
    global_load_dwordx4 v[172:175], v56, s[36:37] offset:-1024
    s_waitcnt lgkmcnt(3)
    v_mfma_f32_16x16x32_bf16 v[16:19], a[96:99], v[112:115], v[16:19]
    v_mfma_f32_16x16x32_bf16 v[20:23], a[100:103], v[112:115], v[20:23]
    s_waitcnt lgkmcnt(2)
    v_mfma_f32_16x16x32_bf16 v[16:19], a[104:107], v[116:119], v[16:19]
    v_mfma_f32_16x16x32_bf16 v[20:23], a[108:111], v[116:119], v[20:23]
    global_load_dwordx4 v[176:179], v56, s[36:37] offset:0
    s_waitcnt lgkmcnt(1)
    v_mfma_f32_16x16x32_bf16 v[16:19], a[112:115], v[120:123], v[16:19]
    v_mfma_f32_16x16x32_bf16 v[20:23], a[116:119], v[120:123], v[20:23]
    s_waitcnt lgkmcnt(0)
    v_mfma_f32_16x16x32_bf16 v[16:19], a[120:123], v[124:127], v[16:19]
    v_mfma_f32_16x16x32_bf16 v[20:23], a[124:127], v[124:127], v[20:23]
    global_load_dwordx4 v[180:183], v56, s[36:37] offset:1024
    s_nop 6
    v_add_f32_dpp v16, v20, v16 row_ror:8 row_mask:0xf bank_mask:0xf
    v_add_f32_dpp v17, v21, v17 row_ror:8 row_mask:0xf bank_mask:0xf
    v_add_f32_dpp v18, v22, v18 row_ror:8 row_mask:0xf bank_mask:0xf
    v_add_f32_dpp v19, v23, v19 row_ror:8 row_mask:0xf bank_mask:0xf
    v_cvt_pk_bf16_f32 v244, v16, v17
    v_cvt_pk_bf16_f32 v245, v18, v19
    s_nop 0
    v_permlane16_swap_b32 v244, v246
    v_permlane16_swap_b32 v245, v247
    s_mov_b64 exec, s[54:55]
    global_store_dwordx4 v9, v[244:247], s[24:25]
    s_mov_b64 exec, -1
    v_mfma_f32_16x16x32_bf16 v[24:27], v[64:67], a[128:131], 0
    v_mfma_f32_16x16x32_bf16 v[28:31], v[64:67], a[132:135], 0
    v_mfma_f32_16x16x32_bf16 v[24:27], v[68:71], a[136:139], v[24:27]
    v_mfma_f32_16x16x32_bf16 v[28:31], v[68:71], a[140:143], v[28:31]
    global_load_dwordx4 v[184:187], v56, s[36:37] offset:2048
    v_mfma_f32_16x16x32_bf16 v[24:27], v[72:75], a[144:147], v[24:27]
    v_mfma_f32_16x16x32_bf16 v[28:31], v[72:75], a[148:151], v[28:31]
    v_mfma_f32_16x16x32_bf16 v[24:27], v[76:79], a[152:155], v[24:27]
    v_mfma_f32_16x16x32_bf16 v[28:31], v[76:79], a[156:159], v[28:31]
    global_load_dwordx4 v[188:191], v56, s[36:37] offset:3072
    v_mfma_f32_16x16x32_bf16 v[24:27], v[80:83], a[160:163], v[24:27]
    v_mfma_f32_16x16x32_bf16 v[28:31], v[80:83], a[164:167], v[28:31]
    v_mfma_f32_16x16x32_bf16 v[24:27], v[84:87], a[168:171], v[24:27]
    v_mfma_f32_16x16x32_bf16 v[28:31], v[84:87], a[172:175], v[28:31]
    v_mfma_f32_16x16x32_bf16 v[24:27], v[88:91], a[176:179], v[24:27]
    v_mfma_f32_16x16x32_bf16 v[28:31], v[88:91], a[180:183], v[28:31]
    v_mfma_f32_16x16x32_bf16 v[24:27], v[92:95], a[184:187], v[24:27]
    v_mfma_f32_16x16x32_bf16 v[28:31], v[92:95], a[188:191], v[28:31]
    global_load_dwordx4 v[192:195], v8, s[24:25] offset:0 sc1
    global_load_dwordx4 v[196:199], v8, s[24:25] offset:1024 sc1
    global_load_dwordx4 v[208:211], v8, s[24:25] offset:2048 sc1
    global_load_dwordx4 v[212:215], v8, s[24:25] offset:3072 sc1
    s_nop 3
    v_cndmask_b32 v24, v28, v24, s[58:59]
    v_cndmask_b32 v25, v29, v25, s[58:59]
    v_cndmask_b32 v26, v30, v26, s[58:59]
    v_cndmask_b32 v27, v31, v27, s[58:59]
    ds_write_b128 v235, v[24:27] offset:32768
    s_waitcnt lgkmcnt(0)
    s_barrier
    s_cmp_lg_u32 s3, 0
    s_cbranch_scc1 RF_L_vred_skip
    ds_read_b128 v[16:19], v59 offset:32768
    ds_read_b128 v[20:23], v59 offset:33280
    ds_read_b128 v[24:27], v59 offset:34816
    ds_read_b128 v[28:31], v59 offset:35328
    s_waitcnt lgkmcnt(0)
    v_add_f32 v16, v16, v20
    v_add_f32 v24, v24, v28
    v_add_f32 v17, v17, v21
    v_add_f32 v25, v25, v29
    v_add_f32 v18, v18, v22
    v_add_f32 v26, v26, v30
    v_add_f32 v19, v19, v23
    v_add_f32 v27, v27, v31
    v_add_f32 v16, v16, v24
    v_add_f32 v17, v17, v25
    v_add_f32 v18, v18, v26
    v_add_f32 v19, v19, v27
    v_cvt_pk_bf16_f32 v244, v16, v17
    v_cvt_pk_bf16_f32 v245, v18, v19
    s_nop 0
    v_permlane32_swap_b32 v244, v246
    v_permlane32_swap_b32 v245, v247
    s_mov_b64 exec, s[58:59]
    global_store_dwordx4 v10, v[244:247], s[26:27]
    s_mov_b64 exec, -1
    s_waitcnt vmcnt(1)
    s_branch RF_L_e1_c
RF_L_e1_r:
    global_load_dwordx4 v[192:195], v8, s[24:25] offset:0 sc1
    global_load_dwordx4 v[196:199], v8, s[24:25] offset:1024 sc1
    global_load_dwordx4 v[208:211], v8, s[24:25] offset:2048 sc1
    global_load_dwordx4 v[212:215], v8, s[24:25] offset:3072 sc1
RF_L_vred_skip:
    s_waitcnt vmcnt(0)
RF_L_e1_c:
    v_max3_u32 v240, v192, v193, v194
    v_max3_u32 v240, v240, v195, v196
    v_max3_u32 v240, v240, v197, v198
    v_max3_u32 v240, v240, v199, v208
    v_max3_u32 v240, v240, v209, v210
    v_max3_u32 v240, v240, v211, v212
    v_max3_u32 v240, v240, v213, v214
    v_max_u32 v240, v240, v215
    v_cmp_eq_u32 vcc, -1, v240
    s_cbranch_vccz RF_L_e1_ok
    s_sub_u32 s52, s52, 1
    s_cbranch_scc0 RF_L_e1_r
    s_mov_b32 s52, 0
RF_L_e1_ok:
    v_mfma_f32_16x16x32_bf16 v[32:35], v[128:131], v[192:195], 0
    v_mov_b32_dpp v200, v192 row_ror:8 row_mask:0xf bank_mask:0xf
    v_mov_b32_dpp v201, v193 row_ror:8 row_mask:0xf bank_mask:0xf
    v_mfma_f32_16x16x32_bf16 v[36:39], v[144:147], v[192:195], 0
    v_mov_b32_dpp v202, v194 row_ror:8 row_mask:0xf bank_mask:0xf
    v_mov_b32_dpp v203, v195 row_ror:8 row_mask:0xf bank_mask:0xf
    v_mfma_f32_16x16x32_bf16 v[40:43], v[208:211], v[192:195], v[60:63]
    v_mov_b32_dpp v204, v196 row_ror:8 row_mask:0xf bank_mask:0xf
    v_mov_b32_dpp v205, v197 row_ror:8 row_mask:0xf bank_mask:0xf
    v_mfma_f32_16x16x32_bf16 v[32:35], v[136:139], v[196:199], v[32:35]
    v_mov_b32_dpp v206, v198 row_ror:8 row_mask:0xf bank_mask:0xf
    v_mov_b32_dpp v207, v199 row_ror:8 row_mask:0xf bank_mask:0xf
    v_mfma_f32_16x16x32_bf16 v[36:39], v[152:155], v[196:199], v[36:39]
    v_mov_b32_dpp v216, v208 row_ror:8 row_mask:0xf bank_mask:0xf
    v_mov_b32_dpp v217, v209 row_ror:8 row_mask:0xf bank_mask:0xf
    v_mfma_f32_16x16x32_bf16 v[40:43], v[212:215], v[196:199], v[40:43]
    v_mov_b32_dpp v218, v210 row_ror:8 row_mask:0xf bank_mask:0xf
    v_mov_b32_dpp v219, v211 row_ror:8 row_mask:0xf bank_mask:0xf
    v_mfma_f32_16x16x32_bf16 v[32:35], v[132:135], v[200:203], v[32:35]
    v_mov_b32_dpp v220, v212 row_ror:8 row_mask:0xf bank_mask:0xf
    v_mov_b32_dpp v221, v213 row_ror:8 row_mask:0xf bank_mask:0xf
    v_mfma_f32_16x16x32_bf16 v[36:39], v[148:151], v[200:203], v[36:39]
    v_mov_b32_dpp v222, v214 row_ror:8 row_mask:0xf bank_mask:0xf
    v_mov_b32_dpp v223, v215 row_ror:8 row_mask:0xf bank_mask:0xf
    v_mfma_f32_16x16x32_bf16 v[32:35], v[140:143], v[204:207], v[32:35]
    v_mfma_f32_16x16x32_bf16 v[36:39], v[156:159], v[204:207], v[36:39]
    v_mfma_f32_16x16x32_bf16 v[40:43], v[216:219], v[200:203], v[40:43]
    v_mfma_f32_16x16x32_bf16 v[40:43], v[220:223], v[204:207], v[40:43]
    s_add_u32 s32, s32, 262144
    s_addc_u32 s33, s33, 0
    global_load_dwordx4 v[224:227], v11, s[26:27] offset:0 sc1
    global_load_dwordx4 v[228:231], v11, s[26:27] offset:1024 sc1
    s_nop 0
    v_max3_f32 v241, v32, v33, v34
    v_max3_f32 v243, v36, v37, v38
    v_max3_f32 v241, v241, v35, v39
    v_max3_f32 v243, v243, v40, v41
    v_max3_f32 v241, v241, v42, v43
    v_max_f32 v241, v241, v243
    v_mov_b32 v242, v241
    s_nop 1
    v_permlane16_swap_b32 v241, v242
    v_max_f32 v241, v241, v242
    v_mov_b32 v242, v241
    s_nop 1
    v_permlane32_swap_b32 v241, v242
    v_max_f32 v241, v241, v242
    v_mul_f32 v242, s60, v241
    v_pk_fma_f32 v[32:33], v[32:33], s[60:61], v[242:243] op_sel_hi:[1,1,0] neg_lo:[0,0,1] neg_hi:[0,0,1]
    v_pk_fma_f32 v[34:35], v[34:35], s[60:61], v[242:243] op_sel_hi:[1,1,0] neg_lo:[0,0,1] neg_hi:[0,0,1]
    v_pk_fma_f32 v[36:37], v[36:37], s[60:61], v[242:243] op_sel_hi:[1,1,0] neg_lo:[0,0,1] neg_hi:[0,0,1]
    v_pk_fma_f32 v[38:39], v[38:39], s[60:61], v[242:243] op_sel_hi:[1,1,0] neg_lo:[0,0,1] neg_hi:[0,0,1]
    v_pk_fma_f32 v[40:41], v[40:41], s[60:61], v[242:243] op_sel_hi:[1,1,0] neg_lo:[0,0,1] neg_hi:[0,0,1]
    v_pk_fma_f32 v[42:43], v[42:43], s[60:61], v[242:243] op_sel_hi:[1,1,0] neg_lo:[0,0,1] neg_hi:[0,0,1]
    v_exp_f32 v32, v32
    global_load_dwordx4 v[128:131], v56, s[32:33] offset:-4096
    v_exp_f32 v33, v33
    v_exp_f32 v34, v34
    v_exp_f32 v35, v35
    v_exp_f32 v36, v36
    v_exp_f32 v37, v37
    v_exp_f32 v38, v38
    v_exp_f32 v39, v39
    global_load_dwordx4 v[132:135], v56, s[32:33] offset:-3072
    v_exp_f32 v40, v40
    v_exp_f32 v41, v41
    v_exp_f32 v42, v42
    v_exp_f32 v43, v43
    v_cvt_pk_bf16_f32 v44, v32, v33
    v_cvt_pk_bf16_f32 v45, v34, v35
    v_cvt_pk_bf16_f32 v46, v36, v37
    v_cvt_pk_bf16_f32 v47, v38, v39
    v_cvt_pk_bf16_f32 v48, v40, v41
    v_cvt_pk_bf16_f32 v49, v42, v43
    v_mfma_f32_16x16x32_bf16 v[32:35], v[4:7], v[44:47], 0
    v_mfma_f32_16x16x32_bf16 v[64:67], v[160:163], v[44:47], 0
    v_mov_b32 v244, v48
    v_mfma_f32_16x16x32_bf16 v[68:71], v[164:167], v[44:47], 0
    v_mov_b32 v245, v49
    v_mfma_f32_16x16x32_bf16 v[72:75], v[168:171], v[44:47], 0
    v_mov_b32 v50, 0
    v_mfma_f32_16x16x32_bf16 v[76:79], v[172:175], v[44:47], 0
    v_mov_b32 v51, 0
    v_mfma_f32_16x16x32_bf16 v[80:83], v[176:179], v[44:47], 0
    v_permlane32_swap_b32 v50, v244
    v_permlane32_swap_b32 v51, v245
    global_load_dwordx4 v[136:139], v56, s[32:33] offset:-2048
    s_waitcnt vmcnt(3)
RF_L_vm_go:
    v_mfma_f32_16x16x16_bf16 v[32:35], v[4:5], v[48:49], v[32:35]
    v_mfma_f32_16x16x32_bf16 v[84:87], v[180:183], v[44:47], 0
    v_max3_u32 v240, v224, v225, v226
    v_max3_u32 v240, v240, v227, v228
    v_mfma_f32_16x16x32_bf16 v[88:91], v[184:187], v[44:47], 0
    v_max3_u32 v240, v240, v229, v230
    v_max_u32 v240, v240, v231
    v_mfma_f32_16x16x32_bf16 v[92:95], v[188:191], v[44:47], 0
    v_cmp_eq_u32 vcc, -1, v240
    s_cbranch_vccz RF_L_vm_fok
RF_L_vm_rr:
    s_sub_u32 s52, s52, 1
    s_cbranch_scc1 RF_L_vm_fto
    global_load_dwordx4 v[224:227], v11, s[26:27] offset:0 sc1
    global_load_dwordx4 v[228:231], v11, s[26:27] offset:1024 sc1
    s_waitcnt vmcnt(0)
    v_max3_u32 v240, v224, v225, v226
    v_max3_u32 v240, v240, v227, v228
    v_max3_u32 v240, v240, v229, v230
    v_max_u32 v240, v240, v231
    v_cmp_eq_u32 vcc, -1, v240
    s_cbranch_vccnz RF_L_vm_rr
    s_branch RF_L_vm_fok
RF_L_vm_fto:
    s_mov_b32 s52, 0
RF_L_vm_fok:
    v_mfma_f32_16x16x16_bf16 v[64:67], v[224:225], v[48:49], v[64:67]
    v_mfma_f32_16x16x16_bf16 v[68:71], v[226:227], v[48:49], v[68:71]
    v_mfma_f32_16x16x16_bf16 v[72:75], v[224:225], v[50:51], v[72:75]
    v_mfma_f32_16x16x16_bf16 v[76:79], v[226:227], v[50:51], v[76:79]
    s_add_u32 s12, s50, 3
    s_and_b32 s13, s12, 7
    s_cmp_lg_u32 s13, 0
    s_cbranch_scc1 RF_L_nofl
    s_lshr_b32 s12, s12, 3
    s_lshl_b32 s12, s12, 3
    s_add_u32 s12, s12, s4
    s_lshl_b32 s12, s12, 7
    v_mov_b32 v57, s12
    global_load_dword v57, v57, s[16:17] sc1
RF_L_nofl:
    s_and_b32 s12, s50, 15
    s_cmp_lg_u32 s12, s5
    s_cbranch_scc1 RF_L_nopub
    global_store_dwordx4 v56, v[208:211], s[38:39] offset:0
    global_store_dwordx4 v56, v[212:215], s[38:39] offset:1024
    global_store_dwordx4 v56, v[224:227], s[40:41] offset:0
    global_store_dwordx4 v56, v[228:231], s[40:41] offset:1024
RF_L_nopub:
    s_cmp_eq_u32 s50, 63
    s_cbranch_scc1 RF_L_rec_last
    global_load_dwordx4 v[252:255], v58, s[18:19]
    v_mfma_f32_16x16x16_bf16 v[80:83], v[228:229], v[48:49], v[80:83]
    v_cvt_pk_bf16_f32 v96, v64, v65
    v_cvt_pk_bf16_f32 v97, v66, v67
    v_rcp_f32 v241, v32
    v_mfma_f32_16x16x16_bf16 v[84:87], v[230:231], v[48:49], v[84:87]
    v_cvt_pk_bf16_f32 v98, v68, v69
    v_cvt_pk_bf16_f32 v99, v70, v71
    global_load_dwordx4 v[140:143], v56, s[32:33] offset:-1024
    v_mfma_f32_16x16x16_bf16 v[88:91], v[228:229], v[50:51], v[88:91]
    v_cvt_pk_bf16_f32 v100, v72, v73
    v_mfma_f32_16x16x32_bf16 v[16:19], a[192:195], v[96:99], 0
    v_cvt_pk_bf16_f32 v101, v74, v75
    v_mfma_f32_16x16x32_bf16 v[20:23], a[208:211], v[96:99], 0
    v_mfma_f32_16x16x16_bf16 v[92:95], v[230:231], v[50:51], v[92:95]
    v_cvt_pk_bf16_f32 v102, v76, v77
    v_mfma_f32_16x16x32_bf16 v[24:27], a[224:227], v[96:99], 0
    v_cvt_pk_bf16_f32 v103, v78, v79
    v_mfma_f32_16x16x32_bf16 v[28:31], a[240:243], v[96:99], 0
    global_load_dwordx4 v[144:147], v56, s[32:33] offset:0
    v_cvt_pk_bf16_f32 v104, v80, v81
    v_mfma_f32_16x16x32_bf16 v[16:19], a[196:199], v[100:103], v[16:19]
    v_cvt_pk_bf16_f32 v105, v82, v83
    v_mfma_f32_16x16x32_bf16 v[20:23], a[212:215], v[100:103], v[20:23]
    v_cvt_pk_bf16_f32 v106, v84, v85
    v_mfma_f32_16x16x32_bf16 v[24:27], a[228:231], v[100:103], v[24:27]
    v_cvt_pk_bf16_f32 v107, v86, v87
    v_mfma_f32_16x16x32_bf16 v[28:31], a[244:247], v[100:103], v[28:31]
    global_load_dwordx4 v[148:151], v56, s[32:33] offset:1024
    v_cvt_pk_bf16_f32 v108, v88, v89
    v_mfma_f32_16x16x32_bf16 v[16:19], a[200:203], v[104:107], v[16:19]
    v_cvt_pk_bf16_f32 v109, v90, v91
    v_mfma_f32_16x16x32_bf16 v[20:23], a[216:219], v[104:107], v[20:23]
    v_cvt_pk_bf16_f32 v110, v92, v93
    v_mfma_f32_16x16x32_bf16 v[24:27], a[232:235], v[104:107], v[24:27]
    v_cvt_pk_bf16_f32 v111, v94, v95
    v_mfma_f32_16x16x32_bf16 v[28:31], a[248:251], v[104:107], v[28:31]
    global_load_dwordx4 v[152:155], v56, s[32:33] offset:2048
    v_mfma_f32_16x16x32_bf16 v[16:19], a[204:207], v[108:111], v[16:19]
    v_mfma_f32_16x16x32_bf16 v[20:23], a[220:223], v[108:111], v[20:23]
    v_mfma_f32_16x16x32_bf16 v[24:27], a[236:239], v[108:111], v[24:27]
    v_mfma_f32_16x16x32_bf16 v[28:31], a[252:255], v[108:111], v[28:31]
    v_mov_b32 v242, v241
    s_nop 3
    v_pk_mul_f32 v[16:17], v[16:17], v[242:243] op_sel_hi:[1,0]
    v_pk_mul_f32 v[18:19], v[18:19], v[242:243] op_sel_hi:[1,0]
    ds_write_b128 v235, v[16:19] offset:16384
    v_pk_mul_f32 v[20:21], v[20:21], v[242:243] op_sel_hi:[1,0]
    v_pk_mul_f32 v[22:23], v[22:23], v[242:243] op_sel_hi:[1,0]
    ds_write_b128 v235, v[20:23] offset:20480
    v_pk_mul_f32 v[24:25], v[24:25], v[242:243] op_sel_hi:[1,0]
    v_pk_mul_f32 v[26:27], v[26:27], v[242:243] op_sel_hi:[1,0]
    ds_write_b128 v235, v[24:27] offset:24576
    v_pk_mul_f32 v[28:29], v[28:29], v[242:243] op_sel_hi:[1,0]
    v_pk_mul_f32 v[30:31], v[30:31], v[242:243] op_sel_hi:[1,0]
    ds_write_b128 v235, v[28:31] offset:28672
    global_load_dwordx4 v[156:159], v56, s[32:33] offset:3072
    s_waitcnt lgkmcnt(0)
    s_barrier
    ds_read_b128 v[112:115], v8 offset:16384
    ds_read_b128 v[116:119], v8 offset:17408
    ds_read_b128 v[120:123], v8 offset:18432
    ds_read_b128 v[124:127], v8 offset:19456
    s_waitcnt lgkmcnt(2)
    v_pk_add_f32 v[112:113], v[112:113], v[116:117]
    v_pk_add_f32 v[114:115], v[114:115], v[118:119]
    s_waitcnt lgkmcnt(0)
    v_pk_add_f32 v[120:121], v[120:121], v[124:125]
    v_pk_add_f32 v[122:123], v[122:123], v[126:127]
    v_pk_add_f32 v[112:113], v[112:113], v[120:121]
    v_pk_add_f32 v[114:115], v[114:115], v[122:123]
    v_cvt_pk_bf16_f32 v244, v112, v113
    v_cvt_pk_bf16_f32 v245, v114, v115
    s_nop 0
    v_permlane16_swap_b32 v244, v246
    v_permlane16_swap_b32 v245, v247
    s_mov_b64 exec, s[54:55]
    global_store_dwordx4 v12, v[244:247], s[28:29] sc1
    global_store_dwordx4 v9, v[236:239], s[42:43]
    s_mov_b64 exec, 0xffff
    global_store_dwordx4 v14, v[236:239], s[48:49]
    s_cmp_lg_u32 s3, 0
    s_cbranch_scc1 RF_L_norv
    s_mov_b64 exec, s[58:59]
    global_store_dwordx4 v10, v[236:239], s[44:45]
RF_L_norv:
    s_mov_b64 exec, -1
    s_add_u32 s36, s36, 262144
    s_addc_u32 s37, s37, 0
    s_add_u32 s38, s38, 65536
    s_addc_u32 s39, s39, 0
    s_add_u32 s40, s40, 65536
    s_addc_u32 s41, s41, 0
    s_sleep 5
    global_load_dwordx4 v[64:67], v13, s[28:29] sc1
    global_load_dwordx4 v[68:71], v13, s[30:31] sc1
RF_L_e2:
    s_waitcnt vmcnt(0)
    v_max3_u32 v240, v64, v65, v66
    v_max3_u32 v240, v240, v67, v68
    v_max3_u32 v240, v240, v69, v70
    v_max_u32 v240, v240, v71
    v_cmp_eq_u32 vcc, -1, v240
    s_cbranch_vccz RF_L_e2_ok0
    global_load_dwordx4 v[64:67], v13, s[28:29] sc1
    global_load_dwordx4 v[68:71], v13, s[30:31] sc1
    s_sub_u32 s52, s52, 1
    s_cbranch_scc0 RF_L_e2
    s_mov_b32 s52, 0
RF_L_e2_ok0:
    v_mfma_f32_16x16x32_bf16 v[20:23], v[52:55], v[64:67], 0
    v_mfma_f32_16x16x32_bf16 v[20:23], v[52:55], v[68:71], v[20:23]
RF_L_e2_done:
    s_add_u32 s18, s18, 262144
    s_addc_u32 s19, s19, 0
    s_nop 7
    v_cvt_pk_bf16_f32 v244, v20, v21
    v_cvt_pk_bf16_f32 v245, v22, v23
    s_nop 0
    v_permlane16_swap_b32 v244, v246
    v_permlane16_swap_b32 v245, v247
    s_mov_b64 exec, 0xffff
    global_store_dwordx4 v14, v[244:247], s[22:23]
    s_mov_b64 exec, -1
    s_add_u32 s50, s50, 1
    s_cmp_lt_u32 s50, 64
    s_cbranch_scc1 RF_L_step
    s_branch RF_L_rec_fin
RF_L_rec_last:
RF_L_rec_fin:
    s_waitcnt vmcnt(0)
RF_L_rec_end:
    s_endpgm
M_rec_slow:
    s_load_dwordx2 s[62:63], s[0:1], 16
    s_load_dwordx2 s[64:65], s[0:1], 24
    s_load_dwordx2 s[66:67], s[0:1], 32
    s_load_dwordx2 s[68:69], s[0:1], 40
    s_load_dwordx2 s[10:11], s[0:1], 128
    s_waitcnt lgkmcnt(0)
    s_lshr_b32 s6, s5, 2
    s_and_b32 s7, s5, 3
    s_lshl_b32 s8, s4, 2
    s_add_u32 s8, s8, s3
    v_and_b32 v1, 15, v0
    v_lshrrev_b32 v2, 4, v0
    v_and_b32 v3, 7, v0
    v_lshlrev_b32 v56, 4, v0
    s_lshl_b32 s12, s4, 2
    s_add_u32 s12, s12, s6
    s_lshl_b32 s12, s12, 8
    s_lshl_b32 s13, s7, 6
    s_add_u32 s12, s12, s13
    v_lshrrev_b32 v4, 2, v0
    v_lshlrev_b32 v4, 13, v4
    v_and_b32 v5, 3, v0
    v_lshl_add_u32 v4, v5, 4, v4
    v_add_u32 v4, s12, v4
    s_lshl_b32 s13, s3, 21
    v_add_u32 v4, s13, v4
    v_mov_b32 v5, v4
    s_lshl_b32 s14, s3, 14
    s_add_u32 s14, s14, 0
    s_mov_b32 m0, s14
    s_add_u32 s14, s14, 1024
    global_load_lds_dwordx4 v5, s[62:63]
    v_add_u32 v5, 131072, v5
    s_mov_b32 m0, s14
    s_add_u32 s14, s14, 1024
    global_load_lds_dwordx4 v5, s[62:63]
    v_add_u32 v5, 131072, v5
    s_mov_b32 m0, s14
    s_add_u32 s14, s14, 1024
    global_load_lds_dwordx4 v5, s[62:63]
    v_add_u32 v5, 131072, v5
    s_mov_b32 m0, s14
    s_add_u32 s14, s14, 1024
    global_load_lds_dwordx4 v5, s[62:63]
    v_add_u32 v5, 131072, v5
    s_mov_b32 m0, s14
    s_add_u32 s14, s14, 1024
    global_load_lds_dwordx4 v5, s[62:63]
    v_add_u32 v5, 131072, v5
    s_mov_b32 m0, s14
    s_add_u32 s14, s14, 1024
    global_load_lds_dwordx4 v5, s[62:63]
    v_add_u32 v5, 131072, v5
    s_mov_b32 m0, s14
    s_add_u32 s14, s14, 1024
    global_load_lds_dwordx4 v5, s[62:63]
    v_add_u32 v5, 131072, v5
    s_mov_b32 m0, s14
    s_add_u32 s14, s14, 1024
    global_load_lds_dwordx4 v5, s[62:63]
    v_add_u32 v5, 131072, v5
    s_mov_b32 m0, s14
    s_add_u32 s14, s14, 1024
    global_load_lds_dwordx4 v5, s[62:63]
    v_add_u32 v5, 131072, v5
    s_mov_b32 m0, s14
    s_add_u32 s14, s14, 1024
    global_load_lds_dwordx4 v5, s[62:63]
    v_add_u32 v5, 131072, v5
    s_mov_b32 m0, s14
    s_add_u32 s14, s14, 1024
    global_load_lds_dwordx4 v5, s[62:63]
    v_add_u32 v5, 131072, v5
    s_mov_b32 m0, s14
    s_add_u32 s14, s14, 1024
    global_load_lds_dwordx4 v5, s[62:63]
    v_add_u32 v5, 131072, v5
    s_mov_b32 m0, s14
    s_add_u32 s14, s14, 1024
    global_load_lds_dwordx4 v5, s[62:63]
    v_add_u32 v5, 131072, v5
    s_mov_b32 m0, s14
    s_add_u32 s14, s14, 1024
    global_load_lds_dwordx4 v5, s[62:63]
    v_add_u32 v5, 131072, v5
    s_mov_b32 m0, s14
    s_add_u32 s14, s14, 1024
    global_load_lds_dwordx4 v5, s[62:63]
    v_add_u32 v5, 131072, v5
    s_mov_b32 m0, s14
    s_add_u32 s14, s14, 1024
    global_load_lds_dwordx4 v5, s[62:63]
    v_mov_b32 v5, v4
    s_lshl_b32 s14, s3, 14
    s_add_u32 s14, s14, 65536
    s_mov_b32 m0, s14
    s_add_u32 s14, s14, 1024
    global_load_lds_dwordx4 v5, s[64:65]
    v_add_u32 v5, 131072, v5
    s_mov_b32 m0, s14
    s_add_u32 s14, s14, 1024
    global_load_lds_dwordx4 v5, s[64:65]
    v_add_u32 v5, 131072, v5
    s_mov_b32 m0, s14
    s_add_u32 s14, s14, 1024
    global_load_lds_dwordx4 v5, s[64:65]
    v_add_u32 v5, 131072, v5
    s_mov_b32 m0, s14
    s_add_u32 s14, s14, 1024
    global_load_lds_dwordx4 v5, s[64:65]
    v_add_u32 v5, 131072, v5
    s_mov_b32 m0, s14
    s_add_u32 s14, s14, 1024
    global_load_lds_dwordx4 v5, s[64:65]
    v_add_u32 v5, 131072, v5
    s_mov_b32 m0, s14
    s_add_u32 s14, s14, 1024
    global_load_lds_dwordx4 v5, s[64:65]
    v_add_u32 v5, 131072, v5
    s_mov_b32 m0, s14
    s_add_u32 s14, s14, 1024
    global_load_lds_dwordx4 v5, s[64:65]
    v_add_u32 v5, 131072, v5
    s_mov_b32 m0, s14
    s_add_u32 s14, s14, 1024
    global_load_lds_dwordx4 v5, s[64:65]
    v_add_u32 v5, 131072, v5
    s_mov_b32 m0, s14
    s_add_u32 s14, s14, 1024
    global_load_lds_dwordx4 v5, s[64:65]
    v_add_u32 v5, 131072, v5
    s_mov_b32 m0, s14
    s_add_u32 s14, s14, 1024
    global_load_lds_dwordx4 v5, s[64:65]
    v_add_u32 v5, 131072, v5
    s_mov_b32 m0, s14
    s_add_u32 s14, s14, 1024
    global_load_lds_dwordx4 v5, s[64:65]
    v_add_u32 v5, 131072, v5
    s_mov_b32 m0, s14
    s_add_u32 s14, s14, 1024
    global_load_lds_dwordx4 v5, s[64:65]
    v_add_u32 v5, 131072, v5
    s_mov_b32 m0, s14
    s_add_u32 s14, s14, 1024
    global_load_lds_dwordx4 v5, s[64:65]
    v_add_u32 v5, 131072, v5
    s_mov_b32 m0, s14
    s_add_u32 s14, s14, 1024
    global_load_lds_dwordx4 v5, s[64:65]
    v_add_u32 v5, 131072, v5
    s_mov_b32 m0, s14
    s_add_u32 s14, s14, 1024
    global_load_lds_dwordx4 v5, s[64:65]
    v_add_u32 v5, 131072, v5
    s_mov_b32 m0, s14
    s_add_u32 s14, s14, 1024
    global_load_lds_dwordx4 v5, s[64:65]
    v_lshrrev_b32 v6, 2, v1
    v_lshl_add_u32 v6, v2, 3, v6
    v_lshlrev_b32 v6, 6, v6
    v_and_b32 v7, 3, v1
    v_lshl_add_u32 v6, v7, 3, v6
    s_waitcnt vmcnt(0)
    s_barrier
    s_lshr_b32 s12, s3, 1
    s_lshl_b32 s12, s12, 16
    s_and_b32 s13, s3, 1
    s_lshl_b32 s13, s13, 5
    s_add_u32 s12, s12, s13
    s_lshl_b32 s14, s3, 2
    s_add_u32 s14, s14, 0
    s_and_b32 s14, s14, 15
    s_lshl_b32 s14, s14, 12
    s_add_u32 s14, s14, s12
    v_add_u32 v7, s14, v6
    ds_read_b64_tr_b16 a[0:1], v7 offset:0
    ds_read_b64_tr_b16 a[2:3], v7 offset:256
    ds_read_b64_tr_b16 a[4:5], v7 offset:2048
    ds_read_b64_tr_b16 a[6:7], v7 offset:2304
    s_lshl_b32 s14, s3, 2
    s_add_u32 s14, s14, 1
    s_and_b32 s14, s14, 15
    s_lshl_b32 s14, s14, 12
    s_add_u32 s14, s14, s12
    v_add_u32 v7, s14, v6
    ds_read_b64_tr_b16 a[8:9], v7 offset:0
    ds_read_b64_tr_b16 a[10:11], v7 offset:256
    ds_read_b64_tr_b16 a[12:13], v7 offset:2048
    ds_read_b64_tr_b16 a[14:15], v7 offset:2304
    s_lshl_b32 s14, s3, 2
    s_add_u32 s14, s14, 2
    s_and_b32 s14, s14, 15
    s_lshl_b32 s14, s14, 12
    s_add_u32 s14, s14, s12
    v_add_u32 v7, s14, v6
    ds_read_b64_tr_b16 a[16:17], v7 offset:0
    ds_read_b64_tr_b16 a[18:19], v7 offset:256
    ds_read_b64_tr_b16 a[20:21], v7 offset:2048
    ds_read_b64_tr_b16 a[22:23], v7 offset:2304
    s_lshl_b32 s14, s3, 2
    s_add_u32 s14, s14, 3
    s_and_b32 s14, s14, 15
    s_lshl_b32 s14, s14, 12
    s_add_u32 s14, s14, s12
    v_add_u32 v7, s14, v6
    ds_read_b64_tr_b16 a[24:25], v7 offset:0
    ds_read_b64_tr_b16 a[26:27], v7 offset:256
    ds_read_b64_tr_b16 a[28:29], v7 offset:2048
    ds_read_b64_tr_b16 a[30:31], v7 offset:2304
    s_waitcnt lgkmcnt(0)
    s_lshl_b32 s14, s3, 2
    s_add_u32 s14, s14, 4
    s_and_b32 s14, s14, 15
    s_lshl_b32 s14, s14, 12
    s_add_u32 s14, s14, s12
    v_add_u32 v7, s14, v6
    ds_read_b64_tr_b16 a[32:33], v7 offset:0
    ds_read_b64_tr_b16 a[34:35], v7 offset:256
    ds_read_b64_tr_b16 a[36:37], v7 offset:2048
    ds_read_b64_tr_b16 a[38:39], v7 offset:2304
    s_lshl_b32 s14, s3, 2
    s_add_u32 s14, s14, 5
    s_and_b32 s14, s14, 15
    s_lshl_b32 s14, s14, 12
    s_add_u32 s14, s14, s12
    v_add_u32 v7, s14, v6
    ds_read_b64_tr_b16 a[40:41], v7 offset:0
    ds_read_b64_tr_b16 a[42:43], v7 offset:256
    ds_read_b64_tr_b16 a[44:45], v7 offset:2048
    ds_read_b64_tr_b16 a[46:47], v7 offset:2304
    s_lshl_b32 s14, s3, 2
    s_add_u32 s14, s14, 6
    s_and_b32 s14, s14, 15
    s_lshl_b32 s14, s14, 12
    s_add_u32 s14, s14, s12
    v_add_u32 v7, s14, v6
    ds_read_b64_tr_b16 a[48:49], v7 offset:0
    ds_read_b64_tr_b16 a[50:51], v7 offset:256
    ds_read_b64_tr_b16 a[52:53], v7 offset:2048
    ds_read_b64_tr_b16 a[54:55], v7 offset:2304
    s_lshl_b32 s14, s3, 2
    s_add_u32 s14, s14, 7
    s_and_b32 s14, s14, 15
    s_lshl_b32 s14, s14, 12
    s_add_u32 s14, s14, s12
    v_add_u32 v7, s14, v6
    ds_read_b64_tr_b16 a[56:57], v7 offset:0
    ds_read_b64_tr_b16 a[58:59], v7 offset:256
    ds_read_b64_tr_b16 a[60:61], v7 offset:2048
    ds_read_b64_tr_b16 a[62:63], v7 offset:2304
    s_waitcnt lgkmcnt(0)
    s_lshl_b32 s14, s3, 2
    s_add_u32 s14, s14, 8
    s_and_b32 s14, s14, 15
    s_lshl_b32 s14, s14, 12
    s_add_u32 s14, s14, s12
    v_add_u32 v7, s14, v6
    ds_read_b64_tr_b16 a[64:65], v7 offset:0
    ds_read_b64_tr_b16 a[66:67], v7 offset:256
    ds_read_b64_tr_b16 a[68:69], v7 offset:2048
    ds_read_b64_tr_b16 a[70:71], v7 offset:2304
    s_lshl_b32 s14, s3, 2
    s_add_u32 s14, s14, 9
    s_and_b32 s14, s14, 15
    s_lshl_b32 s14, s14, 12
    s_add_u32 s14, s14, s12
    v_add_u32 v7, s14, v6
    ds_read_b64_tr_b16 a[72:73], v7 offset:0
    ds_read_b64_tr_b16 a[74:75], v7 offset:256
    ds_read_b64_tr_b16 a[76:77], v7 offset:2048
    ds_read_b64_tr_b16 a[78:79], v7 offset:2304
    s_lshl_b32 s14, s3, 2
    s_add_u32 s14, s14, 10
    s_and_b32 s14, s14, 15
    s_lshl_b32 s14, s14, 12
    s_add_u32 s14, s14, s12
    v_add_u32 v7, s14, v6
    ds_read_b64_tr_b16 a[80:81], v7 offset:0
    ds_read_b64_tr_b16 a[82:83], v7 offset:256
    ds_read_b64_tr_b16 a[84:85], v7 offset:2048
    ds_read_b64_tr_b16 a[86:87], v7 offset:2304
    s_lshl_b32 s14, s3, 2
    s_add_u32 s14, s14, 11
    s_and_b32 s14, s14, 15
    s_lshl_b32 s14, s14, 12
    s_add_u32 s14, s14, s12
    v_add_u32 v7, s14, v6
    ds_read_b64_tr_b16 a[88:89], v7 offset:0
    ds_read_b64_tr_b16 a[90:91], v7 offset:256
    ds_read_b64_tr_b16 a[92:93], v7 offset:2048
    ds_read_b64_tr_b16 a[94:95], v7 offset:2304
    s_waitcnt lgkmcnt(0)
    s_lshl_b32 s14, s3, 2
    s_add_u32 s14, s14, 12
    s_and_b32 s14, s14, 15
    s_lshl_b32 s14, s14, 12
    s_add_u32 s14, s14, s12
    v_add_u32 v7, s14, v6
    ds_read_b64_tr_b16 a[96:97], v7 offset:0
    ds_read_b64_tr_b16 a[98:99], v7 offset:256
    ds_read_b64_tr_b16 a[100:101], v7 offset:2048
    ds_read_b64_tr_b16 a[102:103], v7 offset:2304
    s_lshl_b32 s14, s3, 2
    s_add_u32 s14, s14, 13
    s_and_b32 s14, s14, 15
    s_lshl_b32 s14, s14, 12
    s_add_u32 s14, s14, s12
    v_add_u32 v7, s14, v6
    ds_read_b64_tr_b16 a[104:105], v7 offset:0
    ds_read_b64_tr_b16 a[106:107], v7 offset:256
    ds_read_b64_tr_b16 a[108:109], v7 offset:2048
    ds_read_b64_tr_b16 a[110:111], v7 offset:2304
    s_lshl_b32 s14, s3, 2
    s_add_u32 s14, s14, 14
    s_and_b32 s14, s14, 15
    s_lshl_b32 s14, s14, 12
    s_add_u32 s14, s14, s12
    v_add_u32 v7, s14, v6
    ds_read_b64_tr_b16 a[112:113], v7 offset:0
    ds_read_b64_tr_b16 a[114:115], v7 offset:256
    ds_read_b64_tr_b16 a[116:117], v7 offset:2048
    ds_read_b64_tr_b16 a[118:119], v7 offset:2304
    s_lshl_b32 s14, s3, 2
    s_add_u32 s14, s14, 15
    s_and_b32 s14, s14, 15
    s_lshl_b32 s14, s14, 12
    s_add_u32 s14, s14, s12
    v_add_u32 v7, s14, v6
    ds_read_b64_tr_b16 a[120:121], v7 offset:0
    ds_read_b64_tr_b16 a[122:123], v7 offset:256
    ds_read_b64_tr_b16 a[124:125], v7 offset:2048
    ds_read_b64_tr_b16 a[126:127], v7 offset:2304
    s_waitcnt lgkmcnt(0)
    s_barrier
    v_mov_b32 v5, v4
    s_lshl_b32 s14, s3, 14
    s_add_u32 s14, s14, 0
    s_mov_b32 m0, s14
    s_add_u32 s14, s14, 1024
    global_load_lds_dwordx4 v5, s[66:67]
    v_add_u32 v5, 131072, v5
    s_mov_b32 m0, s14
    s_add_u32 s14, s14, 1024
    global_load_lds_dwordx4 v5, s[66:67]
    v_add_u32 v5, 131072, v5
    s_mov_b32 m0, s14
    s_add_u32 s14, s14, 1024
    global_load_lds_dwordx4 v5, s[66:67]
    v_add_u32 v5, 131072, v5
    s_mov_b32 m0, s14
    s_add_u32 s14, s14, 1024
    global_load_lds_dwordx4 v5, s[66:67]
    v_add_u32 v5, 131072, v5
    s_mov_b32 m0, s14
    s_add_u32 s14, s14, 1024
    global_load_lds_dwordx4 v5, s[66:67]
    v_add_u32 v5, 131072, v5
    s_mov_b32 m0, s14
    s_add_u32 s14, s14, 1024
    global_load_lds_dwordx4 v5, s[66:67]
    v_add_u32 v5, 131072, v5
    s_mov_b32 m0, s14
    s_add_u32 s14, s14, 1024
    global_load_lds_dwordx4 v5, s[66:67]
    v_add_u32 v5, 131072, v5
    s_mov_b32 m0, s14
    s_add_u32 s14, s14, 1024
    global_load_lds_dwordx4 v5, s[66:67]
    v_add_u32 v5, 131072, v5
    s_mov_b32 m0, s14
    s_add_u32 s14, s14, 1024
    global_load_lds_dwordx4 v5, s[66:67]
    v_add_u32 v5, 131072, v5
    s_mov_b32 m0, s14
    s_add_u32 s14, s14, 1024
    global_load_lds_dwordx4 v5, s[66:67]
    v_add_u32 v5, 131072, v5
    s_mov_b32 m0, s14
    s_add_u32 s14, s14, 1024
    global_load_lds_dwordx4 v5, s[66:67]
    v_add_u32 v5, 131072, v5
    s_mov_b32 m0, s14
    s_add_u32 s14, s14, 1024
    global_load_lds_dwordx4 v5, s[66:67]
    v_add_u32 v5, 131072, v5
    s_mov_b32 m0, s14
    s_add_u32 s14, s14, 1024
    global_load_lds_dwordx4 v5, s[66:67]
    v_add_u32 v5, 131072, v5
    s_mov_b32 m0, s14
    s_add_u32 s14, s14, 1024
    global_load_lds_dwordx4 v5, s[66:67]
    v_add_u32 v5, 131072, v5
    s_mov_b32 m0, s14
    s_add_u32 s14, s14, 1024
    global_load_lds_dwordx4 v5, s[66:67]
    v_add_u32 v5, 131072, v5
    s_mov_b32 m0, s14
    s_add_u32 s14, s14, 1024
    global_load_lds_dwordx4 v5, s[66:67]
    v_lshrrev_b32 v4, 3, v0
    v_lshlrev_b32 v4, 11, v4
    v_and_b32 v5, 7, v0
    v_lshl_add_u32 v4, v5, 4, v4
    s_lshl_b32 s12, s4, 20
    s_lshl_b32 s13, s5, 7
    s_add_u32 s12, s12, s13
    s_lshl_b32 s13, s3, 18
    s_add_u32 s12, s12, s13
    v_add_u32 v4, s12, v4
    v_mov_b32 v5, v4
    s_lshl_b32 s14, s3, 14
    s_add_u32 s14, s14, 65536
    s_mov_b32 m0, s14
    s_add_u32 s14, s14, 1024
    global_load_lds_dwordx4 v5, s[68:69]
    v_add_u32 v5, 16384, v5
    s_mov_b32 m0, s14
    s_add_u32 s14, s14, 1024
    global_load_lds_dwordx4 v5, s[68:69]
    v_add_u32 v5, 16384, v5
    s_mov_b32 m0, s14
    s_add_u32 s14, s14, 1024
    global_load_lds_dwordx4 v5, s[68:69]
    v_add_u32 v5, 16384, v5
    s_mov_b32 m0, s14
    s_add_u32 s14, s14, 1024
    global_load_lds_dwordx4 v5, s[68:69]
    v_add_u32 v5, 16384, v5
    s_mov_b32 m0, s14
    s_add_u32 s14, s14, 1024
    global_load_lds_dwordx4 v5, s[68:69]
    v_add_u32 v5, 16384, v5
    s_mov_b32 m0, s14
    s_add_u32 s14, s14, 1024
    global_load_lds_dwordx4 v5, s[68:69]
    v_add_u32 v5, 16384, v5
    s_mov_b32 m0, s14
    s_add_u32 s14, s14, 1024
    global_load_lds_dwordx4 v5, s[68:69]
    v_add_u32 v5, 16384, v5
    s_mov_b32 m0, s14
    s_add_u32 s14, s14, 1024
    global_load_lds_dwordx4 v5, s[68:69]
    v_add_u32 v5, 16384, v5
    s_mov_b32 m0, s14
    s_add_u32 s14, s14, 1024
    global_load_lds_dwordx4 v5, s[68:69]
    v_add_u32 v5, 16384, v5
    s_mov_b32 m0, s14
    s_add_u32 s14, s14, 1024
    global_load_lds_dwordx4 v5, s[68:69]
    v_add_u32 v5, 16384, v5
    s_mov_b32 m0, s14
    s_add_u32 s14, s14, 1024
    global_load_lds_dwordx4 v5, s[68:69]
    v_add_u32 v5, 16384, v5
    s_mov_b32 m0, s14
    s_add_u32 s14, s14, 1024
    global_load_lds_dwordx4 v5, s[68:69]
    v_add_u32 v5, 16384, v5
    s_mov_b32 m0, s14
    s_add_u32 s14, s14, 1024
    global_load_lds_dwordx4 v5, s[68:69]
    v_add_u32 v5, 16384, v5
    s_mov_b32 m0, s14
    s_add_u32 s14, s14, 1024
    global_load_lds_dwordx4 v5, s[68:69]
    v_add_u32 v5, 16384, v5
    s_mov_b32 m0, s14
    s_add_u32 s14, s14, 1024
    global_load_lds_dwordx4 v5, s[68:69]
    v_add_u32 v5, 16384, v5
    s_mov_b32 m0, s14
    s_add_u32 s14, s14, 1024
    global_load_lds_dwordx4 v5, s[68:69]
    s_waitcnt vmcnt(0)
    s_barrier
    s_and_b32 s12, s3, 1
    s_lshl_b32 s12, s12, 5
    s_lshl_b32 s14, s3, 2
    s_add_u32 s14, s14, 0
    s_and_b32 s14, s14, 15
    s_lshl_b32 s14, s14, 12
    s_add_u32 s14, s14, s12
    v_add_u32 v7, s14, v6
    ds_read_b64_tr_b16 a[128:129], v7 offset:0
    ds_read_b64_tr_b16 a[130:131], v7 offset:256
    ds_read_b64_tr_b16 a[132:133], v7 offset:2048
    ds_read_b64_tr_b16 a[134:135], v7 offset:2304
    s_lshl_b32 s14, s3, 2
    s_add_u32 s14, s14, 1
    s_and_b32 s14, s14, 15
    s_lshl_b32 s14, s14, 12
    s_add_u32 s14, s14, s12
    v_add_u32 v7, s14, v6
    ds_read_b64_tr_b16 a[136:137], v7 offset:0
    ds_read_b64_tr_b16 a[138:139], v7 offset:256
    ds_read_b64_tr_b16 a[140:141], v7 offset:2048
    ds_read_b64_tr_b16 a[142:143], v7 offset:2304
    s_lshl_b32 s14, s3, 2
    s_add_u32 s14, s14, 2
    s_and_b32 s14, s14, 15
    s_lshl_b32 s14, s14, 12
    s_add_u32 s14, s14, s12
    v_add_u32 v7, s14, v6
    ds_read_b64_tr_b16 a[144:145], v7 offset:0
    ds_read_b64_tr_b16 a[146:147], v7 offset:256
    ds_read_b64_tr_b16 a[148:149], v7 offset:2048
    ds_read_b64_tr_b16 a[150:151], v7 offset:2304
    s_lshl_b32 s14, s3, 2
    s_add_u32 s14, s14, 3
    s_and_b32 s14, s14, 15
    s_lshl_b32 s14, s14, 12
    s_add_u32 s14, s14, s12
    v_add_u32 v7, s14, v6
    ds_read_b64_tr_b16 a[152:153], v7 offset:0
    ds_read_b64_tr_b16 a[154:155], v7 offset:256
    ds_read_b64_tr_b16 a[156:157], v7 offset:2048
    ds_read_b64_tr_b16 a[158:159], v7 offset:2304
    s_waitcnt lgkmcnt(0)
    s_lshl_b32 s14, s3, 2
    s_add_u32 s14, s14, 4
    s_and_b32 s14, s14, 15
    s_lshl_b32 s14, s14, 12
    s_add_u32 s14, s14, s12
    v_add_u32 v7, s14, v6
    ds_read_b64_tr_b16 a[160:161], v7 offset:0
    ds_read_b64_tr_b16 a[162:163], v7 offset:256
    ds_read_b64_tr_b16 a[164:165], v7 offset:2048
    ds_read_b64_tr_b16 a[166:167], v7 offset:2304
    s_lshl_b32 s14, s3, 2
    s_add_u32 s14, s14, 5
    s_and_b32 s14, s14, 15
    s_lshl_b32 s14, s14, 12
    s_add_u32 s14, s14, s12
    v_add_u32 v7, s14, v6
    ds_read_b64_tr_b16 a[168:169], v7 offset:0
    ds_read_b64_tr_b16 a[170:171], v7 offset:256
    ds_read_b64_tr_b16 a[172:173], v7 offset:2048
    ds_read_b64_tr_b16 a[174:175], v7 offset:2304
    s_lshl_b32 s14, s3, 2
    s_add_u32 s14, s14, 6
    s_and_b32 s14, s14, 15
    s_lshl_b32 s14, s14, 12
    s_add_u32 s14, s14, s12
    v_add_u32 v7, s14, v6
    ds_read_b64_tr_b16 a[176:177], v7 offset:0
    ds_read_b64_tr_b16 a[178:179], v7 offset:256
    ds_read_b64_tr_b16 a[180:181], v7 offset:2048
    ds_read_b64_tr_b16 a[182:183], v7 offset:2304
    s_lshl_b32 s14, s3, 2
    s_add_u32 s14, s14, 7
    s_and_b32 s14, s14, 15
    s_lshl_b32 s14, s14, 12
    s_add_u32 s14, s14, s12
    v_add_u32 v7, s14, v6
    ds_read_b64_tr_b16 a[184:185], v7 offset:0
    ds_read_b64_tr_b16 a[186:187], v7 offset:256
    ds_read_b64_tr_b16 a[188:189], v7 offset:2048
    ds_read_b64_tr_b16 a[190:191], v7 offset:2304
    s_waitcnt lgkmcnt(0)
    v_lshrrev_b32 v6, 2, v1
    v_lshl_add_u32 v6, v2, 2, v6
    v_lshlrev_b32 v6, 7, v6
    v_and_b32 v7, 3, v1
    v_lshl_add_u32 v6, v7, 3, v6
    s_lshl_b32 s12, s3, 14
    s_add_u32 s12, s12, 65536
    v_add_u32 v7, s12, v6
    ds_read_b64_tr_b16 a[192:193], v7 offset:0
    ds_read_b64_tr_b16 a[194:195], v7 offset:2048
    ds_read_b64_tr_b16 a[196:197], v7 offset:4096
    ds_read_b64_tr_b16 a[198:199], v7 offset:6144
    ds_read_b64_tr_b16 a[200:201], v7 offset:8192
    ds_read_b64_tr_b16 a[202:203], v7 offset:10240
    ds_read_b64_tr_b16 a[204:205], v7 offset:12288
    ds_read_b64_tr_b16 a[206:207], v7 offset:14336
    s_waitcnt lgkmcnt(0)
    ds_read_b64_tr_b16 a[208:209], v7 offset:32
    ds_read_b64_tr_b16 a[210:211], v7 offset:2080
    ds_read_b64_tr_b16 a[212:213], v7 offset:4128
    ds_read_b64_tr_b16 a[214:215], v7 offset:6176
    ds_read_b64_tr_b16 a[216:217], v7 offset:8224
    ds_read_b64_tr_b16 a[218:219], v7 offset:10272
    ds_read_b64_tr_b16 a[220:221], v7 offset:12320
    ds_read_b64_tr_b16 a[222:223], v7 offset:14368
    s_waitcnt lgkmcnt(0)
    ds_read_b64_tr_b16 a[224:225], v7 offset:64
    ds_read_b64_tr_b16 a[226:227], v7 offset:2112
    ds_read_b64_tr_b16 a[228:229], v7 offset:4160
    ds_read_b64_tr_b16 a[230:231], v7 offset:6208
    ds_read_b64_tr_b16 a[232:233], v7 offset:8256
    ds_read_b64_tr_b16 a[234:235], v7 offset:10304
    ds_read_b64_tr_b16 a[236:237], v7 offset:12352
    ds_read_b64_tr_b16 a[238:239], v7 offset:14400
    s_waitcnt lgkmcnt(0)
    ds_read_b64_tr_b16 a[240:241], v7 offset:96
    ds_read_b64_tr_b16 a[242:243], v7 offset:2144
    ds_read_b64_tr_b16 a[244:245], v7 offset:4192
    ds_read_b64_tr_b16 a[246:247], v7 offset:6240
    ds_read_b64_tr_b16 a[248:249], v7 offset:8288
    ds_read_b64_tr_b16 a[250:251], v7 offset:10336
    ds_read_b64_tr_b16 a[252:253], v7 offset:12384
    ds_read_b64_tr_b16 a[254:255], v7 offset:14432
    s_waitcnt lgkmcnt(0)
    s_barrier
    s_lshl_b32 s12, s3, 12
    v_add_u32 v8, s12, v56
    v_lshrrev_b32 v4, 1, v2
    v_lshlrev_b32 v4, 8, v4
    v_lshl_add_u32 v4, v3, 4, v4
    s_lshr_b32 s12, s7, 1
    s_lshl_b32 s12, s12, 10
    s_and_b32 s13, s3, 1
    s_lshl_b32 s13, s13, 9
    s_add_u32 s12, s12, s13
    s_and_b32 s13, s7, 1
    s_lshl_b32 s13, s13, 7
    s_add_u32 s12, s12, s13
    v_add_u32 v57, s12, v4
    s_lshl_b32 s12, s6, 12
    s_lshr_b32 s13, s3, 1
    s_lshl_b32 s13, s13, 11
    s_add_u32 s12, s12, s13
    v_add_u32 v9, s12, v57
    s_lshl_b32 s12, s6, 11
    s_lshl_b32 s13, s7, 9
    s_add_u32 s12, s12, s13
    v_add_u32 v10, s12, v56
    s_lshl_b32 s12, s3, 11
    v_add_u32 v11, s12, v56
    s_lshl_b32 s12, s4, 4
    s_add_u32 s12, s12, s5
    s_lshl_b32 s12, s12, 10
    s_and_b32 s13, s3, 1
    s_lshl_b32 s13, s13, 9
    s_add_u32 s12, s12, s13
    s_lshr_b32 s13, s3, 1
    s_lshl_b32 s13, s13, 7
    s_add_u32 s12, s12, s13
    v_add_u32 v12, s12, v4
    v_lshlrev_b32 v13, 14, v2
    v_lshl_add_u32 v13, v1, 4, v13
    s_lshl_b32 s12, s5, 10
    s_lshl_b32 s13, s3, 8
    s_add_u32 s12, s12, s13
    v_add_u32 v13, s12, v13
    v_add_u32 v14, s12, v56
    v_lshlrev_b32 v15, 13, v1
    v_lshl_add_u32 v15, v2, 4, v15
    s_lshl_b32 s12, s8, 8
    v_add_u32 v15, s12, v15
    v_mov_b32 v232, v56
    v_mov_b32 v52, 0
    v_mov_b32 v4, 0x3f80
    v_cmp_eq_u32 vcc, 0, v1
    s_nop 1
    v_cndmask_b32 v52, v52, v4, vcc
    v_mov_b32 v4, 0x3f800000
    v_cmp_eq_u32 vcc, 1, v1
    s_nop 1
    v_cndmask_b32 v52, v52, v4, vcc
    v_mov_b32 v53, 0
    v_mov_b32 v4, 0x3f80
    v_cmp_eq_u32 vcc, 2, v1
    s_nop 1
    v_cndmask_b32 v53, v53, v4, vcc
    v_mov_b32 v4, 0x3f800000
    v_cmp_eq_u32 vcc, 3, v1
    s_nop 1
    v_cndmask_b32 v53, v53, v4, vcc
    v_mov_b32 v54, 0
    v_mov_b32 v4, 0x3f80
    v_cmp_eq_u32 vcc, 4, v1
    s_nop 1
    v_cndmask_b32 v54, v54, v4, vcc
    v_mov_b32 v4, 0x3f800000
    v_cmp_eq_u32 vcc, 5, v1
    s_nop 1
    v_cndmask_b32 v54, v54, v4, vcc
    v_mov_b32 v55, 0
    v_mov_b32 v4, 0x3f80
    v_cmp_eq_u32 vcc, 6, v1
    s_nop 1
    v_cndmask_b32 v55, v55, v4, vcc
    v_mov_b32 v4, 0x3f800000
    v_cmp_eq_u32 vcc, 7, v1
    s_nop 1
    v_cndmask_b32 v55, v55, v4, vcc
    v_mov_b32 v4, 0xff800000
    v_cmp_lt_u32 vcc, 31, v0
    s_nop 1
    v_cndmask_b32 v60, 0, v4, vcc
    v_mov_b32 v61, v60
    v_mov_b32 v62, v60
    v_mov_b32 v63, v60
    v_mov_b32 v236, -1
    v_mov_b32 v237, -1
    v_mov_b32 v238, -1
    v_mov_b32 v239, -1
    s_mov_b32 s54, 0xff
    s_mov_b32 s55, 0xff
    s_mov_b32 s58, -1
    s_mov_b32 s59, 0
    s_mov_b32 s60, 0x3e0293ee
    s_mov_b32 s61, s60
    s_mov_b32 s52, 0x400000
    s_mov_b32 s50, 0
    s_lshl_b32 s12, s8, 13
    s_add_u32 s12, s12, 4096
    s_add_u32 s32, s10, 25165824
    s_addc_u32 s33, s11, 0
    s_add_u32 s32, s32, s12
    s_addc_u32 s33, s33, 0
    s_lshl_b32 s12, s8, 13
    s_add_u32 s12, s12, 4096
    s_add_u32 s36, s10, 41943040
    s_addc_u32 s37, s11, 0
    s_add_u32 s36, s36, s12
    s_addc_u32 s37, s37, 0
    s_lshl_b32 s12, s8, 11
    s_add_u32 s38, s10, 58720256
    s_addc_u32 s39, s11, 0
    s_add_u32 s38, s38, s12
    s_addc_u32 s39, s39, 0
    s_add_u32 s40, s10, 62914560
    s_addc_u32 s41, s11, 0
    s_add_u32 s40, s40, s12
    s_addc_u32 s41, s41, 0
    s_add_u32 s16, s10, 130088960
    s_addc_u32 s17, s11, 0
    s_lshl_b32 s12, s4, 7
    s_mov_b32 s14, 16
    s_cmp_lg_u32 s3, 0
    s_cbranch_scc1 RS_L_gp_k0_ok
    v_mov_b32 v242, s12
RS_L_gp_k0:
    global_load_dword v243, v242, s[16:17] sc1
    s_waitcnt vmcnt(0)
    v_readfirstlane_b32 s13, v243
    s_nop 0
    s_cmp_ge_u32 s13, s14
    s_cbranch_scc1 RS_L_gp_k0_ok
    s_sleep 6
    s_sub_u32 s52, s52, 1
    s_cbranch_scc0 RS_L_gp_k0
    s_mov_b32 s52, 0
RS_L_gp_k0_ok:
    s_barrier
    global_load_dwordx4 v[128:131], v56, s[32:33] offset:-4096
    global_load_dwordx4 v[132:135], v56, s[32:33] offset:-3072
    global_load_dwordx4 v[136:139], v56, s[32:33] offset:-2048
    global_load_dwordx4 v[140:143], v56, s[32:33] offset:-1024
    global_load_dwordx4 v[144:147], v56, s[32:33] offset:0
    global_load_dwordx4 v[148:151], v56, s[32:33] offset:1024
    global_load_dwordx4 v[152:155], v56, s[32:33] offset:2048
    global_load_dwordx4 v[156:159], v56, s[32:33] offset:3072
    s_lshl_b32 s13, s4, 2
    s_add_u32 s13, s13, s6
    s_lshl_b32 s13, s13, 13
    s_lshl_b32 s14, s7, 11
    s_add_u32 s13, s13, s14
    s_and_b32 s14, s3, 1
    s_lshl_b32 s14, s14, 10
    s_add_u32 s13, s13, s14
    v_add_u32 v58, s13, v56
    s_cmp_lt_u32 s3, 2
    s_mov_b32 s12, 25690112
    s_mov_b32 s13, 42467328
    s_cselect_b32 s12, s12, s13
    s_add_u32 s18, s10, s12
    s_addc_u32 s19, s11, 0
    v_add_u32 v232, 4096, v8
    v_and_b32 v232, 0x3fff, v232
    v_add_u32 v233, 8192, v8
    v_and_b32 v233, 0x3fff, v233
    v_add_u32 v234, 12288, v8
    v_and_b32 v234, 0x3fff, v234
    s_lshl_b32 s12, s3, 10
    v_add_u32 v235, s12, v56
    v_and_b32 v59, 31, v0
    v_lshlrev_b32 v59, 4, v59
    v_lshrrev_b32 v242, 5, v0
    v_lshl_add_u32 v59, v242, 10, v59
    v_lshlrev_b32 v243, 2, v0
    s_lshl_b32 s12, s3, 8
    v_add_u32 v15, s12, v243
    s_add_u32 s12, s3, 1
    s_and_b32 s12, s12, 3
    s_lshl_b32 s12, s12, 8
    v_add_u32 v1, s12, v243
    s_add_u32 s12, s3, 2
    s_and_b32 s12, s12, 3
    s_lshl_b32 s12, s12, 8
    v_add_u32 v2, s12, v243
    s_add_u32 s12, s3, 3
    s_and_b32 s12, s12, 3
    s_lshl_b32 s12, s12, 8
    v_add_u32 v3, s12, v243
    v_mov_b32 v4, 0x3f803f80
    v_mov_b32 v5, 0x3f803f80
    v_mov_b32 v6, 0x3f803f80
    v_mov_b32 v7, 0x3f803f80
RS_L_step:
    s_add_u32 s12, s50, 2
    s_and_b32 s13, s12, 7
    s_cmp_lg_u32 s13, 0
    s_cbranch_scc1 RS_L_kvskip
    s_cmp_ge_u32 s12, 64
    s_cbranch_scc1 RS_L_kvskip
    s_lshr_b32 s12, s12, 3
    s_mov_b32 s14, 4
    v_readfirstlane_b32 s13, v57
    s_nop 0
    s_cmp_ge_u32 s13, s14
    s_cbranch_scc1 RS_L_kvskip
    s_lshl_b32 s12, s12, 3
    s_add_u32 s12, s12, s4
    s_lshl_b32 s12, s12, 7
    v_mov_b32 v242, s12
RS_L_gp_n:
    global_load_dword v243, v242, s[16:17] sc1
    s_waitcnt vmcnt(0)
    v_readfirstlane_b32 s13, v243
    s_nop 0
    s_cmp_ge_u32 s13, s14
    s_cbranch_scc1 RS_L_gp_n_ok
    s_sleep 4
    s_sub_u32 s52, s52, 1
    s_cbranch_scc0 RS_L_gp_n
    s_mov_b32 s52, 0
RS_L_gp_n_ok:
RS_L_kvskip:
    s_and_b32 s51, s50, 3
    s_lshl_b32 s12, s51, 17
    s_lshl_b32 s13, s4, 14
    s_add_u32 s14, s12, s13
    s_add_u32 s20, s10, 100663296
    s_addc_u32 s21, s11, 0
    s_add_u32 s20, s20, s14
    s_addc_u32 s21, s21, 0
    s_add_u32 s24, s10, 101711872
    s_addc_u32 s25, s11, 0
    s_add_u32 s24, s24, s14
    s_addc_u32 s25, s25, 0
    s_lshl_b32 s15, s50, 17
    s_add_u32 s28, s10, 117440512
    s_addc_u32 s29, s11, 0
    s_add_u32 s28, s28, s15
    s_addc_u32 s29, s29, 0
    s_add_u32 s30, s28, 65536
    s_addc_u32 s31, s29, 0
    s_lshr_b32 s15, s14, 1
    s_add_u32 s26, s10, 102760448
    s_addc_u32 s27, s11, 0
    s_add_u32 s26, s26, s15
    s_addc_u32 s27, s27, 0
    s_add_u32 s15, s50, 1
    s_and_b32 s15, s15, 3
    s_lshl_b32 s15, s15, 17
    s_add_u32 s15, s15, s13
    s_add_u32 s22, s10, 100663296
    s_addc_u32 s23, s11, 0
    s_add_u32 s22, s22, s15
    s_addc_u32 s23, s23, 0
    s_xor_b32 s15, s12, 262144
    s_add_u32 s15, s15, s13
    s_add_u32 s42, s10, 101711872
    s_addc_u32 s43, s11, 0
    s_add_u32 s42, s42, s15
    s_addc_u32 s43, s43, 0
    s_lshr_b32 s15, s15, 1
    s_add_u32 s44, s10, 102760448
    s_addc_u32 s45, s11, 0
    s_add_u32 s44, s44, s15
    s_addc_u32 s45, s45, 0
    s_add_u32 s15, s50, 3
    s_and_b32 s15, s15, 3
    s_lshl_b32 s15, s15, 17
    s_add_u32 s15, s15, s13
    s_add_u32 s48, s10, 100663296
    s_addc_u32 s49, s11, 0
    s_add_u32 s48, s48, s15
    s_addc_u32 s49, s49, 0
    global_load_dwordx4 v[64:67], v8, s[20:21] offset:0 sc1
    global_load_dwordx4 v[68:71], v8, s[20:21] offset:1024 sc1
    global_load_dwordx4 v[72:75], v8, s[20:21] offset:2048 sc1
    global_load_dwordx4 v[76:79], v8, s[20:21] offset:3072 sc1
    s_waitcnt vmcnt(0)
    s_branch RS_L_e3_c
RS_L_e3_r:
    global_load_dwordx4 v[64:67], v8, s[20:21] offset:0 sc1
    global_load_dwordx4 v[68:71], v8, s[20:21] offset:1024 sc1
    global_load_dwordx4 v[72:75], v8, s[20:21] offset:2048 sc1
    global_load_dwordx4 v[76:79], v8, s[20:21] offset:3072 sc1
    s_waitcnt vmcnt(0)
RS_L_e3_c:
    v_max3_u32 v240, v64, v65, v66
    v_max3_u32 v240, v240, v67, v68
    v_max3_u32 v240, v240, v69, v70
    v_max3_u32 v240, v240, v71, v72
    v_max3_u32 v240, v240, v73, v74
    v_max3_u32 v240, v240, v75, v76
    v_max3_u32 v240, v240, v77, v78
    v_max_u32 v240, v240, v79
    v_cmp_eq_u32 vcc, -1, v240
    s_cbranch_vccz RS_L_e3_ok
    s_sub_u32 s52, s52, 1
    s_cbranch_scc0 RS_L_e3_r
    s_mov_b32 s52, 0
RS_L_e3_ok:
    ds_write_b128 v8, v[64:67] offset:0
    v_mfma_f32_16x16x32_bf16 v[16:19], a[0:3], v[64:67], 0
    ds_write_b128 v8, v[68:71] offset:1024
    v_mfma_f32_16x16x32_bf16 v[20:23], a[4:7], v[64:67], 0
    ds_write_b128 v8, v[72:75] offset:2048
    v_mfma_f32_16x16x32_bf16 v[16:19], a[8:11], v[68:71], v[16:19]
    ds_write_b128 v8, v[76:79] offset:3072
    v_mfma_f32_16x16x32_bf16 v[20:23], a[12:15], v[68:71], v[20:23]
    s_waitcnt lgkmcnt(0)
    s_barrier
    ds_read_b128 v[80:83], v232 offset:0
    ds_read_b128 v[84:87], v232 offset:1024
    ds_read_b128 v[88:91], v232 offset:2048
    ds_read_b128 v[92:95], v232 offset:3072
    ds_read_b128 v[96:99], v233 offset:0
    ds_read_b128 v[100:103], v233 offset:1024
    ds_read_b128 v[104:107], v233 offset:2048
    ds_read_b128 v[108:111], v233 offset:3072
    ds_read_b128 v[112:115], v234 offset:0
    ds_read_b128 v[116:119], v234 offset:1024
    ds_read_b128 v[120:123], v234 offset:2048
    ds_read_b128 v[124:127], v234 offset:3072
    v_mfma_f32_16x16x32_bf16 v[16:19], a[16:19], v[72:75], v[16:19]
    v_mfma_f32_16x16x32_bf16 v[20:23], a[20:23], v[72:75], v[20:23]
    v_mfma_f32_16x16x32_bf16 v[16:19], a[24:27], v[76:79], v[16:19]
    v_mfma_f32_16x16x32_bf16 v[20:23], a[28:31], v[76:79], v[20:23]
    s_waitcnt lgkmcnt(11)
    v_mfma_f32_16x16x32_bf16 v[16:19], a[32:35], v[80:83], v[16:19]
    v_mfma_f32_16x16x32_bf16 v[20:23], a[36:39], v[80:83], v[20:23]
    s_waitcnt lgkmcnt(10)
    v_mfma_f32_16x16x32_bf16 v[16:19], a[40:43], v[84:87], v[16:19]
    v_mfma_f32_16x16x32_bf16 v[20:23], a[44:47], v[84:87], v[20:23]
    global_load_dwordx4 v[160:163], v56, s[36:37] offset:-4096
    s_waitcnt lgkmcnt(9)
    v_mfma_f32_16x16x32_bf16 v[16:19], a[48:51], v[88:91], v[16:19]
    v_mfma_f32_16x16x32_bf16 v[20:23], a[52:55], v[88:91], v[20:23]
    s_waitcnt lgkmcnt(8)
    v_mfma_f32_16x16x32_bf16 v[16:19], a[56:59], v[92:95], v[16:19]
    v_mfma_f32_16x16x32_bf16 v[20:23], a[60:63], v[92:95], v[20:23]
    global_load_dwordx4 v[164:167], v56, s[36:37] offset:-3072
    s_waitcnt lgkmcnt(7)
    v_mfma_f32_16x16x32_bf16 v[16:19], a[64:67], v[96:99], v[16:19]
    v_mfma_f32_16x16x32_bf16 v[20:23], a[68:71], v[96:99], v[20:23]
    s_waitcnt lgkmcnt(6)
    v_mfma_f32_16x16x32_bf16 v[16:19], a[72:75], v[100:103], v[16:19]
    v_mfma_f32_16x16x32_bf16 v[20:23], a[76:79], v[100:103], v[20:23]
    global_load_dwordx4 v[168:171], v56, s[36:37] offset:-2048
    s_waitcnt lgkmcnt(5)
    v_mfma_f32_16x16x32_bf16 v[16:19], a[80:83], v[104:107], v[16:19]
    v_mfma_f32_16x16x32_bf16 v[20:23], a[84:87], v[104:107], v[20:23]
    s_waitcnt lgkmcnt(4)
    v_mfma_f32_16x16x32_bf16 v[16:19], a[88:91], v[108:111], v[16:19]
    v_mfma_f32_16x16x32_bf16 v[20:23], a[92:95], v[108:111], v[20:23]
    global_load_dwordx4 v[172:175], v56, s[36:37] offset:-1024
    s_waitcnt lgkmcnt(3)
    v_mfma_f32_16x16x32_bf16 v[16:19], a[96:99], v[112:115], v[16:19]
    v_mfma_f32_16x16x32_bf16 v[20:23], a[100:103], v[112:115], v[20:23]
    s_waitcnt lgkmcnt(2)
    v_mfma_f32_16x16x32_bf16 v[16:19], a[104:107], v[116:119], v[16:19]
    v_mfma_f32_16x16x32_bf16 v[20:23], a[108:111], v[116:119], v[20:23]
    global_load_dwordx4 v[176:179], v56, s[36:37] offset:0
    s_waitcnt lgkmcnt(1)
    v_mfma_f32_16x16x32_bf16 v[16:19], a[112:115], v[120:123], v[16:19]
    v_mfma_f32_16x16x32_bf16 v[20:23], a[116:119], v[120:123], v[20:23]
    s_waitcnt lgkmcnt(0)
    v_mfma_f32_16x16x32_bf16 v[16:19], a[120:123], v[124:127], v[16:19]
    v_mfma_f32_16x16x32_bf16 v[20:23], a[124:127], v[124:127], v[20:23]
    global_load_dwordx4 v[180:183], v56, s[36:37] offset:1024
    s_nop 6
    v_add_f32_dpp v16, v20, v16 row_ror:8 row_mask:0xf bank_mask:0xf
    v_add_f32_dpp v17, v21, v17 row_ror:8 row_mask:0xf bank_mask:0xf
    v_add_f32_dpp v18, v22, v18 row_ror:8 row_mask:0xf bank_mask:0xf
    v_add_f32_dpp v19, v23, v19 row_ror:8 row_mask:0xf bank_mask:0xf
    v_cvt_pk_bf16_f32 v244, v16, v17
    v_cvt_pk_bf16_f32 v245, v18, v19
    s_nop 0
    v_permlane16_swap_b32 v244, v246
    v_permlane16_swap_b32 v245, v247
    s_mov_b64 exec, s[54:55]
    global_store_dwordx4 v9, v[244:247], s[24:25] sc1
    s_mov_b64 exec, -1
    v_mfma_f32_16x16x32_bf16 v[24:27], v[64:67], a[128:131], 0
    v_mfma_f32_16x16x32_bf16 v[28:31], v[64:67], a[132:135], 0
    v_mfma_f32_16x16x32_bf16 v[24:27], v[68:71], a[136:139], v[24:27]
    v_mfma_f32_16x16x32_bf16 v[28:31], v[68:71], a[140:143], v[28:31]
    global_load_dwordx4 v[184:187], v56, s[36:37] offset:2048
    v_mfma_f32_16x16x32_bf16 v[24:27], v[72:75], a[144:147], v[24:27]
    v_mfma_f32_16x16x32_bf16 v[28:31], v[72:75], a[148:151], v[28:31]
    v_mfma_f32_16x16x32_bf16 v[24:27], v[76:79], a[152:155], v[24:27]
    v_mfma_f32_16x16x32_bf16 v[28:31], v[76:79], a[156:159], v[28:31]
    global_load_dwordx4 v[188:191], v56, s[36:37] offset:3072
    v_mfma_f32_16x16x32_bf16 v[24:27], v[80:83], a[160:163], v[24:27]
    v_mfma_f32_16x16x32_bf16 v[28:31], v[80:83], a[164:167], v[28:31]
    v_mfma_f32_16x16x32_bf16 v[24:27], v[84:87], a[168:171], v[24:27]
    v_mfma_f32_16x16x32_bf16 v[28:31], v[84:87], a[172:175], v[28:31]
    v_mfma_f32_16x16x32_bf16 v[24:27], v[88:91], a[176:179], v[24:27]
    v_mfma_f32_16x16x32_bf16 v[28:31], v[88:91], a[180:183], v[28:31]
    v_mfma_f32_16x16x32_bf16 v[24:27], v[92:95], a[184:187], v[24:27]
    v_mfma_f32_16x16x32_bf16 v[28:31], v[92:95], a[188:191], v[28:31]
    global_load_dwordx4 v[192:195], v8, s[24:25] offset:0 sc1
    global_load_dwordx4 v[196:199], v8, s[24:25] offset:1024 sc1
    global_load_dwordx4 v[208:211], v8, s[24:25] offset:2048 sc1
    global_load_dwordx4 v[212:215], v8, s[24:25] offset:3072 sc1
    s_nop 3
    v_cndmask_b32 v24, v28, v24, s[58:59]
    v_cndmask_b32 v25, v29, v25, s[58:59]
    v_cndmask_b32 v26, v30, v26, s[58:59]
    v_cndmask_b32 v27, v31, v27, s[58:59]
    ds_write_b128 v235, v[24:27] offset:32768
    s_waitcnt lgkmcnt(0)
    s_barrier
    s_cmp_lg_u32 s3, 0
    s_cbranch_scc1 RS_L_vred_skip
    ds_read_b128 v[16:19], v59 offset:32768
    ds_read_b128 v[20:23], v59 offset:33280
    ds_read_b128 v[24:27], v59 offset:34816
    ds_read_b128 v[28:31], v59 offset:35328
    s_waitcnt lgkmcnt(0)
    v_add_f32 v16, v16, v20
    v_add_f32 v24, v24, v28
    v_add_f32 v17, v17, v21
    v_add_f32 v25, v25, v29
    v_add_f32 v18, v18, v22
    v_add_f32 v26, v26, v30
    v_add_f32 v19, v19, v23
    v_add_f32 v27, v27, v31
    v_add_f32 v16, v16, v24
    v_add_f32 v17, v17, v25
    v_add_f32 v18, v18, v26
    v_add_f32 v19, v19, v27
    v_cvt_pk_bf16_f32 v244, v16, v17
    v_cvt_pk_bf16_f32 v245, v18, v19
    s_nop 0
    v_permlane32_swap_b32 v244, v246
    v_permlane32_swap_b32 v245, v247
    s_mov_b64 exec, s[58:59]
    global_store_dwordx4 v10, v[244:247], s[26:27] sc1
    s_mov_b64 exec, -1
    s_waitcnt vmcnt(1)
    s_branch RS_L_e1_c
RS_L_e1_r:
    global_load_dwordx4 v[192:195], v8, s[24:25] offset:0 sc1
    global_load_dwordx4 v[196:199], v8, s[24:25] offset:1024 sc1
    global_load_dwordx4 v[208:211], v8, s[24:25] offset:2048 sc1
    global_load_dwordx4 v[212:215], v8, s[24:25] offset:3072 sc1
RS_L_vred_skip:
    s_waitcnt vmcnt(0)
RS_L_e1_c:
    v_max3_u32 v240, v192, v193, v194
    v_max3_u32 v240, v240, v195, v196
    v_max3_u32 v240, v240, v197, v198
    v_max3_u32 v240, v240, v199, v208
    v_max3_u32 v240, v240, v209, v210
    v_max3_u32 v240, v240, v211, v212
    v_max3_u32 v240, v240, v213, v214
    v_max_u32 v240, v240, v215
    v_cmp_eq_u32 vcc, -1, v240
    s_cbranch_vccz RS_L_e1_ok
    s_sub_u32 s52, s52, 1
    s_cbranch_scc0 RS_L_e1_r
    s_mov_b32 s52, 0
RS_L_e1_ok:
    v_mfma_f32_16x16x32_bf16 v[32:35], v[128:131], v[192:195], 0
    v_mov_b32_dpp v200, v192 row_ror:8 row_mask:0xf bank_mask:0xf
    v_mov_b32_dpp v201, v193 row_ror:8 row_mask:0xf bank_mask:0xf
    v_mfma_f32_16x16x32_bf16 v[36:39], v[144:147], v[192:195], 0
    v_mov_b32_dpp v202, v194 row_ror:8 row_mask:0xf bank_mask:0xf
    v_mov_b32_dpp v203, v195 row_ror:8 row_mask:0xf bank_mask:0xf
    v_mfma_f32_16x16x32_bf16 v[40:43], v[208:211], v[192:195], v[60:63]
    v_mov_b32_dpp v204, v196 row_ror:8 row_mask:0xf bank_mask:0xf
    v_mov_b32_dpp v205, v197 row_ror:8 row_mask:0xf bank_mask:0xf
    v_mfma_f32_16x16x32_bf16 v[32:35], v[136:139], v[196:199], v[32:35]
    v_mov_b32_dpp v206, v198 row_ror:8 row_mask:0xf bank_mask:0xf
    v_mov_b32_dpp v207, v199 row_ror:8 row_mask:0xf bank_mask:0xf
    v_mfma_f32_16x16x32_bf16 v[36:39], v[152:155], v[196:199], v[36:39]
    v_mov_b32_dpp v216, v208 row_ror:8 row_mask:0xf bank_mask:0xf
    v_mov_b32_dpp v217, v209 row_ror:8 row_mask:0xf bank_mask:0xf
    v_mfma_f32_16x16x32_bf16 v[40:43], v[212:215], v[196:199], v[40:43]
    v_mov_b32_dpp v218, v210 row_ror:8 row_mask:0xf bank_mask:0xf
    v_mov_b32_dpp v219, v211 row_ror:8 row_mask:0xf bank_mask:0xf
    v_mfma_f32_16x16x32_bf16 v[32:35], v[132:135], v[200:203], v[32:35]
    v_mov_b32_dpp v220, v212 row_ror:8 row_mask:0xf bank_mask:0xf
    v_mov_b32_dpp v221, v213 row_ror:8 row_mask:0xf bank_mask:0xf
    v_mfma_f32_16x16x32_bf16 v[36:39], v[148:151], v[200:203], v[36:39]
    v_mov_b32_dpp v222, v214 row_ror:8 row_mask:0xf bank_mask:0xf
    v_mov_b32_dpp v223, v215 row_ror:8 row_mask:0xf bank_mask:0xf
    v_mfma_f32_16x16x32_bf16 v[32:35], v[140:143], v[204:207], v[32:35]
    v_mfma_f32_16x16x32_bf16 v[36:39], v[156:159], v[204:207], v[36:39]
    v_mfma_f32_16x16x32_bf16 v[40:43], v[216:219], v[200:203], v[40:43]
    v_mfma_f32_16x16x32_bf16 v[40:43], v[220:223], v[204:207], v[40:43]
    s_add_u32 s32, s32, 262144
    s_addc_u32 s33, s33, 0
    global_load_dwordx4 v[224:227], v11, s[26:27] offset:0 sc1
    global_load_dwordx4 v[228:231], v11, s[26:27] offset:1024 sc1
    s_nop 0
    v_max3_f32 v241, v32, v33, v34
    v_max3_f32 v243, v36, v37, v38
    v_max3_f32 v241, v241, v35, v39
    v_max3_f32 v243, v243, v40, v41
    v_max3_f32 v241, v241, v42, v43
    v_max_f32 v241, v241, v243
    v_mov_b32 v242, v241
    s_nop 1
    v_permlane16_swap_b32 v241, v242
    v_max_f32 v241, v241, v242
    v_mov_b32 v242, v241
    s_nop 1
    v_permlane32_swap_b32 v241, v242
    v_max_f32 v241, v241, v242
    v_mul_f32 v242, s60, v241
    v_pk_fma_f32 v[32:33], v[32:33], s[60:61], v[242:243] op_sel_hi:[1,1,0] neg_lo:[0,0,1] neg_hi:[0,0,1]
    v_pk_fma_f32 v[34:35], v[34:35], s[60:61], v[242:243] op_sel_hi:[1,1,0] neg_lo:[0,0,1] neg_hi:[0,0,1]
    v_pk_fma_f32 v[36:37], v[36:37], s[60:61], v[242:243] op_sel_hi:[1,1,0] neg_lo:[0,0,1] neg_hi:[0,0,1]
    v_pk_fma_f32 v[38:39], v[38:39], s[60:61], v[242:243] op_sel_hi:[1,1,0] neg_lo:[0,0,1] neg_hi:[0,0,1]
    v_pk_fma_f32 v[40:41], v[40:41], s[60:61], v[242:243] op_sel_hi:[1,1,0] neg_lo:[0,0,1] neg_hi:[0,0,1]
    v_pk_fma_f32 v[42:43], v[42:43], s[60:61], v[242:243] op_sel_hi:[1,1,0] neg_lo:[0,0,1] neg_hi:[0,0,1]
    v_exp_f32 v32, v32
    global_load_dwordx4 v[128:131], v56, s[32:33] offset:-4096
    v_exp_f32 v33, v33
    v_exp_f32 v34, v34
    v_exp_f32 v35, v35
    v_exp_f32 v36, v36
    v_exp_f32 v37, v37
    v_exp_f32 v38, v38
    v_exp_f32 v39, v39
    global_load_dwordx4 v[132:135], v56, s[32:33] offset:-3072
    v_exp_f32 v40, v40
    v_exp_f32 v41, v41
    v_exp_f32 v42, v42
    v_exp_f32 v43, v43
    v_cvt_pk_bf16_f32 v44, v32, v33
    v_cvt_pk_bf16_f32 v45, v34, v35
    v_cvt_pk_bf16_f32 v46, v36, v37
    v_cvt_pk_bf16_f32 v47, v38, v39
    v_cvt_pk_bf16_f32 v48, v40, v41
    v_cvt_pk_bf16_f32 v49, v42, v43
    v_mfma_f32_16x16x32_bf16 v[32:35], v[4:7], v[44:47], 0
    v_mfma_f32_16x16x32_bf16 v[64:67], v[160:163], v[44:47], 0
    v_mov_b32 v244, v48
    v_mfma_f32_16x16x32_bf16 v[68:71], v[164:167], v[44:47], 0
    v_mov_b32 v245, v49
    v_mfma_f32_16x16x32_bf16 v[72:75], v[168:171], v[44:47], 0
    v_mov_b32 v50, 0
    v_mfma_f32_16x16x32_bf16 v[76:79], v[172:175], v[44:47], 0
    v_mov_b32 v51, 0
    v_mfma_f32_16x16x32_bf16 v[80:83], v[176:179], v[44:47], 0
    v_permlane32_swap_b32 v50, v244
    v_permlane32_swap_b32 v51, v245
    global_load_dwordx4 v[136:139], v56, s[32:33] offset:-2048
    s_waitcnt vmcnt(3)
RS_L_vm_go:
    v_mfma_f32_16x16x16_bf16 v[32:35], v[4:5], v[48:49], v[32:35]
    v_mfma_f32_16x16x32_bf16 v[84:87], v[180:183], v[44:47], 0
    v_max3_u32 v240, v224, v225, v226
    v_max3_u32 v240, v240, v227, v228
    v_mfma_f32_16x16x32_bf16 v[88:91], v[184:187], v[44:47], 0
    v_max3_u32 v240, v240, v229, v230
    v_max_u32 v240, v240, v231
    v_mfma_f32_16x16x32_bf16 v[92:95], v[188:191], v[44:47], 0
    v_cmp_eq_u32 vcc, -1, v240
    s_cbranch_vccz RS_L_vm_fok
RS_L_vm_rr:
    s_sub_u32 s52, s52, 1
    s_cbranch_scc1 RS_L_vm_fto
    global_load_dwordx4 v[224:227], v11, s[26:27] offset:0 sc1
    global_load_dwordx4 v[228:231], v11, s[26:27] offset:1024 sc1
    s_waitcnt vmcnt(0)
    v_max3_u32 v240, v224, v225, v226
    v_max3_u32 v240, v240, v227, v228
    v_max3_u32 v240, v240, v229, v230
    v_max_u32 v240, v240, v231
    v_cmp_eq_u32 vcc, -1, v240
    s_cbranch_vccnz RS_L_vm_rr
    s_branch RS_L_vm_fok
RS_L_vm_fto:
    s_mov_b32 s52, 0
RS_L_vm_fok:
    v_mfma_f32_16x16x16_bf16 v[64:67], v[224:225], v[48:49], v[64:67]
    v_mfma_f32_16x16x16_bf16 v[68:71], v[226:227], v[48:49], v[68:71]
    v_mfma_f32_16x16x16_bf16 v[72:75], v[224:225], v[50:51], v[72:75]
    v_mfma_f32_16x16x16_bf16 v[76:79], v[226:227], v[50:51], v[76:79]
    s_add_u32 s12, s50, 3
    s_and_b32 s13, s12, 7
    s_cmp_lg_u32 s13, 0
    s_cbranch_scc1 RS_L_nofl
    s_lshr_b32 s12, s12, 3
    s_lshl_b32 s12, s12, 3
    s_add_u32 s12, s12, s4
    s_lshl_b32 s12, s12, 7
    v_mov_b32 v57, s12
    global_load_dword v57, v57, s[16:17] sc1
RS_L_nofl:
    s_and_b32 s12, s50, 15
    s_cmp_lg_u32 s12, s5
    s_cbranch_scc1 RS_L_nopub
    global_store_dwordx4 v56, v[208:211], s[38:39] offset:0
    global_store_dwordx4 v56, v[212:215], s[38:39] offset:1024
    global_store_dwordx4 v56, v[224:227], s[40:41] offset:0
    global_store_dwordx4 v56, v[228:231], s[40:41] offset:1024
RS_L_nopub:
    s_cmp_eq_u32 s50, 63
    s_cbranch_scc1 RS_L_rec_last
    global_load_dwordx4 v[252:255], v58, s[18:19]
    v_mfma_f32_16x16x16_bf16 v[80:83], v[228:229], v[48:49], v[80:83]
    v_cvt_pk_bf16_f32 v96, v64, v65
    v_cvt_pk_bf16_f32 v97, v66, v67
    v_rcp_f32 v241, v32
    v_mfma_f32_16x16x16_bf16 v[84:87], v[230:231], v[48:49], v[84:87]
    v_cvt_pk_bf16_f32 v98, v68, v69
    v_cvt_pk_bf16_f32 v99, v70, v71
    global_load_dwordx4 v[140:143], v56, s[32:33] offset:-1024
    v_mfma_f32_16x16x16_bf16 v[88:91], v[228:229], v[50:51], v[88:91]
    v_cvt_pk_bf16_f32 v100, v72, v73
    v_mfma_f32_16x16x32_bf16 v[16:19], a[192:195], v[96:99], 0
    v_cvt_pk_bf16_f32 v101, v74, v75
    v_mfma_f32_16x16x32_bf16 v[20:23], a[208:211], v[96:99], 0
    v_mfma_f32_16x16x16_bf16 v[92:95], v[230:231], v[50:51], v[92:95]
    v_cvt_pk_bf16_f32 v102, v76, v77
    v_mfma_f32_16x16x32_bf16 v[24:27], a[224:227], v[96:99], 0
    v_cvt_pk_bf16_f32 v103, v78, v79
    v_mfma_f32_16x16x32_bf16 v[28:31], a[240:243], v[96:99], 0
    global_load_dwordx4 v[144:147], v56, s[32:33] offset:0
    v_cvt_pk_bf16_f32 v104, v80, v81
    v_mfma_f32_16x16x32_bf16 v[16:19], a[196:199], v[100:103], v[16:19]
    v_cvt_pk_bf16_f32 v105, v82, v83
    v_mfma_f32_16x16x32_bf16 v[20:23], a[212:215], v[100:103], v[20:23]
    v_cvt_pk_bf16_f32 v106, v84, v85
    v_mfma_f32_16x16x32_bf16 v[24:27], a[228:231], v[100:103], v[24:27]
    v_cvt_pk_bf16_f32 v107, v86, v87
    v_mfma_f32_16x16x32_bf16 v[28:31], a[244:247], v[100:103], v[28:31]
    global_load_dwordx4 v[148:151], v56, s[32:33] offset:1024
    v_cvt_pk_bf16_f32 v108, v88, v89
    v_mfma_f32_16x16x32_bf16 v[16:19], a[200:203], v[104:107], v[16:19]
    v_cvt_pk_bf16_f32 v109, v90, v91
    v_mfma_f32_16x16x32_bf16 v[20:23], a[216:219], v[104:107], v[20:23]
    v_cvt_pk_bf16_f32 v110, v92, v93
    v_mfma_f32_16x16x32_bf16 v[24:27], a[232:235], v[104:107], v[24:27]
    v_cvt_pk_bf16_f32 v111, v94, v95
    v_mfma_f32_16x16x32_bf16 v[28:31], a[248:251], v[104:107], v[28:31]
    global_load_dwordx4 v[152:155], v56, s[32:33] offset:2048
    v_mfma_f32_16x16x32_bf16 v[16:19], a[204:207], v[108:111], v[16:19]
    v_mfma_f32_16x16x32_bf16 v[20:23], a[220:223], v[108:111], v[20:23]
    v_mfma_f32_16x16x32_bf16 v[24:27], a[236:239], v[108:111], v[24:27]
    v_mfma_f32_16x16x32_bf16 v[28:31], a[252:255], v[108:111], v[28:31]
    v_mov_b32 v242, v241
    s_nop 3
    v_pk_mul_f32 v[16:17], v[16:17], v[242:243] op_sel_hi:[1,0]
    v_pk_mul_f32 v[18:19], v[18:19], v[242:243] op_sel_hi:[1,0]
    ds_write_b128 v235, v[16:19] offset:16384
    v_pk_mul_f32 v[20:21], v[20:21], v[242:243] op_sel_hi:[1,0]
    v_pk_mul_f32 v[22:23], v[22:23], v[242:243] op_sel_hi:[1,0]
    ds_write_b128 v235, v[20:23] offset:20480
    v_pk_mul_f32 v[24:25], v[24:25], v[242:243] op_sel_hi:[1,0]
    v_pk_mul_f32 v[26:27], v[26:27], v[242:243] op_sel_hi:[1,0]
    ds_write_b128 v235, v[24:27] offset:24576
    v_pk_mul_f32 v[28:29], v[28:29], v[242:243] op_sel_hi:[1,0]
    v_pk_mul_f32 v[30:31], v[30:31], v[242:243] op_sel_hi:[1,0]
    ds_write_b128 v235, v[28:31] offset:28672
    global_load_dwordx4 v[156:159], v56, s[32:33] offset:3072
    s_waitcnt lgkmcnt(0)
    s_barrier
    ds_read_b128 v[112:115], v8 offset:16384
    ds_read_b128 v[116:119], v8 offset:17408
    ds_read_b128 v[120:123], v8 offset:18432
    ds_read_b128 v[124:127], v8 offset:19456
    s_waitcnt lgkmcnt(2)
    v_pk_add_f32 v[112:113], v[112:113], v[116:117]
    v_pk_add_f32 v[114:115], v[114:115], v[118:119]
    s_waitcnt lgkmcnt(0)
    v_pk_add_f32 v[120:121], v[120:121], v[124:125]
    v_pk_add_f32 v[122:123], v[122:123], v[126:127]
    v_pk_add_f32 v[112:113], v[112:113], v[120:121]
    v_pk_add_f32 v[114:115], v[114:115], v[122:123]
    v_cvt_pk_bf16_f32 v244, v112, v113
    v_cvt_pk_bf16_f32 v245, v114, v115
    s_nop 0
    v_permlane16_swap_b32 v244, v246
    v_permlane16_swap_b32 v245, v247
    s_mov_b64 exec, s[54:55]
    global_store_dwordx4 v12, v[244:247], s[28:29] sc1
    global_store_dwordx4 v9, v[236:239], s[42:43] sc1
    s_mov_b64 exec, 0xffff
    global_store_dwordx4 v14, v[236:239], s[48:49] sc1
    s_cmp_lg_u32 s3, 0
    s_cbranch_scc1 RS_L_norv
    s_mov_b64 exec, s[58:59]
    global_store_dwordx4 v10, v[236:239], s[44:45] sc1
RS_L_norv:
    s_mov_b64 exec, -1
    s_add_u32 s36, s36, 262144
    s_addc_u32 s37, s37, 0
    s_add_u32 s38, s38, 65536
    s_addc_u32 s39, s39, 0
    s_add_u32 s40, s40, 65536
    s_addc_u32 s41, s41, 0
    s_sleep 5
    global_load_dwordx4 v[64:67], v13, s[28:29] sc1
    global_load_dwordx4 v[68:71], v13, s[30:31] sc1
RS_L_e2:
    s_waitcnt vmcnt(0)
    v_max3_u32 v240, v64, v65, v66
    v_max3_u32 v240, v240, v67, v68
    v_max3_u32 v240, v240, v69, v70
    v_max_u32 v240, v240, v71
    v_cmp_eq_u32 vcc, -1, v240
    s_cbranch_vccz RS_L_e2_ok0
    global_load_dwordx4 v[64:67], v13, s[28:29] sc1
    global_load_dwordx4 v[68:71], v13, s[30:31] sc1
    s_sub_u32 s52, s52, 1
    s_cbranch_scc0 RS_L_e2
    s_mov_b32 s52, 0
RS_L_e2_ok0:
    v_mfma_f32_16x16x32_bf16 v[20:23], v[52:55], v[64:67], 0
    v_mfma_f32_16x16x32_bf16 v[20:23], v[52:55], v[68:71], v[20:23]
RS_L_e2_done:
    s_add_u32 s18, s18, 262144
    s_addc_u32 s19, s19, 0
    s_nop 7
    v_cvt_pk_bf16_f32 v244, v20, v21
    v_cvt_pk_bf16_f32 v245, v22, v23
    s_nop 0
    v_permlane16_swap_b32 v244, v246
    v_permlane16_swap_b32 v245, v247
    s_mov_b64 exec, 0xffff
    global_store_dwordx4 v14, v[244:247], s[22:23] sc1
    s_mov_b64 exec, -1
    s_add_u32 s50, s50, 1
    s_cmp_lt_u32 s50, 64
    s_cbranch_scc1 RS_L_step
    s_branch RS_L_rec_fin
RS_L_rec_last:
RS_L_rec_fin:
    s_waitcnt vmcnt(0)
RS_L_rec_end:
    s_endpgm
.section .rodata,"a"
.p2align 6
.amdhsa_kernel mega_kernel
  .amdhsa_next_free_vgpr 512
  .amdhsa_next_free_sgpr 102
  .amdhsa_accum_offset 256
  .amdhsa_group_segment_fixed_size 0
  .amdhsa_kernarg_size 136
  .amdhsa_user_sgpr_count 2
  .amdhsa_user_sgpr_kernarg_segment_ptr 1
  .amdhsa_system_sgpr_workgroup_id_x 1
.end_amdhsa_kernel
.text
.globl tail_kernel
.p2align 8
.type tail_kernel,@function
tail_kernel:
    s_cmp_ge_u32 s2, 256
    s_cbranch_scc1 L_opln_end
    s_load_dwordx2 s[6:7], s[0:1], 128
    s_load_dwordx2 s[52:53], s[0:1], 40
    s_load_dwordx2 s[54:55], s[0:1], 0
    v_lshrrev_b32 v1, 6, v0
    v_and_b32 v0, 63, v0
    v_readfirstlane_b32 s3, v1
    s_waitcnt lgkmcnt(0)
    s_lshl_b32 s8, s2, 2
    s_add_u32 s8, s8, s3
    s_lshl_b32 s8, s8, 1
    v_lshlrev_b32 v194, 4, v0
    s_add_u32 s48, s8, 0
    s_lshl_b32 s49, s48, 13
    s_add_u32 s49, s49, 4096
    s_add_u32 s40, s6, s49
    s_addc_u32 s41, s7, 0
    s_add_u32 s40, s40, 25165824
    s_addc_u32 s41, s41, 0
    s_add_u32 s42, s6, s49
    s_addc_u32 s43, s7, 0
    s_add_u32 s42, s42, 41943040
    s_addc_u32 s43, s43, 0
    s_add_u32 s44, s6, s49
    s_addc_u32 s45, s7, 0
    s_add_u32 s44, s44, 8388608
    s_addc_u32 s45, s45, 0
    s_lshl_b32 s49, s48, 11
    s_add_u32 s46, s6, s49
    s_addc_u32 s47, s7, 0
    s_add_u32 s46, s46, 58720256
    s_addc_u32 s47, s47, 0
    global_load_dwordx4 v[8:11], v194, s[44:45] offset:-4096
    global_load_dwordx4 v[12:15], v194, s[44:45] offset:-3072
    global_load_dwordx4 v[16:19], v194, s[44:45] offset:-2048
    global_load_dwordx4 v[20:23], v194, s[44:45] offset:-1024
    global_load_dwordx4 v[24:27], v194, s[44:45] offset:0
    global_load_dwordx4 v[28:31], v194, s[44:45] offset:1024
    global_load_dwordx4 v[32:35], v194, s[44:45] offset:2048
    global_load_dwordx4 v[36:39], v194, s[44:45] offset:3072
    global_load_dwordx4 v[40:43], v194, s[40:41] offset:-4096
    global_load_dwordx4 v[44:47], v194, s[40:41] offset:-3072
    global_load_dwordx4 v[48:51], v194, s[40:41] offset:-2048
    global_load_dwordx4 v[52:55], v194, s[40:41] offset:-1024
    global_load_dwordx4 v[56:59], v194, s[40:41] offset:0
    global_load_dwordx4 v[60:63], v194, s[40:41] offset:1024
    global_load_dwordx4 v[64:67], v194, s[40:41] offset:2048
    global_load_dwordx4 v[68:71], v194, s[40:41] offset:3072
    global_load_dwordx4 v[104:107], v194, s[46:47] offset:0
    global_load_dwordx4 v[108:111], v194, s[46:47] offset:1024
    s_add_u32 s46, s46, 4194304
    s_addc_u32 s47, s47, 0
    global_load_dwordx4 v[112:115], v194, s[46:47] offset:0
    global_load_dwordx4 v[116:119], v194, s[46:47] offset:1024
    global_load_dwordx4 v[72:75], v194, s[42:43] offset:-4096
    global_load_dwordx4 v[76:79], v194, s[42:43] offset:-3072
    global_load_dwordx4 v[80:83], v194, s[42:43] offset:-2048
    global_load_dwordx4 v[84:87], v194, s[42:43] offset:-1024
    global_load_dwordx4 v[88:91], v194, s[42:43] offset:0
    global_load_dwordx4 v[92:95], v194, s[42:43] offset:1024
    global_load_dwordx4 v[96:99], v194, s[42:43] offset:2048
    global_load_dwordx4 v[100:103], v194, s[42:43] offset:3072
    s_add_u32 s48, s8, 1
    s_lshl_b32 s49, s48, 13
    s_add_u32 s49, s49, 4096
    s_add_u32 s40, s6, s49
    s_addc_u32 s41, s7, 0
    s_add_u32 s40, s40, 25165824
    s_addc_u32 s41, s41, 0
    s_add_u32 s42, s6, s49
    s_addc_u32 s43, s7, 0
    s_add_u32 s42, s42, 41943040
    s_addc_u32 s43, s43, 0
    s_add_u32 s44, s6, s49
    s_addc_u32 s45, s7, 0
    s_add_u32 s44, s44, 8388608
    s_addc_u32 s45, s45, 0
    s_lshl_b32 s49, s48, 11
    s_add_u32 s46, s6, s49
    s_addc_u32 s47, s7, 0
    s_add_u32 s46, s46, 58720256
    s_addc_u32 s47, s47, 0
    global_load_dwordx4 a[0:3], v194, s[44:45] offset:-4096
    global_load_dwordx4 a[4:7], v194, s[44:45] offset:-3072
    global_load_dwordx4 a[8:11], v194, s[44:45] offset:-2048
    global_load_dwordx4 a[12:15], v194, s[44:45] offset:-1024
    global_load_dwordx4 a[16:19], v194, s[44:45] offset:0
    global_load_dwordx4 a[20:23], v194, s[44:45] offset:1024
    global_load_dwordx4 a[24:27], v194, s[44:45] offset:2048
    global_load_dwordx4 a[28:31], v194, s[44:45] offset:3072
    global_load_dwordx4 a[32:35], v194, s[40:41] offset:-4096
    global_load_dwordx4 a[36:39], v194, s[40:41] offset:-3072
    global_load_dwordx4 a[40:43], v194, s[40:41] offset:-2048
    global_load_dwordx4 a[44:47], v194, s[40:41] offset:-1024
    global_load_dwordx4 a[48:51], v194, s[40:41] offset:0
    global_load_dwordx4 a[52:55], v194, s[40:41] offset:1024
    global_load_dwordx4 a[56:59], v194, s[40:41] offset:2048
    global_load_dwordx4 a[60:63], v194, s[40:41] offset:3072
    global_load_dwordx4 a[96:99], v194, s[46:47] offset:0
    global_load_dwordx4 a[100:103], v194, s[46:47] offset:1024
    s_add_u32 s46, s46, 4194304
    s_addc_u32 s47, s47, 0
    global_load_dwordx4 a[104:107], v194, s[46:47] offset:0
    global_load_dwordx4 a[108:111], v194, s[46:47] offset:1024
    global_load_dwordx4 a[64:67], v194, s[42:43] offset:-4096
    global_load_dwordx4 a[68:71], v194, s[42:43] offset:-3072
    global_load_dwordx4 a[72:75], v194, s[42:43] offset:-2048
    global_load_dwordx4 a[76:79], v194, s[42:43] offset:-1024
    global_load_dwordx4 a[80:83], v194, s[42:43] offset:0
    global_load_dwordx4 a[84:87], v194, s[42:43] offset:1024
    global_load_dwordx4 a[88:91], v194, s[42:43] offset:2048
    global_load_dwordx4 a[92:95], v194, s[42:43] offset:3072
    v_mov_b32 v148, 0x3f803f80
    v_mov_b32 v149, 0x3f803f80
    v_mov_b32 v150, 0x3f803f80
    v_mov_b32 v151, 0x3f803f80
    s_mov_b32 s50, 0x3e0293ee
    v_and_b32 v192, 15, v0
    v_lshrrev_b32 v193, 4, v0
    v_lshlrev_b32 v193, 2, v193
    v_sub_u32 v192, v192, v193
    v_mov_b32 v193, 0xff800000
    v_and_b32 v188, 15, v0
    v_lshrrev_b32 v195, 4, v0
    v_and_b32 v190, 1, v195
    v_lshrrev_b32 v195, 1, v195
    v_lshl_or_b32 v195, v190, 1, v195
    v_lshrrev_b32 v190, 2, v188
    v_lshrrev_b32 v191, 1, v190
    v_and_b32 v190, 1, v190
    v_xor_b32 v190, v190, v191
    v_lshl_or_b32 v190, v190, 1, v191
    v_xor_b32 v195, v195, v190
    v_lshl_add_u32 v195, v188, 2, v195
    v_lshlrev_b32 v195, 4, v195
    s_add_u32 s48, s8, 0
    s_lshr_b32 s9, s48, 5
    s_and_b32 s10, s48, 31
    s_waitcnt vmcnt(38)
    v_mfma_f32_16x16x32_bf16 v[120:123], v[40:43], v[8:11], 0
    v_mfma_f32_16x16x32_bf16 v[128:131], v[104:107], v[8:11], 0
    v_mfma_f32_16x16x32_bf16 v[120:123], v[44:47], v[12:15], v[120:123]
    v_mfma_f32_16x16x32_bf16 v[132:135], v[104:107], v[12:15], 0
    v_mfma_f32_16x16x32_bf16 v[120:123], v[48:51], v[16:19], v[120:123]
    v_mfma_f32_16x16x32_bf16 v[128:131], v[108:111], v[16:19], v[128:131]
    v_mfma_f32_16x16x32_bf16 v[120:123], v[52:55], v[20:23], v[120:123]
    v_mfma_f32_16x16x32_bf16 v[132:135], v[108:111], v[20:23], v[132:135]
    s_nop 7
    v_mov_b32 v184, v132
    v_mov_b32 v185, v133
    v_mov_b32 v186, v134
    v_mov_b32 v187, v135
    v_permlane32_swap_b32 v132, v184
    v_permlane32_swap_b32 v133, v185
    v_permlane32_swap_b32 v134, v186
    v_permlane32_swap_b32 v135, v187
    v_add_f32 v128, v128, v184
    v_add_f32 v129, v129, v185
    v_add_f32 v130, v130, v186
    v_add_f32 v131, v131, v187
    v_cmp_lt_u32 vcc, 31, v0
    s_nop 1
    v_cndmask_b32 v128, v128, v193, vcc
    v_cndmask_b32 v129, v129, v193, vcc
    v_cndmask_b32 v130, v130, v193, vcc
    v_cndmask_b32 v131, v131, v193, vcc
    v_cmp_gt_i32 vcc, 0, v192
    s_nop 1
    v_cndmask_b32 v120, v120, v193, vcc
    v_cmp_gt_i32 vcc, 1, v192
    s_nop 1
    v_cndmask_b32 v121, v121, v193, vcc
    v_cmp_gt_i32 vcc, 2, v192
    s_nop 1
    v_cndmask_b32 v122, v122, v193, vcc
    v_cmp_gt_i32 vcc, 3, v192
    s_nop 1
    v_cndmask_b32 v123, v123, v193, vcc
    v_max3_f32 v184, v120, v121, v122
    v_max3_f32 v184, v184, v123, v128
    v_max3_f32 v184, v184, v129, v130
    v_max_f32 v184, v184, v131
    v_mov_b32 v185, v184
    s_nop 1
    v_permlane16_swap_b32 v184, v185
    v_max_f32 v184, v184, v185
    v_mov_b32 v185, v184
    s_nop 1
    v_permlane32_swap_b32 v184, v185
    v_max_f32 v184, v184, v185
    v_mul_f32 v184, s50, v184
    v_fma_f32 v120, v120, s50, -v184
    v_fma_f32 v121, v121, s50, -v184
    v_fma_f32 v122, v122, s50, -v184
    v_fma_f32 v123, v123, s50, -v184
    v_fma_f32 v128, v128, s50, -v184
    v_fma_f32 v129, v129, s50, -v184
    v_fma_f32 v130, v130, s50, -v184
    v_fma_f32 v131, v131, s50, -v184
    v_exp_f32 v120, v120
    v_exp_f32 v121, v121
    v_exp_f32 v122, v122
    v_exp_f32 v123, v123
    v_exp_f32 v128, v128
    v_exp_f32 v129, v129
    v_exp_f32 v130, v130
    v_exp_f32 v131, v131
    v_cvt_pk_bf16_f32 v136, v120, v121
    v_cvt_pk_bf16_f32 v137, v122, v123
    v_mov_b32 v138, 0
    v_mov_b32 v139, 0
    v_cvt_pk_bf16_f32 v140, v128, v129
    v_cvt_pk_bf16_f32 v141, v130, v131
    v_mov_b32 v186, v140
    v_mov_b32 v187, v141
    v_mov_b32 v142, 0
    v_mov_b32 v143, 0
    s_nop 0
    v_permlane32_swap_b32 v142, v186
    v_permlane32_swap_b32 v143, v187
    s_waitcnt vmcnt(28)
    v_mfma_f32_16x16x32_bf16 v[144:147], v[148:151], v[136:139], 0
    v_mfma_f32_16x16x32_bf16 v[152:155], v[72:75], v[136:139], 0
    v_mfma_f32_16x16x32_bf16 v[156:159], v[76:79], v[136:139], 0
    v_mfma_f32_16x16x32_bf16 v[160:163], v[80:83], v[136:139], 0
    v_mfma_f32_16x16x32_bf16 v[164:167], v[84:87], v[136:139], 0
    v_mfma_f32_16x16x32_bf16 v[168:171], v[88:91], v[136:139], 0
    v_mfma_f32_16x16x32_bf16 v[172:175], v[92:95], v[136:139], 0
    v_mfma_f32_16x16x32_bf16 v[176:179], v[96:99], v[136:139], 0
    v_mfma_f32_16x16x32_bf16 v[180:183], v[100:103], v[136:139], 0
    v_mfma_f32_16x16x16_bf16 v[144:147], v[148:149], v[140:141], v[144:147]
    v_mfma_f32_16x16x16_bf16 v[152:155], v[112:113], v[140:141], v[152:155]
    v_mfma_f32_16x16x16_bf16 v[156:159], v[114:115], v[140:141], v[156:159]
    v_mfma_f32_16x16x16_bf16 v[160:163], v[112:113], v[142:143], v[160:163]
    v_mfma_f32_16x16x16_bf16 v[164:167], v[114:115], v[142:143], v[164:167]
    v_mfma_f32_16x16x16_bf16 v[168:171], v[116:117], v[140:141], v[168:171]
    v_mfma_f32_16x16x16_bf16 v[172:175], v[118:119], v[140:141], v[172:175]
    v_mfma_f32_16x16x16_bf16 v[176:179], v[116:117], v[142:143], v[176:179]
    v_mfma_f32_16x16x16_bf16 v[180:183], v[118:119], v[142:143], v[180:183]
    v_rcp_f32 v184, v144
    s_lshl_b32 s48, s10, 19
    s_lshl_b32 s49, s9, 1
    s_add_u32 s49, s49, 0
    s_lshl_b32 s49, s49, 10
    s_add_u32 s48, s48, s49
    s_add_u32 s40, s6, s48
    s_addc_u32 s41, s7, 0
    s_add_u32 s40, s40, 67108864
    s_addc_u32 s41, s41, 0
    v_mul_f32 v152, v152, v184
    v_mul_f32 v153, v153, v184
    v_mul_f32 v154, v154, v184
    v_mul_f32 v155, v155, v184
    v_cvt_pk_bf16_f32 v8, v152, v153
    v_cvt_pk_bf16_f32 v9, v154, v155
    v_mul_f32 v156, v156, v184
    v_mul_f32 v157, v157, v184
    v_mul_f32 v158, v158, v184
    v_mul_f32 v159, v159, v184
    v_cvt_pk_bf16_f32 v10, v156, v157
    v_cvt_pk_bf16_f32 v11, v158, v159
    s_nop 0
    v_permlane16_swap_b32 v8, v10
    v_permlane16_swap_b32 v9, v11
    global_store_dwordx4 v195, v[8:11], s[40:41] sc1
    s_add_u32 s40, s40, 131072
    s_addc_u32 s41, s41, 0
    v_mul_f32 v160, v160, v184
    v_mul_f32 v161, v161, v184
    v_mul_f32 v162, v162, v184
    v_mul_f32 v163, v163, v184
    v_cvt_pk_bf16_f32 v12, v160, v161
    v_cvt_pk_bf16_f32 v13, v162, v163
    v_mul_f32 v164, v164, v184
    v_mul_f32 v165, v165, v184
    v_mul_f32 v166, v166, v184
    v_mul_f32 v167, v167, v184
    v_cvt_pk_bf16_f32 v14, v164, v165
    v_cvt_pk_bf16_f32 v15, v166, v167
    s_nop 0
    v_permlane16_swap_b32 v12, v14
    v_permlane16_swap_b32 v13, v15
    global_store_dwordx4 v195, v[12:15], s[40:41] sc1
    s_add_u32 s40, s40, 131072
    s_addc_u32 s41, s41, 0
    v_mul_f32 v168, v168, v184
    v_mul_f32 v169, v169, v184
    v_mul_f32 v170, v170, v184
    v_mul_f32 v171, v171, v184
    v_cvt_pk_bf16_f32 v16, v168, v169
    v_cvt_pk_bf16_f32 v17, v170, v171
    v_mul_f32 v172, v172, v184
    v_mul_f32 v173, v173, v184
    v_mul_f32 v174, v174, v184
    v_mul_f32 v175, v175, v184
    v_cvt_pk_bf16_f32 v18, v172, v173
    v_cvt_pk_bf16_f32 v19, v174, v175
    s_nop 0
    v_permlane16_swap_b32 v16, v18
    v_permlane16_swap_b32 v17, v19
    global_store_dwordx4 v195, v[16:19], s[40:41] sc1
    s_add_u32 s40, s40, 131072
    s_addc_u32 s41, s41, 0
    v_mul_f32 v176, v176, v184
    v_mul_f32 v177, v177, v184
    v_mul_f32 v178, v178, v184
    v_mul_f32 v179, v179, v184
    v_cvt_pk_bf16_f32 v20, v176, v177
    v_cvt_pk_bf16_f32 v21, v178, v179
    v_mul_f32 v180, v180, v184
    v_mul_f32 v181, v181, v184
    v_mul_f32 v182, v182, v184
    v_mul_f32 v183, v183, v184
    v_cvt_pk_bf16_f32 v22, v180, v181
    v_cvt_pk_bf16_f32 v23, v182, v183
    s_nop 0
    v_permlane16_swap_b32 v20, v22
    v_permlane16_swap_b32 v21, v23
    global_store_dwordx4 v195, v[20:23], s[40:41] sc1
    v_mfma_f32_16x16x32_bf16 v[120:123], v[40:43], v[24:27], 0
    v_mfma_f32_16x16x32_bf16 v[124:127], v[56:59], v[24:27], 0
    v_mfma_f32_16x16x32_bf16 v[128:131], v[104:107], v[24:27], 0
    v_mfma_f32_16x16x32_bf16 v[120:123], v[44:47], v[28:31], v[120:123]
    v_mfma_f32_16x16x32_bf16 v[124:127], v[60:63], v[28:31], v[124:127]
    v_mfma_f32_16x16x32_bf16 v[132:135], v[104:107], v[28:31], 0
    v_mfma_f32_16x16x32_bf16 v[120:123], v[48:51], v[32:35], v[120:123]
    v_mfma_f32_16x16x32_bf16 v[124:127], v[64:67], v[32:35], v[124:127]
    v_mfma_f32_16x16x32_bf16 v[128:131], v[108:111], v[32:35], v[128:131]
    v_mfma_f32_16x16x32_bf16 v[120:123], v[52:55], v[36:39], v[120:123]
    v_mfma_f32_16x16x32_bf16 v[124:127], v[68:71], v[36:39], v[124:127]
    v_mfma_f32_16x16x32_bf16 v[132:135], v[108:111], v[36:39], v[132:135]
    s_nop 7
    v_mov_b32 v184, v132
    v_mov_b32 v185, v133
    v_mov_b32 v186, v134
    v_mov_b32 v187, v135
    v_permlane32_swap_b32 v132, v184
    v_permlane32_swap_b32 v133, v185
    v_permlane32_swap_b32 v134, v186
    v_permlane32_swap_b32 v135, v187
    v_add_f32 v128, v128, v184
    v_add_f32 v129, v129, v185
    v_add_f32 v130, v130, v186
    v_add_f32 v131, v131, v187
    v_cmp_lt_u32 vcc, 31, v0
    s_nop 1
    v_cndmask_b32 v128, v128, v193, vcc
    v_cndmask_b32 v129, v129, v193, vcc
    v_cndmask_b32 v130, v130, v193, vcc
    v_cndmask_b32 v131, v131, v193, vcc
    v_cmp_gt_i32 vcc, 0, v192
    s_nop 1
    v_cndmask_b32 v124, v124, v193, vcc
    v_cmp_gt_i32 vcc, 1, v192
    s_nop 1
    v_cndmask_b32 v125, v125, v193, vcc
    v_cmp_gt_i32 vcc, 2, v192
    s_nop 1
    v_cndmask_b32 v126, v126, v193, vcc
    v_cmp_gt_i32 vcc, 3, v192
    s_nop 1
    v_cndmask_b32 v127, v127, v193, vcc
    v_max3_f32 v184, v120, v121, v122
    v_max3_f32 v184, v184, v123, v124
    v_max3_f32 v184, v184, v125, v126
    v_max3_f32 v184, v184, v127, v128
    v_max3_f32 v184, v184, v129, v130
    v_max_f32 v184, v184, v131
    v_mov_b32 v185, v184
    s_nop 1
    v_permlane16_swap_b32 v184, v185
    v_max_f32 v184, v184, v185
    v_mov_b32 v185, v184
    s_nop 1
    v_permlane32_swap_b32 v184, v185
    v_max_f32 v184, v184, v185
    v_mul_f32 v184, s50, v184
    v_fma_f32 v120, v120, s50, -v184
    v_fma_f32 v121, v121, s50, -v184
    v_fma_f32 v122, v122, s50, -v184
    v_fma_f32 v123, v123, s50, -v184
    v_fma_f32 v124, v124, s50, -v184
    v_fma_f32 v125, v125, s50, -v184
    v_fma_f32 v126, v126, s50, -v184
    v_fma_f32 v127, v127, s50, -v184
    v_fma_f32 v128, v128, s50, -v184
    v_fma_f32 v129, v129, s50, -v184
    v_fma_f32 v130, v130, s50, -v184
    v_fma_f32 v131, v131, s50, -v184
    v_exp_f32 v120, v120
    v_exp_f32 v121, v121
    v_exp_f32 v122, v122
    v_exp_f32 v123, v123
    v_exp_f32 v124, v124
    v_exp_f32 v125, v125
    v_exp_f32 v126, v126
    v_exp_f32 v127, v127
    v_exp_f32 v128, v128
    v_exp_f32 v129, v129
    v_exp_f32 v130, v130
    v_exp_f32 v131, v131
    v_cvt_pk_bf16_f32 v136, v120, v121
    v_cvt_pk_bf16_f32 v137, v122, v123
    v_cvt_pk_bf16_f32 v138, v124, v125
    v_cvt_pk_bf16_f32 v139, v126, v127
    v_cvt_pk_bf16_f32 v140, v128, v129
    v_cvt_pk_bf16_f32 v141, v130, v131
    v_mov_b32 v186, v140
    v_mov_b32 v187, v141
    v_mov_b32 v142, 0
    v_mov_b32 v143, 0
    s_nop 0
    v_permlane32_swap_b32 v142, v186
    v_permlane32_swap_b32 v143, v187
    v_mfma_f32_16x16x32_bf16 v[144:147], v[148:151], v[136:139], 0
    v_mfma_f32_16x16x32_bf16 v[152:155], v[72:75], v[136:139], 0
    v_mfma_f32_16x16x32_bf16 v[156:159], v[76:79], v[136:139], 0
    v_mfma_f32_16x16x32_bf16 v[160:163], v[80:83], v[136:139], 0
    v_mfma_f32_16x16x32_bf16 v[164:167], v[84:87], v[136:139], 0
    v_mfma_f32_16x16x32_bf16 v[168:171], v[88:91], v[136:139], 0
    v_mfma_f32_16x16x32_bf16 v[172:175], v[92:95], v[136:139], 0
    v_mfma_f32_16x16x32_bf16 v[176:179], v[96:99], v[136:139], 0
    v_mfma_f32_16x16x32_bf16 v[180:183], v[100:103], v[136:139], 0
    v_mfma_f32_16x16x16_bf16 v[144:147], v[148:149], v[140:141], v[144:147]
    v_mfma_f32_16x16x16_bf16 v[152:155], v[112:113], v[140:141], v[152:155]
    v_mfma_f32_16x16x16_bf16 v[156:159], v[114:115], v[140:141], v[156:159]
    v_mfma_f32_16x16x16_bf16 v[160:163], v[112:113], v[142:143], v[160:163]
    v_mfma_f32_16x16x16_bf16 v[164:167], v[114:115], v[142:143], v[164:167]
    v_mfma_f32_16x16x16_bf16 v[168:171], v[116:117], v[140:141], v[168:171]
    v_mfma_f32_16x16x16_bf16 v[172:175], v[118:119], v[140:141], v[172:175]
    v_mfma_f32_16x16x16_bf16 v[176:179], v[116:117], v[142:143], v[176:179]
    v_mfma_f32_16x16x16_bf16 v[180:183], v[118:119], v[142:143], v[180:183]
    v_rcp_f32 v184, v144
    s_lshl_b32 s48, s10, 19
    s_lshl_b32 s49, s9, 1
    s_add_u32 s49, s49, 1
    s_lshl_b32 s49, s49, 10
    s_add_u32 s48, s48, s49
    s_add_u32 s40, s6, s48
    s_addc_u32 s41, s7, 0
    s_add_u32 s40, s40, 67108864
    s_addc_u32 s41, s41, 0
    v_mul_f32 v152, v152, v184
    v_mul_f32 v153, v153, v184
    v_mul_f32 v154, v154, v184
    v_mul_f32 v155, v155, v184
    v_cvt_pk_bf16_f32 v24, v152, v153
    v_cvt_pk_bf16_f32 v25, v154, v155
    v_mul_f32 v156, v156, v184
    v_mul_f32 v157, v157, v184
    v_mul_f32 v158, v158, v184
    v_mul_f32 v159, v159, v184
    v_cvt_pk_bf16_f32 v26, v156, v157
    v_cvt_pk_bf16_f32 v27, v158, v159
    s_nop 0
    v_permlane16_swap_b32 v24, v26
    v_permlane16_swap_b32 v25, v27
    global_store_dwordx4 v195, v[24:27], s[40:41] sc1
    s_add_u32 s40, s40, 131072
    s_addc_u32 s41, s41, 0
    v_mul_f32 v160, v160, v184
    v_mul_f32 v161, v161, v184
    v_mul_f32 v162, v162, v184
    v_mul_f32 v163, v163, v184
    v_cvt_pk_bf16_f32 v28, v160, v161
    v_cvt_pk_bf16_f32 v29, v162, v163
    v_mul_f32 v164, v164, v184
    v_mul_f32 v165, v165, v184
    v_mul_f32 v166, v166, v184
    v_mul_f32 v167, v167, v184
    v_cvt_pk_bf16_f32 v30, v164, v165
    v_cvt_pk_bf16_f32 v31, v166, v167
    s_nop 0
    v_permlane16_swap_b32 v28, v30
    v_permlane16_swap_b32 v29, v31
    global_store_dwordx4 v195, v[28:31], s[40:41] sc1
    s_add_u32 s40, s40, 131072
    s_addc_u32 s41, s41, 0
    v_mul_f32 v168, v168, v184
    v_mul_f32 v169, v169, v184
    v_mul_f32 v170, v170, v184
    v_mul_f32 v171, v171, v184
    v_cvt_pk_bf16_f32 v32, v168, v169
    v_cvt_pk_bf16_f32 v33, v170, v171
    v_mul_f32 v172, v172, v184
    v_mul_f32 v173, v173, v184
    v_mul_f32 v174, v174, v184
    v_mul_f32 v175, v175, v184
    v_cvt_pk_bf16_f32 v34, v172, v173
    v_cvt_pk_bf16_f32 v35, v174, v175
    s_nop 0
    v_permlane16_swap_b32 v32, v34
    v_permlane16_swap_b32 v33, v35
    global_store_dwordx4 v195, v[32:35], s[40:41] sc1
    s_add_u32 s40, s40, 131072
    s_addc_u32 s41, s41, 0
    v_mul_f32 v176, v176, v184
    v_mul_f32 v177, v177, v184
    v_mul_f32 v178, v178, v184
    v_mul_f32 v179, v179, v184
    v_cvt_pk_bf16_f32 v36, v176, v177
    v_cvt_pk_bf16_f32 v37, v178, v179
    v_mul_f32 v180, v180, v184
    v_mul_f32 v181, v181, v184
    v_mul_f32 v182, v182, v184
    v_mul_f32 v183, v183, v184
    v_cvt_pk_bf16_f32 v38, v180, v181
    v_cvt_pk_bf16_f32 v39, v182, v183
    s_nop 0
    v_permlane16_swap_b32 v36, v38
    v_permlane16_swap_b32 v37, v39
    global_store_dwordx4 v195, v[36:39], s[40:41] sc1
    s_add_u32 s48, s8, 1
    s_lshr_b32 s9, s48, 5
    s_and_b32 s10, s48, 31
    s_waitcnt vmcnt(18)
    v_mfma_f32_16x16x32_bf16 v[120:123], a[32:35], a[0:3], 0
    v_mfma_f32_16x16x32_bf16 v[128:131], a[96:99], a[0:3], 0
    v_mfma_f32_16x16x32_bf16 v[120:123], a[36:39], a[4:7], v[120:123]
    v_mfma_f32_16x16x32_bf16 v[132:135], a[96:99], a[4:7], 0
    v_mfma_f32_16x16x32_bf16 v[120:123], a[40:43], a[8:11], v[120:123]
    v_mfma_f32_16x16x32_bf16 v[128:131], a[100:103], a[8:11], v[128:131]
    v_mfma_f32_16x16x32_bf16 v[120:123], a[44:47], a[12:15], v[120:123]
    v_mfma_f32_16x16x32_bf16 v[132:135], a[100:103], a[12:15], v[132:135]
    s_nop 7
    v_mov_b32 v184, v132
    v_mov_b32 v185, v133
    v_mov_b32 v186, v134
    v_mov_b32 v187, v135
    v_permlane32_swap_b32 v132, v184
    v_permlane32_swap_b32 v133, v185
    v_permlane32_swap_b32 v134, v186
    v_permlane32_swap_b32 v135, v187
    v_add_f32 v128, v128, v184
    v_add_f32 v129, v129, v185
    v_add_f32 v130, v130, v186
    v_add_f32 v131, v131, v187
    v_cmp_lt_u32 vcc, 31, v0
    s_nop 1
    v_cndmask_b32 v128, v128, v193, vcc
    v_cndmask_b32 v129, v129, v193, vcc
    v_cndmask_b32 v130, v130, v193, vcc
    v_cndmask_b32 v131, v131, v193, vcc
    v_cmp_gt_i32 vcc, 0, v192
    s_nop 1
    v_cndmask_b32 v120, v120, v193, vcc
    v_cmp_gt_i32 vcc, 1, v192
    s_nop 1
    v_cndmask_b32 v121, v121, v193, vcc
    v_cmp_gt_i32 vcc, 2, v192
    s_nop 1
    v_cndmask_b32 v122, v122, v193, vcc
    v_cmp_gt_i32 vcc, 3, v192
    s_nop 1
    v_cndmask_b32 v123, v123, v193, vcc
    v_max3_f32 v184, v120, v121, v122
    v_max3_f32 v184, v184, v123, v128
    v_max3_f32 v184, v184, v129, v130
    v_max_f32 v184, v184, v131
    v_mov_b32 v185, v184
    s_nop 1
    v_permlane16_swap_b32 v184, v185
    v_max_f32 v184, v184, v185
    v_mov_b32 v185, v184
    s_nop 1
    v_permlane32_swap_b32 v184, v185
    v_max_f32 v184, v184, v185
    v_mul_f32 v184, s50, v184
    v_fma_f32 v120, v120, s50, -v184
    v_fma_f32 v121, v121, s50, -v184
    v_fma_f32 v122, v122, s50, -v184
    v_fma_f32 v123, v123, s50, -v184
    v_fma_f32 v128, v128, s50, -v184
    v_fma_f32 v129, v129, s50, -v184
    v_fma_f32 v130, v130, s50, -v184
    v_fma_f32 v131, v131, s50, -v184
    v_exp_f32 v120, v120
    v_exp_f32 v121, v121
    v_exp_f32 v122, v122
    v_exp_f32 v123, v123
    v_exp_f32 v128, v128
    v_exp_f32 v129, v129
    v_exp_f32 v130, v130
    v_exp_f32 v131, v131
    v_cvt_pk_bf16_f32 v136, v120, v121
    v_cvt_pk_bf16_f32 v137, v122, v123
    v_mov_b32 v138, 0
    v_mov_b32 v139, 0
    v_cvt_pk_bf16_f32 v140, v128, v129
    v_cvt_pk_bf16_f32 v141, v130, v131
    v_mov_b32 v186, v140
    v_mov_b32 v187, v141
    v_mov_b32 v142, 0
    v_mov_b32 v143, 0
    s_nop 0
    v_permlane32_swap_b32 v142, v186
    v_permlane32_swap_b32 v143, v187
    s_waitcnt vmcnt(4)
    v_mfma_f32_16x16x32_bf16 v[144:147], v[148:151], v[136:139], 0
    v_mfma_f32_16x16x32_bf16 v[152:155], a[64:67], v[136:139], 0
    v_mfma_f32_16x16x32_bf16 v[156:159], a[68:71], v[136:139], 0
    v_mfma_f32_16x16x32_bf16 v[160:163], a[72:75], v[136:139], 0
    v_mfma_f32_16x16x32_bf16 v[164:167], a[76:79], v[136:139], 0
    v_mfma_f32_16x16x32_bf16 v[168:171], a[80:83], v[136:139], 0
    v_mfma_f32_16x16x32_bf16 v[172:175], a[84:87], v[136:139], 0
    v_mfma_f32_16x16x32_bf16 v[176:179], a[88:91], v[136:139], 0
    v_mfma_f32_16x16x32_bf16 v[180:183], a[92:95], v[136:139], 0
    v_mfma_f32_16x16x16_bf16 v[144:147], v[148:149], v[140:141], v[144:147]
    v_mfma_f32_16x16x16_bf16 v[152:155], a[104:105], v[140:141], v[152:155]
    v_mfma_f32_16x16x16_bf16 v[156:159], a[106:107], v[140:141], v[156:159]
    v_mfma_f32_16x16x16_bf16 v[160:163], a[104:105], v[142:143], v[160:163]
    v_mfma_f32_16x16x16_bf16 v[164:167], a[106:107], v[142:143], v[164:167]
    v_mfma_f32_16x16x16_bf16 v[168:171], a[108:109], v[140:141], v[168:171]
    v_mfma_f32_16x16x16_bf16 v[172:175], a[110:111], v[140:141], v[172:175]
    v_mfma_f32_16x16x16_bf16 v[176:179], a[108:109], v[142:143], v[176:179]
    v_mfma_f32_16x16x16_bf16 v[180:183], a[110:111], v[142:143], v[180:183]
    v_rcp_f32 v184, v144
    s_lshl_b32 s48, s10, 19
    s_lshl_b32 s49, s9, 1
    s_add_u32 s49, s49, 0
    s_lshl_b32 s49, s49, 10
    s_add_u32 s48, s48, s49
    s_add_u32 s40, s6, s48
    s_addc_u32 s41, s7, 0
    s_add_u32 s40, s40, 67108864
    s_addc_u32 s41, s41, 0
    v_mul_f32 v152, v152, v184
    v_mul_f32 v153, v153, v184
    v_mul_f32 v154, v154, v184
    v_mul_f32 v155, v155, v184
    v_cvt_pk_bf16_f32 v8, v152, v153
    v_cvt_pk_bf16_f32 v9, v154, v155
    v_mul_f32 v156, v156, v184
    v_mul_f32 v157, v157, v184
    v_mul_f32 v158, v158, v184
    v_mul_f32 v159, v159, v184
    v_cvt_pk_bf16_f32 v10, v156, v157
    v_cvt_pk_bf16_f32 v11, v158, v159
    s_nop 0
    v_permlane16_swap_b32 v8, v10
    v_permlane16_swap_b32 v9, v11
    global_store_dwordx4 v195, v[8:11], s[40:41] sc1
    s_add_u32 s40, s40, 131072
    s_addc_u32 s41, s41, 0
    v_mul_f32 v160, v160, v184
    v_mul_f32 v161, v161, v184
    v_mul_f32 v162, v162, v184
    v_mul_f32 v163, v163, v184
    v_cvt_pk_bf16_f32 v12, v160, v161
    v_cvt_pk_bf16_f32 v13, v162, v163
    v_mul_f32 v164, v164, v184
    v_mul_f32 v165, v165, v184
    v_mul_f32 v166, v166, v184
    v_mul_f32 v167, v167, v184
    v_cvt_pk_bf16_f32 v14, v164, v165
    v_cvt_pk_bf16_f32 v15, v166, v167
    s_nop 0
    v_permlane16_swap_b32 v12, v14
    v_permlane16_swap_b32 v13, v15
    global_store_dwordx4 v195, v[12:15], s[40:41] sc1
    s_add_u32 s40, s40, 131072
    s_addc_u32 s41, s41, 0
    v_mul_f32 v168, v168, v184
    v_mul_f32 v169, v169, v184
    v_mul_f32 v170, v170, v184
    v_mul_f32 v171, v171, v184
    v_cvt_pk_bf16_f32 v16, v168, v169
    v_cvt_pk_bf16_f32 v17, v170, v171
    v_mul_f32 v172, v172, v184
    v_mul_f32 v173, v173, v184
    v_mul_f32 v174, v174, v184
    v_mul_f32 v175, v175, v184
    v_cvt_pk_bf16_f32 v18, v172, v173
    v_cvt_pk_bf16_f32 v19, v174, v175
    s_nop 0
    v_permlane16_swap_b32 v16, v18
    v_permlane16_swap_b32 v17, v19
    global_store_dwordx4 v195, v[16:19], s[40:41] sc1
    s_add_u32 s40, s40, 131072
    s_addc_u32 s41, s41, 0
    v_mul_f32 v176, v176, v184
    v_mul_f32 v177, v177, v184
    v_mul_f32 v178, v178, v184
    v_mul_f32 v179, v179, v184
    v_cvt_pk_bf16_f32 v20, v176, v177
    v_cvt_pk_bf16_f32 v21, v178, v179
    v_mul_f32 v180, v180, v184
    v_mul_f32 v181, v181, v184
    v_mul_f32 v182, v182, v184
    v_mul_f32 v183, v183, v184
    v_cvt_pk_bf16_f32 v22, v180, v181
    v_cvt_pk_bf16_f32 v23, v182, v183
    s_nop 0
    v_permlane16_swap_b32 v20, v22
    v_permlane16_swap_b32 v21, v23
    global_store_dwordx4 v195, v[20:23], s[40:41] sc1
    v_mfma_f32_16x16x32_bf16 v[120:123], a[32:35], a[16:19], 0
    v_mfma_f32_16x16x32_bf16 v[124:127], a[48:51], a[16:19], 0
    v_mfma_f32_16x16x32_bf16 v[128:131], a[96:99], a[16:19], 0
    v_mfma_f32_16x16x32_bf16 v[120:123], a[36:39], a[20:23], v[120:123]
    v_mfma_f32_16x16x32_bf16 v[124:127], a[52:55], a[20:23], v[124:127]
    v_mfma_f32_16x16x32_bf16 v[132:135], a[96:99], a[20:23], 0
    v_mfma_f32_16x16x32_bf16 v[120:123], a[40:43], a[24:27], v[120:123]
    v_mfma_f32_16x16x32_bf16 v[124:127], a[56:59], a[24:27], v[124:127]
    v_mfma_f32_16x16x32_bf16 v[128:131], a[100:103], a[24:27], v[128:131]
    v_mfma_f32_16x16x32_bf16 v[120:123], a[44:47], a[28:31], v[120:123]
    v_mfma_f32_16x16x32_bf16 v[124:127], a[60:63], a[28:31], v[124:127]
    v_mfma_f32_16x16x32_bf16 v[132:135], a[100:103], a[28:31], v[132:135]
    s_nop 7
    v_mov_b32 v184, v132
    v_mov_b32 v185, v133
    v_mov_b32 v186, v134
    v_mov_b32 v187, v135
    v_permlane32_swap_b32 v132, v184
    v_permlane32_swap_b32 v133, v185
    v_permlane32_swap_b32 v134, v186
    v_permlane32_swap_b32 v135, v187
    v_add_f32 v128, v128, v184
    v_add_f32 v129, v129, v185
    v_add_f32 v130, v130, v186
    v_add_f32 v131, v131, v187
    v_cmp_lt_u32 vcc, 31, v0
    s_nop 1
    v_cndmask_b32 v128, v128, v193, vcc
    v_cndmask_b32 v129, v129, v193, vcc
    v_cndmask_b32 v130, v130, v193, vcc
    v_cndmask_b32 v131, v131, v193, vcc
    v_cmp_gt_i32 vcc, 0, v192
    s_nop 1
    v_cndmask_b32 v124, v124, v193, vcc
    v_cmp_gt_i32 vcc, 1, v192
    s_nop 1
    v_cndmask_b32 v125, v125, v193, vcc
    v_cmp_gt_i32 vcc, 2, v192
    s_nop 1
    v_cndmask_b32 v126, v126, v193, vcc
    v_cmp_gt_i32 vcc, 3, v192
    s_nop 1
    v_cndmask_b32 v127, v127, v193, vcc
    v_max3_f32 v184, v120, v121, v122
    v_max3_f32 v184, v184, v123, v124
    v_max3_f32 v184, v184, v125, v126
    v_max3_f32 v184, v184, v127, v128
    v_max3_f32 v184, v184, v129, v130
    v_max_f32 v184, v184, v131
    v_mov_b32 v185, v184
    s_nop 1
    v_permlane16_swap_b32 v184, v185
    v_max_f32 v184, v184, v185
    v_mov_b32 v185, v184
    s_nop 1
    v_permlane32_swap_b32 v184, v185
    v_max_f32 v184, v184, v185
    v_mul_f32 v184, s50, v184
    v_fma_f32 v120, v120, s50, -v184
    v_fma_f32 v121, v121, s50, -v184
    v_fma_f32 v122, v122, s50, -v184
    v_fma_f32 v123, v123, s50, -v184
    v_fma_f32 v124, v124, s50, -v184
    v_fma_f32 v125, v125, s50, -v184
    v_fma_f32 v126, v126, s50, -v184
    v_fma_f32 v127, v127, s50, -v184
    v_fma_f32 v128, v128, s50, -v184
    v_fma_f32 v129, v129, s50, -v184
    v_fma_f32 v130, v130, s50, -v184
    v_fma_f32 v131, v131, s50, -v184
    v_exp_f32 v120, v120
    v_exp_f32 v121, v121
    v_exp_f32 v122, v122
    v_exp_f32 v123, v123
    v_exp_f32 v124, v124
    v_exp_f32 v125, v125
    v_exp_f32 v126, v126
    v_exp_f32 v127, v127
    v_exp_f32 v128, v128
    v_exp_f32 v129, v129
    v_exp_f32 v130, v130
    v_exp_f32 v131, v131
    v_cvt_pk_bf16_f32 v136, v120, v121
    v_cvt_pk_bf16_f32 v137, v122, v123
    v_cvt_pk_bf16_f32 v138, v124, v125
    v_cvt_pk_bf16_f32 v139, v126, v127
    v_cvt_pk_bf16_f32 v140, v128, v129
    v_cvt_pk_bf16_f32 v141, v130, v131
    v_mov_b32 v186, v140
    v_mov_b32 v187, v141
    v_mov_b32 v142, 0
    v_mov_b32 v143, 0
    s_nop 0
    v_permlane32_swap_b32 v142, v186
    v_permlane32_swap_b32 v143, v187
    v_mfma_f32_16x16x32_bf16 v[144:147], v[148:151], v[136:139], 0
    v_mfma_f32_16x16x32_bf16 v[152:155], a[64:67], v[136:139], 0
    v_mfma_f32_16x16x32_bf16 v[156:159], a[68:71], v[136:139], 0
    v_mfma_f32_16x16x32_bf16 v[160:163], a[72:75], v[136:139], 0
    v_mfma_f32_16x16x32_bf16 v[164:167], a[76:79], v[136:139], 0
    v_mfma_f32_16x16x32_bf16 v[168:171], a[80:83], v[136:139], 0
    v_mfma_f32_16x16x32_bf16 v[172:175], a[84:87], v[136:139], 0
    v_mfma_f32_16x16x32_bf16 v[176:179], a[88:91], v[136:139], 0
    v_mfma_f32_16x16x32_bf16 v[180:183], a[92:95], v[136:139], 0
    v_mfma_f32_16x16x16_bf16 v[144:147], v[148:149], v[140:141], v[144:147]
    v_mfma_f32_16x16x16_bf16 v[152:155], a[104:105], v[140:141], v[152:155]
    v_mfma_f32_16x16x16_bf16 v[156:159], a[106:107], v[140:141], v[156:159]
    v_mfma_f32_16x16x16_bf16 v[160:163], a[104:105], v[142:143], v[160:163]
    v_mfma_f32_16x16x16_bf16 v[164:167], a[106:107], v[142:143], v[164:167]
    v_mfma_f32_16x16x16_bf16 v[168:171], a[108:109], v[140:141], v[168:171]
    v_mfma_f32_16x16x16_bf16 v[172:175], a[110:111], v[140:141], v[172:175]
    v_mfma_f32_16x16x16_bf16 v[176:179], a[108:109], v[142:143], v[176:179]
    v_mfma_f32_16x16x16_bf16 v[180:183], a[110:111], v[142:143], v[180:183]
    v_rcp_f32 v184, v144
    s_lshl_b32 s48, s10, 19
    s_lshl_b32 s49, s9, 1
    s_add_u32 s49, s49, 1
    s_lshl_b32 s49, s49, 10
    s_add_u32 s48, s48, s49
    s_add_u32 s40, s6, s48
    s_addc_u32 s41, s7, 0
    s_add_u32 s40, s40, 67108864
    s_addc_u32 s41, s41, 0
    v_mul_f32 v152, v152, v184
    v_mul_f32 v153, v153, v184
    v_mul_f32 v154, v154, v184
    v_mul_f32 v155, v155, v184
    v_cvt_pk_bf16_f32 v24, v152, v153
    v_cvt_pk_bf16_f32 v25, v154, v155
    v_mul_f32 v156, v156, v184
    v_mul_f32 v157, v157, v184
    v_mul_f32 v158, v158, v184
    v_mul_f32 v159, v159, v184
    v_cvt_pk_bf16_f32 v26, v156, v157
    v_cvt_pk_bf16_f32 v27, v158, v159
    s_nop 0
    v_permlane16_swap_b32 v24, v26
    v_permlane16_swap_b32 v25, v27
    global_store_dwordx4 v195, v[24:27], s[40:41] sc1
    s_add_u32 s40, s40, 131072
    s_addc_u32 s41, s41, 0
    v_mul_f32 v160, v160, v184
    v_mul_f32 v161, v161, v184
    v_mul_f32 v162, v162, v184
    v_mul_f32 v163, v163, v184
    v_cvt_pk_bf16_f32 v28, v160, v161
    v_cvt_pk_bf16_f32 v29, v162, v163
    v_mul_f32 v164, v164, v184
    v_mul_f32 v165, v165, v184
    v_mul_f32 v166, v166, v184
    v_mul_f32 v167, v167, v184
    v_cvt_pk_bf16_f32 v30, v164, v165
    v_cvt_pk_bf16_f32 v31, v166, v167
    s_nop 0
    v_permlane16_swap_b32 v28, v30
    v_permlane16_swap_b32 v29, v31
    global_store_dwordx4 v195, v[28:31], s[40:41] sc1
    s_add_u32 s40, s40, 131072
    s_addc_u32 s41, s41, 0
    v_mul_f32 v168, v168, v184
    v_mul_f32 v169, v169, v184
    v_mul_f32 v170, v170, v184
    v_mul_f32 v171, v171, v184
    v_cvt_pk_bf16_f32 v32, v168, v169
    v_cvt_pk_bf16_f32 v33, v170, v171
    v_mul_f32 v172, v172, v184
    v_mul_f32 v173, v173, v184
    v_mul_f32 v174, v174, v184
    v_mul_f32 v175, v175, v184
    v_cvt_pk_bf16_f32 v34, v172, v173
    v_cvt_pk_bf16_f32 v35, v174, v175
    s_nop 0
    v_permlane16_swap_b32 v32, v34
    v_permlane16_swap_b32 v33, v35
    global_store_dwordx4 v195, v[32:35], s[40:41] sc1
    s_add_u32 s40, s40, 131072
    s_addc_u32 s41, s41, 0
    v_mul_f32 v176, v176, v184
    v_mul_f32 v177, v177, v184
    v_mul_f32 v178, v178, v184
    v_mul_f32 v179, v179, v184
    v_cvt_pk_bf16_f32 v36, v176, v177
    v_cvt_pk_bf16_f32 v37, v178, v179
    v_mul_f32 v180, v180, v184
    v_mul_f32 v181, v181, v184
    v_mul_f32 v182, v182, v184
    v_mul_f32 v183, v183, v184
    v_cvt_pk_bf16_f32 v38, v180, v181
    v_cvt_pk_bf16_f32 v39, v182, v183
    s_nop 0
    v_permlane16_swap_b32 v36, v38
    v_permlane16_swap_b32 v37, v39
    global_store_dwordx4 v195, v[36:39], s[40:41] sc1
    s_waitcnt vmcnt(0)
    s_add_u32 s48, s6, 130023424
    s_addc_u32 s49, s7, 0
    s_lshr_b32 s25, s8, 7
    s_lshl_b32 s25, s25, 1
    s_bfe_u32 s26, s8, 0x10004
    s_add_u32 s25, s25, s26
    s_lshl_b32 s25, s25, 7
    s_add_u32 s25, s25, 167936
    v_mov_b32 v14, s25
    v_mov_b32 v15, 2
    s_mov_b64 exec, 1
    global_atomic_add v14, v15, s[48:49]
    s_mov_b64 exec, -1
    s_add_u32 s8, s52, 0
    s_addc_u32 s9, s53, 0
    s_and_b32 s9, s9, 0xffff
    s_mov_b32 s10, 8388608
    s_mov_b32 s11, 0x00020000
    s_add_u32 s12, s6, 67108864
    s_addc_u32 s13, s7, 0
    s_and_b32 s13, s13, 0xffff
    s_mov_b32 s14, 16777216
    s_mov_b32 s15, 0x00020000
    s_and_b32 s25, s2, 7
    s_lshr_b32 s26, s2, 3
    s_and_b32 s56, s25, 1
    s_lshr_b32 s4, s25, 2
    s_lshl_b32 s4, s4, 2
    s_and_b32 s27, s26, 3
    s_add_u32 s4, s4, s27
    s_bfe_u32 s5, s25, 0x10001
    s_lshl_b32 s5, s5, 3
    s_lshr_b32 s27, s26, 2
    s_add_u32 s5, s5, s27
    s_lshl_b32 s57, s5, 3
    s_add_u32 s57, s57, s4
    s_lshl_b32 s20, s4, 8
    s_lshl_b32 s25, s56, 22
    s_add_u32 s20, s20, s25
    s_lshl_b32 s21, s5, 13
    s_lshl_b32 s25, s56, 23
    s_add_u32 s21, s21, s25
    s_add_u32 s25, s56, 1
    s_lshl_b32 s14, s25, 23
    s_mul_i32 s22, s3, 2048
    s_mul_i32 s23, s3, 2048
    v_and_b32 v1, 15, v0
    v_lshrrev_b32 v2, 4, v0
    v_lshrrev_b32 v3, 2, v1
    v_and_b32 v4, 1, v2
    v_lshrrev_b32 v5, 1, v2
    v_lshl_add_u32 v6, v2, 3, v3
    v_lshl_or_b32 v3, v4, 2, v3
    v_lshlrev_b32 v6, 8, v6
    v_and_b32 v4, 3, v1
    v_lshl_add_u32 v6, v4, 3, v6
    s_and_b32 s25, s3, 1
    s_mul_i32 s25, s25, 4
    s_add_u32 s26, s25, 0
    v_xor_b32 v4, s26, v3
    v_lshl_add_u32 v8, v4, 5, v6
    s_add_u32 s26, s25, 1
    v_xor_b32 v4, s26, v3
    v_lshl_add_u32 v9, v4, 5, v6
    s_add_u32 s26, s25, 2
    v_xor_b32 v4, s26, v3
    v_lshl_add_u32 v10, v4, 5, v6
    s_add_u32 s26, s25, 3
    v_xor_b32 v4, s26, v3
    v_lshl_add_u32 v11, v4, 5, v6
    v_lshrrev_b32 v3, 2, v1
    v_lshrrev_b32 v4, 1, v3
    v_and_b32 v5, 1, v3
    v_xor_b32 v5, v5, v4
    v_lshl_or_b32 v5, v5, 1, v4
    v_xor_b32 v5, v5, v2
    v_lshlrev_b32 v5, 4, v5
    v_lshl_add_u32 v5, v1, 6, v5
    s_lshr_b32 s25, s3, 1
    s_mul_i32 s25, s25, 4096
    s_add_u32 s25, s25, 8192
    v_add_u32 v12, s25, v5
    v_lshrrev_b32 v3, 4, v0
    v_and_b32 v4, 15, v0
    s_and_b32 s25, s3, 1
    s_lshl_b32 s26, s25, 3
    v_add_u32 v5, s26, v3
    s_lshr_b32 s26, s3, 1
    s_lshl_b32 s26, s26, 4
    v_add_u32 v5, s26, v5
    s_lshl_b32 s25, s25, 2
    v_or_b32 v6, s25, v3
    v_lshrrev_b32 v1, 1, v4
    v_xor_b32 v1, v1, v6
    v_lshlrev_b32 v1, 5, v1
    v_and_b32 v4, 1, v4
    v_lshl_or_b32 v1, v4, 4, v1
    s_mov_b32 s25, 2048
    v_mul_lo_u32 v5, v5, s25
    v_add_u32 v13, v5, v1
    v_add_u32 v14, 8192, v13
    v_lshlrev_b32 v3, 4, v0
    s_mul_i32 s25, s3, 2048
    v_add_u32 v15, s25, v3
    v_add_u32 v16, 1024, v15
    v_add_u32 v148, 65536, v8
    v_add_u32 v149, 65536, v9
    v_add_u32 v150, 65536, v10
    v_add_u32 v151, 65536, v11
    v_add_u32 v152, 65536, v12
    s_mov_b32 s35, s20
    s_add_u32 m0, s22, 0
    s_nop 0
    buffer_load_dwordx4 v13, s[8:11], s20 offen lds
    s_add_u32 m0, s22, 1024
    s_nop 0
    buffer_load_dwordx4 v14, s[8:11], s20 offen lds
    s_add_u32 s20, s20, 65536
    s_add_u32 m0, s22, 16384
    s_nop 0
    buffer_load_dwordx4 v13, s[8:11], s20 offen lds
    s_add_u32 m0, s22, 17408
    s_nop 0
    buffer_load_dwordx4 v14, s[8:11], s20 offen lds
    s_add_u32 s20, s20, 65536
    s_add_u32 m0, s22, 32768
    s_nop 0
    buffer_load_dwordx4 v13, s[8:11], s20 offen lds
    s_add_u32 m0, s22, 33792
    s_nop 0
    buffer_load_dwordx4 v14, s[8:11], s20 offen lds
    s_add_u32 s20, s20, 65536
    s_add_u32 m0, s22, 49152
    s_nop 0
    buffer_load_dwordx4 v13, s[8:11], s20 offen lds
    s_add_u32 m0, s22, 50176
    s_nop 0
    buffer_load_dwordx4 v14, s[8:11], s20 offen lds
    s_add_u32 s20, s20, 65536
    s_add_u32 m0, s22, 65536
    s_nop 0
    buffer_load_dwordx4 v13, s[8:11], s20 offen lds
    s_add_u32 m0, s22, 66560
    s_nop 0
    buffer_load_dwordx4 v14, s[8:11], s20 offen lds
    s_add_u32 s20, s20, 65536
    s_add_u32 m0, s22, 81920
    s_nop 0
    buffer_load_dwordx4 v13, s[8:11], s20 offen lds
    s_add_u32 m0, s22, 82944
    s_nop 0
    buffer_load_dwordx4 v14, s[8:11], s20 offen lds
    s_add_u32 s20, s20, 65536
    s_add_u32 m0, s22, 98304
    s_nop 0
    buffer_load_dwordx4 v13, s[8:11], s20 offen lds
    s_add_u32 m0, s22, 99328
    s_nop 0
    buffer_load_dwordx4 v14, s[8:11], s20 offen lds
    s_add_u32 s20, s20, 65536
    s_lshl_b32 s58, s5, 1
    s_add_u32 s58, s58, s56
    s_lshl_b32 s58, s58, 7
    s_add_u32 s58, s58, 167936
    s_add_u32 s48, s6, 130023424
    s_addc_u32 s49, s7, 0
    s_cmp_lg_u32 s3, 0
    s_cbranch_scc1 L_opln_aw_b
    v_mov_b32 v2, s58
    s_mov_b32 s50, 0x200000
L_opln_aw:
    global_load_dword v3, v2, s[48:49] sc1
    s_waitcnt vmcnt(0)
    v_readfirstlane_b32 s44, v3
    s_nop 0
    s_cmp_ge_u32 s44, 64
    s_cbranch_scc1 L_opln_aw_ok
    s_sleep 5
    s_sub_u32 s50, s50, 1
    s_cbranch_scc0 L_opln_aw
L_opln_aw_ok:
L_opln_aw_b:
    s_barrier
    s_add_u32 m0, s23, 8192
    s_nop 0
    buffer_load_dwordx4 v15, s[12:15], s21 offen lds
    s_add_u32 m0, s23, 9216
    s_nop 0
    buffer_load_dwordx4 v16, s[12:15], s21 offen lds
    s_add_u32 s21, s21, 131072
    s_add_u32 m0, s23, 24576
    s_nop 0
    buffer_load_dwordx4 v15, s[12:15], s21 offen lds
    s_add_u32 m0, s23, 25600
    s_nop 0
    buffer_load_dwordx4 v16, s[12:15], s21 offen lds
    s_add_u32 s21, s21, 131072
    s_add_u32 m0, s23, 40960
    s_nop 0
    buffer_load_dwordx4 v15, s[12:15], s21 offen lds
    s_add_u32 m0, s23, 41984
    s_nop 0
    buffer_load_dwordx4 v16, s[12:15], s21 offen lds
    s_add_u32 s21, s21, 131072
    s_add_u32 m0, s23, 57344
    s_nop 0
    buffer_load_dwordx4 v15, s[12:15], s21 offen lds
    s_add_u32 m0, s23, 58368
    s_nop 0
    buffer_load_dwordx4 v16, s[12:15], s21 offen lds
    s_add_u32 s21, s21, 131072
    s_add_u32 m0, s23, 73728
    s_nop 0
    buffer_load_dwordx4 v15, s[12:15], s21 offen lds
    s_add_u32 m0, s23, 74752
    s_nop 0
    buffer_load_dwordx4 v16, s[12:15], s21 offen lds
    s_add_u32 s21, s21, 131072
    s_add_u32 m0, s23, 90112
    s_nop 0
    buffer_load_dwordx4 v15, s[12:15], s21 offen lds
    s_add_u32 m0, s23, 91136
    s_nop 0
    buffer_load_dwordx4 v16, s[12:15], s21 offen lds
    s_add_u32 s21, s21, 131072
    s_add_u32 m0, s23, 106496
    s_nop 0
    buffer_load_dwordx4 v15, s[12:15], s21 offen lds
    s_add_u32 m0, s23, 107520
    s_nop 0
    buffer_load_dwordx4 v16, s[12:15], s21 offen lds
    s_add_u32 s21, s21, 131072
    s_waitcnt vmcnt(10)
    s_barrier
    ds_read_b128 v[36:39], v12 offset:0
    ds_read_b64_tr_b16 v[20:21], v8 offset:0
    ds_read_b64_tr_b16 v[22:23], v8 offset:1024
    ds_read_b128 v[40:43], v12 offset:1024
    ds_read_b64_tr_b16 v[24:25], v9 offset:0
    ds_read_b64_tr_b16 v[26:27], v9 offset:1024
    ds_read_b128 v[44:47], v12 offset:2048
    ds_read_b64_tr_b16 v[28:29], v10 offset:0
    ds_read_b64_tr_b16 v[30:31], v10 offset:1024
    ds_read_b128 v[48:51], v12 offset:3072
    ds_read_b64_tr_b16 v[32:33], v11 offset:0
    ds_read_b64_tr_b16 v[34:35], v11 offset:1024
    ds_read_b128 v[68:71], v12 offset:16384
    ds_read_b64_tr_b16 v[52:53], v8 offset:16384
    ds_read_b64_tr_b16 v[54:55], v8 offset:17408
    ds_read_b128 v[72:75], v12 offset:17408
    ds_read_b64_tr_b16 v[56:57], v9 offset:16384
    ds_read_b64_tr_b16 v[58:59], v9 offset:17408
    ds_read_b128 v[76:79], v12 offset:18432
    ds_read_b64_tr_b16 v[60:61], v10 offset:16384
    ds_read_b64_tr_b16 v[62:63], v10 offset:17408
    ds_read_b128 v[80:83], v12 offset:19456
    ds_read_b64_tr_b16 v[64:65], v11 offset:16384
    ds_read_b64_tr_b16 v[66:67], v11 offset:17408
    s_waitcnt vmcnt(6) lgkmcnt(12)
    s_barrier
    v_mfma_f32_16x16x32_bf16 a[0:3], v[20:23], v[36:39], 0
    ds_read_b128 v[100:103], v12 offset:32768
    s_add_u32 m0, s22, 114688
    v_mfma_f32_16x16x32_bf16 a[16:19], v[24:27], v[36:39], 0
    buffer_load_dwordx4 v13, s[8:11], s20 offen lds
    ds_read_b64_tr_b16 v[84:85], v8 offset:32768
    v_mfma_f32_16x16x32_bf16 a[32:35], v[28:31], v[36:39], 0
    ds_read_b64_tr_b16 v[86:87], v8 offset:33792
    v_mfma_f32_16x16x32_bf16 a[48:51], v[32:35], v[36:39], 0
    v_mfma_f32_16x16x32_bf16 a[4:7], v[20:23], v[40:43], 0
    ds_read_b128 v[104:107], v12 offset:33792
    s_add_u32 m0, s22, 115712
    v_mfma_f32_16x16x32_bf16 a[20:23], v[24:27], v[40:43], 0
    buffer_load_dwordx4 v14, s[8:11], s20 offen lds
    ds_read_b64_tr_b16 v[88:89], v9 offset:32768
    v_mfma_f32_16x16x32_bf16 a[36:39], v[28:31], v[40:43], 0
    ds_read_b64_tr_b16 v[90:91], v9 offset:33792
    v_mfma_f32_16x16x32_bf16 a[52:55], v[32:35], v[40:43], 0
    v_mfma_f32_16x16x32_bf16 a[8:11], v[20:23], v[44:47], 0
    ds_read_b128 v[108:111], v12 offset:34816
    s_add_u32 m0, s23, 122880
    v_mfma_f32_16x16x32_bf16 a[24:27], v[24:27], v[44:47], 0
    buffer_load_dwordx4 v15, s[12:15], s21 offen lds
    ds_read_b64_tr_b16 v[92:93], v10 offset:32768
    v_mfma_f32_16x16x32_bf16 a[40:43], v[28:31], v[44:47], 0
    ds_read_b64_tr_b16 v[94:95], v10 offset:33792
    v_mfma_f32_16x16x32_bf16 a[56:59], v[32:35], v[44:47], 0
    v_mfma_f32_16x16x32_bf16 a[12:15], v[20:23], v[48:51], 0
    ds_read_b128 v[112:115], v12 offset:35840
    s_add_u32 m0, s23, 123904
    v_mfma_f32_16x16x32_bf16 a[28:31], v[24:27], v[48:51], 0
    buffer_load_dwordx4 v16, s[12:15], s21 offen lds
    ds_read_b64_tr_b16 v[96:97], v11 offset:32768
    v_mfma_f32_16x16x32_bf16 a[44:47], v[28:31], v[48:51], 0
    ds_read_b64_tr_b16 v[98:99], v11 offset:33792
    v_mfma_f32_16x16x32_bf16 a[60:63], v[32:35], v[48:51], 0
    s_add_u32 s20, s20, 65536
    s_add_u32 s21, s21, 131072
    s_waitcnt lgkmcnt(12)
    v_mfma_f32_16x16x32_bf16 a[0:3], v[52:55], v[68:71], a[0:3]
    ds_read_b128 v[132:135], v12 offset:49152
    s_add_u32 m0, s22, 0
    v_mfma_f32_16x16x32_bf16 a[16:19], v[56:59], v[68:71], a[16:19]
    buffer_load_dwordx4 v13, s[8:11], s20 offen lds
    ds_read_b64_tr_b16 v[116:117], v8 offset:49152
    v_mfma_f32_16x16x32_bf16 a[32:35], v[60:63], v[68:71], a[32:35]
    ds_read_b64_tr_b16 v[118:119], v8 offset:50176
    v_mfma_f32_16x16x32_bf16 a[48:51], v[64:67], v[68:71], a[48:51]
    v_mfma_f32_16x16x32_bf16 a[4:7], v[52:55], v[72:75], a[4:7]
    ds_read_b128 v[136:139], v12 offset:50176
    s_add_u32 m0, s22, 1024
    v_mfma_f32_16x16x32_bf16 a[20:23], v[56:59], v[72:75], a[20:23]
    buffer_load_dwordx4 v14, s[8:11], s20 offen lds
    ds_read_b64_tr_b16 v[120:121], v9 offset:49152
    v_mfma_f32_16x16x32_bf16 a[36:39], v[60:63], v[72:75], a[36:39]
    ds_read_b64_tr_b16 v[122:123], v9 offset:50176
    v_mfma_f32_16x16x32_bf16 a[52:55], v[64:67], v[72:75], a[52:55]
    v_mfma_f32_16x16x32_bf16 a[8:11], v[52:55], v[76:79], a[8:11]
    ds_read_b128 v[140:143], v12 offset:51200
    s_add_u32 m0, s23, 8192
    v_mfma_f32_16x16x32_bf16 a[24:27], v[56:59], v[76:79], a[24:27]
    buffer_load_dwordx4 v15, s[12:15], s21 offen lds
    ds_read_b64_tr_b16 v[124:125], v10 offset:49152
    v_mfma_f32_16x16x32_bf16 a[40:43], v[60:63], v[76:79], a[40:43]
    ds_read_b64_tr_b16 v[126:127], v10 offset:50176
    v_mfma_f32_16x16x32_bf16 a[56:59], v[64:67], v[76:79], a[56:59]
    v_mfma_f32_16x16x32_bf16 a[12:15], v[52:55], v[80:83], a[12:15]
    ds_read_b128 v[144:147], v12 offset:52224
    s_add_u32 m0, s23, 9216
    v_mfma_f32_16x16x32_bf16 a[28:31], v[56:59], v[80:83], a[28:31]
    buffer_load_dwordx4 v16, s[12:15], s21 offen lds
    ds_read_b64_tr_b16 v[128:129], v11 offset:49152
    v_mfma_f32_16x16x32_bf16 a[44:47], v[60:63], v[80:83], a[44:47]
    ds_read_b64_tr_b16 v[130:131], v11 offset:50176
    v_mfma_f32_16x16x32_bf16 a[60:63], v[64:67], v[80:83], a[60:63]
    s_add_u32 s20, s20, 65536
    s_add_u32 s21, s21, 131072
    s_waitcnt vmcnt(10) lgkmcnt(12)
    s_barrier
    v_mfma_f32_16x16x32_bf16 a[0:3], v[84:87], v[100:103], a[0:3]
    ds_read_b128 v[36:39], v152 offset:0
    s_add_u32 m0, s22, 16384
    v_mfma_f32_16x16x32_bf16 a[16:19], v[88:91], v[100:103], a[16:19]
    buffer_load_dwordx4 v13, s[8:11], s20 offen lds
    ds_read_b64_tr_b16 v[20:21], v148 offset:0
    v_mfma_f32_16x16x32_bf16 a[32:35], v[92:95], v[100:103], a[32:35]
    ds_read_b64_tr_b16 v[22:23], v148 offset:1024
    v_mfma_f32_16x16x32_bf16 a[48:51], v[96:99], v[100:103], a[48:51]
    v_mfma_f32_16x16x32_bf16 a[4:7], v[84:87], v[104:107], a[4:7]
    ds_read_b128 v[40:43], v152 offset:1024
    s_add_u32 m0, s22, 17408
    v_mfma_f32_16x16x32_bf16 a[20:23], v[88:91], v[104:107], a[20:23]
    buffer_load_dwordx4 v14, s[8:11], s20 offen lds
    ds_read_b64_tr_b16 v[24:25], v149 offset:0
    v_mfma_f32_16x16x32_bf16 a[36:39], v[92:95], v[104:107], a[36:39]
    ds_read_b64_tr_b16 v[26:27], v149 offset:1024
    v_mfma_f32_16x16x32_bf16 a[52:55], v[96:99], v[104:107], a[52:55]
    v_mfma_f32_16x16x32_bf16 a[8:11], v[84:87], v[108:111], a[8:11]
    ds_read_b128 v[44:47], v152 offset:2048
    s_add_u32 m0, s23, 24576
    v_mfma_f32_16x16x32_bf16 a[24:27], v[88:91], v[108:111], a[24:27]
    buffer_load_dwordx4 v15, s[12:15], s21 offen lds
    ds_read_b64_tr_b16 v[28:29], v150 offset:0
    v_mfma_f32_16x16x32_bf16 a[40:43], v[92:95], v[108:111], a[40:43]
    ds_read_b64_tr_b16 v[30:31], v150 offset:1024
    v_mfma_f32_16x16x32_bf16 a[56:59], v[96:99], v[108:111], a[56:59]
    v_mfma_f32_16x16x32_bf16 a[12:15], v[84:87], v[112:115], a[12:15]
    ds_read_b128 v[48:51], v152 offset:3072
    s_add_u32 m0, s23, 25600
    v_mfma_f32_16x16x32_bf16 a[28:31], v[88:91], v[112:115], a[28:31]
    buffer_load_dwordx4 v16, s[12:15], s21 offen lds
    ds_read_b64_tr_b16 v[32:33], v151 offset:0
    v_mfma_f32_16x16x32_bf16 a[44:47], v[92:95], v[112:115], a[44:47]
    ds_read_b64_tr_b16 v[34:35], v151 offset:1024
    v_mfma_f32_16x16x32_bf16 a[60:63], v[96:99], v[112:115], a[60:63]
    s_add_u32 s20, s20, 65536
    s_add_u32 s21, s21, 131072
    s_waitcnt lgkmcnt(12)
    v_mfma_f32_16x16x32_bf16 a[0:3], v[116:119], v[132:135], a[0:3]
    ds_read_b128 v[68:71], v152 offset:16384
    s_add_u32 m0, s22, 32768
    v_mfma_f32_16x16x32_bf16 a[16:19], v[120:123], v[132:135], a[16:19]
    buffer_load_dwordx4 v13, s[8:11], s20 offen lds
    ds_read_b64_tr_b16 v[52:53], v148 offset:16384
    v_mfma_f32_16x16x32_bf16 a[32:35], v[124:127], v[132:135], a[32:35]
    ds_read_b64_tr_b16 v[54:55], v148 offset:17408
    v_mfma_f32_16x16x32_bf16 a[48:51], v[128:131], v[132:135], a[48:51]
    v_mfma_f32_16x16x32_bf16 a[4:7], v[116:119], v[136:139], a[4:7]
    ds_read_b128 v[72:75], v152 offset:17408
    s_add_u32 m0, s22, 33792
    v_mfma_f32_16x16x32_bf16 a[20:23], v[120:123], v[136:139], a[20:23]
    buffer_load_dwordx4 v14, s[8:11], s20 offen lds
    ds_read_b64_tr_b16 v[56:57], v149 offset:16384
    v_mfma_f32_16x16x32_bf16 a[36:39], v[124:127], v[136:139], a[36:39]
    ds_read_b64_tr_b16 v[58:59], v149 offset:17408
    v_mfma_f32_16x16x32_bf16 a[52:55], v[128:131], v[136:139], a[52:55]
    v_mfma_f32_16x16x32_bf16 a[8:11], v[116:119], v[140:143], a[8:11]
    ds_read_b128 v[76:79], v152 offset:18432
    s_add_u32 m0, s23, 40960
    v_mfma_f32_16x16x32_bf16 a[24:27], v[120:123], v[140:143], a[24:27]
    buffer_load_dwordx4 v15, s[12:15], s21 offen lds
    ds_read_b64_tr_b16 v[60:61], v150 offset:16384
    v_mfma_f32_16x16x32_bf16 a[40:43], v[124:127], v[140:143], a[40:43]
    ds_read_b64_tr_b16 v[62:63], v150 offset:17408
    v_mfma_f32_16x16x32_bf16 a[56:59], v[128:131], v[140:143], a[56:59]
    v_mfma_f32_16x16x32_bf16 a[12:15], v[116:119], v[144:147], a[12:15]
    ds_read_b128 v[80:83], v152 offset:19456
    s_add_u32 m0, s23, 41984
    v_mfma_f32_16x16x32_bf16 a[28:31], v[120:123], v[144:147], a[28:31]
    buffer_load_dwordx4 v16, s[12:15], s21 offen lds
    ds_read_b64_tr_b16 v[64:65], v151 offset:16384
    v_mfma_f32_16x16x32_bf16 a[44:47], v[124:127], v[144:147], a[44:47]
    ds_read_b64_tr_b16 v[66:67], v151 offset:17408
    v_mfma_f32_16x16x32_bf16 a[60:63], v[128:131], v[144:147], a[60:63]
    s_add_u32 s20, s20, 65536
    s_add_u32 s21, s21, 131072
    s_waitcnt vmcnt(12) lgkmcnt(12)
    s_barrier
    v_mfma_f32_16x16x32_bf16 a[0:3], v[20:23], v[36:39], a[0:3]
    ds_read_b128 v[100:103], v152 offset:32768
    s_add_u32 m0, s22, 49152
    v_mfma_f32_16x16x32_bf16 a[16:19], v[24:27], v[36:39], a[16:19]
    buffer_load_dwordx4 v13, s[8:11], s20 offen lds
    ds_read_b64_tr_b16 v[84:85], v148 offset:32768
    v_mfma_f32_16x16x32_bf16 a[32:35], v[28:31], v[36:39], a[32:35]
    ds_read_b64_tr_b16 v[86:87], v148 offset:33792
    v_mfma_f32_16x16x32_bf16 a[48:51], v[32:35], v[36:39], a[48:51]
    v_mfma_f32_16x16x32_bf16 a[4:7], v[20:23], v[40:43], a[4:7]
    ds_read_b128 v[104:107], v152 offset:33792
    s_add_u32 m0, s22, 50176
    v_mfma_f32_16x16x32_bf16 a[20:23], v[24:27], v[40:43], a[20:23]
    buffer_load_dwordx4 v14, s[8:11], s20 offen lds
    ds_read_b64_tr_b16 v[88:89], v149 offset:32768
    v_mfma_f32_16x16x32_bf16 a[36:39], v[28:31], v[40:43], a[36:39]
    ds_read_b64_tr_b16 v[90:91], v149 offset:33792
    v_mfma_f32_16x16x32_bf16 a[52:55], v[32:35], v[40:43], a[52:55]
    v_mfma_f32_16x16x32_bf16 a[8:11], v[20:23], v[44:47], a[8:11]
    ds_read_b128 v[108:111], v152 offset:34816
    s_add_u32 m0, s23, 57344
    v_mfma_f32_16x16x32_bf16 a[24:27], v[24:27], v[44:47], a[24:27]
    buffer_load_dwordx4 v15, s[12:15], s21 offen lds
    ds_read_b64_tr_b16 v[92:93], v150 offset:32768
    v_mfma_f32_16x16x32_bf16 a[40:43], v[28:31], v[44:47], a[40:43]
    ds_read_b64_tr_b16 v[94:95], v150 offset:33792
    v_mfma_f32_16x16x32_bf16 a[56:59], v[32:35], v[44:47], a[56:59]
    v_mfma_f32_16x16x32_bf16 a[12:15], v[20:23], v[48:51], a[12:15]
    ds_read_b128 v[112:115], v152 offset:35840
    s_add_u32 m0, s23, 58368
    v_mfma_f32_16x16x32_bf16 a[28:31], v[24:27], v[48:51], a[28:31]
    buffer_load_dwordx4 v16, s[12:15], s21 offen lds
    ds_read_b64_tr_b16 v[96:97], v151 offset:32768
    v_mfma_f32_16x16x32_bf16 a[44:47], v[28:31], v[48:51], a[44:47]
    ds_read_b64_tr_b16 v[98:99], v151 offset:33792
    v_mfma_f32_16x16x32_bf16 a[60:63], v[32:35], v[48:51], a[60:63]
    s_add_u32 s20, s20, 65536
    s_add_u32 s21, s21, 131072
    s_waitcnt lgkmcnt(12)
    v_mfma_f32_16x16x32_bf16 a[0:3], v[52:55], v[68:71], a[0:3]
    ds_read_b128 v[132:135], v152 offset:49152
    s_add_u32 m0, s22, 65536
    v_mfma_f32_16x16x32_bf16 a[16:19], v[56:59], v[68:71], a[16:19]
    buffer_load_dwordx4 v13, s[8:11], s20 offen lds
    ds_read_b64_tr_b16 v[116:117], v148 offset:49152
    v_mfma_f32_16x16x32_bf16 a[32:35], v[60:63], v[68:71], a[32:35]
    ds_read_b64_tr_b16 v[118:119], v148 offset:50176
    v_mfma_f32_16x16x32_bf16 a[48:51], v[64:67], v[68:71], a[48:51]
    v_mfma_f32_16x16x32_bf16 a[4:7], v[52:55], v[72:75], a[4:7]
    ds_read_b128 v[136:139], v152 offset:50176
    s_add_u32 m0, s22, 66560
    v_mfma_f32_16x16x32_bf16 a[20:23], v[56:59], v[72:75], a[20:23]
    buffer_load_dwordx4 v14, s[8:11], s20 offen lds
    ds_read_b64_tr_b16 v[120:121], v149 offset:49152
    v_mfma_f32_16x16x32_bf16 a[36:39], v[60:63], v[72:75], a[36:39]
    ds_read_b64_tr_b16 v[122:123], v149 offset:50176
    v_mfma_f32_16x16x32_bf16 a[52:55], v[64:67], v[72:75], a[52:55]
    v_mfma_f32_16x16x32_bf16 a[8:11], v[52:55], v[76:79], a[8:11]
    ds_read_b128 v[140:143], v152 offset:51200
    s_add_u32 m0, s23, 73728
    v_mfma_f32_16x16x32_bf16 a[24:27], v[56:59], v[76:79], a[24:27]
    buffer_load_dwordx4 v15, s[12:15], s21 offen lds
    ds_read_b64_tr_b16 v[124:125], v150 offset:49152
    v_mfma_f32_16x16x32_bf16 a[40:43], v[60:63], v[76:79], a[40:43]
    ds_read_b64_tr_b16 v[126:127], v150 offset:50176
    v_mfma_f32_16x16x32_bf16 a[56:59], v[64:67], v[76:79], a[56:59]
    v_mfma_f32_16x16x32_bf16 a[12:15], v[52:55], v[80:83], a[12:15]
    ds_read_b128 v[144:147], v152 offset:52224
    s_add_u32 m0, s23, 74752
    v_mfma_f32_16x16x32_bf16 a[28:31], v[56:59], v[80:83], a[28:31]
    buffer_load_dwordx4 v16, s[12:15], s21 offen lds
    ds_read_b64_tr_b16 v[128:129], v151 offset:49152
    v_mfma_f32_16x16x32_bf16 a[44:47], v[60:63], v[80:83], a[44:47]
    ds_read_b64_tr_b16 v[130:131], v151 offset:50176
    v_mfma_f32_16x16x32_bf16 a[60:63], v[64:67], v[80:83], a[60:63]
    s_add_u32 s20, s20, 65536
    s_add_u32 s21, s21, 131072
    s_waitcnt vmcnt(12) lgkmcnt(12)
    s_barrier
    v_mfma_f32_16x16x32_bf16 a[0:3], v[84:87], v[100:103], a[0:3]
    ds_read_b128 v[36:39], v12 offset:0
    s_add_u32 m0, s22, 81920
    v_mfma_f32_16x16x32_bf16 a[16:19], v[88:91], v[100:103], a[16:19]
    buffer_load_dwordx4 v13, s[8:11], s20 offen lds
    ds_read_b64_tr_b16 v[20:21], v8 offset:0
    v_mfma_f32_16x16x32_bf16 a[32:35], v[92:95], v[100:103], a[32:35]
    ds_read_b64_tr_b16 v[22:23], v8 offset:1024
    v_mfma_f32_16x16x32_bf16 a[48:51], v[96:99], v[100:103], a[48:51]
    v_mfma_f32_16x16x32_bf16 a[4:7], v[84:87], v[104:107], a[4:7]
    ds_read_b128 v[40:43], v12 offset:1024
    s_add_u32 m0, s22, 82944
    v_mfma_f32_16x16x32_bf16 a[20:23], v[88:91], v[104:107], a[20:23]
    buffer_load_dwordx4 v14, s[8:11], s20 offen lds
    ds_read_b64_tr_b16 v[24:25], v9 offset:0
    v_mfma_f32_16x16x32_bf16 a[36:39], v[92:95], v[104:107], a[36:39]
    ds_read_b64_tr_b16 v[26:27], v9 offset:1024
    v_mfma_f32_16x16x32_bf16 a[52:55], v[96:99], v[104:107], a[52:55]
    v_mfma_f32_16x16x32_bf16 a[8:11], v[84:87], v[108:111], a[8:11]
    ds_read_b128 v[44:47], v12 offset:2048
    s_add_u32 m0, s23, 90112
    v_mfma_f32_16x16x32_bf16 a[24:27], v[88:91], v[108:111], a[24:27]
    buffer_load_dwordx4 v15, s[12:15], s21 offen lds
    ds_read_b64_tr_b16 v[28:29], v10 offset:0
    v_mfma_f32_16x16x32_bf16 a[40:43], v[92:95], v[108:111], a[40:43]
    ds_read_b64_tr_b16 v[30:31], v10 offset:1024
    v_mfma_f32_16x16x32_bf16 a[56:59], v[96:99], v[108:111], a[56:59]
    v_mfma_f32_16x16x32_bf16 a[12:15], v[84:87], v[112:115], a[12:15]
    ds_read_b128 v[48:51], v12 offset:3072
    s_add_u32 m0, s23, 91136
    v_mfma_f32_16x16x32_bf16 a[28:31], v[88:91], v[112:115], a[28:31]
    buffer_load_dwordx4 v16, s[12:15], s21 offen lds
    ds_read_b64_tr_b16 v[32:33], v11 offset:0
    v_mfma_f32_16x16x32_bf16 a[44:47], v[92:95], v[112:115], a[44:47]
    ds_read_b64_tr_b16 v[34:35], v11 offset:1024
    v_mfma_f32_16x16x32_bf16 a[60:63], v[96:99], v[112:115], a[60:63]
    s_add_u32 s20, s20, 65536
    s_add_u32 s21, s21, 131072
    s_waitcnt lgkmcnt(12)
    v_mfma_f32_16x16x32_bf16 a[0:3], v[116:119], v[132:135], a[0:3]
    ds_read_b128 v[68:71], v12 offset:16384
    s_add_u32 m0, s22, 98304
    v_mfma_f32_16x16x32_bf16 a[16:19], v[120:123], v[132:135], a[16:19]
    buffer_load_dwordx4 v13, s[8:11], s20 offen lds
    ds_read_b64_tr_b16 v[52:53], v8 offset:16384
    v_mfma_f32_16x16x32_bf16 a[32:35], v[124:127], v[132:135], a[32:35]
    ds_read_b64_tr_b16 v[54:55], v8 offset:17408
    v_mfma_f32_16x16x32_bf16 a[48:51], v[128:131], v[132:135], a[48:51]
    v_mfma_f32_16x16x32_bf16 a[4:7], v[116:119], v[136:139], a[4:7]
    ds_read_b128 v[72:75], v12 offset:17408
    s_add_u32 m0, s22, 99328
    v_mfma_f32_16x16x32_bf16 a[20:23], v[120:123], v[136:139], a[20:23]
    buffer_load_dwordx4 v14, s[8:11], s20 offen lds
    ds_read_b64_tr_b16 v[56:57], v9 offset:16384
    v_mfma_f32_16x16x32_bf16 a[36:39], v[124:127], v[136:139], a[36:39]
    ds_read_b64_tr_b16 v[58:59], v9 offset:17408
    v_mfma_f32_16x16x32_bf16 a[52:55], v[128:131], v[136:139], a[52:55]
    v_mfma_f32_16x16x32_bf16 a[8:11], v[116:119], v[140:143], a[8:11]
    ds_read_b128 v[76:79], v12 offset:18432
    s_add_u32 m0, s23, 106496
    v_mfma_f32_16x16x32_bf16 a[24:27], v[120:123], v[140:143], a[24:27]
    buffer_load_dwordx4 v15, s[12:15], s21 offen lds
    ds_read_b64_tr_b16 v[60:61], v10 offset:16384
    v_mfma_f32_16x16x32_bf16 a[40:43], v[124:127], v[140:143], a[40:43]
    ds_read_b64_tr_b16 v[62:63], v10 offset:17408
    v_mfma_f32_16x16x32_bf16 a[56:59], v[128:131], v[140:143], a[56:59]
    v_mfma_f32_16x16x32_bf16 a[12:15], v[116:119], v[144:147], a[12:15]
    ds_read_b128 v[80:83], v12 offset:19456
    s_add_u32 m0, s23, 107520
    v_mfma_f32_16x16x32_bf16 a[28:31], v[120:123], v[144:147], a[28:31]
    buffer_load_dwordx4 v16, s[12:15], s21 offen lds
    ds_read_b64_tr_b16 v[64:65], v11 offset:16384
    v_mfma_f32_16x16x32_bf16 a[44:47], v[124:127], v[144:147], a[44:47]
    ds_read_b64_tr_b16 v[66:67], v11 offset:17408
    v_mfma_f32_16x16x32_bf16 a[60:63], v[128:131], v[144:147], a[60:63]
    s_add_u32 s20, s20, 65536
    s_add_u32 s21, s21, 131072
    s_waitcnt vmcnt(12) lgkmcnt(12)
    s_barrier
    s_mov_b32 s24, 7
L_opln_loop:
    v_mfma_f32_16x16x32_bf16 a[0:3], v[20:23], v[36:39], a[0:3]
    ds_read_b128 v[100:103], v12 offset:32768
    s_add_u32 m0, s22, 114688
    v_mfma_f32_16x16x32_bf16 a[16:19], v[24:27], v[36:39], a[16:19]
    buffer_load_dwordx4 v13, s[8:11], s20 offen lds
    ds_read_b64_tr_b16 v[84:85], v8 offset:32768
    v_mfma_f32_16x16x32_bf16 a[32:35], v[28:31], v[36:39], a[32:35]
    ds_read_b64_tr_b16 v[86:87], v8 offset:33792
    v_mfma_f32_16x16x32_bf16 a[48:51], v[32:35], v[36:39], a[48:51]
    v_mfma_f32_16x16x32_bf16 a[4:7], v[20:23], v[40:43], a[4:7]
    ds_read_b128 v[104:107], v12 offset:33792
    s_add_u32 m0, s22, 115712
    v_mfma_f32_16x16x32_bf16 a[20:23], v[24:27], v[40:43], a[20:23]
    buffer_load_dwordx4 v14, s[8:11], s20 offen lds
    ds_read_b64_tr_b16 v[88:89], v9 offset:32768
    v_mfma_f32_16x16x32_bf16 a[36:39], v[28:31], v[40:43], a[36:39]
    ds_read_b64_tr_b16 v[90:91], v9 offset:33792
    v_mfma_f32_16x16x32_bf16 a[52:55], v[32:35], v[40:43], a[52:55]
    v_mfma_f32_16x16x32_bf16 a[8:11], v[20:23], v[44:47], a[8:11]
    ds_read_b128 v[108:111], v12 offset:34816
    s_add_u32 m0, s23, 122880
    v_mfma_f32_16x16x32_bf16 a[24:27], v[24:27], v[44:47], a[24:27]
    buffer_load_dwordx4 v15, s[12:15], s21 offen lds
    ds_read_b64_tr_b16 v[92:93], v10 offset:32768
    v_mfma_f32_16x16x32_bf16 a[40:43], v[28:31], v[44:47], a[40:43]
    ds_read_b64_tr_b16 v[94:95], v10 offset:33792
    v_mfma_f32_16x16x32_bf16 a[56:59], v[32:35], v[44:47], a[56:59]
    v_mfma_f32_16x16x32_bf16 a[12:15], v[20:23], v[48:51], a[12:15]
    ds_read_b128 v[112:115], v12 offset:35840
    s_add_u32 m0, s23, 123904
    v_mfma_f32_16x16x32_bf16 a[28:31], v[24:27], v[48:51], a[28:31]
    buffer_load_dwordx4 v16, s[12:15], s21 offen lds
    ds_read_b64_tr_b16 v[96:97], v11 offset:32768
    v_mfma_f32_16x16x32_bf16 a[44:47], v[28:31], v[48:51], a[44:47]
    ds_read_b64_tr_b16 v[98:99], v11 offset:33792
    v_mfma_f32_16x16x32_bf16 a[60:63], v[32:35], v[48:51], a[60:63]
    s_add_u32 s20, s20, 65536
    s_add_u32 s21, s21, 131072
    s_waitcnt lgkmcnt(12)
    v_mfma_f32_16x16x32_bf16 a[0:3], v[52:55], v[68:71], a[0:3]
    ds_read_b128 v[132:135], v12 offset:49152
    s_add_u32 m0, s22, 0
    v_mfma_f32_16x16x32_bf16 a[16:19], v[56:59], v[68:71], a[16:19]
    buffer_load_dwordx4 v13, s[8:11], s20 offen lds
    ds_read_b64_tr_b16 v[116:117], v8 offset:49152
    v_mfma_f32_16x16x32_bf16 a[32:35], v[60:63], v[68:71], a[32:35]
    ds_read_b64_tr_b16 v[118:119], v8 offset:50176
    v_mfma_f32_16x16x32_bf16 a[48:51], v[64:67], v[68:71], a[48:51]
    v_mfma_f32_16x16x32_bf16 a[4:7], v[52:55], v[72:75], a[4:7]
    ds_read_b128 v[136:139], v12 offset:50176
    s_add_u32 m0, s22, 1024
    v_mfma_f32_16x16x32_bf16 a[20:23], v[56:59], v[72:75], a[20:23]
    buffer_load_dwordx4 v14, s[8:11], s20 offen lds
    ds_read_b64_tr_b16 v[120:121], v9 offset:49152
    v_mfma_f32_16x16x32_bf16 a[36:39], v[60:63], v[72:75], a[36:39]
    ds_read_b64_tr_b16 v[122:123], v9 offset:50176
    v_mfma_f32_16x16x32_bf16 a[52:55], v[64:67], v[72:75], a[52:55]
    v_mfma_f32_16x16x32_bf16 a[8:11], v[52:55], v[76:79], a[8:11]
    ds_read_b128 v[140:143], v12 offset:51200
    s_add_u32 m0, s23, 8192
    v_mfma_f32_16x16x32_bf16 a[24:27], v[56:59], v[76:79], a[24:27]
    buffer_load_dwordx4 v15, s[12:15], s21 offen lds
    ds_read_b64_tr_b16 v[124:125], v10 offset:49152
    v_mfma_f32_16x16x32_bf16 a[40:43], v[60:63], v[76:79], a[40:43]
    ds_read_b64_tr_b16 v[126:127], v10 offset:50176
    v_mfma_f32_16x16x32_bf16 a[56:59], v[64:67], v[76:79], a[56:59]
    v_mfma_f32_16x16x32_bf16 a[12:15], v[52:55], v[80:83], a[12:15]
    ds_read_b128 v[144:147], v12 offset:52224
    s_add_u32 m0, s23, 9216
    v_mfma_f32_16x16x32_bf16 a[28:31], v[56:59], v[80:83], a[28:31]
    buffer_load_dwordx4 v16, s[12:15], s21 offen lds
    ds_read_b64_tr_b16 v[128:129], v11 offset:49152
    v_mfma_f32_16x16x32_bf16 a[44:47], v[60:63], v[80:83], a[44:47]
    ds_read_b64_tr_b16 v[130:131], v11 offset:50176
    v_mfma_f32_16x16x32_bf16 a[60:63], v[64:67], v[80:83], a[60:63]
    s_add_u32 s20, s20, 65536
    s_add_u32 s21, s21, 131072
    s_waitcnt vmcnt(12) lgkmcnt(12)
    s_barrier
    v_mfma_f32_16x16x32_bf16 a[0:3], v[84:87], v[100:103], a[0:3]
    ds_read_b128 v[36:39], v152 offset:0
    s_add_u32 m0, s22, 16384
    v_mfma_f32_16x16x32_bf16 a[16:19], v[88:91], v[100:103], a[16:19]
    buffer_load_dwordx4 v13, s[8:11], s20 offen lds
    ds_read_b64_tr_b16 v[20:21], v148 offset:0
    v_mfma_f32_16x16x32_bf16 a[32:35], v[92:95], v[100:103], a[32:35]
    ds_read_b64_tr_b16 v[22:23], v148 offset:1024
    v_mfma_f32_16x16x32_bf16 a[48:51], v[96:99], v[100:103], a[48:51]
    v_mfma_f32_16x16x32_bf16 a[4:7], v[84:87], v[104:107], a[4:7]
    ds_read_b128 v[40:43], v152 offset:1024
    s_add_u32 m0, s22, 17408
    v_mfma_f32_16x16x32_bf16 a[20:23], v[88:91], v[104:107], a[20:23]
    buffer_load_dwordx4 v14, s[8:11], s20 offen lds
    ds_read_b64_tr_b16 v[24:25], v149 offset:0
    v_mfma_f32_16x16x32_bf16 a[36:39], v[92:95], v[104:107], a[36:39]
    ds_read_b64_tr_b16 v[26:27], v149 offset:1024
    v_mfma_f32_16x16x32_bf16 a[52:55], v[96:99], v[104:107], a[52:55]
    v_mfma_f32_16x16x32_bf16 a[8:11], v[84:87], v[108:111], a[8:11]
    ds_read_b128 v[44:47], v152 offset:2048
    s_add_u32 m0, s23, 24576
    v_mfma_f32_16x16x32_bf16 a[24:27], v[88:91], v[108:111], a[24:27]
    buffer_load_dwordx4 v15, s[12:15], s21 offen lds
    ds_read_b64_tr_b16 v[28:29], v150 offset:0
    v_mfma_f32_16x16x32_bf16 a[40:43], v[92:95], v[108:111], a[40:43]
    ds_read_b64_tr_b16 v[30:31], v150 offset:1024
    v_mfma_f32_16x16x32_bf16 a[56:59], v[96:99], v[108:111], a[56:59]
    v_mfma_f32_16x16x32_bf16 a[12:15], v[84:87], v[112:115], a[12:15]
    ds_read_b128 v[48:51], v152 offset:3072
    s_add_u32 m0, s23, 25600
    v_mfma_f32_16x16x32_bf16 a[28:31], v[88:91], v[112:115], a[28:31]
    buffer_load_dwordx4 v16, s[12:15], s21 offen lds
    ds_read_b64_tr_b16 v[32:33], v151 offset:0
    v_mfma_f32_16x16x32_bf16 a[44:47], v[92:95], v[112:115], a[44:47]
    ds_read_b64_tr_b16 v[34:35], v151 offset:1024
    v_mfma_f32_16x16x32_bf16 a[60:63], v[96:99], v[112:115], a[60:63]
    s_add_u32 s20, s20, 65536
    s_add_u32 s21, s21, 131072
    s_waitcnt lgkmcnt(12)
    v_mfma_f32_16x16x32_bf16 a[0:3], v[116:119], v[132:135], a[0:3]
    ds_read_b128 v[68:71], v152 offset:16384
    s_add_u32 m0, s22, 32768
    v_mfma_f32_16x16x32_bf16 a[16:19], v[120:123], v[132:135], a[16:19]
    buffer_load_dwordx4 v13, s[8:11], s20 offen lds
    ds_read_b64_tr_b16 v[52:53], v148 offset:16384
    v_mfma_f32_16x16x32_bf16 a[32:35], v[124:127], v[132:135], a[32:35]
    ds_read_b64_tr_b16 v[54:55], v148 offset:17408
    v_mfma_f32_16x16x32_bf16 a[48:51], v[128:131], v[132:135], a[48:51]
    v_mfma_f32_16x16x32_bf16 a[4:7], v[116:119], v[136:139], a[4:7]
    ds_read_b128 v[72:75], v152 offset:17408
    s_add_u32 m0, s22, 33792
    v_mfma_f32_16x16x32_bf16 a[20:23], v[120:123], v[136:139], a[20:23]
    buffer_load_dwordx4 v14, s[8:11], s20 offen lds
    ds_read_b64_tr_b16 v[56:57], v149 offset:16384
    v_mfma_f32_16x16x32_bf16 a[36:39], v[124:127], v[136:139], a[36:39]
    ds_read_b64_tr_b16 v[58:59], v149 offset:17408
    v_mfma_f32_16x16x32_bf16 a[52:55], v[128:131], v[136:139], a[52:55]
    v_mfma_f32_16x16x32_bf16 a[8:11], v[116:119], v[140:143], a[8:11]
    ds_read_b128 v[76:79], v152 offset:18432
    s_add_u32 m0, s23, 40960
    v_mfma_f32_16x16x32_bf16 a[24:27], v[120:123], v[140:143], a[24:27]
    buffer_load_dwordx4 v15, s[12:15], s21 offen lds
    ds_read_b64_tr_b16 v[60:61], v150 offset:16384
    v_mfma_f32_16x16x32_bf16 a[40:43], v[124:127], v[140:143], a[40:43]
    ds_read_b64_tr_b16 v[62:63], v150 offset:17408
    v_mfma_f32_16x16x32_bf16 a[56:59], v[128:131], v[140:143], a[56:59]
    v_mfma_f32_16x16x32_bf16 a[12:15], v[116:119], v[144:147], a[12:15]
    ds_read_b128 v[80:83], v152 offset:19456
    s_add_u32 m0, s23, 41984
    v_mfma_f32_16x16x32_bf16 a[28:31], v[120:123], v[144:147], a[28:31]
    buffer_load_dwordx4 v16, s[12:15], s21 offen lds
    ds_read_b64_tr_b16 v[64:65], v151 offset:16384
    v_mfma_f32_16x16x32_bf16 a[44:47], v[124:127], v[144:147], a[44:47]
    ds_read_b64_tr_b16 v[66:67], v151 offset:17408
    v_mfma_f32_16x16x32_bf16 a[60:63], v[128:131], v[144:147], a[60:63]
    s_add_u32 s20, s20, 65536
    s_add_u32 s21, s21, 131072
    s_waitcnt vmcnt(12) lgkmcnt(12)
    s_barrier
    v_mfma_f32_16x16x32_bf16 a[0:3], v[20:23], v[36:39], a[0:3]
    ds_read_b128 v[100:103], v152 offset:32768
    s_add_u32 m0, s22, 49152
    v_mfma_f32_16x16x32_bf16 a[16:19], v[24:27], v[36:39], a[16:19]
    buffer_load_dwordx4 v13, s[8:11], s20 offen lds
    ds_read_b64_tr_b16 v[84:85], v148 offset:32768
    v_mfma_f32_16x16x32_bf16 a[32:35], v[28:31], v[36:39], a[32:35]
    ds_read_b64_tr_b16 v[86:87], v148 offset:33792
    v_mfma_f32_16x16x32_bf16 a[48:51], v[32:35], v[36:39], a[48:51]
    v_mfma_f32_16x16x32_bf16 a[4:7], v[20:23], v[40:43], a[4:7]
    ds_read_b128 v[104:107], v152 offset:33792
    s_add_u32 m0, s22, 50176
    v_mfma_f32_16x16x32_bf16 a[20:23], v[24:27], v[40:43], a[20:23]
    buffer_load_dwordx4 v14, s[8:11], s20 offen lds
    ds_read_b64_tr_b16 v[88:89], v149 offset:32768
    v_mfma_f32_16x16x32_bf16 a[36:39], v[28:31], v[40:43], a[36:39]
    ds_read_b64_tr_b16 v[90:91], v149 offset:33792
    v_mfma_f32_16x16x32_bf16 a[52:55], v[32:35], v[40:43], a[52:55]
    v_mfma_f32_16x16x32_bf16 a[8:11], v[20:23], v[44:47], a[8:11]
    ds_read_b128 v[108:111], v152 offset:34816
    s_add_u32 m0, s23, 57344
    v_mfma_f32_16x16x32_bf16 a[24:27], v[24:27], v[44:47], a[24:27]
    buffer_load_dwordx4 v15, s[12:15], s21 offen lds
    ds_read_b64_tr_b16 v[92:93], v150 offset:32768
    v_mfma_f32_16x16x32_bf16 a[40:43], v[28:31], v[44:47], a[40:43]
    ds_read_b64_tr_b16 v[94:95], v150 offset:33792
    v_mfma_f32_16x16x32_bf16 a[56:59], v[32:35], v[44:47], a[56:59]
    v_mfma_f32_16x16x32_bf16 a[12:15], v[20:23], v[48:51], a[12:15]
    ds_read_b128 v[112:115], v152 offset:35840
    s_add_u32 m0, s23, 58368
    v_mfma_f32_16x16x32_bf16 a[28:31], v[24:27], v[48:51], a[28:31]
    buffer_load_dwordx4 v16, s[12:15], s21 offen lds
    ds_read_b64_tr_b16 v[96:97], v151 offset:32768
    v_mfma_f32_16x16x32_bf16 a[44:47], v[28:31], v[48:51], a[44:47]
    ds_read_b64_tr_b16 v[98:99], v151 offset:33792
    v_mfma_f32_16x16x32_bf16 a[60:63], v[32:35], v[48:51], a[60:63]
    s_add_u32 s20, s20, 65536
    s_add_u32 s21, s21, 131072
    s_waitcnt lgkmcnt(12)
    v_mfma_f32_16x16x32_bf16 a[0:3], v[52:55], v[68:71], a[0:3]
    ds_read_b128 v[132:135], v152 offset:49152
    s_add_u32 m0, s22, 65536
    v_mfma_f32_16x16x32_bf16 a[16:19], v[56:59], v[68:71], a[16:19]
    buffer_load_dwordx4 v13, s[8:11], s20 offen lds
    ds_read_b64_tr_b16 v[116:117], v148 offset:49152
    v_mfma_f32_16x16x32_bf16 a[32:35], v[60:63], v[68:71], a[32:35]
    ds_read_b64_tr_b16 v[118:119], v148 offset:50176
    v_mfma_f32_16x16x32_bf16 a[48:51], v[64:67], v[68:71], a[48:51]
    v_mfma_f32_16x16x32_bf16 a[4:7], v[52:55], v[72:75], a[4:7]
    ds_read_b128 v[136:139], v152 offset:50176
    s_add_u32 m0, s22, 66560
    v_mfma_f32_16x16x32_bf16 a[20:23], v[56:59], v[72:75], a[20:23]
    buffer_load_dwordx4 v14, s[8:11], s20 offen lds
    ds_read_b64_tr_b16 v[120:121], v149 offset:49152
    v_mfma_f32_16x16x32_bf16 a[36:39], v[60:63], v[72:75], a[36:39]
    ds_read_b64_tr_b16 v[122:123], v149 offset:50176
    v_mfma_f32_16x16x32_bf16 a[52:55], v[64:67], v[72:75], a[52:55]
    v_mfma_f32_16x16x32_bf16 a[8:11], v[52:55], v[76:79], a[8:11]
    ds_read_b128 v[140:143], v152 offset:51200
    s_add_u32 m0, s23, 73728
    v_mfma_f32_16x16x32_bf16 a[24:27], v[56:59], v[76:79], a[24:27]
    buffer_load_dwordx4 v15, s[12:15], s21 offen lds
    ds_read_b64_tr_b16 v[124:125], v150 offset:49152
    v_mfma_f32_16x16x32_bf16 a[40:43], v[60:63], v[76:79], a[40:43]
    ds_read_b64_tr_b16 v[126:127], v150 offset:50176
    v_mfma_f32_16x16x32_bf16 a[56:59], v[64:67], v[76:79], a[56:59]
    v_mfma_f32_16x16x32_bf16 a[12:15], v[52:55], v[80:83], a[12:15]
    ds_read_b128 v[144:147], v152 offset:52224
    s_add_u32 m0, s23, 74752
    v_mfma_f32_16x16x32_bf16 a[28:31], v[56:59], v[80:83], a[28:31]
    buffer_load_dwordx4 v16, s[12:15], s21 offen lds
    ds_read_b64_tr_b16 v[128:129], v151 offset:49152
    v_mfma_f32_16x16x32_bf16 a[44:47], v[60:63], v[80:83], a[44:47]
    ds_read_b64_tr_b16 v[130:131], v151 offset:50176
    v_mfma_f32_16x16x32_bf16 a[60:63], v[64:67], v[80:83], a[60:63]
    s_add_u32 s20, s20, 65536
    s_add_u32 s21, s21, 131072
    s_waitcnt vmcnt(12) lgkmcnt(12)
    s_barrier
    v_mfma_f32_16x16x32_bf16 a[0:3], v[84:87], v[100:103], a[0:3]
    ds_read_b128 v[36:39], v12 offset:0
    s_add_u32 m0, s22, 81920
    v_mfma_f32_16x16x32_bf16 a[16:19], v[88:91], v[100:103], a[16:19]
    buffer_load_dwordx4 v13, s[8:11], s20 offen lds
    ds_read_b64_tr_b16 v[20:21], v8 offset:0
    v_mfma_f32_16x16x32_bf16 a[32:35], v[92:95], v[100:103], a[32:35]
    ds_read_b64_tr_b16 v[22:23], v8 offset:1024
    v_mfma_f32_16x16x32_bf16 a[48:51], v[96:99], v[100:103], a[48:51]
    v_mfma_f32_16x16x32_bf16 a[4:7], v[84:87], v[104:107], a[4:7]
    ds_read_b128 v[40:43], v12 offset:1024
    s_add_u32 m0, s22, 82944
    v_mfma_f32_16x16x32_bf16 a[20:23], v[88:91], v[104:107], a[20:23]
    buffer_load_dwordx4 v14, s[8:11], s20 offen lds
    ds_read_b64_tr_b16 v[24:25], v9 offset:0
    v_mfma_f32_16x16x32_bf16 a[36:39], v[92:95], v[104:107], a[36:39]
    ds_read_b64_tr_b16 v[26:27], v9 offset:1024
    v_mfma_f32_16x16x32_bf16 a[52:55], v[96:99], v[104:107], a[52:55]
    v_mfma_f32_16x16x32_bf16 a[8:11], v[84:87], v[108:111], a[8:11]
    ds_read_b128 v[44:47], v12 offset:2048
    s_add_u32 m0, s23, 90112
    v_mfma_f32_16x16x32_bf16 a[24:27], v[88:91], v[108:111], a[24:27]
    buffer_load_dwordx4 v15, s[12:15], s21 offen lds
    ds_read_b64_tr_b16 v[28:29], v10 offset:0
    v_mfma_f32_16x16x32_bf16 a[40:43], v[92:95], v[108:111], a[40:43]
    ds_read_b64_tr_b16 v[30:31], v10 offset:1024
    v_mfma_f32_16x16x32_bf16 a[56:59], v[96:99], v[108:111], a[56:59]
    v_mfma_f32_16x16x32_bf16 a[12:15], v[84:87], v[112:115], a[12:15]
    ds_read_b128 v[48:51], v12 offset:3072
    s_add_u32 m0, s23, 91136
    v_mfma_f32_16x16x32_bf16 a[28:31], v[88:91], v[112:115], a[28:31]
    buffer_load_dwordx4 v16, s[12:15], s21 offen lds
    ds_read_b64_tr_b16 v[32:33], v11 offset:0
    v_mfma_f32_16x16x32_bf16 a[44:47], v[92:95], v[112:115], a[44:47]
    ds_read_b64_tr_b16 v[34:35], v11 offset:1024
    v_mfma_f32_16x16x32_bf16 a[60:63], v[96:99], v[112:115], a[60:63]
    s_add_u32 s20, s20, 65536
    s_add_u32 s21, s21, 131072
    s_waitcnt lgkmcnt(12)
    v_mfma_f32_16x16x32_bf16 a[0:3], v[116:119], v[132:135], a[0:3]
    ds_read_b128 v[68:71], v12 offset:16384
    s_add_u32 m0, s22, 98304
    v_mfma_f32_16x16x32_bf16 a[16:19], v[120:123], v[132:135], a[16:19]
    buffer_load_dwordx4 v13, s[8:11], s20 offen lds
    ds_read_b64_tr_b16 v[52:53], v8 offset:16384
    v_mfma_f32_16x16x32_bf16 a[32:35], v[124:127], v[132:135], a[32:35]
    ds_read_b64_tr_b16 v[54:55], v8 offset:17408
    v_mfma_f32_16x16x32_bf16 a[48:51], v[128:131], v[132:135], a[48:51]
    v_mfma_f32_16x16x32_bf16 a[4:7], v[116:119], v[136:139], a[4:7]
    ds_read_b128 v[72:75], v12 offset:17408
    s_add_u32 m0, s22, 99328
    v_mfma_f32_16x16x32_bf16 a[20:23], v[120:123], v[136:139], a[20:23]
    buffer_load_dwordx4 v14, s[8:11], s20 offen lds
    ds_read_b64_tr_b16 v[56:57], v9 offset:16384
    v_mfma_f32_16x16x32_bf16 a[36:39], v[124:127], v[136:139], a[36:39]
    ds_read_b64_tr_b16 v[58:59], v9 offset:17408
    v_mfma_f32_16x16x32_bf16 a[52:55], v[128:131], v[136:139], a[52:55]
    v_mfma_f32_16x16x32_bf16 a[8:11], v[116:119], v[140:143], a[8:11]
    ds_read_b128 v[76:79], v12 offset:18432
    s_add_u32 m0, s23, 106496
    v_mfma_f32_16x16x32_bf16 a[24:27], v[120:123], v[140:143], a[24:27]
    buffer_load_dwordx4 v15, s[12:15], s21 offen lds
    ds_read_b64_tr_b16 v[60:61], v10 offset:16384
    v_mfma_f32_16x16x32_bf16 a[40:43], v[124:127], v[140:143], a[40:43]
    ds_read_b64_tr_b16 v[62:63], v10 offset:17408
    v_mfma_f32_16x16x32_bf16 a[56:59], v[128:131], v[140:143], a[56:59]
    v_mfma_f32_16x16x32_bf16 a[12:15], v[116:119], v[144:147], a[12:15]
    ds_read_b128 v[80:83], v12 offset:19456
    s_add_u32 m0, s23, 107520
    v_mfma_f32_16x16x32_bf16 a[28:31], v[120:123], v[144:147], a[28:31]
    buffer_load_dwordx4 v16, s[12:15], s21 offen lds
    ds_read_b64_tr_b16 v[64:65], v11 offset:16384
    v_mfma_f32_16x16x32_bf16 a[44:47], v[124:127], v[144:147], a[44:47]
    ds_read_b64_tr_b16 v[66:67], v11 offset:17408
    v_mfma_f32_16x16x32_bf16 a[60:63], v[128:131], v[144:147], a[60:63]
    s_add_u32 s20, s20, 65536
    s_add_u32 s21, s21, 131072
    s_waitcnt vmcnt(12) lgkmcnt(12)
    s_barrier
    s_sub_u32 s24, s24, 1
    s_cmp_lg_u32 s24, 0
    s_cbranch_scc1 L_opln_loop
    s_waitcnt vmcnt(0) lgkmcnt(0)
    s_barrier
    v_and_b32 v1, 15, v0
    v_lshrrev_b32 v2, 4, v0
    v_and_b32 v3, 1, v2
    v_lshrrev_b32 v2, 1, v2
    v_lshlrev_b32 v3, 4, v3
    v_lshl_add_u32 v3, v2, 3, v3
    s_lshl_b32 s25, s4, 7
    s_and_b32 s26, s3, 1
    s_lshl_b32 s26, s26, 6
    s_add_u32 s25, s25, s26
    v_add_u32 v4, s25, v3
    s_lshl_b32 s58, s5, 7
    s_lshr_b32 s26, s3, 1
    s_lshl_b32 s26, s26, 6
    s_add_u32 s58, s58, s26
    s_lshl_b32 s26, s56, 5
    s_add_u32 s58, s58, s26
    v_add_u32 v5, s58, v1
    v_lshlrev_b32 v6, 11, v5
    v_lshl_add_u32 v6, v4, 1, v6
    v_lshlrev_b32 v7, 2, v4
    s_add_u32 s44, s6, 8192
    s_addc_u32 s45, s7, 0
    global_load_dwordx4 v[84:87], v7, s[44:45] offset:0
    global_load_dwordx4 v[88:91], v7, s[44:45] offset:16
    global_load_dwordx4 v[92:95], v7, s[44:45] offset:128
    global_load_dwordx4 v[96:99], v7, s[44:45] offset:144
    s_add_u32 s44, s6, 12288
    s_addc_u32 s45, s7, 0
    global_load_dwordx4 v[100:103], v7, s[44:45] offset:0
    global_load_dwordx4 v[104:107], v7, s[44:45] offset:16
    global_load_dwordx4 v[108:111], v7, s[44:45] offset:128
    global_load_dwordx4 v[112:115], v7, s[44:45] offset:144
    s_add_u32 s44, s6, 16384
    s_addc_u32 s45, s7, 0
    global_load_dwordx4 v[116:119], v7, s[44:45] offset:0
    global_load_dwordx4 v[120:123], v7, s[44:45] offset:16
    global_load_dwordx4 v[124:127], v7, s[44:45] offset:128
    global_load_dwordx4 v[128:131], v7, s[44:45] offset:144
    v_add_u32 v8, 0, v6
    global_load_dwordx4 v[132:135], v8, s[54:55] offset:0
    global_load_dwordx4 v[136:139], v8, s[54:55] offset:64
    v_add_u32 v8, 32768, v6
    global_load_dwordx4 v[140:143], v8, s[54:55] offset:0
    global_load_dwordx4 v[144:147], v8, s[54:55] offset:64
    v_mov_b32 v17, v1
    v_mov_b32 v18, v3
    s_mov_b32 s62, s25
    s_lshl_b32 s25, s57, 1
    s_add_u32 s26, s25, s56
    s_lshl_b32 s26, s26, 2
    s_add_u32 s26, s26, s3
    s_lshl_b32 s26, s26, 13
    s_xor_b32 s27, s56, 1
    s_add_u32 s27, s25, s27
    s_lshl_b32 s27, s27, 2
    s_add_u32 s27, s27, s3
    s_lshl_b32 s27, s27, 13
    s_add_u32 s26, s26, 134217728
    s_add_u32 s27, s27, 134217728
    s_add_u32 s40, s6, s26
    s_addc_u32 s41, s7, 0
    s_add_u32 s42, s6, s27
    s_addc_u32 s43, s7, 0
    s_add_u32 s40, s40, 4096
    s_addc_u32 s41, s41, 0
    s_add_u32 s42, s42, 4096
    s_addc_u32 s43, s43, 0
    v_lshlrev_b32 v1, 4, v0
    s_cmp_lg_u32 s56, 0
    s_cbranch_scc1 L_oplnx_k1
    v_accvgpr_read_b32 v52, a8
    v_accvgpr_read_b32 v53, a9
    v_accvgpr_read_b32 v54, a10
    v_accvgpr_read_b32 v55, a11
    global_store_dwordx4 v1, v[52:55], s[40:41] offset:-4096 sc1
    v_accvgpr_read_b32 v56, a24
    v_accvgpr_read_b32 v57, a25
    v_accvgpr_read_b32 v58, a26
    v_accvgpr_read_b32 v59, a27
    global_store_dwordx4 v1, v[56:59], s[40:41] offset:-3072 sc1
    v_accvgpr_read_b32 v60, a40
    v_accvgpr_read_b32 v61, a41
    v_accvgpr_read_b32 v62, a42
    v_accvgpr_read_b32 v63, a43
    global_store_dwordx4 v1, v[60:63], s[40:41] offset:-2048 sc1
    v_accvgpr_read_b32 v64, a56
    v_accvgpr_read_b32 v65, a57
    v_accvgpr_read_b32 v66, a58
    v_accvgpr_read_b32 v67, a59
    global_store_dwordx4 v1, v[64:67], s[40:41] offset:-1024 sc1
    v_accvgpr_read_b32 v52, a12
    v_accvgpr_read_b32 v53, a13
    v_accvgpr_read_b32 v54, a14
    v_accvgpr_read_b32 v55, a15
    global_store_dwordx4 v1, v[52:55], s[40:41] offset:0 sc1
    v_accvgpr_read_b32 v56, a28
    v_accvgpr_read_b32 v57, a29
    v_accvgpr_read_b32 v58, a30
    v_accvgpr_read_b32 v59, a31
    global_store_dwordx4 v1, v[56:59], s[40:41] offset:1024 sc1
    v_accvgpr_read_b32 v60, a44
    v_accvgpr_read_b32 v61, a45
    v_accvgpr_read_b32 v62, a46
    v_accvgpr_read_b32 v63, a47
    global_store_dwordx4 v1, v[60:63], s[40:41] offset:2048 sc1
    v_accvgpr_read_b32 v64, a60
    v_accvgpr_read_b32 v65, a61
    v_accvgpr_read_b32 v66, a62
    v_accvgpr_read_b32 v67, a63
    global_store_dwordx4 v1, v[64:67], s[40:41] offset:3072 sc1
    v_accvgpr_read_b32 v20, a0
    v_accvgpr_read_b32 v21, a1
    v_accvgpr_read_b32 v22, a2
    v_accvgpr_read_b32 v23, a3
    v_accvgpr_read_b32 v24, a16
    v_accvgpr_read_b32 v25, a17
    v_accvgpr_read_b32 v26, a18
    v_accvgpr_read_b32 v27, a19
    v_accvgpr_read_b32 v28, a32
    v_accvgpr_read_b32 v29, a33
    v_accvgpr_read_b32 v30, a34
    v_accvgpr_read_b32 v31, a35
    v_accvgpr_read_b32 v32, a48
    v_accvgpr_read_b32 v33, a49
    v_accvgpr_read_b32 v34, a50
    v_accvgpr_read_b32 v35, a51
    v_accvgpr_read_b32 v36, a4
    v_accvgpr_read_b32 v37, a5
    v_accvgpr_read_b32 v38, a6
    v_accvgpr_read_b32 v39, a7
    v_accvgpr_read_b32 v40, a20
    v_accvgpr_read_b32 v41, a21
    v_accvgpr_read_b32 v42, a22
    v_accvgpr_read_b32 v43, a23
    v_accvgpr_read_b32 v44, a36
    v_accvgpr_read_b32 v45, a37
    v_accvgpr_read_b32 v46, a38
    v_accvgpr_read_b32 v47, a39
    v_accvgpr_read_b32 v48, a52
    v_accvgpr_read_b32 v49, a53
    v_accvgpr_read_b32 v50, a54
    v_accvgpr_read_b32 v51, a55
    s_branch L_oplnx_kd
L_oplnx_k1:
    v_accvgpr_read_b32 v52, a0
    v_accvgpr_read_b32 v53, a1
    v_accvgpr_read_b32 v54, a2
    v_accvgpr_read_b32 v55, a3
    global_store_dwordx4 v1, v[52:55], s[40:41] offset:-4096 sc1
    v_accvgpr_read_b32 v56, a16
    v_accvgpr_read_b32 v57, a17
    v_accvgpr_read_b32 v58, a18
    v_accvgpr_read_b32 v59, a19
    global_store_dwordx4 v1, v[56:59], s[40:41] offset:-3072 sc1
    v_accvgpr_read_b32 v60, a32
    v_accvgpr_read_b32 v61, a33
    v_accvgpr_read_b32 v62, a34
    v_accvgpr_read_b32 v63, a35
    global_store_dwordx4 v1, v[60:63], s[40:41] offset:-2048 sc1
    v_accvgpr_read_b32 v64, a48
    v_accvgpr_read_b32 v65, a49
    v_accvgpr_read_b32 v66, a50
    v_accvgpr_read_b32 v67, a51
    global_store_dwordx4 v1, v[64:67], s[40:41] offset:-1024 sc1
    v_accvgpr_read_b32 v52, a4
    v_accvgpr_read_b32 v53, a5
    v_accvgpr_read_b32 v54, a6
    v_accvgpr_read_b32 v55, a7
    global_store_dwordx4 v1, v[52:55], s[40:41] offset:0 sc1
    v_accvgpr_read_b32 v56, a20
    v_accvgpr_read_b32 v57, a21
    v_accvgpr_read_b32 v58, a22
    v_accvgpr_read_b32 v59, a23
    global_store_dwordx4 v1, v[56:59], s[40:41] offset:1024 sc1
    v_accvgpr_read_b32 v60, a36
    v_accvgpr_read_b32 v61, a37
    v_accvgpr_read_b32 v62, a38
    v_accvgpr_read_b32 v63, a39
    global_store_dwordx4 v1, v[60:63], s[40:41] offset:2048 sc1
    v_accvgpr_read_b32 v64, a52
    v_accvgpr_read_b32 v65, a53
    v_accvgpr_read_b32 v66, a54
    v_accvgpr_read_b32 v67, a55
    global_store_dwordx4 v1, v[64:67], s[40:41] offset:3072 sc1
    v_accvgpr_read_b32 v20, a8
    v_accvgpr_read_b32 v21, a9
    v_accvgpr_read_b32 v22, a10
    v_accvgpr_read_b32 v23, a11
    v_accvgpr_read_b32 v24, a24
    v_accvgpr_read_b32 v25, a25
    v_accvgpr_read_b32 v26, a26
    v_accvgpr_read_b32 v27, a27
    v_accvgpr_read_b32 v28, a40
    v_accvgpr_read_b32 v29, a41
    v_accvgpr_read_b32 v30, a42
    v_accvgpr_read_b32 v31, a43
    v_accvgpr_read_b32 v32, a56
    v_accvgpr_read_b32 v33, a57
    v_accvgpr_read_b32 v34, a58
    v_accvgpr_read_b32 v35, a59
    v_accvgpr_read_b32 v36, a12
    v_accvgpr_read_b32 v37, a13
    v_accvgpr_read_b32 v38, a14
    v_accvgpr_read_b32 v39, a15
    v_accvgpr_read_b32 v40, a28
    v_accvgpr_read_b32 v41, a29
    v_accvgpr_read_b32 v42, a30
    v_accvgpr_read_b32 v43, a31
    v_accvgpr_read_b32 v44, a44
    v_accvgpr_read_b32 v45, a45
    v_accvgpr_read_b32 v46, a46
    v_accvgpr_read_b32 v47, a47
    v_accvgpr_read_b32 v48, a60
    v_accvgpr_read_b32 v49, a61
    v_accvgpr_read_b32 v50, a62
    v_accvgpr_read_b32 v51, a63
L_oplnx_kd:
    s_mov_b32 s50, 0x200000
L_oplnx_sp:
    global_load_dwordx4 v[52:55], v1, s[42:43] offset:-4096 sc1
    global_load_dwordx4 v[56:59], v1, s[42:43] offset:-3072 sc1
    global_load_dwordx4 v[60:63], v1, s[42:43] offset:-2048 sc1
    global_load_dwordx4 v[64:67], v1, s[42:43] offset:-1024 sc1
    global_load_dwordx4 v[68:71], v1, s[42:43] offset:0 sc1
    global_load_dwordx4 v[72:75], v1, s[42:43] offset:1024 sc1
    global_load_dwordx4 v[76:79], v1, s[42:43] offset:2048 sc1
    global_load_dwordx4 v[80:83], v1, s[42:43] offset:3072 sc1
    s_waitcnt vmcnt(0)
    v_max3_u32 v2, v52, v53, v54
    v_max3_u32 v2, v2, v55, v56
    v_max3_u32 v2, v2, v57, v58
    v_max3_u32 v2, v2, v59, v60
    v_max3_u32 v2, v2, v61, v62
    v_max3_u32 v2, v2, v63, v64
    v_max3_u32 v2, v2, v65, v66
    v_max3_u32 v2, v2, v67, v68
    v_max3_u32 v2, v2, v69, v70
    v_max3_u32 v2, v2, v71, v72
    v_max3_u32 v2, v2, v73, v74
    v_max3_u32 v2, v2, v75, v76
    v_max3_u32 v2, v2, v77, v78
    v_max3_u32 v2, v2, v79, v80
    v_max3_u32 v2, v2, v81, v82
    v_max_u32 v2, v2, v83
    v_cmp_eq_u32 vcc, -1, v2
    s_cbranch_vccz L_oplnx_sok
    s_sub_u32 s50, s50, 1
    s_cbranch_scc0 L_oplnx_sp
L_oplnx_sok:
    v_add_f32 v20, v20, v52
    v_add_f32 v21, v21, v53
    v_add_f32 v22, v22, v54
    v_add_f32 v23, v23, v55
    v_add_f32 v24, v24, v56
    v_add_f32 v25, v25, v57
    v_add_f32 v26, v26, v58
    v_add_f32 v27, v27, v59
    v_add_f32 v28, v28, v60
    v_add_f32 v29, v29, v61
    v_add_f32 v30, v30, v62
    v_add_f32 v31, v31, v63
    v_add_f32 v32, v32, v64
    v_add_f32 v33, v33, v65
    v_add_f32 v34, v34, v66
    v_add_f32 v35, v35, v67
    v_add_f32 v36, v36, v68
    v_add_f32 v37, v37, v69
    v_add_f32 v38, v38, v70
    v_add_f32 v39, v39, v71
    v_add_f32 v40, v40, v72
    v_add_f32 v41, v41, v73
    v_add_f32 v42, v42, v74
    v_add_f32 v43, v43, v75
    v_add_f32 v44, v44, v76
    v_add_f32 v45, v45, v77
    v_add_f32 v46, v46, v78
    v_add_f32 v47, v47, v79
    v_add_f32 v48, v48, v80
    v_add_f32 v49, v49, v81
    v_add_f32 v50, v50, v82
    v_add_f32 v51, v51, v83
    v_permlane16_swap_b32 v20, v24
    v_permlane16_swap_b32 v21, v25
    v_permlane16_swap_b32 v22, v26
    v_permlane16_swap_b32 v23, v27
    v_permlane16_swap_b32 v28, v32
    v_permlane16_swap_b32 v29, v33
    v_permlane16_swap_b32 v30, v34
    v_permlane16_swap_b32 v31, v35
    v_permlane16_swap_b32 v36, v40
    v_permlane16_swap_b32 v37, v41
    v_permlane16_swap_b32 v38, v42
    v_permlane16_swap_b32 v39, v43
    v_permlane16_swap_b32 v44, v48
    v_permlane16_swap_b32 v45, v49
    v_permlane16_swap_b32 v46, v50
    v_permlane16_swap_b32 v47, v51
    v_mov_b32 v1, v17
    v_mov_b32 v3, v18
    s_mov_b32 s25, s62
    s_waitcnt vmcnt(0)
    s_add_u32 s44, s6, 83886080
    s_addc_u32 s45, s7, 0
    v_add_u32 v8, 0, v6
    v_lshlrev_b32 v148, 16, v132
    v_and_b32 v149, 0xffff0000, v132
    v_lshlrev_b32 v150, 16, v133
    v_and_b32 v151, 0xffff0000, v133
    v_lshlrev_b32 v152, 16, v134
    v_and_b32 v153, 0xffff0000, v134
    v_lshlrev_b32 v154, 16, v135
    v_and_b32 v155, 0xffff0000, v135
    v_fma_f32 v20, v20, v84, v148
    v_fma_f32 v21, v21, v85, v149
    v_fma_f32 v22, v22, v86, v150
    v_fma_f32 v23, v23, v87, v151
    v_fma_f32 v24, v24, v88, v152
    v_fma_f32 v25, v25, v89, v153
    v_fma_f32 v26, v26, v90, v154
    v_fma_f32 v27, v27, v91, v155
    v_cvt_pk_bf16_f32 v132, v20, v21
    v_cvt_pk_bf16_f32 v133, v22, v23
    v_cvt_pk_bf16_f32 v134, v24, v25
    v_cvt_pk_bf16_f32 v135, v26, v27
    global_store_dwordx4 v8, v[132:135], s[44:45] offset:0 sc1
    v_lshlrev_b32 v20, 16, v132
    v_and_b32 v21, 0xffff0000, v132
    v_lshlrev_b32 v22, 16, v133
    v_and_b32 v23, 0xffff0000, v133
    v_lshlrev_b32 v24, 16, v134
    v_and_b32 v25, 0xffff0000, v134
    v_lshlrev_b32 v26, 16, v135
    v_and_b32 v27, 0xffff0000, v135
    v_lshlrev_b32 v148, 16, v136
    v_and_b32 v149, 0xffff0000, v136
    v_lshlrev_b32 v150, 16, v137
    v_and_b32 v151, 0xffff0000, v137
    v_lshlrev_b32 v152, 16, v138
    v_and_b32 v153, 0xffff0000, v138
    v_lshlrev_b32 v154, 16, v139
    v_and_b32 v155, 0xffff0000, v139
    v_fma_f32 v28, v28, v92, v148
    v_fma_f32 v29, v29, v93, v149
    v_fma_f32 v30, v30, v94, v150
    v_fma_f32 v31, v31, v95, v151
    v_fma_f32 v32, v32, v96, v152
    v_fma_f32 v33, v33, v97, v153
    v_fma_f32 v34, v34, v98, v154
    v_fma_f32 v35, v35, v99, v155
    v_cvt_pk_bf16_f32 v136, v28, v29
    v_cvt_pk_bf16_f32 v137, v30, v31
    v_cvt_pk_bf16_f32 v138, v32, v33
    v_cvt_pk_bf16_f32 v139, v34, v35
    global_store_dwordx4 v8, v[136:139], s[44:45] offset:64 sc1
    v_lshlrev_b32 v28, 16, v136
    v_and_b32 v29, 0xffff0000, v136
    v_lshlrev_b32 v30, 16, v137
    v_and_b32 v31, 0xffff0000, v137
    v_lshlrev_b32 v32, 16, v138
    v_and_b32 v33, 0xffff0000, v138
    v_lshlrev_b32 v34, 16, v139
    v_and_b32 v35, 0xffff0000, v139
    v_add_u32 v8, 32768, v6
    v_lshlrev_b32 v148, 16, v140
    v_and_b32 v149, 0xffff0000, v140
    v_lshlrev_b32 v150, 16, v141
    v_and_b32 v151, 0xffff0000, v141
    v_lshlrev_b32 v152, 16, v142
    v_and_b32 v153, 0xffff0000, v142
    v_lshlrev_b32 v154, 16, v143
    v_and_b32 v155, 0xffff0000, v143
    v_fma_f32 v36, v36, v84, v148
    v_fma_f32 v37, v37, v85, v149
    v_fma_f32 v38, v38, v86, v150
    v_fma_f32 v39, v39, v87, v151
    v_fma_f32 v40, v40, v88, v152
    v_fma_f32 v41, v41, v89, v153
    v_fma_f32 v42, v42, v90, v154
    v_fma_f32 v43, v43, v91, v155
    v_cvt_pk_bf16_f32 v140, v36, v37
    v_cvt_pk_bf16_f32 v141, v38, v39
    v_cvt_pk_bf16_f32 v142, v40, v41
    v_cvt_pk_bf16_f32 v143, v42, v43
    global_store_dwordx4 v8, v[140:143], s[44:45] offset:0 sc1
    v_lshlrev_b32 v36, 16, v140
    v_and_b32 v37, 0xffff0000, v140
    v_lshlrev_b32 v38, 16, v141
    v_and_b32 v39, 0xffff0000, v141
    v_lshlrev_b32 v40, 16, v142
    v_and_b32 v41, 0xffff0000, v142
    v_lshlrev_b32 v42, 16, v143
    v_and_b32 v43, 0xffff0000, v143
    v_lshlrev_b32 v148, 16, v144
    v_and_b32 v149, 0xffff0000, v144
    v_lshlrev_b32 v150, 16, v145
    v_and_b32 v151, 0xffff0000, v145
    v_lshlrev_b32 v152, 16, v146
    v_and_b32 v153, 0xffff0000, v146
    v_lshlrev_b32 v154, 16, v147
    v_and_b32 v155, 0xffff0000, v147
    v_fma_f32 v44, v44, v92, v148
    v_fma_f32 v45, v45, v93, v149
    v_fma_f32 v46, v46, v94, v150
    v_fma_f32 v47, v47, v95, v151
    v_fma_f32 v48, v48, v96, v152
    v_fma_f32 v49, v49, v97, v153
    v_fma_f32 v50, v50, v98, v154
    v_fma_f32 v51, v51, v99, v155
    v_cvt_pk_bf16_f32 v144, v44, v45
    v_cvt_pk_bf16_f32 v145, v46, v47
    v_cvt_pk_bf16_f32 v146, v48, v49
    v_cvt_pk_bf16_f32 v147, v50, v51
    global_store_dwordx4 v8, v[144:147], s[44:45] offset:64 sc1
    v_lshlrev_b32 v44, 16, v144
    v_and_b32 v45, 0xffff0000, v144
    v_lshlrev_b32 v46, 16, v145
    v_and_b32 v47, 0xffff0000, v145
    v_lshlrev_b32 v48, 16, v146
    v_and_b32 v49, 0xffff0000, v146
    v_lshlrev_b32 v50, 16, v147
    v_and_b32 v51, 0xffff0000, v147
    v_add_f32 v148, v20, v21
    v_add_f32 v148, v148, v22
    v_add_f32 v148, v148, v23
    v_add_f32 v148, v148, v24
    v_add_f32 v148, v148, v25
    v_add_f32 v148, v148, v26
    v_add_f32 v148, v148, v27
    v_add_f32 v148, v148, v28
    v_add_f32 v148, v148, v29
    v_add_f32 v148, v148, v30
    v_add_f32 v148, v148, v31
    v_add_f32 v148, v148, v32
    v_add_f32 v148, v148, v33
    v_add_f32 v148, v148, v34
    v_add_f32 v148, v148, v35
    v_mul_f32 v150, v20, v20
    v_fmac_f32 v150, v21, v21
    v_fmac_f32 v150, v22, v22
    v_fmac_f32 v150, v23, v23
    v_fmac_f32 v150, v24, v24
    v_fmac_f32 v150, v25, v25
    v_fmac_f32 v150, v26, v26
    v_fmac_f32 v150, v27, v27
    v_fmac_f32 v150, v28, v28
    v_fmac_f32 v150, v29, v29
    v_fmac_f32 v150, v30, v30
    v_fmac_f32 v150, v31, v31
    v_fmac_f32 v150, v32, v32
    v_fmac_f32 v150, v33, v33
    v_fmac_f32 v150, v34, v34
    v_fmac_f32 v150, v35, v35
    v_add_f32 v149, v36, v37
    v_add_f32 v149, v149, v38
    v_add_f32 v149, v149, v39
    v_add_f32 v149, v149, v40
    v_add_f32 v149, v149, v41
    v_add_f32 v149, v149, v42
    v_add_f32 v149, v149, v43
    v_add_f32 v149, v149, v44
    v_add_f32 v149, v149, v45
    v_add_f32 v149, v149, v46
    v_add_f32 v149, v149, v47
    v_add_f32 v149, v149, v48
    v_add_f32 v149, v149, v49
    v_add_f32 v149, v149, v50
    v_add_f32 v149, v149, v51
    v_mul_f32 v151, v36, v36
    v_fmac_f32 v151, v37, v37
    v_fmac_f32 v151, v38, v38
    v_fmac_f32 v151, v39, v39
    v_fmac_f32 v151, v40, v40
    v_fmac_f32 v151, v41, v41
    v_fmac_f32 v151, v42, v42
    v_fmac_f32 v151, v43, v43
    v_fmac_f32 v151, v44, v44
    v_fmac_f32 v151, v45, v45
    v_fmac_f32 v151, v46, v46
    v_fmac_f32 v151, v47, v47
    v_fmac_f32 v151, v48, v48
    v_fmac_f32 v151, v49, v49
    v_fmac_f32 v151, v50, v50
    v_fmac_f32 v151, v51, v51
    v_mov_b32 v152, v148
    s_nop 1
    v_permlane16_swap_b32 v148, v152
    v_add_f32 v148, v148, v152
    v_mov_b32 v152, v148
    s_nop 1
    v_permlane32_swap_b32 v148, v152
    v_add_f32 v148, v148, v152
    v_mov_b32 v152, v149
    s_nop 1
    v_permlane16_swap_b32 v149, v152
    v_add_f32 v149, v149, v152
    v_mov_b32 v152, v149
    s_nop 1
    v_permlane32_swap_b32 v149, v152
    v_add_f32 v149, v149, v152
    v_mov_b32 v152, v150
    s_nop 1
    v_permlane16_swap_b32 v150, v152
    v_add_f32 v150, v150, v152
    v_mov_b32 v152, v150
    s_nop 1
    v_permlane32_swap_b32 v150, v152
    v_add_f32 v150, v150, v152
    v_mov_b32 v152, v151
    s_nop 1
    v_permlane16_swap_b32 v151, v152
    v_add_f32 v151, v151, v152
    v_mov_b32 v152, v151
    s_nop 1
    v_permlane32_swap_b32 v151, v152
    v_add_f32 v151, v151, v152
    s_lshr_b32 s59, s58, 5
    s_lshl_b32 s26, s59, 12
    s_lshl_b32 s27, s4, 1
    s_and_b32 s28, s3, 1
    s_add_u32 s27, s27, s28
    s_lshl_b32 s27, s27, 8
    s_add_u32 s46, s6, 150994944
    s_addc_u32 s47, s7, 0
    s_add_u32 s46, s46, s26
    s_addc_u32 s47, s47, 0
    v_lshlrev_b32 v9, 3, v1
    v_add_u32 v14, s27, v9
    v_mov_b32 v156, v148
    v_mov_b32 v157, v150
    v_mov_b32 v158, v149
    v_mov_b32 v159, v151
    s_mov_b64 exec, 0xffff
    global_store_dwordx2 v14, v[156:157], s[46:47] offset:0 sc1
    global_store_dwordx2 v14, v[158:159], s[46:47] offset:128 sc1
    s_mov_b64 exec, -1
    v_lshrrev_b32 v15, 4, v0
    v_lshlrev_b32 v15, 10, v15
    v_add_u32 v15, v15, v9
    s_mov_b32 s50, 0x200000
L_opln_stp:
    global_load_dwordx2 v[52:53], v15, s[46:47] offset:0 sc1
    global_load_dwordx2 v[54:55], v15, s[46:47] offset:256 sc1
    global_load_dwordx2 v[56:57], v15, s[46:47] offset:512 sc1
    global_load_dwordx2 v[58:59], v15, s[46:47] offset:768 sc1
    global_load_dwordx2 v[60:61], v15, s[46:47] offset:128 sc1
    global_load_dwordx2 v[62:63], v15, s[46:47] offset:384 sc1
    global_load_dwordx2 v[64:65], v15, s[46:47] offset:640 sc1
    global_load_dwordx2 v[66:67], v15, s[46:47] offset:896 sc1
    s_waitcnt vmcnt(0)
    v_max3_u32 v2, v52, v53, v54
    v_max3_u32 v2, v2, v55, v56
    v_max3_u32 v2, v2, v57, v58
    v_max3_u32 v2, v2, v59, v60
    v_max3_u32 v2, v2, v61, v62
    v_max3_u32 v2, v2, v63, v64
    v_max3_u32 v2, v2, v65, v66
    v_max_u32 v2, v2, v67
    v_cmp_eq_u32 vcc, -1, v2
    s_cbranch_vccz L_opln_stok
    s_sleep 1
    s_sub_u32 s50, s50, 1
    s_cbranch_scc0 L_opln_stp
L_opln_stok:
    v_add_f32 v156, v52, v54
    v_add_f32 v157, v53, v55
    v_add_f32 v56, v56, v58
    v_add_f32 v57, v57, v59
    v_add_f32 v156, v156, v56
    v_add_f32 v157, v157, v57
    v_add_f32 v158, v60, v62
    v_add_f32 v159, v61, v63
    v_add_f32 v64, v64, v66
    v_add_f32 v65, v65, v67
    v_add_f32 v158, v158, v64
    v_add_f32 v159, v159, v65
    v_mov_b32 v152, v156
    s_nop 1
    v_permlane16_swap_b32 v156, v152
    v_add_f32 v156, v156, v152
    v_mov_b32 v152, v156
    s_nop 1
    v_permlane32_swap_b32 v156, v152
    v_add_f32 v156, v156, v152
    v_mov_b32 v152, v157
    s_nop 1
    v_permlane16_swap_b32 v157, v152
    v_add_f32 v157, v157, v152
    v_mov_b32 v152, v157
    s_nop 1
    v_permlane32_swap_b32 v157, v152
    v_add_f32 v157, v157, v152
    v_mov_b32 v152, v158
    s_nop 1
    v_permlane16_swap_b32 v158, v152
    v_add_f32 v158, v158, v152
    v_mov_b32 v152, v158
    s_nop 1
    v_permlane32_swap_b32 v158, v152
    v_add_f32 v158, v158, v152
    v_mov_b32 v152, v159
    s_nop 1
    v_permlane16_swap_b32 v159, v152
    v_add_f32 v159, v159, v152
    v_mov_b32 v152, v159
    s_nop 1
    v_permlane32_swap_b32 v159, v152
    v_add_f32 v159, v159, v152
    v_add_f32 v116, 1.0, v116
    v_add_f32 v117, 1.0, v117
    v_add_f32 v118, 1.0, v118
    v_add_f32 v119, 1.0, v119
    v_add_f32 v120, 1.0, v120
    v_add_f32 v121, 1.0, v121
    v_add_f32 v122, 1.0, v122
    v_add_f32 v123, 1.0, v123
    v_add_f32 v124, 1.0, v124
    v_add_f32 v125, 1.0, v125
    v_add_f32 v126, 1.0, v126
    v_add_f32 v127, 1.0, v127
    v_add_f32 v128, 1.0, v128
    v_add_f32 v129, 1.0, v129
    v_add_f32 v130, 1.0, v130
    v_add_f32 v131, 1.0, v131
    s_lshl_b32 s26, s3, 13
    v_mul_u32_u24 v10, 160, v1
    v_lshl_add_u32 v10, v3, 1, v10
    v_add_u32 v10, s26, v10
    v_mul_f32 v156, 0x3a800000, v156
    v_mul_f32 v157, 0x3a800000, v157
    v_fma_f32 v157, -v156, v156, v157
    v_max_f32 v157, 0, v157
    v_add_f32 v157, 0x3727c5ac, v157
    v_rsq_f32 v157, v157
    v_sub_f32 v20, v20, v156
    v_mul_f32 v20, v20, v157
    v_fma_f32 v20, v20, v116, v100
    v_sub_f32 v21, v21, v156
    v_mul_f32 v21, v21, v157
    v_fma_f32 v21, v21, v117, v101
    v_sub_f32 v22, v22, v156
    v_mul_f32 v22, v22, v157
    v_fma_f32 v22, v22, v118, v102
    v_sub_f32 v23, v23, v156
    v_mul_f32 v23, v23, v157
    v_fma_f32 v23, v23, v119, v103
    v_sub_f32 v24, v24, v156
    v_mul_f32 v24, v24, v157
    v_fma_f32 v24, v24, v120, v104
    v_sub_f32 v25, v25, v156
    v_mul_f32 v25, v25, v157
    v_fma_f32 v25, v25, v121, v105
    v_sub_f32 v26, v26, v156
    v_mul_f32 v26, v26, v157
    v_fma_f32 v26, v26, v122, v106
    v_sub_f32 v27, v27, v156
    v_mul_f32 v27, v27, v157
    v_fma_f32 v27, v27, v123, v107
    v_cvt_pk_bf16_f32 v132, v20, v21
    v_cvt_pk_bf16_f32 v133, v22, v23
    v_cvt_pk_bf16_f32 v134, v24, v25
    v_cvt_pk_bf16_f32 v135, v26, v27
    ds_write_b128 v10, v[132:135] offset:0
    v_sub_f32 v28, v28, v156
    v_mul_f32 v28, v28, v157
    v_fma_f32 v28, v28, v124, v108
    v_sub_f32 v29, v29, v156
    v_mul_f32 v29, v29, v157
    v_fma_f32 v29, v29, v125, v109
    v_sub_f32 v30, v30, v156
    v_mul_f32 v30, v30, v157
    v_fma_f32 v30, v30, v126, v110
    v_sub_f32 v31, v31, v156
    v_mul_f32 v31, v31, v157
    v_fma_f32 v31, v31, v127, v111
    v_sub_f32 v32, v32, v156
    v_mul_f32 v32, v32, v157
    v_fma_f32 v32, v32, v128, v112
    v_sub_f32 v33, v33, v156
    v_mul_f32 v33, v33, v157
    v_fma_f32 v33, v33, v129, v113
    v_sub_f32 v34, v34, v156
    v_mul_f32 v34, v34, v157
    v_fma_f32 v34, v34, v130, v114
    v_sub_f32 v35, v35, v156
    v_mul_f32 v35, v35, v157
    v_fma_f32 v35, v35, v131, v115
    v_cvt_pk_bf16_f32 v136, v28, v29
    v_cvt_pk_bf16_f32 v137, v30, v31
    v_cvt_pk_bf16_f32 v138, v32, v33
    v_cvt_pk_bf16_f32 v139, v34, v35
    ds_write_b128 v10, v[136:139] offset:64
    v_mul_f32 v158, 0x3a800000, v158
    v_mul_f32 v159, 0x3a800000, v159
    v_fma_f32 v159, -v158, v158, v159
    v_max_f32 v159, 0, v159
    v_add_f32 v159, 0x3727c5ac, v159
    v_rsq_f32 v159, v159
    v_sub_f32 v36, v36, v158
    v_mul_f32 v36, v36, v159
    v_fma_f32 v36, v36, v116, v100
    v_sub_f32 v37, v37, v158
    v_mul_f32 v37, v37, v159
    v_fma_f32 v37, v37, v117, v101
    v_sub_f32 v38, v38, v158
    v_mul_f32 v38, v38, v159
    v_fma_f32 v38, v38, v118, v102
    v_sub_f32 v39, v39, v158
    v_mul_f32 v39, v39, v159
    v_fma_f32 v39, v39, v119, v103
    v_sub_f32 v40, v40, v158
    v_mul_f32 v40, v40, v159
    v_fma_f32 v40, v40, v120, v104
    v_sub_f32 v41, v41, v158
    v_mul_f32 v41, v41, v159
    v_fma_f32 v41, v41, v121, v105
    v_sub_f32 v42, v42, v158
    v_mul_f32 v42, v42, v159
    v_fma_f32 v42, v42, v122, v106
    v_sub_f32 v43, v43, v158
    v_mul_f32 v43, v43, v159
    v_fma_f32 v43, v43, v123, v107
    v_cvt_pk_bf16_f32 v140, v36, v37
    v_cvt_pk_bf16_f32 v141, v38, v39
    v_cvt_pk_bf16_f32 v142, v40, v41
    v_cvt_pk_bf16_f32 v143, v42, v43
    ds_write_b128 v10, v[140:143] offset:2560
    v_sub_f32 v44, v44, v158
    v_mul_f32 v44, v44, v159
    v_fma_f32 v44, v44, v124, v108
    v_sub_f32 v45, v45, v158
    v_mul_f32 v45, v45, v159
    v_fma_f32 v45, v45, v125, v109
    v_sub_f32 v46, v46, v158
    v_mul_f32 v46, v46, v159
    v_fma_f32 v46, v46, v126, v110
    v_sub_f32 v47, v47, v158
    v_mul_f32 v47, v47, v159
    v_fma_f32 v47, v47, v127, v111
    v_sub_f32 v48, v48, v158
    v_mul_f32 v48, v48, v159
    v_fma_f32 v48, v48, v128, v112
    v_sub_f32 v49, v49, v158
    v_mul_f32 v49, v49, v159
    v_fma_f32 v49, v49, v129, v113
    v_sub_f32 v50, v50, v158
    v_mul_f32 v50, v50, v159
    v_fma_f32 v50, v50, v130, v114
    v_sub_f32 v51, v51, v158
    v_mul_f32 v51, v51, v159
    v_fma_f32 v51, v51, v131, v115
    v_cvt_pk_bf16_f32 v144, v44, v45
    v_cvt_pk_bf16_f32 v145, v46, v47
    v_cvt_pk_bf16_f32 v146, v48, v49
    v_cvt_pk_bf16_f32 v147, v50, v51
    ds_write_b128 v10, v[144:147] offset:2624
    s_waitcnt lgkmcnt(0)
    v_lshrrev_b32 v2, 4, v0
    v_lshrrev_b32 v11, 2, v1
    v_lshl_add_u32 v11, v2, 3, v11
    v_mul_u32_u24 v11, 160, v11
    v_and_b32 v12, 3, v1
    v_lshl_add_u32 v11, v12, 3, v11
    v_add_u32 v11, s26, v11
    ds_read_b64_tr_b16 v[132:133], v11 offset:0
    ds_read_b64_tr_b16 v[134:135], v11 offset:640
    ds_read_b64_tr_b16 v[136:137], v11 offset:32
    ds_read_b64_tr_b16 v[138:139], v11 offset:672
    ds_read_b64_tr_b16 v[140:141], v11 offset:64
    ds_read_b64_tr_b16 v[142:143], v11 offset:704
    ds_read_b64_tr_b16 v[144:145], v11 offset:96
    ds_read_b64_tr_b16 v[146:147], v11 offset:736
    v_lshrrev_b32 v12, 2, v1
    v_lshrrev_b32 v13, 1, v12
    v_and_b32 v12, 1, v12
    v_xor_b32 v12, v12, v13
    v_lshl_or_b32 v12, v12, 1, v13
    v_xor_b32 v12, v12, v2
    v_lshl_add_u32 v12, v1, 2, v12
    v_lshlrev_b32 v12, 4, v12
    s_lshl_b32 s26, s59, 16
    s_lshl_b32 s27, s25, 6
    s_add_u32 s26, s26, s27
    s_add_u32 s26, s26, 88080384
    v_add_u32 v12, s26, v12
    s_waitcnt lgkmcnt(0)
    global_store_dwordx4 v12, v[132:135], s[6:7] offset:0 sc1
    global_store_dwordx4 v12, v[136:139], s[6:7] offset:1024 sc1
    global_store_dwordx4 v12, v[140:143], s[6:7] offset:2048 sc1
    global_store_dwordx4 v12, v[144:147], s[6:7] offset:3072 sc1
    s_waitcnt vmcnt(0)
    s_barrier
    s_cmp_lg_u32 s3, 0
    s_cbranch_scc1 L_opln_nh2
    s_add_u32 s48, s6, 130023424
    s_addc_u32 s49, s7, 0
    s_lshl_b32 s26, s4, 7
    s_add_u32 s26, s26, 163840
    v_mov_b32 v14, s26
    v_mov_b32 v15, 1
    s_mov_b64 exec, 1
    global_atomic_add v14, v15, s[48:49]
    s_mov_b64 exec, -1
L_opln_nh2:
    s_branch T_g1
L_opln_end:
    s_endpgm
T_g1:
    s_cmp_ge_u32 s2, 224
    s_cbranch_scc1 T_g2
    s_load_dwordx2 s[6:7], s[0:1], 128
    s_load_dwordx2 s[40:41], s[0:1], 64
    s_load_dwordx2 s[42:43], s[0:1], 72
    s_waitcnt lgkmcnt(0)
    s_add_u32 s8, s40, 0
    s_addc_u32 s9, s41, 0
    s_and_b32 s9, s9, 0xffff
    s_mov_b32 s10, 14680064
    s_mov_b32 s11, 0x00020000
    s_add_u32 s12, s6, 88080384
    s_addc_u32 s13, s7, 0
    s_and_b32 s13, s13, 0xffff
    s_mov_b32 s14, 4194304
    s_mov_b32 s15, 0x00020000
    s_and_b32 s25, s2, 7
    s_lshr_b32 s26, s2, 3
    s_lshr_b32 s4, s25, 1
    s_mul_i32 s4, s4, 7
    s_lshr_b32 s27, s26, 2
    s_add_u32 s4, s4, s27
    s_and_b32 s5, s25, 1
    s_lshl_b32 s5, s5, 2
    s_and_b32 s27, s26, 3
    s_add_u32 s5, s5, s27
    s_lshl_b32 s20, s4, 8
    s_lshl_b32 s21, s5, 13
    s_mul_i32 s22, s3, 2048
    s_mul_i32 s23, s3, 2048
    v_and_b32 v1, 15, v0
    v_lshrrev_b32 v2, 4, v0
    v_lshrrev_b32 v3, 2, v1
    v_and_b32 v4, 1, v2
    v_lshrrev_b32 v5, 1, v2
    v_lshl_add_u32 v6, v2, 3, v3
    v_lshl_or_b32 v3, v4, 2, v3
    v_lshlrev_b32 v6, 8, v6
    v_and_b32 v4, 3, v1
    v_lshl_add_u32 v6, v4, 3, v6
    s_and_b32 s25, s3, 1
    s_mul_i32 s25, s25, 4
    s_add_u32 s26, s25, 0
    v_xor_b32 v4, s26, v3
    v_lshl_add_u32 v8, v4, 5, v6
    s_add_u32 s26, s25, 1
    v_xor_b32 v4, s26, v3
    v_lshl_add_u32 v9, v4, 5, v6
    s_add_u32 s26, s25, 2
    v_xor_b32 v4, s26, v3
    v_lshl_add_u32 v10, v4, 5, v6
    s_add_u32 s26, s25, 3
    v_xor_b32 v4, s26, v3
    v_lshl_add_u32 v11, v4, 5, v6
    v_lshrrev_b32 v3, 2, v1
    v_lshrrev_b32 v4, 1, v3
    v_and_b32 v5, 1, v3
    v_xor_b32 v5, v5, v4
    v_lshl_or_b32 v5, v5, 1, v4
    v_xor_b32 v5, v5, v2
    v_lshlrev_b32 v5, 4, v5
    v_lshl_add_u32 v5, v1, 6, v5
    s_lshr_b32 s25, s3, 1
    s_mul_i32 s25, s25, 4096
    s_add_u32 s25, s25, 8192
    v_add_u32 v12, s25, v5
    v_lshrrev_b32 v3, 4, v0
    v_and_b32 v4, 15, v0
    s_and_b32 s25, s3, 1
    s_lshl_b32 s26, s25, 3
    v_add_u32 v5, s26, v3
    s_lshr_b32 s26, s3, 1
    s_lshl_b32 s26, s26, 4
    v_add_u32 v5, s26, v5
    s_lshl_b32 s25, s25, 2
    v_or_b32 v6, s25, v3
    v_lshrrev_b32 v1, 1, v4
    v_xor_b32 v1, v1, v6
    v_lshlrev_b32 v1, 5, v1
    v_and_b32 v4, 1, v4
    v_lshl_or_b32 v1, v4, 4, v1
    s_mov_b32 s25, 7168
    v_mul_lo_u32 v5, v5, s25
    v_add_u32 v13, v5, v1
    v_add_u32 v14, 28672, v13
    v_lshlrev_b32 v3, 4, v0
    s_mul_i32 s25, s3, 2048
    v_add_u32 v15, s25, v3
    v_add_u32 v16, 1024, v15
    v_add_u32 v148, 65536, v8
    v_add_u32 v149, 65536, v9
    v_add_u32 v150, 65536, v10
    v_add_u32 v151, 65536, v11
    v_add_u32 v152, 65536, v12
    s_mov_b32 s35, s20
    s_add_u32 m0, s22, 0
    s_nop 0
    buffer_load_dwordx4 v13, s[8:11], s20 offen lds
    s_add_u32 m0, s22, 1024
    s_nop 0
    buffer_load_dwordx4 v14, s[8:11], s20 offen lds
    s_add_u32 s20, s20, 229376
    s_add_u32 m0, s22, 16384
    s_nop 0
    buffer_load_dwordx4 v13, s[8:11], s20 offen lds
    s_add_u32 m0, s22, 17408
    s_nop 0
    buffer_load_dwordx4 v14, s[8:11], s20 offen lds
    s_add_u32 s20, s20, 229376
    s_add_u32 m0, s22, 32768
    s_nop 0
    buffer_load_dwordx4 v13, s[8:11], s20 offen lds
    s_add_u32 m0, s22, 33792
    s_nop 0
    buffer_load_dwordx4 v14, s[8:11], s20 offen lds
    s_add_u32 s20, s20, 229376
    s_add_u32 m0, s22, 49152
    s_nop 0
    buffer_load_dwordx4 v13, s[8:11], s20 offen lds
    s_add_u32 m0, s22, 50176
    s_nop 0
    buffer_load_dwordx4 v14, s[8:11], s20 offen lds
    s_add_u32 s20, s20, 229376
    s_add_u32 m0, s22, 65536
    s_nop 0
    buffer_load_dwordx4 v13, s[8:11], s20 offen lds
    s_add_u32 m0, s22, 66560
    s_nop 0
    buffer_load_dwordx4 v14, s[8:11], s20 offen lds
    s_add_u32 s20, s20, 229376
    s_add_u32 m0, s22, 81920
    s_nop 0
    buffer_load_dwordx4 v13, s[8:11], s20 offen lds
    s_add_u32 m0, s22, 82944
    s_nop 0
    buffer_load_dwordx4 v14, s[8:11], s20 offen lds
    s_add_u32 s20, s20, 229376
    s_add_u32 m0, s22, 98304
    s_nop 0
    buffer_load_dwordx4 v13, s[8:11], s20 offen lds
    s_add_u32 m0, s22, 99328
    s_nop 0
    buffer_load_dwordx4 v14, s[8:11], s20 offen lds
    s_add_u32 s20, s20, 229376
    s_lshl_b32 s58, s5, 7
    s_add_u32 s58, s58, 163840
    s_add_u32 s48, s6, 130023424
    s_addc_u32 s49, s7, 0
    s_cmp_lg_u32 s3, 0
    s_cbranch_scc1 L_g1f_hw_b
    v_mov_b32 v2, s58
    s_mov_b32 s50, 0x200000
L_g1f_hw:
    global_load_dword v3, v2, s[48:49] sc1
    s_waitcnt vmcnt(0)
    v_readfirstlane_b32 s44, v3
    s_nop 0
    s_cmp_ge_u32 s44, 32
    s_cbranch_scc1 L_g1f_hw_ok
    s_sleep 5
    s_sub_u32 s50, s50, 1
    s_cbranch_scc0 L_g1f_hw
L_g1f_hw_ok:
L_g1f_hw_b:
    s_barrier
    s_add_u32 m0, s23, 8192
    s_nop 0
    buffer_load_dwordx4 v15, s[12:15], s21 offen lds
    s_add_u32 m0, s23, 9216
    s_nop 0
    buffer_load_dwordx4 v16, s[12:15], s21 offen lds
    s_add_u32 s21, s21, 65536
    s_add_u32 m0, s23, 24576
    s_nop 0
    buffer_load_dwordx4 v15, s[12:15], s21 offen lds
    s_add_u32 m0, s23, 25600
    s_nop 0
    buffer_load_dwordx4 v16, s[12:15], s21 offen lds
    s_add_u32 s21, s21, 65536
    s_add_u32 m0, s23, 40960
    s_nop 0
    buffer_load_dwordx4 v15, s[12:15], s21 offen lds
    s_add_u32 m0, s23, 41984
    s_nop 0
    buffer_load_dwordx4 v16, s[12:15], s21 offen lds
    s_add_u32 s21, s21, 65536
    s_add_u32 m0, s23, 57344
    s_nop 0
    buffer_load_dwordx4 v15, s[12:15], s21 offen lds
    s_add_u32 m0, s23, 58368
    s_nop 0
    buffer_load_dwordx4 v16, s[12:15], s21 offen lds
    s_add_u32 s21, s21, 65536
    s_add_u32 m0, s23, 73728
    s_nop 0
    buffer_load_dwordx4 v15, s[12:15], s21 offen lds
    s_add_u32 m0, s23, 74752
    s_nop 0
    buffer_load_dwordx4 v16, s[12:15], s21 offen lds
    s_add_u32 s21, s21, 65536
    s_add_u32 m0, s23, 90112
    s_nop 0
    buffer_load_dwordx4 v15, s[12:15], s21 offen lds
    s_add_u32 m0, s23, 91136
    s_nop 0
    buffer_load_dwordx4 v16, s[12:15], s21 offen lds
    s_add_u32 s21, s21, 65536
    s_add_u32 m0, s23, 106496
    s_nop 0
    buffer_load_dwordx4 v15, s[12:15], s21 offen lds
    s_add_u32 m0, s23, 107520
    s_nop 0
    buffer_load_dwordx4 v16, s[12:15], s21 offen lds
    s_add_u32 s21, s21, 65536
    s_waitcnt vmcnt(10)
    s_barrier
    ds_read_b128 v[36:39], v12 offset:0
    ds_read_b64_tr_b16 v[20:21], v8 offset:0
    ds_read_b64_tr_b16 v[22:23], v8 offset:1024
    ds_read_b128 v[40:43], v12 offset:1024
    ds_read_b64_tr_b16 v[24:25], v9 offset:0
    ds_read_b64_tr_b16 v[26:27], v9 offset:1024
    ds_read_b128 v[44:47], v12 offset:2048
    ds_read_b64_tr_b16 v[28:29], v10 offset:0
    ds_read_b64_tr_b16 v[30:31], v10 offset:1024
    ds_read_b128 v[48:51], v12 offset:3072
    ds_read_b64_tr_b16 v[32:33], v11 offset:0
    ds_read_b64_tr_b16 v[34:35], v11 offset:1024
    ds_read_b128 v[68:71], v12 offset:16384
    ds_read_b64_tr_b16 v[52:53], v8 offset:16384
    ds_read_b64_tr_b16 v[54:55], v8 offset:17408
    ds_read_b128 v[72:75], v12 offset:17408
    ds_read_b64_tr_b16 v[56:57], v9 offset:16384
    ds_read_b64_tr_b16 v[58:59], v9 offset:17408
    ds_read_b128 v[76:79], v12 offset:18432
    ds_read_b64_tr_b16 v[60:61], v10 offset:16384
    ds_read_b64_tr_b16 v[62:63], v10 offset:17408
    ds_read_b128 v[80:83], v12 offset:19456
    ds_read_b64_tr_b16 v[64:65], v11 offset:16384
    ds_read_b64_tr_b16 v[66:67], v11 offset:17408
    s_waitcnt vmcnt(6) lgkmcnt(12)
    s_barrier
    v_mfma_f32_16x16x32_bf16 a[0:3], v[20:23], v[36:39], 0
    ds_read_b128 v[100:103], v12 offset:32768
    s_add_u32 m0, s22, 114688
    v_mfma_f32_16x16x32_bf16 a[16:19], v[24:27], v[36:39], 0
    buffer_load_dwordx4 v13, s[8:11], s20 offen lds
    ds_read_b64_tr_b16 v[84:85], v8 offset:32768
    v_mfma_f32_16x16x32_bf16 a[32:35], v[28:31], v[36:39], 0
    ds_read_b64_tr_b16 v[86:87], v8 offset:33792
    v_mfma_f32_16x16x32_bf16 a[48:51], v[32:35], v[36:39], 0
    v_mfma_f32_16x16x32_bf16 a[4:7], v[20:23], v[40:43], 0
    ds_read_b128 v[104:107], v12 offset:33792
    s_add_u32 m0, s22, 115712
    v_mfma_f32_16x16x32_bf16 a[20:23], v[24:27], v[40:43], 0
    buffer_load_dwordx4 v14, s[8:11], s20 offen lds
    ds_read_b64_tr_b16 v[88:89], v9 offset:32768
    v_mfma_f32_16x16x32_bf16 a[36:39], v[28:31], v[40:43], 0
    ds_read_b64_tr_b16 v[90:91], v9 offset:33792
    v_mfma_f32_16x16x32_bf16 a[52:55], v[32:35], v[40:43], 0
    v_mfma_f32_16x16x32_bf16 a[8:11], v[20:23], v[44:47], 0
    ds_read_b128 v[108:111], v12 offset:34816
    s_add_u32 m0, s23, 122880
    v_mfma_f32_16x16x32_bf16 a[24:27], v[24:27], v[44:47], 0
    buffer_load_dwordx4 v15, s[12:15], s21 offen lds
    ds_read_b64_tr_b16 v[92:93], v10 offset:32768
    v_mfma_f32_16x16x32_bf16 a[40:43], v[28:31], v[44:47], 0
    ds_read_b64_tr_b16 v[94:95], v10 offset:33792
    v_mfma_f32_16x16x32_bf16 a[56:59], v[32:35], v[44:47], 0
    v_mfma_f32_16x16x32_bf16 a[12:15], v[20:23], v[48:51], 0
    ds_read_b128 v[112:115], v12 offset:35840
    s_add_u32 m0, s23, 123904
    v_mfma_f32_16x16x32_bf16 a[28:31], v[24:27], v[48:51], 0
    buffer_load_dwordx4 v16, s[12:15], s21 offen lds
    ds_read_b64_tr_b16 v[96:97], v11 offset:32768
    v_mfma_f32_16x16x32_bf16 a[44:47], v[28:31], v[48:51], 0
    ds_read_b64_tr_b16 v[98:99], v11 offset:33792
    v_mfma_f32_16x16x32_bf16 a[60:63], v[32:35], v[48:51], 0
    s_add_u32 s20, s20, 229376
    s_add_u32 s21, s21, 65536
    s_waitcnt lgkmcnt(12)
    v_mfma_f32_16x16x32_bf16 a[0:3], v[52:55], v[68:71], a[0:3]
    ds_read_b128 v[132:135], v12 offset:49152
    s_add_u32 m0, s22, 0
    v_mfma_f32_16x16x32_bf16 a[16:19], v[56:59], v[68:71], a[16:19]
    buffer_load_dwordx4 v13, s[8:11], s20 offen lds
    ds_read_b64_tr_b16 v[116:117], v8 offset:49152
    v_mfma_f32_16x16x32_bf16 a[32:35], v[60:63], v[68:71], a[32:35]
    ds_read_b64_tr_b16 v[118:119], v8 offset:50176
    v_mfma_f32_16x16x32_bf16 a[48:51], v[64:67], v[68:71], a[48:51]
    v_mfma_f32_16x16x32_bf16 a[4:7], v[52:55], v[72:75], a[4:7]
    ds_read_b128 v[136:139], v12 offset:50176
    s_add_u32 m0, s22, 1024
    v_mfma_f32_16x16x32_bf16 a[20:23], v[56:59], v[72:75], a[20:23]
    buffer_load_dwordx4 v14, s[8:11], s20 offen lds
    ds_read_b64_tr_b16 v[120:121], v9 offset:49152
    v_mfma_f32_16x16x32_bf16 a[36:39], v[60:63], v[72:75], a[36:39]
    ds_read_b64_tr_b16 v[122:123], v9 offset:50176
    v_mfma_f32_16x16x32_bf16 a[52:55], v[64:67], v[72:75], a[52:55]
    v_mfma_f32_16x16x32_bf16 a[8:11], v[52:55], v[76:79], a[8:11]
    ds_read_b128 v[140:143], v12 offset:51200
    s_add_u32 m0, s23, 8192
    v_mfma_f32_16x16x32_bf16 a[24:27], v[56:59], v[76:79], a[24:27]
    buffer_load_dwordx4 v15, s[12:15], s21 offen lds
    ds_read_b64_tr_b16 v[124:125], v10 offset:49152
    v_mfma_f32_16x16x32_bf16 a[40:43], v[60:63], v[76:79], a[40:43]
    ds_read_b64_tr_b16 v[126:127], v10 offset:50176
    v_mfma_f32_16x16x32_bf16 a[56:59], v[64:67], v[76:79], a[56:59]
    v_mfma_f32_16x16x32_bf16 a[12:15], v[52:55], v[80:83], a[12:15]
    ds_read_b128 v[144:147], v12 offset:52224
    s_add_u32 m0, s23, 9216
    v_mfma_f32_16x16x32_bf16 a[28:31], v[56:59], v[80:83], a[28:31]
    buffer_load_dwordx4 v16, s[12:15], s21 offen lds
    ds_read_b64_tr_b16 v[128:129], v11 offset:49152
    v_mfma_f32_16x16x32_bf16 a[44:47], v[60:63], v[80:83], a[44:47]
    ds_read_b64_tr_b16 v[130:131], v11 offset:50176
    v_mfma_f32_16x16x32_bf16 a[60:63], v[64:67], v[80:83], a[60:63]
    s_add_u32 s20, s20, 229376
    s_add_u32 s21, s21, 65536
    s_waitcnt vmcnt(10) lgkmcnt(12)
    s_barrier
    v_mfma_f32_16x16x32_bf16 a[0:3], v[84:87], v[100:103], a[0:3]
    ds_read_b128 v[36:39], v152 offset:0
    s_add_u32 m0, s22, 16384
    v_mfma_f32_16x16x32_bf16 a[16:19], v[88:91], v[100:103], a[16:19]
    buffer_load_dwordx4 v13, s[8:11], s20 offen lds
    ds_read_b64_tr_b16 v[20:21], v148 offset:0
    v_mfma_f32_16x16x32_bf16 a[32:35], v[92:95], v[100:103], a[32:35]
    ds_read_b64_tr_b16 v[22:23], v148 offset:1024
    v_mfma_f32_16x16x32_bf16 a[48:51], v[96:99], v[100:103], a[48:51]
    v_mfma_f32_16x16x32_bf16 a[4:7], v[84:87], v[104:107], a[4:7]
    ds_read_b128 v[40:43], v152 offset:1024
    s_add_u32 m0, s22, 17408
    v_mfma_f32_16x16x32_bf16 a[20:23], v[88:91], v[104:107], a[20:23]
    buffer_load_dwordx4 v14, s[8:11], s20 offen lds
    ds_read_b64_tr_b16 v[24:25], v149 offset:0
    v_mfma_f32_16x16x32_bf16 a[36:39], v[92:95], v[104:107], a[36:39]
    ds_read_b64_tr_b16 v[26:27], v149 offset:1024
    v_mfma_f32_16x16x32_bf16 a[52:55], v[96:99], v[104:107], a[52:55]
    v_mfma_f32_16x16x32_bf16 a[8:11], v[84:87], v[108:111], a[8:11]
    ds_read_b128 v[44:47], v152 offset:2048
    s_add_u32 m0, s23, 24576
    v_mfma_f32_16x16x32_bf16 a[24:27], v[88:91], v[108:111], a[24:27]
    buffer_load_dwordx4 v15, s[12:15], s21 offen lds
    ds_read_b64_tr_b16 v[28:29], v150 offset:0
    v_mfma_f32_16x16x32_bf16 a[40:43], v[92:95], v[108:111], a[40:43]
    ds_read_b64_tr_b16 v[30:31], v150 offset:1024
    v_mfma_f32_16x16x32_bf16 a[56:59], v[96:99], v[108:111], a[56:59]
    v_mfma_f32_16x16x32_bf16 a[12:15], v[84:87], v[112:115], a[12:15]
    ds_read_b128 v[48:51], v152 offset:3072
    s_add_u32 m0, s23, 25600
    v_mfma_f32_16x16x32_bf16 a[28:31], v[88:91], v[112:115], a[28:31]
    buffer_load_dwordx4 v16, s[12:15], s21 offen lds
    ds_read_b64_tr_b16 v[32:33], v151 offset:0
    v_mfma_f32_16x16x32_bf16 a[44:47], v[92:95], v[112:115], a[44:47]
    ds_read_b64_tr_b16 v[34:35], v151 offset:1024
    v_mfma_f32_16x16x32_bf16 a[60:63], v[96:99], v[112:115], a[60:63]
    s_add_u32 s20, s20, 229376
    s_add_u32 s21, s21, 65536
    s_waitcnt lgkmcnt(12)
    v_mfma_f32_16x16x32_bf16 a[0:3], v[116:119], v[132:135], a[0:3]
    ds_read_b128 v[68:71], v152 offset:16384
    s_add_u32 m0, s22, 32768
    v_mfma_f32_16x16x32_bf16 a[16:19], v[120:123], v[132:135], a[16:19]
    buffer_load_dwordx4 v13, s[8:11], s20 offen lds
    ds_read_b64_tr_b16 v[52:53], v148 offset:16384
    v_mfma_f32_16x16x32_bf16 a[32:35], v[124:127], v[132:135], a[32:35]
    ds_read_b64_tr_b16 v[54:55], v148 offset:17408
    v_mfma_f32_16x16x32_bf16 a[48:51], v[128:131], v[132:135], a[48:51]
    v_mfma_f32_16x16x32_bf16 a[4:7], v[116:119], v[136:139], a[4:7]
    ds_read_b128 v[72:75], v152 offset:17408
    s_add_u32 m0, s22, 33792
    v_mfma_f32_16x16x32_bf16 a[20:23], v[120:123], v[136:139], a[20:23]
    buffer_load_dwordx4 v14, s[8:11], s20 offen lds
    ds_read_b64_tr_b16 v[56:57], v149 offset:16384
    v_mfma_f32_16x16x32_bf16 a[36:39], v[124:127], v[136:139], a[36:39]
    ds_read_b64_tr_b16 v[58:59], v149 offset:17408
    v_mfma_f32_16x16x32_bf16 a[52:55], v[128:131], v[136:139], a[52:55]
    v_mfma_f32_16x16x32_bf16 a[8:11], v[116:119], v[140:143], a[8:11]
    ds_read_b128 v[76:79], v152 offset:18432
    s_add_u32 m0, s23, 40960
    v_mfma_f32_16x16x32_bf16 a[24:27], v[120:123], v[140:143], a[24:27]
    buffer_load_dwordx4 v15, s[12:15], s21 offen lds
    ds_read_b64_tr_b16 v[60:61], v150 offset:16384
    v_mfma_f32_16x16x32_bf16 a[40:43], v[124:127], v[140:143], a[40:43]
    ds_read_b64_tr_b16 v[62:63], v150 offset:17408
    v_mfma_f32_16x16x32_bf16 a[56:59], v[128:131], v[140:143], a[56:59]
    v_mfma_f32_16x16x32_bf16 a[12:15], v[116:119], v[144:147], a[12:15]
    ds_read_b128 v[80:83], v152 offset:19456
    s_add_u32 m0, s23, 41984
    v_mfma_f32_16x16x32_bf16 a[28:31], v[120:123], v[144:147], a[28:31]
    buffer_load_dwordx4 v16, s[12:15], s21 offen lds
    ds_read_b64_tr_b16 v[64:65], v151 offset:16384
    v_mfma_f32_16x16x32_bf16 a[44:47], v[124:127], v[144:147], a[44:47]
    ds_read_b64_tr_b16 v[66:67], v151 offset:17408
    v_mfma_f32_16x16x32_bf16 a[60:63], v[128:131], v[144:147], a[60:63]
    s_add_u32 s20, s20, 229376
    s_add_u32 s21, s21, 65536
    s_waitcnt vmcnt(12) lgkmcnt(12)
    s_barrier
    v_mfma_f32_16x16x32_bf16 a[0:3], v[20:23], v[36:39], a[0:3]
    ds_read_b128 v[100:103], v152 offset:32768
    s_add_u32 m0, s22, 49152
    v_mfma_f32_16x16x32_bf16 a[16:19], v[24:27], v[36:39], a[16:19]
    buffer_load_dwordx4 v13, s[8:11], s20 offen lds
    ds_read_b64_tr_b16 v[84:85], v148 offset:32768
    v_mfma_f32_16x16x32_bf16 a[32:35], v[28:31], v[36:39], a[32:35]
    ds_read_b64_tr_b16 v[86:87], v148 offset:33792
    v_mfma_f32_16x16x32_bf16 a[48:51], v[32:35], v[36:39], a[48:51]
    v_mfma_f32_16x16x32_bf16 a[4:7], v[20:23], v[40:43], a[4:7]
    ds_read_b128 v[104:107], v152 offset:33792
    s_add_u32 m0, s22, 50176
    v_mfma_f32_16x16x32_bf16 a[20:23], v[24:27], v[40:43], a[20:23]
    buffer_load_dwordx4 v14, s[8:11], s20 offen lds
    ds_read_b64_tr_b16 v[88:89], v149 offset:32768
    v_mfma_f32_16x16x32_bf16 a[36:39], v[28:31], v[40:43], a[36:39]
    ds_read_b64_tr_b16 v[90:91], v149 offset:33792
    v_mfma_f32_16x16x32_bf16 a[52:55], v[32:35], v[40:43], a[52:55]
    v_mfma_f32_16x16x32_bf16 a[8:11], v[20:23], v[44:47], a[8:11]
    ds_read_b128 v[108:111], v152 offset:34816
    s_add_u32 m0, s23, 57344
    v_mfma_f32_16x16x32_bf16 a[24:27], v[24:27], v[44:47], a[24:27]
    buffer_load_dwordx4 v15, s[12:15], s21 offen lds
    ds_read_b64_tr_b16 v[92:93], v150 offset:32768
    v_mfma_f32_16x16x32_bf16 a[40:43], v[28:31], v[44:47], a[40:43]
    ds_read_b64_tr_b16 v[94:95], v150 offset:33792
    v_mfma_f32_16x16x32_bf16 a[56:59], v[32:35], v[44:47], a[56:59]
    v_mfma_f32_16x16x32_bf16 a[12:15], v[20:23], v[48:51], a[12:15]
    ds_read_b128 v[112:115], v152 offset:35840
    s_add_u32 m0, s23, 58368
    v_mfma_f32_16x16x32_bf16 a[28:31], v[24:27], v[48:51], a[28:31]
    buffer_load_dwordx4 v16, s[12:15], s21 offen lds
    ds_read_b64_tr_b16 v[96:97], v151 offset:32768
    v_mfma_f32_16x16x32_bf16 a[44:47], v[28:31], v[48:51], a[44:47]
    ds_read_b64_tr_b16 v[98:99], v151 offset:33792
    v_mfma_f32_16x16x32_bf16 a[60:63], v[32:35], v[48:51], a[60:63]
    s_add_u32 s20, s20, 229376
    s_add_u32 s21, s21, 65536
    s_waitcnt lgkmcnt(12)
    v_mfma_f32_16x16x32_bf16 a[0:3], v[52:55], v[68:71], a[0:3]
    ds_read_b128 v[132:135], v152 offset:49152
    s_add_u32 m0, s22, 65536
    v_mfma_f32_16x16x32_bf16 a[16:19], v[56:59], v[68:71], a[16:19]
    buffer_load_dwordx4 v13, s[8:11], s20 offen lds
    ds_read_b64_tr_b16 v[116:117], v148 offset:49152
    v_mfma_f32_16x16x32_bf16 a[32:35], v[60:63], v[68:71], a[32:35]
    ds_read_b64_tr_b16 v[118:119], v148 offset:50176
    v_mfma_f32_16x16x32_bf16 a[48:51], v[64:67], v[68:71], a[48:51]
    v_mfma_f32_16x16x32_bf16 a[4:7], v[52:55], v[72:75], a[4:7]
    ds_read_b128 v[136:139], v152 offset:50176
    s_add_u32 m0, s22, 66560
    v_mfma_f32_16x16x32_bf16 a[20:23], v[56:59], v[72:75], a[20:23]
    buffer_load_dwordx4 v14, s[8:11], s20 offen lds
    ds_read_b64_tr_b16 v[120:121], v149 offset:49152
    v_mfma_f32_16x16x32_bf16 a[36:39], v[60:63], v[72:75], a[36:39]
    ds_read_b64_tr_b16 v[122:123], v149 offset:50176
    v_mfma_f32_16x16x32_bf16 a[52:55], v[64:67], v[72:75], a[52:55]
    v_mfma_f32_16x16x32_bf16 a[8:11], v[52:55], v[76:79], a[8:11]
    ds_read_b128 v[140:143], v152 offset:51200
    s_add_u32 m0, s23, 73728
    v_mfma_f32_16x16x32_bf16 a[24:27], v[56:59], v[76:79], a[24:27]
    buffer_load_dwordx4 v15, s[12:15], s21 offen lds
    ds_read_b64_tr_b16 v[124:125], v150 offset:49152
    v_mfma_f32_16x16x32_bf16 a[40:43], v[60:63], v[76:79], a[40:43]
    ds_read_b64_tr_b16 v[126:127], v150 offset:50176
    v_mfma_f32_16x16x32_bf16 a[56:59], v[64:67], v[76:79], a[56:59]
    v_mfma_f32_16x16x32_bf16 a[12:15], v[52:55], v[80:83], a[12:15]
    ds_read_b128 v[144:147], v152 offset:52224
    s_add_u32 m0, s23, 74752
    v_mfma_f32_16x16x32_bf16 a[28:31], v[56:59], v[80:83], a[28:31]
    buffer_load_dwordx4 v16, s[12:15], s21 offen lds
    ds_read_b64_tr_b16 v[128:129], v151 offset:49152
    v_mfma_f32_16x16x32_bf16 a[44:47], v[60:63], v[80:83], a[44:47]
    ds_read_b64_tr_b16 v[130:131], v151 offset:50176
    v_mfma_f32_16x16x32_bf16 a[60:63], v[64:67], v[80:83], a[60:63]
    s_add_u32 s20, s20, 229376
    s_add_u32 s21, s21, 65536
    s_waitcnt vmcnt(12) lgkmcnt(12)
    s_barrier
    v_mfma_f32_16x16x32_bf16 a[0:3], v[84:87], v[100:103], a[0:3]
    ds_read_b128 v[36:39], v12 offset:0
    s_add_u32 m0, s22, 81920
    v_mfma_f32_16x16x32_bf16 a[16:19], v[88:91], v[100:103], a[16:19]
    buffer_load_dwordx4 v13, s[8:11], s20 offen lds
    ds_read_b64_tr_b16 v[20:21], v8 offset:0
    v_mfma_f32_16x16x32_bf16 a[32:35], v[92:95], v[100:103], a[32:35]
    ds_read_b64_tr_b16 v[22:23], v8 offset:1024
    v_mfma_f32_16x16x32_bf16 a[48:51], v[96:99], v[100:103], a[48:51]
    v_mfma_f32_16x16x32_bf16 a[4:7], v[84:87], v[104:107], a[4:7]
    ds_read_b128 v[40:43], v12 offset:1024
    s_add_u32 m0, s22, 82944
    v_mfma_f32_16x16x32_bf16 a[20:23], v[88:91], v[104:107], a[20:23]
    buffer_load_dwordx4 v14, s[8:11], s20 offen lds
    ds_read_b64_tr_b16 v[24:25], v9 offset:0
    v_mfma_f32_16x16x32_bf16 a[36:39], v[92:95], v[104:107], a[36:39]
    ds_read_b64_tr_b16 v[26:27], v9 offset:1024
    v_mfma_f32_16x16x32_bf16 a[52:55], v[96:99], v[104:107], a[52:55]
    v_mfma_f32_16x16x32_bf16 a[8:11], v[84:87], v[108:111], a[8:11]
    ds_read_b128 v[44:47], v12 offset:2048
    s_add_u32 m0, s23, 90112
    v_mfma_f32_16x16x32_bf16 a[24:27], v[88:91], v[108:111], a[24:27]
    buffer_load_dwordx4 v15, s[12:15], s21 offen lds
    ds_read_b64_tr_b16 v[28:29], v10 offset:0
    v_mfma_f32_16x16x32_bf16 a[40:43], v[92:95], v[108:111], a[40:43]
    ds_read_b64_tr_b16 v[30:31], v10 offset:1024
    v_mfma_f32_16x16x32_bf16 a[56:59], v[96:99], v[108:111], a[56:59]
    v_mfma_f32_16x16x32_bf16 a[12:15], v[84:87], v[112:115], a[12:15]
    ds_read_b128 v[48:51], v12 offset:3072
    s_add_u32 m0, s23, 91136
    v_mfma_f32_16x16x32_bf16 a[28:31], v[88:91], v[112:115], a[28:31]
    buffer_load_dwordx4 v16, s[12:15], s21 offen lds
    ds_read_b64_tr_b16 v[32:33], v11 offset:0
    v_mfma_f32_16x16x32_bf16 a[44:47], v[92:95], v[112:115], a[44:47]
    ds_read_b64_tr_b16 v[34:35], v11 offset:1024
    v_mfma_f32_16x16x32_bf16 a[60:63], v[96:99], v[112:115], a[60:63]
    s_add_u32 s20, s20, 229376
    s_add_u32 s21, s21, 65536
    s_waitcnt lgkmcnt(12)
    v_mfma_f32_16x16x32_bf16 a[0:3], v[116:119], v[132:135], a[0:3]
    ds_read_b128 v[68:71], v12 offset:16384
    s_add_u32 m0, s22, 98304
    v_mfma_f32_16x16x32_bf16 a[16:19], v[120:123], v[132:135], a[16:19]
    buffer_load_dwordx4 v13, s[8:11], s20 offen lds
    ds_read_b64_tr_b16 v[52:53], v8 offset:16384
    v_mfma_f32_16x16x32_bf16 a[32:35], v[124:127], v[132:135], a[32:35]
    ds_read_b64_tr_b16 v[54:55], v8 offset:17408
    v_mfma_f32_16x16x32_bf16 a[48:51], v[128:131], v[132:135], a[48:51]
    v_mfma_f32_16x16x32_bf16 a[4:7], v[116:119], v[136:139], a[4:7]
    ds_read_b128 v[72:75], v12 offset:17408
    s_add_u32 m0, s22, 99328
    v_mfma_f32_16x16x32_bf16 a[20:23], v[120:123], v[136:139], a[20:23]
    buffer_load_dwordx4 v14, s[8:11], s20 offen lds
    ds_read_b64_tr_b16 v[56:57], v9 offset:16384
    v_mfma_f32_16x16x32_bf16 a[36:39], v[124:127], v[136:139], a[36:39]
    ds_read_b64_tr_b16 v[58:59], v9 offset:17408
    v_mfma_f32_16x16x32_bf16 a[52:55], v[128:131], v[136:139], a[52:55]
    v_mfma_f32_16x16x32_bf16 a[8:11], v[116:119], v[140:143], a[8:11]
    ds_read_b128 v[76:79], v12 offset:18432
    s_add_u32 m0, s23, 106496
    v_mfma_f32_16x16x32_bf16 a[24:27], v[120:123], v[140:143], a[24:27]
    buffer_load_dwordx4 v15, s[12:15], s21 offen lds
    ds_read_b64_tr_b16 v[60:61], v10 offset:16384
    v_mfma_f32_16x16x32_bf16 a[40:43], v[124:127], v[140:143], a[40:43]
    ds_read_b64_tr_b16 v[62:63], v10 offset:17408
    v_mfma_f32_16x16x32_bf16 a[56:59], v[128:131], v[140:143], a[56:59]
    v_mfma_f32_16x16x32_bf16 a[12:15], v[116:119], v[144:147], a[12:15]
    ds_read_b128 v[80:83], v12 offset:19456
    s_add_u32 m0, s23, 107520
    v_mfma_f32_16x16x32_bf16 a[28:31], v[120:123], v[144:147], a[28:31]
    buffer_load_dwordx4 v16, s[12:15], s21 offen lds
    ds_read_b64_tr_b16 v[64:65], v11 offset:16384
    v_mfma_f32_16x16x32_bf16 a[44:47], v[124:127], v[144:147], a[44:47]
    ds_read_b64_tr_b16 v[66:67], v11 offset:17408
    v_mfma_f32_16x16x32_bf16 a[60:63], v[128:131], v[144:147], a[60:63]
    s_add_u32 s20, s20, 229376
    s_add_u32 s21, s21, 65536
    s_waitcnt vmcnt(12) lgkmcnt(12)
    s_barrier
    s_mov_b32 s24, 7
L_g1f_loop:
    v_mfma_f32_16x16x32_bf16 a[0:3], v[20:23], v[36:39], a[0:3]
    ds_read_b128 v[100:103], v12 offset:32768
    s_add_u32 m0, s22, 114688
    v_mfma_f32_16x16x32_bf16 a[16:19], v[24:27], v[36:39], a[16:19]
    buffer_load_dwordx4 v13, s[8:11], s20 offen lds
    ds_read_b64_tr_b16 v[84:85], v8 offset:32768
    v_mfma_f32_16x16x32_bf16 a[32:35], v[28:31], v[36:39], a[32:35]
    ds_read_b64_tr_b16 v[86:87], v8 offset:33792
    v_mfma_f32_16x16x32_bf16 a[48:51], v[32:35], v[36:39], a[48:51]
    v_mfma_f32_16x16x32_bf16 a[4:7], v[20:23], v[40:43], a[4:7]
    ds_read_b128 v[104:107], v12 offset:33792
    s_add_u32 m0, s22, 115712
    v_mfma_f32_16x16x32_bf16 a[20:23], v[24:27], v[40:43], a[20:23]
    buffer_load_dwordx4 v14, s[8:11], s20 offen lds
    ds_read_b64_tr_b16 v[88:89], v9 offset:32768
    v_mfma_f32_16x16x32_bf16 a[36:39], v[28:31], v[40:43], a[36:39]
    ds_read_b64_tr_b16 v[90:91], v9 offset:33792
    v_mfma_f32_16x16x32_bf16 a[52:55], v[32:35], v[40:43], a[52:55]
    v_mfma_f32_16x16x32_bf16 a[8:11], v[20:23], v[44:47], a[8:11]
    ds_read_b128 v[108:111], v12 offset:34816
    s_add_u32 m0, s23, 122880
    v_mfma_f32_16x16x32_bf16 a[24:27], v[24:27], v[44:47], a[24:27]
    buffer_load_dwordx4 v15, s[12:15], s21 offen lds
    ds_read_b64_tr_b16 v[92:93], v10 offset:32768
    v_mfma_f32_16x16x32_bf16 a[40:43], v[28:31], v[44:47], a[40:43]
    ds_read_b64_tr_b16 v[94:95], v10 offset:33792
    v_mfma_f32_16x16x32_bf16 a[56:59], v[32:35], v[44:47], a[56:59]
    v_mfma_f32_16x16x32_bf16 a[12:15], v[20:23], v[48:51], a[12:15]
    ds_read_b128 v[112:115], v12 offset:35840
    s_add_u32 m0, s23, 123904
    v_mfma_f32_16x16x32_bf16 a[28:31], v[24:27], v[48:51], a[28:31]
    buffer_load_dwordx4 v16, s[12:15], s21 offen lds
    ds_read_b64_tr_b16 v[96:97], v11 offset:32768
    v_mfma_f32_16x16x32_bf16 a[44:47], v[28:31], v[48:51], a[44:47]
    ds_read_b64_tr_b16 v[98:99], v11 offset:33792
    v_mfma_f32_16x16x32_bf16 a[60:63], v[32:35], v[48:51], a[60:63]
    s_add_u32 s20, s20, 229376
    s_add_u32 s21, s21, 65536
    s_waitcnt lgkmcnt(12)
    v_mfma_f32_16x16x32_bf16 a[0:3], v[52:55], v[68:71], a[0:3]
    ds_read_b128 v[132:135], v12 offset:49152
    s_add_u32 m0, s22, 0
    v_mfma_f32_16x16x32_bf16 a[16:19], v[56:59], v[68:71], a[16:19]
    buffer_load_dwordx4 v13, s[8:11], s20 offen lds
    ds_read_b64_tr_b16 v[116:117], v8 offset:49152
    v_mfma_f32_16x16x32_bf16 a[32:35], v[60:63], v[68:71], a[32:35]
    ds_read_b64_tr_b16 v[118:119], v8 offset:50176
    v_mfma_f32_16x16x32_bf16 a[48:51], v[64:67], v[68:71], a[48:51]
    v_mfma_f32_16x16x32_bf16 a[4:7], v[52:55], v[72:75], a[4:7]
    ds_read_b128 v[136:139], v12 offset:50176
    s_add_u32 m0, s22, 1024
    v_mfma_f32_16x16x32_bf16 a[20:23], v[56:59], v[72:75], a[20:23]
    buffer_load_dwordx4 v14, s[8:11], s20 offen lds
    ds_read_b64_tr_b16 v[120:121], v9 offset:49152
    v_mfma_f32_16x16x32_bf16 a[36:39], v[60:63], v[72:75], a[36:39]
    ds_read_b64_tr_b16 v[122:123], v9 offset:50176
    v_mfma_f32_16x16x32_bf16 a[52:55], v[64:67], v[72:75], a[52:55]
    v_mfma_f32_16x16x32_bf16 a[8:11], v[52:55], v[76:79], a[8:11]
    ds_read_b128 v[140:143], v12 offset:51200
    s_add_u32 m0, s23, 8192
    v_mfma_f32_16x16x32_bf16 a[24:27], v[56:59], v[76:79], a[24:27]
    buffer_load_dwordx4 v15, s[12:15], s21 offen lds
    ds_read_b64_tr_b16 v[124:125], v10 offset:49152
    v_mfma_f32_16x16x32_bf16 a[40:43], v[60:63], v[76:79], a[40:43]
    ds_read_b64_tr_b16 v[126:127], v10 offset:50176
    v_mfma_f32_16x16x32_bf16 a[56:59], v[64:67], v[76:79], a[56:59]
    v_mfma_f32_16x16x32_bf16 a[12:15], v[52:55], v[80:83], a[12:15]
    ds_read_b128 v[144:147], v12 offset:52224
    s_add_u32 m0, s23, 9216
    v_mfma_f32_16x16x32_bf16 a[28:31], v[56:59], v[80:83], a[28:31]
    buffer_load_dwordx4 v16, s[12:15], s21 offen lds
    ds_read_b64_tr_b16 v[128:129], v11 offset:49152
    v_mfma_f32_16x16x32_bf16 a[44:47], v[60:63], v[80:83], a[44:47]
    ds_read_b64_tr_b16 v[130:131], v11 offset:50176
    v_mfma_f32_16x16x32_bf16 a[60:63], v[64:67], v[80:83], a[60:63]
    s_add_u32 s20, s20, 229376
    s_add_u32 s21, s21, 65536
    s_waitcnt vmcnt(12) lgkmcnt(12)
    s_barrier
    v_mfma_f32_16x16x32_bf16 a[0:3], v[84:87], v[100:103], a[0:3]
    ds_read_b128 v[36:39], v152 offset:0
    s_add_u32 m0, s22, 16384
    v_mfma_f32_16x16x32_bf16 a[16:19], v[88:91], v[100:103], a[16:19]
    buffer_load_dwordx4 v13, s[8:11], s20 offen lds
    ds_read_b64_tr_b16 v[20:21], v148 offset:0
    v_mfma_f32_16x16x32_bf16 a[32:35], v[92:95], v[100:103], a[32:35]
    ds_read_b64_tr_b16 v[22:23], v148 offset:1024
    v_mfma_f32_16x16x32_bf16 a[48:51], v[96:99], v[100:103], a[48:51]
    v_mfma_f32_16x16x32_bf16 a[4:7], v[84:87], v[104:107], a[4:7]
    ds_read_b128 v[40:43], v152 offset:1024
    s_add_u32 m0, s22, 17408
    v_mfma_f32_16x16x32_bf16 a[20:23], v[88:91], v[104:107], a[20:23]
    buffer_load_dwordx4 v14, s[8:11], s20 offen lds
    ds_read_b64_tr_b16 v[24:25], v149 offset:0
    v_mfma_f32_16x16x32_bf16 a[36:39], v[92:95], v[104:107], a[36:39]
    ds_read_b64_tr_b16 v[26:27], v149 offset:1024
    v_mfma_f32_16x16x32_bf16 a[52:55], v[96:99], v[104:107], a[52:55]
    v_mfma_f32_16x16x32_bf16 a[8:11], v[84:87], v[108:111], a[8:11]
    ds_read_b128 v[44:47], v152 offset:2048
    s_add_u32 m0, s23, 24576
    v_mfma_f32_16x16x32_bf16 a[24:27], v[88:91], v[108:111], a[24:27]
    buffer_load_dwordx4 v15, s[12:15], s21 offen lds
    ds_read_b64_tr_b16 v[28:29], v150 offset:0
    v_mfma_f32_16x16x32_bf16 a[40:43], v[92:95], v[108:111], a[40:43]
    ds_read_b64_tr_b16 v[30:31], v150 offset:1024
    v_mfma_f32_16x16x32_bf16 a[56:59], v[96:99], v[108:111], a[56:59]
    v_mfma_f32_16x16x32_bf16 a[12:15], v[84:87], v[112:115], a[12:15]
    ds_read_b128 v[48:51], v152 offset:3072
    s_add_u32 m0, s23, 25600
    v_mfma_f32_16x16x32_bf16 a[28:31], v[88:91], v[112:115], a[28:31]
    buffer_load_dwordx4 v16, s[12:15], s21 offen lds
    ds_read_b64_tr_b16 v[32:33], v151 offset:0
    v_mfma_f32_16x16x32_bf16 a[44:47], v[92:95], v[112:115], a[44:47]
    ds_read_b64_tr_b16 v[34:35], v151 offset:1024
    v_mfma_f32_16x16x32_bf16 a[60:63], v[96:99], v[112:115], a[60:63]
    s_add_u32 s20, s20, 229376
    s_add_u32 s21, s21, 65536
    s_waitcnt lgkmcnt(12)
    v_mfma_f32_16x16x32_bf16 a[0:3], v[116:119], v[132:135], a[0:3]
    ds_read_b128 v[68:71], v152 offset:16384
    s_add_u32 m0, s22, 32768
    v_mfma_f32_16x16x32_bf16 a[16:19], v[120:123], v[132:135], a[16:19]
    buffer_load_dwordx4 v13, s[8:11], s20 offen lds
    ds_read_b64_tr_b16 v[52:53], v148 offset:16384
    v_mfma_f32_16x16x32_bf16 a[32:35], v[124:127], v[132:135], a[32:35]
    ds_read_b64_tr_b16 v[54:55], v148 offset:17408
    v_mfma_f32_16x16x32_bf16 a[48:51], v[128:131], v[132:135], a[48:51]
    v_mfma_f32_16x16x32_bf16 a[4:7], v[116:119], v[136:139], a[4:7]
    ds_read_b128 v[72:75], v152 offset:17408
    s_add_u32 m0, s22, 33792
    v_mfma_f32_16x16x32_bf16 a[20:23], v[120:123], v[136:139], a[20:23]
    buffer_load_dwordx4 v14, s[8:11], s20 offen lds
    ds_read_b64_tr_b16 v[56:57], v149 offset:16384
    v_mfma_f32_16x16x32_bf16 a[36:39], v[124:127], v[136:139], a[36:39]
    ds_read_b64_tr_b16 v[58:59], v149 offset:17408
    v_mfma_f32_16x16x32_bf16 a[52:55], v[128:131], v[136:139], a[52:55]
    v_mfma_f32_16x16x32_bf16 a[8:11], v[116:119], v[140:143], a[8:11]
    ds_read_b128 v[76:79], v152 offset:18432
    s_add_u32 m0, s23, 40960
    v_mfma_f32_16x16x32_bf16 a[24:27], v[120:123], v[140:143], a[24:27]
    buffer_load_dwordx4 v15, s[12:15], s21 offen lds
    ds_read_b64_tr_b16 v[60:61], v150 offset:16384
    v_mfma_f32_16x16x32_bf16 a[40:43], v[124:127], v[140:143], a[40:43]
    ds_read_b64_tr_b16 v[62:63], v150 offset:17408
    v_mfma_f32_16x16x32_bf16 a[56:59], v[128:131], v[140:143], a[56:59]
    v_mfma_f32_16x16x32_bf16 a[12:15], v[116:119], v[144:147], a[12:15]
    ds_read_b128 v[80:83], v152 offset:19456
    s_add_u32 m0, s23, 41984
    v_mfma_f32_16x16x32_bf16 a[28:31], v[120:123], v[144:147], a[28:31]
    buffer_load_dwordx4 v16, s[12:15], s21 offen lds
    ds_read_b64_tr_b16 v[64:65], v151 offset:16384
    v_mfma_f32_16x16x32_bf16 a[44:47], v[124:127], v[144:147], a[44:47]
    ds_read_b64_tr_b16 v[66:67], v151 offset:17408
    v_mfma_f32_16x16x32_bf16 a[60:63], v[128:131], v[144:147], a[60:63]
    s_add_u32 s20, s20, 229376
    s_add_u32 s21, s21, 65536
    s_waitcnt vmcnt(12) lgkmcnt(12)
    s_barrier
    v_mfma_f32_16x16x32_bf16 a[0:3], v[20:23], v[36:39], a[0:3]
    ds_read_b128 v[100:103], v152 offset:32768
    s_add_u32 m0, s22, 49152
    v_mfma_f32_16x16x32_bf16 a[16:19], v[24:27], v[36:39], a[16:19]
    buffer_load_dwordx4 v13, s[8:11], s20 offen lds
    ds_read_b64_tr_b16 v[84:85], v148 offset:32768
    v_mfma_f32_16x16x32_bf16 a[32:35], v[28:31], v[36:39], a[32:35]
    ds_read_b64_tr_b16 v[86:87], v148 offset:33792
    v_mfma_f32_16x16x32_bf16 a[48:51], v[32:35], v[36:39], a[48:51]
    v_mfma_f32_16x16x32_bf16 a[4:7], v[20:23], v[40:43], a[4:7]
    ds_read_b128 v[104:107], v152 offset:33792
    s_add_u32 m0, s22, 50176
    v_mfma_f32_16x16x32_bf16 a[20:23], v[24:27], v[40:43], a[20:23]
    buffer_load_dwordx4 v14, s[8:11], s20 offen lds
    ds_read_b64_tr_b16 v[88:89], v149 offset:32768
    v_mfma_f32_16x16x32_bf16 a[36:39], v[28:31], v[40:43], a[36:39]
    ds_read_b64_tr_b16 v[90:91], v149 offset:33792
    v_mfma_f32_16x16x32_bf16 a[52:55], v[32:35], v[40:43], a[52:55]
    v_mfma_f32_16x16x32_bf16 a[8:11], v[20:23], v[44:47], a[8:11]
    ds_read_b128 v[108:111], v152 offset:34816
    s_add_u32 m0, s23, 57344
    v_mfma_f32_16x16x32_bf16 a[24:27], v[24:27], v[44:47], a[24:27]
    buffer_load_dwordx4 v15, s[12:15], s21 offen lds
    ds_read_b64_tr_b16 v[92:93], v150 offset:32768
    v_mfma_f32_16x16x32_bf16 a[40:43], v[28:31], v[44:47], a[40:43]
    ds_read_b64_tr_b16 v[94:95], v150 offset:33792
    v_mfma_f32_16x16x32_bf16 a[56:59], v[32:35], v[44:47], a[56:59]
    v_mfma_f32_16x16x32_bf16 a[12:15], v[20:23], v[48:51], a[12:15]
    ds_read_b128 v[112:115], v152 offset:35840
    s_add_u32 m0, s23, 58368
    v_mfma_f32_16x16x32_bf16 a[28:31], v[24:27], v[48:51], a[28:31]
    buffer_load_dwordx4 v16, s[12:15], s21 offen lds
    ds_read_b64_tr_b16 v[96:97], v151 offset:32768
    v_mfma_f32_16x16x32_bf16 a[44:47], v[28:31], v[48:51], a[44:47]
    ds_read_b64_tr_b16 v[98:99], v151 offset:33792
    v_mfma_f32_16x16x32_bf16 a[60:63], v[32:35], v[48:51], a[60:63]
    s_add_u32 s20, s20, 229376
    s_add_u32 s21, s21, 65536
    s_waitcnt lgkmcnt(12)
    v_mfma_f32_16x16x32_bf16 a[0:3], v[52:55], v[68:71], a[0:3]
    ds_read_b128 v[132:135], v152 offset:49152
    s_add_u32 m0, s22, 65536
    v_mfma_f32_16x16x32_bf16 a[16:19], v[56:59], v[68:71], a[16:19]
    buffer_load_dwordx4 v13, s[8:11], s20 offen lds
    ds_read_b64_tr_b16 v[116:117], v148 offset:49152
    v_mfma_f32_16x16x32_bf16 a[32:35], v[60:63], v[68:71], a[32:35]
    ds_read_b64_tr_b16 v[118:119], v148 offset:50176
    v_mfma_f32_16x16x32_bf16 a[48:51], v[64:67], v[68:71], a[48:51]
    v_mfma_f32_16x16x32_bf16 a[4:7], v[52:55], v[72:75], a[4:7]
    ds_read_b128 v[136:139], v152 offset:50176
    s_add_u32 m0, s22, 66560
    v_mfma_f32_16x16x32_bf16 a[20:23], v[56:59], v[72:75], a[20:23]
    buffer_load_dwordx4 v14, s[8:11], s20 offen lds
    ds_read_b64_tr_b16 v[120:121], v149 offset:49152
    v_mfma_f32_16x16x32_bf16 a[36:39], v[60:63], v[72:75], a[36:39]
    ds_read_b64_tr_b16 v[122:123], v149 offset:50176
    v_mfma_f32_16x16x32_bf16 a[52:55], v[64:67], v[72:75], a[52:55]
    v_mfma_f32_16x16x32_bf16 a[8:11], v[52:55], v[76:79], a[8:11]
    ds_read_b128 v[140:143], v152 offset:51200
    s_add_u32 m0, s23, 73728
    v_mfma_f32_16x16x32_bf16 a[24:27], v[56:59], v[76:79], a[24:27]
    buffer_load_dwordx4 v15, s[12:15], s21 offen lds
    ds_read_b64_tr_b16 v[124:125], v150 offset:49152
    v_mfma_f32_16x16x32_bf16 a[40:43], v[60:63], v[76:79], a[40:43]
    ds_read_b64_tr_b16 v[126:127], v150 offset:50176
    v_mfma_f32_16x16x32_bf16 a[56:59], v[64:67], v[76:79], a[56:59]
    v_mfma_f32_16x16x32_bf16 a[12:15], v[52:55], v[80:83], a[12:15]
    ds_read_b128 v[144:147], v152 offset:52224
    s_add_u32 m0, s23, 74752
    v_mfma_f32_16x16x32_bf16 a[28:31], v[56:59], v[80:83], a[28:31]
    buffer_load_dwordx4 v16, s[12:15], s21 offen lds
    ds_read_b64_tr_b16 v[128:129], v151 offset:49152
    v_mfma_f32_16x16x32_bf16 a[44:47], v[60:63], v[80:83], a[44:47]
    ds_read_b64_tr_b16 v[130:131], v151 offset:50176
    v_mfma_f32_16x16x32_bf16 a[60:63], v[64:67], v[80:83], a[60:63]
    s_add_u32 s20, s20, 229376
    s_add_u32 s21, s21, 65536
    s_waitcnt vmcnt(12) lgkmcnt(12)
    s_barrier
    v_mfma_f32_16x16x32_bf16 a[0:3], v[84:87], v[100:103], a[0:3]
    ds_read_b128 v[36:39], v12 offset:0
    s_add_u32 m0, s22, 81920
    v_mfma_f32_16x16x32_bf16 a[16:19], v[88:91], v[100:103], a[16:19]
    buffer_load_dwordx4 v13, s[8:11], s20 offen lds
    ds_read_b64_tr_b16 v[20:21], v8 offset:0
    v_mfma_f32_16x16x32_bf16 a[32:35], v[92:95], v[100:103], a[32:35]
    ds_read_b64_tr_b16 v[22:23], v8 offset:1024
    v_mfma_f32_16x16x32_bf16 a[48:51], v[96:99], v[100:103], a[48:51]
    v_mfma_f32_16x16x32_bf16 a[4:7], v[84:87], v[104:107], a[4:7]
    ds_read_b128 v[40:43], v12 offset:1024
    s_add_u32 m0, s22, 82944
    v_mfma_f32_16x16x32_bf16 a[20:23], v[88:91], v[104:107], a[20:23]
    buffer_load_dwordx4 v14, s[8:11], s20 offen lds
    ds_read_b64_tr_b16 v[24:25], v9 offset:0
    v_mfma_f32_16x16x32_bf16 a[36:39], v[92:95], v[104:107], a[36:39]
    ds_read_b64_tr_b16 v[26:27], v9 offset:1024
    v_mfma_f32_16x16x32_bf16 a[52:55], v[96:99], v[104:107], a[52:55]
    v_mfma_f32_16x16x32_bf16 a[8:11], v[84:87], v[108:111], a[8:11]
    ds_read_b128 v[44:47], v12 offset:2048
    s_add_u32 m0, s23, 90112
    v_mfma_f32_16x16x32_bf16 a[24:27], v[88:91], v[108:111], a[24:27]
    buffer_load_dwordx4 v15, s[12:15], s21 offen lds
    ds_read_b64_tr_b16 v[28:29], v10 offset:0
    v_mfma_f32_16x16x32_bf16 a[40:43], v[92:95], v[108:111], a[40:43]
    ds_read_b64_tr_b16 v[30:31], v10 offset:1024
    v_mfma_f32_16x16x32_bf16 a[56:59], v[96:99], v[108:111], a[56:59]
    v_mfma_f32_16x16x32_bf16 a[12:15], v[84:87], v[112:115], a[12:15]
    ds_read_b128 v[48:51], v12 offset:3072
    s_add_u32 m0, s23, 91136
    v_mfma_f32_16x16x32_bf16 a[28:31], v[88:91], v[112:115], a[28:31]
    buffer_load_dwordx4 v16, s[12:15], s21 offen lds
    ds_read_b64_tr_b16 v[32:33], v11 offset:0
    v_mfma_f32_16x16x32_bf16 a[44:47], v[92:95], v[112:115], a[44:47]
    ds_read_b64_tr_b16 v[34:35], v11 offset:1024
    v_mfma_f32_16x16x32_bf16 a[60:63], v[96:99], v[112:115], a[60:63]
    s_add_u32 s20, s20, 229376
    s_add_u32 s21, s21, 65536
    s_waitcnt lgkmcnt(12)
    v_mfma_f32_16x16x32_bf16 a[0:3], v[116:119], v[132:135], a[0:3]
    ds_read_b128 v[68:71], v12 offset:16384
    s_add_u32 m0, s22, 98304
    v_mfma_f32_16x16x32_bf16 a[16:19], v[120:123], v[132:135], a[16:19]
    buffer_load_dwordx4 v13, s[8:11], s20 offen lds
    ds_read_b64_tr_b16 v[52:53], v8 offset:16384
    v_mfma_f32_16x16x32_bf16 a[32:35], v[124:127], v[132:135], a[32:35]
    ds_read_b64_tr_b16 v[54:55], v8 offset:17408
    v_mfma_f32_16x16x32_bf16 a[48:51], v[128:131], v[132:135], a[48:51]
    v_mfma_f32_16x16x32_bf16 a[4:7], v[116:119], v[136:139], a[4:7]
    ds_read_b128 v[72:75], v12 offset:17408
    s_add_u32 m0, s22, 99328
    v_mfma_f32_16x16x32_bf16 a[20:23], v[120:123], v[136:139], a[20:23]
    buffer_load_dwordx4 v14, s[8:11], s20 offen lds
    ds_read_b64_tr_b16 v[56:57], v9 offset:16384
    v_mfma_f32_16x16x32_bf16 a[36:39], v[124:127], v[136:139], a[36:39]
    ds_read_b64_tr_b16 v[58:59], v9 offset:17408
    v_mfma_f32_16x16x32_bf16 a[52:55], v[128:131], v[136:139], a[52:55]
    v_mfma_f32_16x16x32_bf16 a[8:11], v[116:119], v[140:143], a[8:11]
    ds_read_b128 v[76:79], v12 offset:18432
    s_add_u32 m0, s23, 106496
    v_mfma_f32_16x16x32_bf16 a[24:27], v[120:123], v[140:143], a[24:27]
    buffer_load_dwordx4 v15, s[12:15], s21 offen lds
    ds_read_b64_tr_b16 v[60:61], v10 offset:16384
    v_mfma_f32_16x16x32_bf16 a[40:43], v[124:127], v[140:143], a[40:43]
    ds_read_b64_tr_b16 v[62:63], v10 offset:17408
    v_mfma_f32_16x16x32_bf16 a[56:59], v[128:131], v[140:143], a[56:59]
    v_mfma_f32_16x16x32_bf16 a[12:15], v[116:119], v[144:147], a[12:15]
    ds_read_b128 v[80:83], v12 offset:19456
    s_add_u32 m0, s23, 107520
    v_mfma_f32_16x16x32_bf16 a[28:31], v[120:123], v[144:147], a[28:31]
    buffer_load_dwordx4 v16, s[12:15], s21 offen lds
    ds_read_b64_tr_b16 v[64:65], v11 offset:16384
    v_mfma_f32_16x16x32_bf16 a[44:47], v[124:127], v[144:147], a[44:47]
    ds_read_b64_tr_b16 v[66:67], v11 offset:17408
    v_mfma_f32_16x16x32_bf16 a[60:63], v[128:131], v[144:147], a[60:63]
    s_add_u32 s20, s20, 229376
    s_add_u32 s21, s21, 65536
    s_waitcnt vmcnt(12) lgkmcnt(12)
    s_barrier
    s_sub_u32 s24, s24, 1
    s_cmp_lg_u32 s24, 0
    s_cbranch_scc1 L_g1f_loop
    s_waitcnt vmcnt(0) lgkmcnt(0)
    v_and_b32 v1, 15, v0
    v_lshrrev_b32 v2, 4, v0
    v_and_b32 v3, 1, v2
    v_lshrrev_b32 v2, 1, v2
    v_lshlrev_b32 v4, 4, v3
    v_lshl_add_u32 v4, v2, 3, v4
    v_lshl_or_b32 v2, v3, 1, v2
    v_lshrrev_b32 v3, 2, v1
    v_lshrrev_b32 v5, 1, v3
    v_and_b32 v3, 1, v3
    v_xor_b32 v3, v3, v5
    v_lshl_or_b32 v3, v3, 1, v5
    v_xor_b32 v2, v2, v3
    v_lshl_add_u32 v2, v1, 2, v2
    v_lshlrev_b32 v2, 4, v2
    s_lshl_b32 s25, s4, 7
    s_and_b32 s26, s3, 1
    s_lshl_b32 s26, s26, 6
    s_add_u32 s25, s25, s26
    v_add_u32 v4, s25, v4
    v_lshlrev_b32 v4, 1, v4
    global_load_dwordx4 v[84:87], v4, s[42:43] offset:0
    global_load_dwordx4 v[88:91], v4, s[42:43] offset:64
    s_lshr_b32 s26, s25, 5
    s_lshl_b32 s26, s26, 16
    s_lshl_b32 s27, s5, 3
    s_lshr_b32 s28, s3, 1
    s_lshl_b32 s28, s28, 2
    s_add_u32 s27, s27, s28
    s_lshl_b32 s27, s27, 10
    s_add_u32 s26, s26, s27
    s_add_u32 s26, s26, 92274688
    s_add_u32 s44, s6, s26
    s_addc_u32 s45, s7, 0
    s_waitcnt vmcnt(0)
    v_lshlrev_b32 v92, 16, v84
    v_and_b32 v93, 0xffff0000, v84
    v_lshlrev_b32 v94, 16, v85
    v_and_b32 v95, 0xffff0000, v85
    v_lshlrev_b32 v96, 16, v86
    v_and_b32 v97, 0xffff0000, v86
    v_lshlrev_b32 v98, 16, v87
    v_and_b32 v99, 0xffff0000, v87
    v_lshlrev_b32 v100, 16, v88
    v_and_b32 v101, 0xffff0000, v88
    v_lshlrev_b32 v102, 16, v89
    v_and_b32 v103, 0xffff0000, v89
    v_lshlrev_b32 v104, 16, v90
    v_and_b32 v105, 0xffff0000, v90
    v_lshlrev_b32 v106, 16, v91
    v_and_b32 v107, 0xffff0000, v91
    s_mov_b32 s46, 0x3d372713
    s_mov_b32 s47, 0xc0135761
    v_accvgpr_read_b32 v24, a0
    v_accvgpr_read_b32 v25, a1
    v_accvgpr_read_b32 v26, a2
    v_accvgpr_read_b32 v27, a3
    v_accvgpr_read_b32 v28, a16
    v_accvgpr_read_b32 v29, a17
    v_accvgpr_read_b32 v30, a18
    v_accvgpr_read_b32 v31, a19
    v_permlane16_swap_b32 v24, v28
    v_permlane16_swap_b32 v25, v29
    v_permlane16_swap_b32 v26, v30
    v_permlane16_swap_b32 v27, v31
    v_add_f32 v24, v24, v92
    v_add_f32 v25, v25, v93
    v_add_f32 v26, v26, v94
    v_add_f32 v27, v27, v95
    v_add_f32 v28, v28, v96
    v_add_f32 v29, v29, v97
    v_add_f32 v30, v30, v98
    v_add_f32 v31, v31, v99
    v_mul_f32 v68, v24, v24
    v_mul_f32 v69, v25, v25
    v_mul_f32 v70, v26, v26
    v_mul_f32 v71, v27, v27
    v_mul_f32 v72, v28, v28
    v_mul_f32 v73, v29, v29
    v_mul_f32 v74, v30, v30
    v_mul_f32 v75, v31, v31
    v_fma_f32 v68, v68, s46, 1.0
    v_fma_f32 v69, v69, s46, 1.0
    v_fma_f32 v70, v70, s46, 1.0
    v_fma_f32 v71, v71, s46, 1.0
    v_fma_f32 v72, v72, s46, 1.0
    v_fma_f32 v73, v73, s46, 1.0
    v_fma_f32 v74, v74, s46, 1.0
    v_fma_f32 v75, v75, s46, 1.0
    v_mul_f32 v68, v68, v24
    v_mul_f32 v69, v69, v25
    v_mul_f32 v70, v70, v26
    v_mul_f32 v71, v71, v27
    v_mul_f32 v72, v72, v28
    v_mul_f32 v73, v73, v29
    v_mul_f32 v74, v74, v30
    v_mul_f32 v75, v75, v31
    v_mul_f32 v68, s47, v68
    v_mul_f32 v69, s47, v69
    v_mul_f32 v70, s47, v70
    v_mul_f32 v71, s47, v71
    v_mul_f32 v72, s47, v72
    v_mul_f32 v73, s47, v73
    v_mul_f32 v74, s47, v74
    v_mul_f32 v75, s47, v75
    v_exp_f32 v68, v68
    v_exp_f32 v69, v69
    v_exp_f32 v70, v70
    v_exp_f32 v71, v71
    v_exp_f32 v72, v72
    v_exp_f32 v73, v73
    v_exp_f32 v74, v74
    v_exp_f32 v75, v75
    v_add_f32 v68, 1.0, v68
    v_add_f32 v69, 1.0, v69
    v_add_f32 v70, 1.0, v70
    v_add_f32 v71, 1.0, v71
    v_add_f32 v72, 1.0, v72
    v_add_f32 v73, 1.0, v73
    v_add_f32 v74, 1.0, v74
    v_add_f32 v75, 1.0, v75
    v_rcp_f32 v68, v68
    v_rcp_f32 v69, v69
    v_rcp_f32 v70, v70
    v_rcp_f32 v71, v71
    v_rcp_f32 v72, v72
    v_rcp_f32 v73, v73
    v_rcp_f32 v74, v74
    v_rcp_f32 v75, v75
    v_mul_f32 v24, v24, v68
    v_mul_f32 v25, v25, v69
    v_mul_f32 v26, v26, v70
    v_mul_f32 v27, v27, v71
    v_mul_f32 v28, v28, v72
    v_mul_f32 v29, v29, v73
    v_mul_f32 v30, v30, v74
    v_mul_f32 v31, v31, v75
    v_cvt_pk_bf16_f32 v20, v24, v25
    v_cvt_pk_bf16_f32 v21, v26, v27
    v_cvt_pk_bf16_f32 v22, v28, v29
    v_cvt_pk_bf16_f32 v23, v30, v31
    v_add_u32 v5, 0, v2
    global_store_dwordx4 v5, v[20:23], s[44:45] sc1
    v_accvgpr_read_b32 v40, a4
    v_accvgpr_read_b32 v41, a5
    v_accvgpr_read_b32 v42, a6
    v_accvgpr_read_b32 v43, a7
    v_accvgpr_read_b32 v44, a20
    v_accvgpr_read_b32 v45, a21
    v_accvgpr_read_b32 v46, a22
    v_accvgpr_read_b32 v47, a23
    v_permlane16_swap_b32 v40, v44
    v_permlane16_swap_b32 v41, v45
    v_permlane16_swap_b32 v42, v46
    v_permlane16_swap_b32 v43, v47
    v_add_f32 v40, v40, v92
    v_add_f32 v41, v41, v93
    v_add_f32 v42, v42, v94
    v_add_f32 v43, v43, v95
    v_add_f32 v44, v44, v96
    v_add_f32 v45, v45, v97
    v_add_f32 v46, v46, v98
    v_add_f32 v47, v47, v99
    v_mul_f32 v68, v40, v40
    v_mul_f32 v69, v41, v41
    v_mul_f32 v70, v42, v42
    v_mul_f32 v71, v43, v43
    v_mul_f32 v72, v44, v44
    v_mul_f32 v73, v45, v45
    v_mul_f32 v74, v46, v46
    v_mul_f32 v75, v47, v47
    v_fma_f32 v68, v68, s46, 1.0
    v_fma_f32 v69, v69, s46, 1.0
    v_fma_f32 v70, v70, s46, 1.0
    v_fma_f32 v71, v71, s46, 1.0
    v_fma_f32 v72, v72, s46, 1.0
    v_fma_f32 v73, v73, s46, 1.0
    v_fma_f32 v74, v74, s46, 1.0
    v_fma_f32 v75, v75, s46, 1.0
    v_mul_f32 v68, v68, v40
    v_mul_f32 v69, v69, v41
    v_mul_f32 v70, v70, v42
    v_mul_f32 v71, v71, v43
    v_mul_f32 v72, v72, v44
    v_mul_f32 v73, v73, v45
    v_mul_f32 v74, v74, v46
    v_mul_f32 v75, v75, v47
    v_mul_f32 v68, s47, v68
    v_mul_f32 v69, s47, v69
    v_mul_f32 v70, s47, v70
    v_mul_f32 v71, s47, v71
    v_mul_f32 v72, s47, v72
    v_mul_f32 v73, s47, v73
    v_mul_f32 v74, s47, v74
    v_mul_f32 v75, s47, v75
    v_exp_f32 v68, v68
    v_exp_f32 v69, v69
    v_exp_f32 v70, v70
    v_exp_f32 v71, v71
    v_exp_f32 v72, v72
    v_exp_f32 v73, v73
    v_exp_f32 v74, v74
    v_exp_f32 v75, v75
    v_add_f32 v68, 1.0, v68
    v_add_f32 v69, 1.0, v69
    v_add_f32 v70, 1.0, v70
    v_add_f32 v71, 1.0, v71
    v_add_f32 v72, 1.0, v72
    v_add_f32 v73, 1.0, v73
    v_add_f32 v74, 1.0, v74
    v_add_f32 v75, 1.0, v75
    v_rcp_f32 v68, v68
    v_rcp_f32 v69, v69
    v_rcp_f32 v70, v70
    v_rcp_f32 v71, v71
    v_rcp_f32 v72, v72
    v_rcp_f32 v73, v73
    v_rcp_f32 v74, v74
    v_rcp_f32 v75, v75
    v_mul_f32 v40, v40, v68
    v_mul_f32 v41, v41, v69
    v_mul_f32 v42, v42, v70
    v_mul_f32 v43, v43, v71
    v_mul_f32 v44, v44, v72
    v_mul_f32 v45, v45, v73
    v_mul_f32 v46, v46, v74
    v_mul_f32 v47, v47, v75
    v_cvt_pk_bf16_f32 v36, v40, v41
    v_cvt_pk_bf16_f32 v37, v42, v43
    v_cvt_pk_bf16_f32 v38, v44, v45
    v_cvt_pk_bf16_f32 v39, v46, v47
    v_add_u32 v5, 1024, v2
    global_store_dwordx4 v5, v[36:39], s[44:45] sc1
    v_accvgpr_read_b32 v56, a8
    v_accvgpr_read_b32 v57, a9
    v_accvgpr_read_b32 v58, a10
    v_accvgpr_read_b32 v59, a11
    v_accvgpr_read_b32 v60, a24
    v_accvgpr_read_b32 v61, a25
    v_accvgpr_read_b32 v62, a26
    v_accvgpr_read_b32 v63, a27
    v_permlane16_swap_b32 v56, v60
    v_permlane16_swap_b32 v57, v61
    v_permlane16_swap_b32 v58, v62
    v_permlane16_swap_b32 v59, v63
    v_add_f32 v56, v56, v92
    v_add_f32 v57, v57, v93
    v_add_f32 v58, v58, v94
    v_add_f32 v59, v59, v95
    v_add_f32 v60, v60, v96
    v_add_f32 v61, v61, v97
    v_add_f32 v62, v62, v98
    v_add_f32 v63, v63, v99
    v_mul_f32 v68, v56, v56
    v_mul_f32 v69, v57, v57
    v_mul_f32 v70, v58, v58
    v_mul_f32 v71, v59, v59
    v_mul_f32 v72, v60, v60
    v_mul_f32 v73, v61, v61
    v_mul_f32 v74, v62, v62
    v_mul_f32 v75, v63, v63
    v_fma_f32 v68, v68, s46, 1.0
    v_fma_f32 v69, v69, s46, 1.0
    v_fma_f32 v70, v70, s46, 1.0
    v_fma_f32 v71, v71, s46, 1.0
    v_fma_f32 v72, v72, s46, 1.0
    v_fma_f32 v73, v73, s46, 1.0
    v_fma_f32 v74, v74, s46, 1.0
    v_fma_f32 v75, v75, s46, 1.0
    v_mul_f32 v68, v68, v56
    v_mul_f32 v69, v69, v57
    v_mul_f32 v70, v70, v58
    v_mul_f32 v71, v71, v59
    v_mul_f32 v72, v72, v60
    v_mul_f32 v73, v73, v61
    v_mul_f32 v74, v74, v62
    v_mul_f32 v75, v75, v63
    v_mul_f32 v68, s47, v68
    v_mul_f32 v69, s47, v69
    v_mul_f32 v70, s47, v70
    v_mul_f32 v71, s47, v71
    v_mul_f32 v72, s47, v72
    v_mul_f32 v73, s47, v73
    v_mul_f32 v74, s47, v74
    v_mul_f32 v75, s47, v75
    v_exp_f32 v68, v68
    v_exp_f32 v69, v69
    v_exp_f32 v70, v70
    v_exp_f32 v71, v71
    v_exp_f32 v72, v72
    v_exp_f32 v73, v73
    v_exp_f32 v74, v74
    v_exp_f32 v75, v75
    v_add_f32 v68, 1.0, v68
    v_add_f32 v69, 1.0, v69
    v_add_f32 v70, 1.0, v70
    v_add_f32 v71, 1.0, v71
    v_add_f32 v72, 1.0, v72
    v_add_f32 v73, 1.0, v73
    v_add_f32 v74, 1.0, v74
    v_add_f32 v75, 1.0, v75
    v_rcp_f32 v68, v68
    v_rcp_f32 v69, v69
    v_rcp_f32 v70, v70
    v_rcp_f32 v71, v71
    v_rcp_f32 v72, v72
    v_rcp_f32 v73, v73
    v_rcp_f32 v74, v74
    v_rcp_f32 v75, v75
    v_mul_f32 v56, v56, v68
    v_mul_f32 v57, v57, v69
    v_mul_f32 v58, v58, v70
    v_mul_f32 v59, v59, v71
    v_mul_f32 v60, v60, v72
    v_mul_f32 v61, v61, v73
    v_mul_f32 v62, v62, v74
    v_mul_f32 v63, v63, v75
    v_cvt_pk_bf16_f32 v52, v56, v57
    v_cvt_pk_bf16_f32 v53, v58, v59
    v_cvt_pk_bf16_f32 v54, v60, v61
    v_cvt_pk_bf16_f32 v55, v62, v63
    v_add_u32 v5, 2048, v2
    global_store_dwordx4 v5, v[52:55], s[44:45] sc1
    v_accvgpr_read_b32 v24, a12
    v_accvgpr_read_b32 v25, a13
    v_accvgpr_read_b32 v26, a14
    v_accvgpr_read_b32 v27, a15
    v_accvgpr_read_b32 v28, a28
    v_accvgpr_read_b32 v29, a29
    v_accvgpr_read_b32 v30, a30
    v_accvgpr_read_b32 v31, a31
    v_permlane16_swap_b32 v24, v28
    v_permlane16_swap_b32 v25, v29
    v_permlane16_swap_b32 v26, v30
    v_permlane16_swap_b32 v27, v31
    v_add_f32 v24, v24, v92
    v_add_f32 v25, v25, v93
    v_add_f32 v26, v26, v94
    v_add_f32 v27, v27, v95
    v_add_f32 v28, v28, v96
    v_add_f32 v29, v29, v97
    v_add_f32 v30, v30, v98
    v_add_f32 v31, v31, v99
    v_mul_f32 v68, v24, v24
    v_mul_f32 v69, v25, v25
    v_mul_f32 v70, v26, v26
    v_mul_f32 v71, v27, v27
    v_mul_f32 v72, v28, v28
    v_mul_f32 v73, v29, v29
    v_mul_f32 v74, v30, v30
    v_mul_f32 v75, v31, v31
    v_fma_f32 v68, v68, s46, 1.0
    v_fma_f32 v69, v69, s46, 1.0
    v_fma_f32 v70, v70, s46, 1.0
    v_fma_f32 v71, v71, s46, 1.0
    v_fma_f32 v72, v72, s46, 1.0
    v_fma_f32 v73, v73, s46, 1.0
    v_fma_f32 v74, v74, s46, 1.0
    v_fma_f32 v75, v75, s46, 1.0
    v_mul_f32 v68, v68, v24
    v_mul_f32 v69, v69, v25
    v_mul_f32 v70, v70, v26
    v_mul_f32 v71, v71, v27
    v_mul_f32 v72, v72, v28
    v_mul_f32 v73, v73, v29
    v_mul_f32 v74, v74, v30
    v_mul_f32 v75, v75, v31
    v_mul_f32 v68, s47, v68
    v_mul_f32 v69, s47, v69
    v_mul_f32 v70, s47, v70
    v_mul_f32 v71, s47, v71
    v_mul_f32 v72, s47, v72
    v_mul_f32 v73, s47, v73
    v_mul_f32 v74, s47, v74
    v_mul_f32 v75, s47, v75
    v_exp_f32 v68, v68
    v_exp_f32 v69, v69
    v_exp_f32 v70, v70
    v_exp_f32 v71, v71
    v_exp_f32 v72, v72
    v_exp_f32 v73, v73
    v_exp_f32 v74, v74
    v_exp_f32 v75, v75
    v_add_f32 v68, 1.0, v68
    v_add_f32 v69, 1.0, v69
    v_add_f32 v70, 1.0, v70
    v_add_f32 v71, 1.0, v71
    v_add_f32 v72, 1.0, v72
    v_add_f32 v73, 1.0, v73
    v_add_f32 v74, 1.0, v74
    v_add_f32 v75, 1.0, v75
    v_rcp_f32 v68, v68
    v_rcp_f32 v69, v69
    v_rcp_f32 v70, v70
    v_rcp_f32 v71, v71
    v_rcp_f32 v72, v72
    v_rcp_f32 v73, v73
    v_rcp_f32 v74, v74
    v_rcp_f32 v75, v75
    v_mul_f32 v24, v24, v68
    v_mul_f32 v25, v25, v69
    v_mul_f32 v26, v26, v70
    v_mul_f32 v27, v27, v71
    v_mul_f32 v28, v28, v72
    v_mul_f32 v29, v29, v73
    v_mul_f32 v30, v30, v74
    v_mul_f32 v31, v31, v75
    v_cvt_pk_bf16_f32 v20, v24, v25
    v_cvt_pk_bf16_f32 v21, v26, v27
    v_cvt_pk_bf16_f32 v22, v28, v29
    v_cvt_pk_bf16_f32 v23, v30, v31
    v_add_u32 v5, 3072, v2
    global_store_dwordx4 v5, v[20:23], s[44:45] sc1
    v_accvgpr_read_b32 v40, a32
    v_accvgpr_read_b32 v41, a33
    v_accvgpr_read_b32 v42, a34
    v_accvgpr_read_b32 v43, a35
    v_accvgpr_read_b32 v44, a48
    v_accvgpr_read_b32 v45, a49
    v_accvgpr_read_b32 v46, a50
    v_accvgpr_read_b32 v47, a51
    v_permlane16_swap_b32 v40, v44
    v_permlane16_swap_b32 v41, v45
    v_permlane16_swap_b32 v42, v46
    v_permlane16_swap_b32 v43, v47
    v_add_f32 v40, v40, v100
    v_add_f32 v41, v41, v101
    v_add_f32 v42, v42, v102
    v_add_f32 v43, v43, v103
    v_add_f32 v44, v44, v104
    v_add_f32 v45, v45, v105
    v_add_f32 v46, v46, v106
    v_add_f32 v47, v47, v107
    v_mul_f32 v68, v40, v40
    v_mul_f32 v69, v41, v41
    v_mul_f32 v70, v42, v42
    v_mul_f32 v71, v43, v43
    v_mul_f32 v72, v44, v44
    v_mul_f32 v73, v45, v45
    v_mul_f32 v74, v46, v46
    v_mul_f32 v75, v47, v47
    v_fma_f32 v68, v68, s46, 1.0
    v_fma_f32 v69, v69, s46, 1.0
    v_fma_f32 v70, v70, s46, 1.0
    v_fma_f32 v71, v71, s46, 1.0
    v_fma_f32 v72, v72, s46, 1.0
    v_fma_f32 v73, v73, s46, 1.0
    v_fma_f32 v74, v74, s46, 1.0
    v_fma_f32 v75, v75, s46, 1.0
    v_mul_f32 v68, v68, v40
    v_mul_f32 v69, v69, v41
    v_mul_f32 v70, v70, v42
    v_mul_f32 v71, v71, v43
    v_mul_f32 v72, v72, v44
    v_mul_f32 v73, v73, v45
    v_mul_f32 v74, v74, v46
    v_mul_f32 v75, v75, v47
    v_mul_f32 v68, s47, v68
    v_mul_f32 v69, s47, v69
    v_mul_f32 v70, s47, v70
    v_mul_f32 v71, s47, v71
    v_mul_f32 v72, s47, v72
    v_mul_f32 v73, s47, v73
    v_mul_f32 v74, s47, v74
    v_mul_f32 v75, s47, v75
    v_exp_f32 v68, v68
    v_exp_f32 v69, v69
    v_exp_f32 v70, v70
    v_exp_f32 v71, v71
    v_exp_f32 v72, v72
    v_exp_f32 v73, v73
    v_exp_f32 v74, v74
    v_exp_f32 v75, v75
    v_add_f32 v68, 1.0, v68
    v_add_f32 v69, 1.0, v69
    v_add_f32 v70, 1.0, v70
    v_add_f32 v71, 1.0, v71
    v_add_f32 v72, 1.0, v72
    v_add_f32 v73, 1.0, v73
    v_add_f32 v74, 1.0, v74
    v_add_f32 v75, 1.0, v75
    v_rcp_f32 v68, v68
    v_rcp_f32 v69, v69
    v_rcp_f32 v70, v70
    v_rcp_f32 v71, v71
    v_rcp_f32 v72, v72
    v_rcp_f32 v73, v73
    v_rcp_f32 v74, v74
    v_rcp_f32 v75, v75
    v_mul_f32 v40, v40, v68
    v_mul_f32 v41, v41, v69
    v_mul_f32 v42, v42, v70
    v_mul_f32 v43, v43, v71
    v_mul_f32 v44, v44, v72
    v_mul_f32 v45, v45, v73
    v_mul_f32 v46, v46, v74
    v_mul_f32 v47, v47, v75
    v_cvt_pk_bf16_f32 v36, v40, v41
    v_cvt_pk_bf16_f32 v37, v42, v43
    v_cvt_pk_bf16_f32 v38, v44, v45
    v_cvt_pk_bf16_f32 v39, v46, v47
    v_add_u32 v5, 65536, v2
    global_store_dwordx4 v5, v[36:39], s[44:45] sc1
    v_accvgpr_read_b32 v56, a36
    v_accvgpr_read_b32 v57, a37
    v_accvgpr_read_b32 v58, a38
    v_accvgpr_read_b32 v59, a39
    v_accvgpr_read_b32 v60, a52
    v_accvgpr_read_b32 v61, a53
    v_accvgpr_read_b32 v62, a54
    v_accvgpr_read_b32 v63, a55
    v_permlane16_swap_b32 v56, v60
    v_permlane16_swap_b32 v57, v61
    v_permlane16_swap_b32 v58, v62
    v_permlane16_swap_b32 v59, v63
    v_add_f32 v56, v56, v100
    v_add_f32 v57, v57, v101
    v_add_f32 v58, v58, v102
    v_add_f32 v59, v59, v103
    v_add_f32 v60, v60, v104
    v_add_f32 v61, v61, v105
    v_add_f32 v62, v62, v106
    v_add_f32 v63, v63, v107
    v_mul_f32 v68, v56, v56
    v_mul_f32 v69, v57, v57
    v_mul_f32 v70, v58, v58
    v_mul_f32 v71, v59, v59
    v_mul_f32 v72, v60, v60
    v_mul_f32 v73, v61, v61
    v_mul_f32 v74, v62, v62
    v_mul_f32 v75, v63, v63
    v_fma_f32 v68, v68, s46, 1.0
    v_fma_f32 v69, v69, s46, 1.0
    v_fma_f32 v70, v70, s46, 1.0
    v_fma_f32 v71, v71, s46, 1.0
    v_fma_f32 v72, v72, s46, 1.0
    v_fma_f32 v73, v73, s46, 1.0
    v_fma_f32 v74, v74, s46, 1.0
    v_fma_f32 v75, v75, s46, 1.0
    v_mul_f32 v68, v68, v56
    v_mul_f32 v69, v69, v57
    v_mul_f32 v70, v70, v58
    v_mul_f32 v71, v71, v59
    v_mul_f32 v72, v72, v60
    v_mul_f32 v73, v73, v61
    v_mul_f32 v74, v74, v62
    v_mul_f32 v75, v75, v63
    v_mul_f32 v68, s47, v68
    v_mul_f32 v69, s47, v69
    v_mul_f32 v70, s47, v70
    v_mul_f32 v71, s47, v71
    v_mul_f32 v72, s47, v72
    v_mul_f32 v73, s47, v73
    v_mul_f32 v74, s47, v74
    v_mul_f32 v75, s47, v75
    v_exp_f32 v68, v68
    v_exp_f32 v69, v69
    v_exp_f32 v70, v70
    v_exp_f32 v71, v71
    v_exp_f32 v72, v72
    v_exp_f32 v73, v73
    v_exp_f32 v74, v74
    v_exp_f32 v75, v75
    v_add_f32 v68, 1.0, v68
    v_add_f32 v69, 1.0, v69
    v_add_f32 v70, 1.0, v70
    v_add_f32 v71, 1.0, v71
    v_add_f32 v72, 1.0, v72
    v_add_f32 v73, 1.0, v73
    v_add_f32 v74, 1.0, v74
    v_add_f32 v75, 1.0, v75
    v_rcp_f32 v68, v68
    v_rcp_f32 v69, v69
    v_rcp_f32 v70, v70
    v_rcp_f32 v71, v71
    v_rcp_f32 v72, v72
    v_rcp_f32 v73, v73
    v_rcp_f32 v74, v74
    v_rcp_f32 v75, v75
    v_mul_f32 v56, v56, v68
    v_mul_f32 v57, v57, v69
    v_mul_f32 v58, v58, v70
    v_mul_f32 v59, v59, v71
    v_mul_f32 v60, v60, v72
    v_mul_f32 v61, v61, v73
    v_mul_f32 v62, v62, v74
    v_mul_f32 v63, v63, v75
    v_cvt_pk_bf16_f32 v52, v56, v57
    v_cvt_pk_bf16_f32 v53, v58, v59
    v_cvt_pk_bf16_f32 v54, v60, v61
    v_cvt_pk_bf16_f32 v55, v62, v63
    v_add_u32 v5, 66560, v2
    global_store_dwordx4 v5, v[52:55], s[44:45] sc1
    v_accvgpr_read_b32 v24, a40
    v_accvgpr_read_b32 v25, a41
    v_accvgpr_read_b32 v26, a42
    v_accvgpr_read_b32 v27, a43
    v_accvgpr_read_b32 v28, a56
    v_accvgpr_read_b32 v29, a57
    v_accvgpr_read_b32 v30, a58
    v_accvgpr_read_b32 v31, a59
    v_permlane16_swap_b32 v24, v28
    v_permlane16_swap_b32 v25, v29
    v_permlane16_swap_b32 v26, v30
    v_permlane16_swap_b32 v27, v31
    v_add_f32 v24, v24, v100
    v_add_f32 v25, v25, v101
    v_add_f32 v26, v26, v102
    v_add_f32 v27, v27, v103
    v_add_f32 v28, v28, v104
    v_add_f32 v29, v29, v105
    v_add_f32 v30, v30, v106
    v_add_f32 v31, v31, v107
    v_mul_f32 v68, v24, v24
    v_mul_f32 v69, v25, v25
    v_mul_f32 v70, v26, v26
    v_mul_f32 v71, v27, v27
    v_mul_f32 v72, v28, v28
    v_mul_f32 v73, v29, v29
    v_mul_f32 v74, v30, v30
    v_mul_f32 v75, v31, v31
    v_fma_f32 v68, v68, s46, 1.0
    v_fma_f32 v69, v69, s46, 1.0
    v_fma_f32 v70, v70, s46, 1.0
    v_fma_f32 v71, v71, s46, 1.0
    v_fma_f32 v72, v72, s46, 1.0
    v_fma_f32 v73, v73, s46, 1.0
    v_fma_f32 v74, v74, s46, 1.0
    v_fma_f32 v75, v75, s46, 1.0
    v_mul_f32 v68, v68, v24
    v_mul_f32 v69, v69, v25
    v_mul_f32 v70, v70, v26
    v_mul_f32 v71, v71, v27
    v_mul_f32 v72, v72, v28
    v_mul_f32 v73, v73, v29
    v_mul_f32 v74, v74, v30
    v_mul_f32 v75, v75, v31
    v_mul_f32 v68, s47, v68
    v_mul_f32 v69, s47, v69
    v_mul_f32 v70, s47, v70
    v_mul_f32 v71, s47, v71
    v_mul_f32 v72, s47, v72
    v_mul_f32 v73, s47, v73
    v_mul_f32 v74, s47, v74
    v_mul_f32 v75, s47, v75
    v_exp_f32 v68, v68
    v_exp_f32 v69, v69
    v_exp_f32 v70, v70
    v_exp_f32 v71, v71
    v_exp_f32 v72, v72
    v_exp_f32 v73, v73
    v_exp_f32 v74, v74
    v_exp_f32 v75, v75
    v_add_f32 v68, 1.0, v68
    v_add_f32 v69, 1.0, v69
    v_add_f32 v70, 1.0, v70
    v_add_f32 v71, 1.0, v71
    v_add_f32 v72, 1.0, v72
    v_add_f32 v73, 1.0, v73
    v_add_f32 v74, 1.0, v74
    v_add_f32 v75, 1.0, v75
    v_rcp_f32 v68, v68
    v_rcp_f32 v69, v69
    v_rcp_f32 v70, v70
    v_rcp_f32 v71, v71
    v_rcp_f32 v72, v72
    v_rcp_f32 v73, v73
    v_rcp_f32 v74, v74
    v_rcp_f32 v75, v75
    v_mul_f32 v24, v24, v68
    v_mul_f32 v25, v25, v69
    v_mul_f32 v26, v26, v70
    v_mul_f32 v27, v27, v71
    v_mul_f32 v28, v28, v72
    v_mul_f32 v29, v29, v73
    v_mul_f32 v30, v30, v74
    v_mul_f32 v31, v31, v75
    v_cvt_pk_bf16_f32 v20, v24, v25
    v_cvt_pk_bf16_f32 v21, v26, v27
    v_cvt_pk_bf16_f32 v22, v28, v29
    v_cvt_pk_bf16_f32 v23, v30, v31
    v_add_u32 v5, 67584, v2
    global_store_dwordx4 v5, v[20:23], s[44:45] sc1
    v_accvgpr_read_b32 v40, a44
    v_accvgpr_read_b32 v41, a45
    v_accvgpr_read_b32 v42, a46
    v_accvgpr_read_b32 v43, a47
    v_accvgpr_read_b32 v44, a60
    v_accvgpr_read_b32 v45, a61
    v_accvgpr_read_b32 v46, a62
    v_accvgpr_read_b32 v47, a63
    v_permlane16_swap_b32 v40, v44
    v_permlane16_swap_b32 v41, v45
    v_permlane16_swap_b32 v42, v46
    v_permlane16_swap_b32 v43, v47
    v_add_f32 v40, v40, v100
    v_add_f32 v41, v41, v101
    v_add_f32 v42, v42, v102
    v_add_f32 v43, v43, v103
    v_add_f32 v44, v44, v104
    v_add_f32 v45, v45, v105
    v_add_f32 v46, v46, v106
    v_add_f32 v47, v47, v107
    v_mul_f32 v68, v40, v40
    v_mul_f32 v69, v41, v41
    v_mul_f32 v70, v42, v42
    v_mul_f32 v71, v43, v43
    v_mul_f32 v72, v44, v44
    v_mul_f32 v73, v45, v45
    v_mul_f32 v74, v46, v46
    v_mul_f32 v75, v47, v47
    v_fma_f32 v68, v68, s46, 1.0
    v_fma_f32 v69, v69, s46, 1.0
    v_fma_f32 v70, v70, s46, 1.0
    v_fma_f32 v71, v71, s46, 1.0
    v_fma_f32 v72, v72, s46, 1.0
    v_fma_f32 v73, v73, s46, 1.0
    v_fma_f32 v74, v74, s46, 1.0
    v_fma_f32 v75, v75, s46, 1.0
    v_mul_f32 v68, v68, v40
    v_mul_f32 v69, v69, v41
    v_mul_f32 v70, v70, v42
    v_mul_f32 v71, v71, v43
    v_mul_f32 v72, v72, v44
    v_mul_f32 v73, v73, v45
    v_mul_f32 v74, v74, v46
    v_mul_f32 v75, v75, v47
    v_mul_f32 v68, s47, v68
    v_mul_f32 v69, s47, v69
    v_mul_f32 v70, s47, v70
    v_mul_f32 v71, s47, v71
    v_mul_f32 v72, s47, v72
    v_mul_f32 v73, s47, v73
    v_mul_f32 v74, s47, v74
    v_mul_f32 v75, s47, v75
    v_exp_f32 v68, v68
    v_exp_f32 v69, v69
    v_exp_f32 v70, v70
    v_exp_f32 v71, v71
    v_exp_f32 v72, v72
    v_exp_f32 v73, v73
    v_exp_f32 v74, v74
    v_exp_f32 v75, v75
    v_add_f32 v68, 1.0, v68
    v_add_f32 v69, 1.0, v69
    v_add_f32 v70, 1.0, v70
    v_add_f32 v71, 1.0, v71
    v_add_f32 v72, 1.0, v72
    v_add_f32 v73, 1.0, v73
    v_add_f32 v74, 1.0, v74
    v_add_f32 v75, 1.0, v75
    v_rcp_f32 v68, v68
    v_rcp_f32 v69, v69
    v_rcp_f32 v70, v70
    v_rcp_f32 v71, v71
    v_rcp_f32 v72, v72
    v_rcp_f32 v73, v73
    v_rcp_f32 v74, v74
    v_rcp_f32 v75, v75
    v_mul_f32 v40, v40, v68
    v_mul_f32 v41, v41, v69
    v_mul_f32 v42, v42, v70
    v_mul_f32 v43, v43, v71
    v_mul_f32 v44, v44, v72
    v_mul_f32 v45, v45, v73
    v_mul_f32 v46, v46, v74
    v_mul_f32 v47, v47, v75
    v_cvt_pk_bf16_f32 v36, v40, v41
    v_cvt_pk_bf16_f32 v37, v42, v43
    v_cvt_pk_bf16_f32 v38, v44, v45
    v_cvt_pk_bf16_f32 v39, v46, v47
    v_add_u32 v5, 68608, v2
    global_store_dwordx4 v5, v[36:39], s[44:45] sc1
    s_waitcnt vmcnt(0)
    s_barrier
    s_cmp_lg_u32 s3, 0
    s_cbranch_scc1 L_g1f_ns
    s_add_u32 s48, s6, 130023424
    s_addc_u32 s49, s7, 0
    s_cmp_ge_u32 s4, 14
    s_cselect_b32 s26, 1, 0
    s_lshl_b32 s27, s5, 1
    s_add_u32 s26, s26, s27
    s_lshl_b32 s26, s26, 7
    s_add_u32 s26, s26, 165888
    v_mov_b32 v14, s26
    v_mov_b32 v15, 1
    s_mov_b64 exec, 1
    global_atomic_add v14, v15, s[48:49]
    s_mov_b64 exec, -1
L_g1f_ns:
    s_branch T_g2
T_g2:
    s_load_dwordx2 s[6:7], s[0:1], 128
    s_load_dwordx2 s[52:53], s[0:1], 80
    s_load_dwordx2 s[54:55], s[0:1], 88
    s_load_dwordx2 s[60:61], s[0:1], 112
    s_waitcnt lgkmcnt(0)
    s_add_u32 s8, s52, 0
    s_addc_u32 s9, s53, 0
    s_and_b32 s9, s9, 0xffff
    s_mov_b32 s10, 14680064
    s_mov_b32 s11, 0x00020000
    s_add_u32 s12, s6, 92274688
    s_addc_u32 s13, s7, 0
    s_and_b32 s13, s13, 0xffff
    s_mov_b32 s14, 7340032
    s_mov_b32 s15, 0x00020000
    s_and_b32 s25, s2, 7
    s_lshr_b32 s26, s2, 3
    s_and_b32 s56, s25, 1
    s_lshr_b32 s5, s25, 2
    s_lshl_b32 s5, s5, 2
    s_and_b32 s27, s26, 3
    s_add_u32 s5, s5, s27
    s_bfe_u32 s4, s25, 0x10001
    s_lshl_b32 s4, s4, 3
    s_lshr_b32 s27, s26, 2
    s_add_u32 s4, s4, s27
    s_lshl_b32 s57, s4, 3
    s_add_u32 s57, s57, s5
    s_lshl_b32 s20, s4, 8
    s_mul_i32 s25, s56, 7340032
    s_add_u32 s20, s20, s25
    s_lshl_b32 s21, s5, 13
    s_mul_i32 s25, s56, 3670016
    s_add_u32 s21, s21, s25
    s_add_u32 s25, s56, 1
    s_mul_i32 s14, s25, 3670016
    s_mul_i32 s22, s3, 2048
    s_mul_i32 s23, s3, 2048
    v_and_b32 v1, 15, v0
    v_lshrrev_b32 v2, 4, v0
    v_lshrrev_b32 v3, 2, v1
    v_and_b32 v4, 1, v2
    v_lshrrev_b32 v5, 1, v2
    v_lshl_add_u32 v6, v2, 3, v3
    v_lshl_or_b32 v3, v4, 2, v3
    v_lshlrev_b32 v6, 8, v6
    v_and_b32 v4, 3, v1
    v_lshl_add_u32 v6, v4, 3, v6
    s_and_b32 s25, s3, 1
    s_mul_i32 s25, s25, 4
    s_add_u32 s26, s25, 0
    v_xor_b32 v4, s26, v3
    v_lshl_add_u32 v8, v4, 5, v6
    s_add_u32 s26, s25, 1
    v_xor_b32 v4, s26, v3
    v_lshl_add_u32 v9, v4, 5, v6
    s_add_u32 s26, s25, 2
    v_xor_b32 v4, s26, v3
    v_lshl_add_u32 v10, v4, 5, v6
    s_add_u32 s26, s25, 3
    v_xor_b32 v4, s26, v3
    v_lshl_add_u32 v11, v4, 5, v6
    v_lshrrev_b32 v3, 2, v1
    v_lshrrev_b32 v4, 1, v3
    v_and_b32 v5, 1, v3
    v_xor_b32 v5, v5, v4
    v_lshl_or_b32 v5, v5, 1, v4
    v_xor_b32 v5, v5, v2
    v_lshlrev_b32 v5, 4, v5
    v_lshl_add_u32 v5, v1, 6, v5
    s_lshr_b32 s25, s3, 1
    s_mul_i32 s25, s25, 4096
    s_add_u32 s25, s25, 8192
    v_add_u32 v12, s25, v5
    v_lshrrev_b32 v3, 4, v0
    v_and_b32 v4, 15, v0
    s_and_b32 s25, s3, 1
    s_lshl_b32 s26, s25, 3
    v_add_u32 v5, s26, v3
    s_lshr_b32 s26, s3, 1
    s_lshl_b32 s26, s26, 4
    v_add_u32 v5, s26, v5
    s_lshl_b32 s25, s25, 2
    v_or_b32 v6, s25, v3
    v_lshrrev_b32 v1, 1, v4
    v_xor_b32 v1, v1, v6
    v_lshlrev_b32 v1, 5, v1
    v_and_b32 v4, 1, v4
    v_lshl_or_b32 v1, v4, 4, v1
    s_mov_b32 s25, 4096
    v_mul_lo_u32 v5, v5, s25
    v_add_u32 v13, v5, v1
    v_add_u32 v14, 16384, v13
    v_lshlrev_b32 v3, 4, v0
    s_mul_i32 s25, s3, 2048
    v_add_u32 v15, s25, v3
    v_add_u32 v16, 1024, v15
    v_add_u32 v148, 65536, v8
    v_add_u32 v149, 65536, v9
    v_add_u32 v150, 65536, v10
    v_add_u32 v151, 65536, v11
    v_add_u32 v152, 65536, v12
    s_mov_b32 s35, s20
    s_add_u32 m0, s22, 0
    s_nop 0
    buffer_load_dwordx4 v13, s[8:11], s20 offen lds
    s_add_u32 m0, s22, 1024
    s_nop 0
    buffer_load_dwordx4 v14, s[8:11], s20 offen lds
    s_add_u32 s20, s20, 131072
    s_add_u32 m0, s22, 16384
    s_nop 0
    buffer_load_dwordx4 v13, s[8:11], s20 offen lds
    s_add_u32 m0, s22, 17408
    s_nop 0
    buffer_load_dwordx4 v14, s[8:11], s20 offen lds
    s_add_u32 s20, s20, 131072
    s_add_u32 m0, s22, 32768
    s_nop 0
    buffer_load_dwordx4 v13, s[8:11], s20 offen lds
    s_add_u32 m0, s22, 33792
    s_nop 0
    buffer_load_dwordx4 v14, s[8:11], s20 offen lds
    s_add_u32 s20, s20, 131072
    s_add_u32 m0, s22, 49152
    s_nop 0
    buffer_load_dwordx4 v13, s[8:11], s20 offen lds
    s_add_u32 m0, s22, 50176
    s_nop 0
    buffer_load_dwordx4 v14, s[8:11], s20 offen lds
    s_add_u32 s20, s20, 131072
    s_add_u32 m0, s22, 65536
    s_nop 0
    buffer_load_dwordx4 v13, s[8:11], s20 offen lds
    s_add_u32 m0, s22, 66560
    s_nop 0
    buffer_load_dwordx4 v14, s[8:11], s20 offen lds
    s_add_u32 s20, s20, 131072
    s_add_u32 m0, s22, 81920
    s_nop 0
    buffer_load_dwordx4 v13, s[8:11], s20 offen lds
    s_add_u32 m0, s22, 82944
    s_nop 0
    buffer_load_dwordx4 v14, s[8:11], s20 offen lds
    s_add_u32 s20, s20, 131072
    s_add_u32 m0, s22, 98304
    s_nop 0
    buffer_load_dwordx4 v13, s[8:11], s20 offen lds
    s_add_u32 m0, s22, 99328
    s_nop 0
    buffer_load_dwordx4 v14, s[8:11], s20 offen lds
    s_add_u32 s20, s20, 131072
    s_lshl_b32 s58, s5, 1
    s_add_u32 s58, s58, s56
    s_lshl_b32 s58, s58, 7
    s_add_u32 s58, s58, 165888
    s_add_u32 s48, s6, 130023424
    s_addc_u32 s49, s7, 0
    s_cmp_lg_u32 s3, 0
    s_cbranch_scc1 L_g2f_uw_b
    v_mov_b32 v2, s58
    s_mov_b32 s50, 0x200000
L_g2f_uw:
    global_load_dword v3, v2, s[48:49] sc1
    s_waitcnt vmcnt(0)
    v_readfirstlane_b32 s44, v3
    s_nop 0
    s_cmp_ge_u32 s44, 14
    s_cbranch_scc1 L_g2f_uw_ok
    s_sleep 5
    s_sub_u32 s50, s50, 1
    s_cbranch_scc0 L_g2f_uw
L_g2f_uw_ok:
L_g2f_uw_b:
    s_barrier
    s_add_u32 m0, s23, 8192
    s_nop 0
    buffer_load_dwordx4 v15, s[12:15], s21 offen lds
    s_add_u32 m0, s23, 9216
    s_nop 0
    buffer_load_dwordx4 v16, s[12:15], s21 offen lds
    s_add_u32 s21, s21, 65536
    s_add_u32 m0, s23, 24576
    s_nop 0
    buffer_load_dwordx4 v15, s[12:15], s21 offen lds
    s_add_u32 m0, s23, 25600
    s_nop 0
    buffer_load_dwordx4 v16, s[12:15], s21 offen lds
    s_add_u32 s21, s21, 65536
    s_add_u32 m0, s23, 40960
    s_nop 0
    buffer_load_dwordx4 v15, s[12:15], s21 offen lds
    s_add_u32 m0, s23, 41984
    s_nop 0
    buffer_load_dwordx4 v16, s[12:15], s21 offen lds
    s_add_u32 s21, s21, 65536
    s_add_u32 m0, s23, 57344
    s_nop 0
    buffer_load_dwordx4 v15, s[12:15], s21 offen lds
    s_add_u32 m0, s23, 58368
    s_nop 0
    buffer_load_dwordx4 v16, s[12:15], s21 offen lds
    s_add_u32 s21, s21, 65536
    s_add_u32 m0, s23, 73728
    s_nop 0
    buffer_load_dwordx4 v15, s[12:15], s21 offen lds
    s_add_u32 m0, s23, 74752
    s_nop 0
    buffer_load_dwordx4 v16, s[12:15], s21 offen lds
    s_add_u32 s21, s21, 65536
    s_add_u32 m0, s23, 90112
    s_nop 0
    buffer_load_dwordx4 v15, s[12:15], s21 offen lds
    s_add_u32 m0, s23, 91136
    s_nop 0
    buffer_load_dwordx4 v16, s[12:15], s21 offen lds
    s_add_u32 s21, s21, 65536
    s_add_u32 m0, s23, 106496
    s_nop 0
    buffer_load_dwordx4 v15, s[12:15], s21 offen lds
    s_add_u32 m0, s23, 107520
    s_nop 0
    buffer_load_dwordx4 v16, s[12:15], s21 offen lds
    s_add_u32 s21, s21, 65536
    s_waitcnt vmcnt(10)
    s_barrier
    ds_read_b128 v[36:39], v12 offset:0
    ds_read_b64_tr_b16 v[20:21], v8 offset:0
    ds_read_b64_tr_b16 v[22:23], v8 offset:1024
    ds_read_b128 v[40:43], v12 offset:1024
    ds_read_b64_tr_b16 v[24:25], v9 offset:0
    ds_read_b64_tr_b16 v[26:27], v9 offset:1024
    ds_read_b128 v[44:47], v12 offset:2048
    ds_read_b64_tr_b16 v[28:29], v10 offset:0
    ds_read_b64_tr_b16 v[30:31], v10 offset:1024
    ds_read_b128 v[48:51], v12 offset:3072
    ds_read_b64_tr_b16 v[32:33], v11 offset:0
    ds_read_b64_tr_b16 v[34:35], v11 offset:1024
    ds_read_b128 v[68:71], v12 offset:16384
    ds_read_b64_tr_b16 v[52:53], v8 offset:16384
    ds_read_b64_tr_b16 v[54:55], v8 offset:17408
    ds_read_b128 v[72:75], v12 offset:17408
    ds_read_b64_tr_b16 v[56:57], v9 offset:16384
    ds_read_b64_tr_b16 v[58:59], v9 offset:17408
    ds_read_b128 v[76:79], v12 offset:18432
    ds_read_b64_tr_b16 v[60:61], v10 offset:16384
    ds_read_b64_tr_b16 v[62:63], v10 offset:17408
    ds_read_b128 v[80:83], v12 offset:19456
    ds_read_b64_tr_b16 v[64:65], v11 offset:16384
    ds_read_b64_tr_b16 v[66:67], v11 offset:17408
    s_waitcnt vmcnt(6) lgkmcnt(12)
    s_barrier
    v_mfma_f32_16x16x32_bf16 a[0:3], v[36:39], v[20:23], 0
    ds_read_b128 v[100:103], v12 offset:32768
    s_add_u32 m0, s22, 114688
    v_mfma_f32_16x16x32_bf16 a[16:19], v[36:39], v[24:27], 0
    buffer_load_dwordx4 v13, s[8:11], s20 offen lds
    ds_read_b64_tr_b16 v[84:85], v8 offset:32768
    v_mfma_f32_16x16x32_bf16 a[32:35], v[36:39], v[28:31], 0
    ds_read_b64_tr_b16 v[86:87], v8 offset:33792
    v_mfma_f32_16x16x32_bf16 a[48:51], v[36:39], v[32:35], 0
    v_mfma_f32_16x16x32_bf16 a[4:7], v[40:43], v[20:23], 0
    ds_read_b128 v[104:107], v12 offset:33792
    s_add_u32 m0, s22, 115712
    v_mfma_f32_16x16x32_bf16 a[20:23], v[40:43], v[24:27], 0
    buffer_load_dwordx4 v14, s[8:11], s20 offen lds
    ds_read_b64_tr_b16 v[88:89], v9 offset:32768
    v_mfma_f32_16x16x32_bf16 a[36:39], v[40:43], v[28:31], 0
    ds_read_b64_tr_b16 v[90:91], v9 offset:33792
    v_mfma_f32_16x16x32_bf16 a[52:55], v[40:43], v[32:35], 0
    v_mfma_f32_16x16x32_bf16 a[8:11], v[44:47], v[20:23], 0
    ds_read_b128 v[108:111], v12 offset:34816
    s_add_u32 m0, s23, 122880
    v_mfma_f32_16x16x32_bf16 a[24:27], v[44:47], v[24:27], 0
    buffer_load_dwordx4 v15, s[12:15], s21 offen lds
    ds_read_b64_tr_b16 v[92:93], v10 offset:32768
    v_mfma_f32_16x16x32_bf16 a[40:43], v[44:47], v[28:31], 0
    ds_read_b64_tr_b16 v[94:95], v10 offset:33792
    v_mfma_f32_16x16x32_bf16 a[56:59], v[44:47], v[32:35], 0
    v_mfma_f32_16x16x32_bf16 a[12:15], v[48:51], v[20:23], 0
    ds_read_b128 v[112:115], v12 offset:35840
    s_add_u32 m0, s23, 123904
    v_mfma_f32_16x16x32_bf16 a[28:31], v[48:51], v[24:27], 0
    buffer_load_dwordx4 v16, s[12:15], s21 offen lds
    ds_read_b64_tr_b16 v[96:97], v11 offset:32768
    v_mfma_f32_16x16x32_bf16 a[44:47], v[48:51], v[28:31], 0
    ds_read_b64_tr_b16 v[98:99], v11 offset:33792
    v_mfma_f32_16x16x32_bf16 a[60:63], v[48:51], v[32:35], 0
    s_add_u32 s20, s20, 131072
    s_add_u32 s21, s21, 65536
    s_waitcnt lgkmcnt(12)
    v_mfma_f32_16x16x32_bf16 a[0:3], v[68:71], v[52:55], a[0:3]
    ds_read_b128 v[132:135], v12 offset:49152
    s_add_u32 m0, s22, 0
    v_mfma_f32_16x16x32_bf16 a[16:19], v[68:71], v[56:59], a[16:19]
    buffer_load_dwordx4 v13, s[8:11], s20 offen lds
    ds_read_b64_tr_b16 v[116:117], v8 offset:49152
    v_mfma_f32_16x16x32_bf16 a[32:35], v[68:71], v[60:63], a[32:35]
    ds_read_b64_tr_b16 v[118:119], v8 offset:50176
    v_mfma_f32_16x16x32_bf16 a[48:51], v[68:71], v[64:67], a[48:51]
    v_mfma_f32_16x16x32_bf16 a[4:7], v[72:75], v[52:55], a[4:7]
    ds_read_b128 v[136:139], v12 offset:50176
    s_add_u32 m0, s22, 1024
    v_mfma_f32_16x16x32_bf16 a[20:23], v[72:75], v[56:59], a[20:23]
    buffer_load_dwordx4 v14, s[8:11], s20 offen lds
    ds_read_b64_tr_b16 v[120:121], v9 offset:49152
    v_mfma_f32_16x16x32_bf16 a[36:39], v[72:75], v[60:63], a[36:39]
    ds_read_b64_tr_b16 v[122:123], v9 offset:50176
    v_mfma_f32_16x16x32_bf16 a[52:55], v[72:75], v[64:67], a[52:55]
    v_mfma_f32_16x16x32_bf16 a[8:11], v[76:79], v[52:55], a[8:11]
    ds_read_b128 v[140:143], v12 offset:51200
    s_add_u32 m0, s23, 8192
    v_mfma_f32_16x16x32_bf16 a[24:27], v[76:79], v[56:59], a[24:27]
    buffer_load_dwordx4 v15, s[12:15], s21 offen lds
    ds_read_b64_tr_b16 v[124:125], v10 offset:49152
    v_mfma_f32_16x16x32_bf16 a[40:43], v[76:79], v[60:63], a[40:43]
    ds_read_b64_tr_b16 v[126:127], v10 offset:50176
    v_mfma_f32_16x16x32_bf16 a[56:59], v[76:79], v[64:67], a[56:59]
    v_mfma_f32_16x16x32_bf16 a[12:15], v[80:83], v[52:55], a[12:15]
    ds_read_b128 v[144:147], v12 offset:52224
    s_add_u32 m0, s23, 9216
    v_mfma_f32_16x16x32_bf16 a[28:31], v[80:83], v[56:59], a[28:31]
    buffer_load_dwordx4 v16, s[12:15], s21 offen lds
    ds_read_b64_tr_b16 v[128:129], v11 offset:49152
    v_mfma_f32_16x16x32_bf16 a[44:47], v[80:83], v[60:63], a[44:47]
    ds_read_b64_tr_b16 v[130:131], v11 offset:50176
    v_mfma_f32_16x16x32_bf16 a[60:63], v[80:83], v[64:67], a[60:63]
    s_add_u32 s20, s20, 131072
    s_add_u32 s21, s21, 65536
    s_waitcnt vmcnt(10) lgkmcnt(12)
    s_barrier
    v_mfma_f32_16x16x32_bf16 a[0:3], v[100:103], v[84:87], a[0:3]
    ds_read_b128 v[36:39], v152 offset:0
    s_add_u32 m0, s22, 16384
    v_mfma_f32_16x16x32_bf16 a[16:19], v[100:103], v[88:91], a[16:19]
    buffer_load_dwordx4 v13, s[8:11], s20 offen lds
    ds_read_b64_tr_b16 v[20:21], v148 offset:0
    v_mfma_f32_16x16x32_bf16 a[32:35], v[100:103], v[92:95], a[32:35]
    ds_read_b64_tr_b16 v[22:23], v148 offset:1024
    v_mfma_f32_16x16x32_bf16 a[48:51], v[100:103], v[96:99], a[48:51]
    v_mfma_f32_16x16x32_bf16 a[4:7], v[104:107], v[84:87], a[4:7]
    ds_read_b128 v[40:43], v152 offset:1024
    s_add_u32 m0, s22, 17408
    v_mfma_f32_16x16x32_bf16 a[20:23], v[104:107], v[88:91], a[20:23]
    buffer_load_dwordx4 v14, s[8:11], s20 offen lds
    ds_read_b64_tr_b16 v[24:25], v149 offset:0
    v_mfma_f32_16x16x32_bf16 a[36:39], v[104:107], v[92:95], a[36:39]
    ds_read_b64_tr_b16 v[26:27], v149 offset:1024
    v_mfma_f32_16x16x32_bf16 a[52:55], v[104:107], v[96:99], a[52:55]
    v_mfma_f32_16x16x32_bf16 a[8:11], v[108:111], v[84:87], a[8:11]
    ds_read_b128 v[44:47], v152 offset:2048
    s_add_u32 m0, s23, 24576
    v_mfma_f32_16x16x32_bf16 a[24:27], v[108:111], v[88:91], a[24:27]
    buffer_load_dwordx4 v15, s[12:15], s21 offen lds
    ds_read_b64_tr_b16 v[28:29], v150 offset:0
    v_mfma_f32_16x16x32_bf16 a[40:43], v[108:111], v[92:95], a[40:43]
    ds_read_b64_tr_b16 v[30:31], v150 offset:1024
    v_mfma_f32_16x16x32_bf16 a[56:59], v[108:111], v[96:99], a[56:59]
    v_mfma_f32_16x16x32_bf16 a[12:15], v[112:115], v[84:87], a[12:15]
    ds_read_b128 v[48:51], v152 offset:3072
    s_add_u32 m0, s23, 25600
    v_mfma_f32_16x16x32_bf16 a[28:31], v[112:115], v[88:91], a[28:31]
    buffer_load_dwordx4 v16, s[12:15], s21 offen lds
    ds_read_b64_tr_b16 v[32:33], v151 offset:0
    v_mfma_f32_16x16x32_bf16 a[44:47], v[112:115], v[92:95], a[44:47]
    ds_read_b64_tr_b16 v[34:35], v151 offset:1024
    v_mfma_f32_16x16x32_bf16 a[60:63], v[112:115], v[96:99], a[60:63]
    s_add_u32 s20, s20, 131072
    s_add_u32 s21, s21, 65536
    s_waitcnt lgkmcnt(12)
    v_mfma_f32_16x16x32_bf16 a[0:3], v[132:135], v[116:119], a[0:3]
    ds_read_b128 v[68:71], v152 offset:16384
    s_add_u32 m0, s22, 32768
    v_mfma_f32_16x16x32_bf16 a[16:19], v[132:135], v[120:123], a[16:19]
    buffer_load_dwordx4 v13, s[8:11], s20 offen lds
    ds_read_b64_tr_b16 v[52:53], v148 offset:16384
    v_mfma_f32_16x16x32_bf16 a[32:35], v[132:135], v[124:127], a[32:35]
    ds_read_b64_tr_b16 v[54:55], v148 offset:17408
    v_mfma_f32_16x16x32_bf16 a[48:51], v[132:135], v[128:131], a[48:51]
    v_mfma_f32_16x16x32_bf16 a[4:7], v[136:139], v[116:119], a[4:7]
    ds_read_b128 v[72:75], v152 offset:17408
    s_add_u32 m0, s22, 33792
    v_mfma_f32_16x16x32_bf16 a[20:23], v[136:139], v[120:123], a[20:23]
    buffer_load_dwordx4 v14, s[8:11], s20 offen lds
    ds_read_b64_tr_b16 v[56:57], v149 offset:16384
    v_mfma_f32_16x16x32_bf16 a[36:39], v[136:139], v[124:127], a[36:39]
    ds_read_b64_tr_b16 v[58:59], v149 offset:17408
    v_mfma_f32_16x16x32_bf16 a[52:55], v[136:139], v[128:131], a[52:55]
    v_mfma_f32_16x16x32_bf16 a[8:11], v[140:143], v[116:119], a[8:11]
    ds_read_b128 v[76:79], v152 offset:18432
    s_add_u32 m0, s23, 40960
    v_mfma_f32_16x16x32_bf16 a[24:27], v[140:143], v[120:123], a[24:27]
    buffer_load_dwordx4 v15, s[12:15], s21 offen lds
    ds_read_b64_tr_b16 v[60:61], v150 offset:16384
    v_mfma_f32_16x16x32_bf16 a[40:43], v[140:143], v[124:127], a[40:43]
    ds_read_b64_tr_b16 v[62:63], v150 offset:17408
    v_mfma_f32_16x16x32_bf16 a[56:59], v[140:143], v[128:131], a[56:59]
    v_mfma_f32_16x16x32_bf16 a[12:15], v[144:147], v[116:119], a[12:15]
    ds_read_b128 v[80:83], v152 offset:19456
    s_add_u32 m0, s23, 41984
    v_mfma_f32_16x16x32_bf16 a[28:31], v[144:147], v[120:123], a[28:31]
    buffer_load_dwordx4 v16, s[12:15], s21 offen lds
    ds_read_b64_tr_b16 v[64:65], v151 offset:16384
    v_mfma_f32_16x16x32_bf16 a[44:47], v[144:147], v[124:127], a[44:47]
    ds_read_b64_tr_b16 v[66:67], v151 offset:17408
    v_mfma_f32_16x16x32_bf16 a[60:63], v[144:147], v[128:131], a[60:63]
    s_add_u32 s20, s20, 131072
    s_add_u32 s21, s21, 65536
    s_waitcnt vmcnt(12) lgkmcnt(12)
    s_barrier
    v_mfma_f32_16x16x32_bf16 a[0:3], v[36:39], v[20:23], a[0:3]
    ds_read_b128 v[100:103], v152 offset:32768
    s_add_u32 m0, s22, 49152
    v_mfma_f32_16x16x32_bf16 a[16:19], v[36:39], v[24:27], a[16:19]
    buffer_load_dwordx4 v13, s[8:11], s20 offen lds
    ds_read_b64_tr_b16 v[84:85], v148 offset:32768
    v_mfma_f32_16x16x32_bf16 a[32:35], v[36:39], v[28:31], a[32:35]
    ds_read_b64_tr_b16 v[86:87], v148 offset:33792
    v_mfma_f32_16x16x32_bf16 a[48:51], v[36:39], v[32:35], a[48:51]
    v_mfma_f32_16x16x32_bf16 a[4:7], v[40:43], v[20:23], a[4:7]
    ds_read_b128 v[104:107], v152 offset:33792
    s_add_u32 m0, s22, 50176
    v_mfma_f32_16x16x32_bf16 a[20:23], v[40:43], v[24:27], a[20:23]
    buffer_load_dwordx4 v14, s[8:11], s20 offen lds
    ds_read_b64_tr_b16 v[88:89], v149 offset:32768
    v_mfma_f32_16x16x32_bf16 a[36:39], v[40:43], v[28:31], a[36:39]
    ds_read_b64_tr_b16 v[90:91], v149 offset:33792
    v_mfma_f32_16x16x32_bf16 a[52:55], v[40:43], v[32:35], a[52:55]
    v_mfma_f32_16x16x32_bf16 a[8:11], v[44:47], v[20:23], a[8:11]
    ds_read_b128 v[108:111], v152 offset:34816
    s_add_u32 m0, s23, 57344
    v_mfma_f32_16x16x32_bf16 a[24:27], v[44:47], v[24:27], a[24:27]
    buffer_load_dwordx4 v15, s[12:15], s21 offen lds
    ds_read_b64_tr_b16 v[92:93], v150 offset:32768
    v_mfma_f32_16x16x32_bf16 a[40:43], v[44:47], v[28:31], a[40:43]
    ds_read_b64_tr_b16 v[94:95], v150 offset:33792
    v_mfma_f32_16x16x32_bf16 a[56:59], v[44:47], v[32:35], a[56:59]
    v_mfma_f32_16x16x32_bf16 a[12:15], v[48:51], v[20:23], a[12:15]
    ds_read_b128 v[112:115], v152 offset:35840
    s_add_u32 m0, s23, 58368
    v_mfma_f32_16x16x32_bf16 a[28:31], v[48:51], v[24:27], a[28:31]
    buffer_load_dwordx4 v16, s[12:15], s21 offen lds
    ds_read_b64_tr_b16 v[96:97], v151 offset:32768
    v_mfma_f32_16x16x32_bf16 a[44:47], v[48:51], v[28:31], a[44:47]
    ds_read_b64_tr_b16 v[98:99], v151 offset:33792
    v_mfma_f32_16x16x32_bf16 a[60:63], v[48:51], v[32:35], a[60:63]
    s_add_u32 s20, s20, 131072
    s_add_u32 s21, s21, 65536
    s_waitcnt lgkmcnt(12)
    v_mfma_f32_16x16x32_bf16 a[0:3], v[68:71], v[52:55], a[0:3]
    ds_read_b128 v[132:135], v152 offset:49152
    s_add_u32 m0, s22, 65536
    v_mfma_f32_16x16x32_bf16 a[16:19], v[68:71], v[56:59], a[16:19]
    buffer_load_dwordx4 v13, s[8:11], s20 offen lds
    ds_read_b64_tr_b16 v[116:117], v148 offset:49152
    v_mfma_f32_16x16x32_bf16 a[32:35], v[68:71], v[60:63], a[32:35]
    ds_read_b64_tr_b16 v[118:119], v148 offset:50176
    v_mfma_f32_16x16x32_bf16 a[48:51], v[68:71], v[64:67], a[48:51]
    v_mfma_f32_16x16x32_bf16 a[4:7], v[72:75], v[52:55], a[4:7]
    ds_read_b128 v[136:139], v152 offset:50176
    s_add_u32 m0, s22, 66560
    v_mfma_f32_16x16x32_bf16 a[20:23], v[72:75], v[56:59], a[20:23]
    buffer_load_dwordx4 v14, s[8:11], s20 offen lds
    ds_read_b64_tr_b16 v[120:121], v149 offset:49152
    v_mfma_f32_16x16x32_bf16 a[36:39], v[72:75], v[60:63], a[36:39]
    ds_read_b64_tr_b16 v[122:123], v149 offset:50176
    v_mfma_f32_16x16x32_bf16 a[52:55], v[72:75], v[64:67], a[52:55]
    v_mfma_f32_16x16x32_bf16 a[8:11], v[76:79], v[52:55], a[8:11]
    ds_read_b128 v[140:143], v152 offset:51200
    s_add_u32 m0, s23, 73728
    v_mfma_f32_16x16x32_bf16 a[24:27], v[76:79], v[56:59], a[24:27]
    buffer_load_dwordx4 v15, s[12:15], s21 offen lds
    ds_read_b64_tr_b16 v[124:125], v150 offset:49152
    v_mfma_f32_16x16x32_bf16 a[40:43], v[76:79], v[60:63], a[40:43]
    ds_read_b64_tr_b16 v[126:127], v150 offset:50176
    v_mfma_f32_16x16x32_bf16 a[56:59], v[76:79], v[64:67], a[56:59]
    v_mfma_f32_16x16x32_bf16 a[12:15], v[80:83], v[52:55], a[12:15]
    ds_read_b128 v[144:147], v152 offset:52224
    s_add_u32 m0, s23, 74752
    v_mfma_f32_16x16x32_bf16 a[28:31], v[80:83], v[56:59], a[28:31]
    buffer_load_dwordx4 v16, s[12:15], s21 offen lds
    ds_read_b64_tr_b16 v[128:129], v151 offset:49152
    v_mfma_f32_16x16x32_bf16 a[44:47], v[80:83], v[60:63], a[44:47]
    ds_read_b64_tr_b16 v[130:131], v151 offset:50176
    v_mfma_f32_16x16x32_bf16 a[60:63], v[80:83], v[64:67], a[60:63]
    s_add_u32 s20, s20, 131072
    s_add_u32 s21, s21, 65536
    s_waitcnt vmcnt(12) lgkmcnt(12)
    s_barrier
    v_mfma_f32_16x16x32_bf16 a[0:3], v[100:103], v[84:87], a[0:3]
    ds_read_b128 v[36:39], v12 offset:0
    s_add_u32 m0, s22, 81920
    v_mfma_f32_16x16x32_bf16 a[16:19], v[100:103], v[88:91], a[16:19]
    buffer_load_dwordx4 v13, s[8:11], s20 offen lds
    ds_read_b64_tr_b16 v[20:21], v8 offset:0
    v_mfma_f32_16x16x32_bf16 a[32:35], v[100:103], v[92:95], a[32:35]
    ds_read_b64_tr_b16 v[22:23], v8 offset:1024
    v_mfma_f32_16x16x32_bf16 a[48:51], v[100:103], v[96:99], a[48:51]
    v_mfma_f32_16x16x32_bf16 a[4:7], v[104:107], v[84:87], a[4:7]
    ds_read_b128 v[40:43], v12 offset:1024
    s_add_u32 m0, s22, 82944
    v_mfma_f32_16x16x32_bf16 a[20:23], v[104:107], v[88:91], a[20:23]
    buffer_load_dwordx4 v14, s[8:11], s20 offen lds
    ds_read_b64_tr_b16 v[24:25], v9 offset:0
    v_mfma_f32_16x16x32_bf16 a[36:39], v[104:107], v[92:95], a[36:39]
    ds_read_b64_tr_b16 v[26:27], v9 offset:1024
    v_mfma_f32_16x16x32_bf16 a[52:55], v[104:107], v[96:99], a[52:55]
    v_mfma_f32_16x16x32_bf16 a[8:11], v[108:111], v[84:87], a[8:11]
    ds_read_b128 v[44:47], v12 offset:2048
    s_add_u32 m0, s23, 90112
    v_mfma_f32_16x16x32_bf16 a[24:27], v[108:111], v[88:91], a[24:27]
    buffer_load_dwordx4 v15, s[12:15], s21 offen lds
    ds_read_b64_tr_b16 v[28:29], v10 offset:0
    v_mfma_f32_16x16x32_bf16 a[40:43], v[108:111], v[92:95], a[40:43]
    ds_read_b64_tr_b16 v[30:31], v10 offset:1024
    v_mfma_f32_16x16x32_bf16 a[56:59], v[108:111], v[96:99], a[56:59]
    v_mfma_f32_16x16x32_bf16 a[12:15], v[112:115], v[84:87], a[12:15]
    ds_read_b128 v[48:51], v12 offset:3072
    s_add_u32 m0, s23, 91136
    v_mfma_f32_16x16x32_bf16 a[28:31], v[112:115], v[88:91], a[28:31]
    buffer_load_dwordx4 v16, s[12:15], s21 offen lds
    ds_read_b64_tr_b16 v[32:33], v11 offset:0
    v_mfma_f32_16x16x32_bf16 a[44:47], v[112:115], v[92:95], a[44:47]
    ds_read_b64_tr_b16 v[34:35], v11 offset:1024
    v_mfma_f32_16x16x32_bf16 a[60:63], v[112:115], v[96:99], a[60:63]
    s_add_u32 s20, s20, 131072
    s_add_u32 s21, s21, 65536
    s_waitcnt lgkmcnt(12)
    v_mfma_f32_16x16x32_bf16 a[0:3], v[132:135], v[116:119], a[0:3]
    ds_read_b128 v[68:71], v12 offset:16384
    s_add_u32 m0, s22, 98304
    v_mfma_f32_16x16x32_bf16 a[16:19], v[132:135], v[120:123], a[16:19]
    buffer_load_dwordx4 v13, s[8:11], s20 offen lds
    ds_read_b64_tr_b16 v[52:53], v8 offset:16384
    v_mfma_f32_16x16x32_bf16 a[32:35], v[132:135], v[124:127], a[32:35]
    ds_read_b64_tr_b16 v[54:55], v8 offset:17408
    v_mfma_f32_16x16x32_bf16 a[48:51], v[132:135], v[128:131], a[48:51]
    v_mfma_f32_16x16x32_bf16 a[4:7], v[136:139], v[116:119], a[4:7]
    ds_read_b128 v[72:75], v12 offset:17408
    s_add_u32 m0, s22, 99328
    v_mfma_f32_16x16x32_bf16 a[20:23], v[136:139], v[120:123], a[20:23]
    buffer_load_dwordx4 v14, s[8:11], s20 offen lds
    ds_read_b64_tr_b16 v[56:57], v9 offset:16384
    v_mfma_f32_16x16x32_bf16 a[36:39], v[136:139], v[124:127], a[36:39]
    ds_read_b64_tr_b16 v[58:59], v9 offset:17408
    v_mfma_f32_16x16x32_bf16 a[52:55], v[136:139], v[128:131], a[52:55]
    v_mfma_f32_16x16x32_bf16 a[8:11], v[140:143], v[116:119], a[8:11]
    ds_read_b128 v[76:79], v12 offset:18432
    s_add_u32 m0, s23, 106496
    v_mfma_f32_16x16x32_bf16 a[24:27], v[140:143], v[120:123], a[24:27]
    buffer_load_dwordx4 v15, s[12:15], s21 offen lds
    ds_read_b64_tr_b16 v[60:61], v10 offset:16384
    v_mfma_f32_16x16x32_bf16 a[40:43], v[140:143], v[124:127], a[40:43]
    ds_read_b64_tr_b16 v[62:63], v10 offset:17408
    v_mfma_f32_16x16x32_bf16 a[56:59], v[140:143], v[128:131], a[56:59]
    v_mfma_f32_16x16x32_bf16 a[12:15], v[144:147], v[116:119], a[12:15]
    ds_read_b128 v[80:83], v12 offset:19456
    s_add_u32 m0, s23, 107520
    v_mfma_f32_16x16x32_bf16 a[28:31], v[144:147], v[120:123], a[28:31]
    buffer_load_dwordx4 v16, s[12:15], s21 offen lds
    ds_read_b64_tr_b16 v[64:65], v11 offset:16384
    v_mfma_f32_16x16x32_bf16 a[44:47], v[144:147], v[124:127], a[44:47]
    ds_read_b64_tr_b16 v[66:67], v11 offset:17408
    v_mfma_f32_16x16x32_bf16 a[60:63], v[144:147], v[128:131], a[60:63]
    s_add_u32 s20, s20, 131072
    s_add_u32 s21, s21, 65536
    s_waitcnt vmcnt(12) lgkmcnt(12)
    s_barrier
    s_mov_b32 s24, 6
L_g2f_loop:
    v_mfma_f32_16x16x32_bf16 a[0:3], v[36:39], v[20:23], a[0:3]
    ds_read_b128 v[100:103], v12 offset:32768
    s_add_u32 m0, s22, 114688
    v_mfma_f32_16x16x32_bf16 a[16:19], v[36:39], v[24:27], a[16:19]
    buffer_load_dwordx4 v13, s[8:11], s20 offen lds
    ds_read_b64_tr_b16 v[84:85], v8 offset:32768
    v_mfma_f32_16x16x32_bf16 a[32:35], v[36:39], v[28:31], a[32:35]
    ds_read_b64_tr_b16 v[86:87], v8 offset:33792
    v_mfma_f32_16x16x32_bf16 a[48:51], v[36:39], v[32:35], a[48:51]
    v_mfma_f32_16x16x32_bf16 a[4:7], v[40:43], v[20:23], a[4:7]
    ds_read_b128 v[104:107], v12 offset:33792
    s_add_u32 m0, s22, 115712
    v_mfma_f32_16x16x32_bf16 a[20:23], v[40:43], v[24:27], a[20:23]
    buffer_load_dwordx4 v14, s[8:11], s20 offen lds
    ds_read_b64_tr_b16 v[88:89], v9 offset:32768
    v_mfma_f32_16x16x32_bf16 a[36:39], v[40:43], v[28:31], a[36:39]
    ds_read_b64_tr_b16 v[90:91], v9 offset:33792
    v_mfma_f32_16x16x32_bf16 a[52:55], v[40:43], v[32:35], a[52:55]
    v_mfma_f32_16x16x32_bf16 a[8:11], v[44:47], v[20:23], a[8:11]
    ds_read_b128 v[108:111], v12 offset:34816
    s_add_u32 m0, s23, 122880
    v_mfma_f32_16x16x32_bf16 a[24:27], v[44:47], v[24:27], a[24:27]
    buffer_load_dwordx4 v15, s[12:15], s21 offen lds
    ds_read_b64_tr_b16 v[92:93], v10 offset:32768
    v_mfma_f32_16x16x32_bf16 a[40:43], v[44:47], v[28:31], a[40:43]
    ds_read_b64_tr_b16 v[94:95], v10 offset:33792
    v_mfma_f32_16x16x32_bf16 a[56:59], v[44:47], v[32:35], a[56:59]
    v_mfma_f32_16x16x32_bf16 a[12:15], v[48:51], v[20:23], a[12:15]
    ds_read_b128 v[112:115], v12 offset:35840
    s_add_u32 m0, s23, 123904
    v_mfma_f32_16x16x32_bf16 a[28:31], v[48:51], v[24:27], a[28:31]
    buffer_load_dwordx4 v16, s[12:15], s21 offen lds
    ds_read_b64_tr_b16 v[96:97], v11 offset:32768
    v_mfma_f32_16x16x32_bf16 a[44:47], v[48:51], v[28:31], a[44:47]
    ds_read_b64_tr_b16 v[98:99], v11 offset:33792
    v_mfma_f32_16x16x32_bf16 a[60:63], v[48:51], v[32:35], a[60:63]
    s_add_u32 s20, s20, 131072
    s_add_u32 s21, s21, 65536
    s_waitcnt lgkmcnt(12)
    v_mfma_f32_16x16x32_bf16 a[0:3], v[68:71], v[52:55], a[0:3]
    ds_read_b128 v[132:135], v12 offset:49152
    s_add_u32 m0, s22, 0
    v_mfma_f32_16x16x32_bf16 a[16:19], v[68:71], v[56:59], a[16:19]
    buffer_load_dwordx4 v13, s[8:11], s20 offen lds
    ds_read_b64_tr_b16 v[116:117], v8 offset:49152
    v_mfma_f32_16x16x32_bf16 a[32:35], v[68:71], v[60:63], a[32:35]
    ds_read_b64_tr_b16 v[118:119], v8 offset:50176
    v_mfma_f32_16x16x32_bf16 a[48:51], v[68:71], v[64:67], a[48:51]
    v_mfma_f32_16x16x32_bf16 a[4:7], v[72:75], v[52:55], a[4:7]
    ds_read_b128 v[136:139], v12 offset:50176
    s_add_u32 m0, s22, 1024
    v_mfma_f32_16x16x32_bf16 a[20:23], v[72:75], v[56:59], a[20:23]
    buffer_load_dwordx4 v14, s[8:11], s20 offen lds
    ds_read_b64_tr_b16 v[120:121], v9 offset:49152
    v_mfma_f32_16x16x32_bf16 a[36:39], v[72:75], v[60:63], a[36:39]
    ds_read_b64_tr_b16 v[122:123], v9 offset:50176
    v_mfma_f32_16x16x32_bf16 a[52:55], v[72:75], v[64:67], a[52:55]
    v_mfma_f32_16x16x32_bf16 a[8:11], v[76:79], v[52:55], a[8:11]
    ds_read_b128 v[140:143], v12 offset:51200
    s_add_u32 m0, s23, 8192
    v_mfma_f32_16x16x32_bf16 a[24:27], v[76:79], v[56:59], a[24:27]
    buffer_load_dwordx4 v15, s[12:15], s21 offen lds
    ds_read_b64_tr_b16 v[124:125], v10 offset:49152
    v_mfma_f32_16x16x32_bf16 a[40:43], v[76:79], v[60:63], a[40:43]
    ds_read_b64_tr_b16 v[126:127], v10 offset:50176
    v_mfma_f32_16x16x32_bf16 a[56:59], v[76:79], v[64:67], a[56:59]
    v_mfma_f32_16x16x32_bf16 a[12:15], v[80:83], v[52:55], a[12:15]
    ds_read_b128 v[144:147], v12 offset:52224
    s_add_u32 m0, s23, 9216
    v_mfma_f32_16x16x32_bf16 a[28:31], v[80:83], v[56:59], a[28:31]
    buffer_load_dwordx4 v16, s[12:15], s21 offen lds
    ds_read_b64_tr_b16 v[128:129], v11 offset:49152
    v_mfma_f32_16x16x32_bf16 a[44:47], v[80:83], v[60:63], a[44:47]
    ds_read_b64_tr_b16 v[130:131], v11 offset:50176
    v_mfma_f32_16x16x32_bf16 a[60:63], v[80:83], v[64:67], a[60:63]
    s_add_u32 s20, s20, 131072
    s_add_u32 s21, s21, 65536
    s_waitcnt vmcnt(12) lgkmcnt(12)
    s_barrier
    v_mfma_f32_16x16x32_bf16 a[0:3], v[100:103], v[84:87], a[0:3]
    ds_read_b128 v[36:39], v152 offset:0
    s_add_u32 m0, s22, 16384
    v_mfma_f32_16x16x32_bf16 a[16:19], v[100:103], v[88:91], a[16:19]
    buffer_load_dwordx4 v13, s[8:11], s20 offen lds
    ds_read_b64_tr_b16 v[20:21], v148 offset:0
    v_mfma_f32_16x16x32_bf16 a[32:35], v[100:103], v[92:95], a[32:35]
    ds_read_b64_tr_b16 v[22:23], v148 offset:1024
    v_mfma_f32_16x16x32_bf16 a[48:51], v[100:103], v[96:99], a[48:51]
    v_mfma_f32_16x16x32_bf16 a[4:7], v[104:107], v[84:87], a[4:7]
    ds_read_b128 v[40:43], v152 offset:1024
    s_add_u32 m0, s22, 17408
    v_mfma_f32_16x16x32_bf16 a[20:23], v[104:107], v[88:91], a[20:23]
    buffer_load_dwordx4 v14, s[8:11], s20 offen lds
    ds_read_b64_tr_b16 v[24:25], v149 offset:0
    v_mfma_f32_16x16x32_bf16 a[36:39], v[104:107], v[92:95], a[36:39]
    ds_read_b64_tr_b16 v[26:27], v149 offset:1024
    v_mfma_f32_16x16x32_bf16 a[52:55], v[104:107], v[96:99], a[52:55]
    v_mfma_f32_16x16x32_bf16 a[8:11], v[108:111], v[84:87], a[8:11]
    ds_read_b128 v[44:47], v152 offset:2048
    s_add_u32 m0, s23, 24576
    v_mfma_f32_16x16x32_bf16 a[24:27], v[108:111], v[88:91], a[24:27]
    buffer_load_dwordx4 v15, s[12:15], s21 offen lds
    ds_read_b64_tr_b16 v[28:29], v150 offset:0
    v_mfma_f32_16x16x32_bf16 a[40:43], v[108:111], v[92:95], a[40:43]
    ds_read_b64_tr_b16 v[30:31], v150 offset:1024
    v_mfma_f32_16x16x32_bf16 a[56:59], v[108:111], v[96:99], a[56:59]
    v_mfma_f32_16x16x32_bf16 a[12:15], v[112:115], v[84:87], a[12:15]
    ds_read_b128 v[48:51], v152 offset:3072
    s_add_u32 m0, s23, 25600
    v_mfma_f32_16x16x32_bf16 a[28:31], v[112:115], v[88:91], a[28:31]
    buffer_load_dwordx4 v16, s[12:15], s21 offen lds
    ds_read_b64_tr_b16 v[32:33], v151 offset:0
    v_mfma_f32_16x16x32_bf16 a[44:47], v[112:115], v[92:95], a[44:47]
    ds_read_b64_tr_b16 v[34:35], v151 offset:1024
    v_mfma_f32_16x16x32_bf16 a[60:63], v[112:115], v[96:99], a[60:63]
    s_add_u32 s20, s20, 131072
    s_add_u32 s21, s21, 65536
    s_waitcnt lgkmcnt(12)
    v_mfma_f32_16x16x32_bf16 a[0:3], v[132:135], v[116:119], a[0:3]
    ds_read_b128 v[68:71], v152 offset:16384
    s_add_u32 m0, s22, 32768
    v_mfma_f32_16x16x32_bf16 a[16:19], v[132:135], v[120:123], a[16:19]
    buffer_load_dwordx4 v13, s[8:11], s20 offen lds
    ds_read_b64_tr_b16 v[52:53], v148 offset:16384
    v_mfma_f32_16x16x32_bf16 a[32:35], v[132:135], v[124:127], a[32:35]
    ds_read_b64_tr_b16 v[54:55], v148 offset:17408
    v_mfma_f32_16x16x32_bf16 a[48:51], v[132:135], v[128:131], a[48:51]
    v_mfma_f32_16x16x32_bf16 a[4:7], v[136:139], v[116:119], a[4:7]
    ds_read_b128 v[72:75], v152 offset:17408
    s_add_u32 m0, s22, 33792
    v_mfma_f32_16x16x32_bf16 a[20:23], v[136:139], v[120:123], a[20:23]
    buffer_load_dwordx4 v14, s[8:11], s20 offen lds
    ds_read_b64_tr_b16 v[56:57], v149 offset:16384
    v_mfma_f32_16x16x32_bf16 a[36:39], v[136:139], v[124:127], a[36:39]
    ds_read_b64_tr_b16 v[58:59], v149 offset:17408
    v_mfma_f32_16x16x32_bf16 a[52:55], v[136:139], v[128:131], a[52:55]
    v_mfma_f32_16x16x32_bf16 a[8:11], v[140:143], v[116:119], a[8:11]
    ds_read_b128 v[76:79], v152 offset:18432
    s_add_u32 m0, s23, 40960
    v_mfma_f32_16x16x32_bf16 a[24:27], v[140:143], v[120:123], a[24:27]
    buffer_load_dwordx4 v15, s[12:15], s21 offen lds
    ds_read_b64_tr_b16 v[60:61], v150 offset:16384
    v_mfma_f32_16x16x32_bf16 a[40:43], v[140:143], v[124:127], a[40:43]
    ds_read_b64_tr_b16 v[62:63], v150 offset:17408
    v_mfma_f32_16x16x32_bf16 a[56:59], v[140:143], v[128:131], a[56:59]
    v_mfma_f32_16x16x32_bf16 a[12:15], v[144:147], v[116:119], a[12:15]
    ds_read_b128 v[80:83], v152 offset:19456
    s_add_u32 m0, s23, 41984
    v_mfma_f32_16x16x32_bf16 a[28:31], v[144:147], v[120:123], a[28:31]
    buffer_load_dwordx4 v16, s[12:15], s21 offen lds
    ds_read_b64_tr_b16 v[64:65], v151 offset:16384
    v_mfma_f32_16x16x32_bf16 a[44:47], v[144:147], v[124:127], a[44:47]
    ds_read_b64_tr_b16 v[66:67], v151 offset:17408
    v_mfma_f32_16x16x32_bf16 a[60:63], v[144:147], v[128:131], a[60:63]
    s_add_u32 s20, s20, 131072
    s_add_u32 s21, s21, 65536
    s_waitcnt vmcnt(12) lgkmcnt(12)
    s_barrier
    v_mfma_f32_16x16x32_bf16 a[0:3], v[36:39], v[20:23], a[0:3]
    ds_read_b128 v[100:103], v152 offset:32768
    s_add_u32 m0, s22, 49152
    v_mfma_f32_16x16x32_bf16 a[16:19], v[36:39], v[24:27], a[16:19]
    buffer_load_dwordx4 v13, s[8:11], s20 offen lds
    ds_read_b64_tr_b16 v[84:85], v148 offset:32768
    v_mfma_f32_16x16x32_bf16 a[32:35], v[36:39], v[28:31], a[32:35]
    ds_read_b64_tr_b16 v[86:87], v148 offset:33792
    v_mfma_f32_16x16x32_bf16 a[48:51], v[36:39], v[32:35], a[48:51]
    v_mfma_f32_16x16x32_bf16 a[4:7], v[40:43], v[20:23], a[4:7]
    ds_read_b128 v[104:107], v152 offset:33792
    s_add_u32 m0, s22, 50176
    v_mfma_f32_16x16x32_bf16 a[20:23], v[40:43], v[24:27], a[20:23]
    buffer_load_dwordx4 v14, s[8:11], s20 offen lds
    ds_read_b64_tr_b16 v[88:89], v149 offset:32768
    v_mfma_f32_16x16x32_bf16 a[36:39], v[40:43], v[28:31], a[36:39]
    ds_read_b64_tr_b16 v[90:91], v149 offset:33792
    v_mfma_f32_16x16x32_bf16 a[52:55], v[40:43], v[32:35], a[52:55]
    v_mfma_f32_16x16x32_bf16 a[8:11], v[44:47], v[20:23], a[8:11]
    ds_read_b128 v[108:111], v152 offset:34816
    s_add_u32 m0, s23, 57344
    v_mfma_f32_16x16x32_bf16 a[24:27], v[44:47], v[24:27], a[24:27]
    buffer_load_dwordx4 v15, s[12:15], s21 offen lds
    ds_read_b64_tr_b16 v[92:93], v150 offset:32768
    v_mfma_f32_16x16x32_bf16 a[40:43], v[44:47], v[28:31], a[40:43]
    ds_read_b64_tr_b16 v[94:95], v150 offset:33792
    v_mfma_f32_16x16x32_bf16 a[56:59], v[44:47], v[32:35], a[56:59]
    v_mfma_f32_16x16x32_bf16 a[12:15], v[48:51], v[20:23], a[12:15]
    ds_read_b128 v[112:115], v152 offset:35840
    s_add_u32 m0, s23, 58368
    v_mfma_f32_16x16x32_bf16 a[28:31], v[48:51], v[24:27], a[28:31]
    buffer_load_dwordx4 v16, s[12:15], s21 offen lds
    ds_read_b64_tr_b16 v[96:97], v151 offset:32768
    v_mfma_f32_16x16x32_bf16 a[44:47], v[48:51], v[28:31], a[44:47]
    ds_read_b64_tr_b16 v[98:99], v151 offset:33792
    v_mfma_f32_16x16x32_bf16 a[60:63], v[48:51], v[32:35], a[60:63]
    s_add_u32 s20, s20, 131072
    s_add_u32 s21, s21, 65536
    s_waitcnt lgkmcnt(12)
    v_mfma_f32_16x16x32_bf16 a[0:3], v[68:71], v[52:55], a[0:3]
    ds_read_b128 v[132:135], v152 offset:49152
    s_add_u32 m0, s22, 65536
    v_mfma_f32_16x16x32_bf16 a[16:19], v[68:71], v[56:59], a[16:19]
    buffer_load_dwordx4 v13, s[8:11], s20 offen lds
    ds_read_b64_tr_b16 v[116:117], v148 offset:49152
    v_mfma_f32_16x16x32_bf16 a[32:35], v[68:71], v[60:63], a[32:35]
    ds_read_b64_tr_b16 v[118:119], v148 offset:50176
    v_mfma_f32_16x16x32_bf16 a[48:51], v[68:71], v[64:67], a[48:51]
    v_mfma_f32_16x16x32_bf16 a[4:7], v[72:75], v[52:55], a[4:7]
    ds_read_b128 v[136:139], v152 offset:50176
    s_add_u32 m0, s22, 66560
    v_mfma_f32_16x16x32_bf16 a[20:23], v[72:75], v[56:59], a[20:23]
    buffer_load_dwordx4 v14, s[8:11], s20 offen lds
    ds_read_b64_tr_b16 v[120:121], v149 offset:49152
    v_mfma_f32_16x16x32_bf16 a[36:39], v[72:75], v[60:63], a[36:39]
    ds_read_b64_tr_b16 v[122:123], v149 offset:50176
    v_mfma_f32_16x16x32_bf16 a[52:55], v[72:75], v[64:67], a[52:55]
    v_mfma_f32_16x16x32_bf16 a[8:11], v[76:79], v[52:55], a[8:11]
    ds_read_b128 v[140:143], v152 offset:51200
    s_add_u32 m0, s23, 73728
    v_mfma_f32_16x16x32_bf16 a[24:27], v[76:79], v[56:59], a[24:27]
    buffer_load_dwordx4 v15, s[12:15], s21 offen lds
    ds_read_b64_tr_b16 v[124:125], v150 offset:49152
    v_mfma_f32_16x16x32_bf16 a[40:43], v[76:79], v[60:63], a[40:43]
    ds_read_b64_tr_b16 v[126:127], v150 offset:50176
    v_mfma_f32_16x16x32_bf16 a[56:59], v[76:79], v[64:67], a[56:59]
    v_mfma_f32_16x16x32_bf16 a[12:15], v[80:83], v[52:55], a[12:15]
    ds_read_b128 v[144:147], v152 offset:52224
    s_add_u32 m0, s23, 74752
    v_mfma_f32_16x16x32_bf16 a[28:31], v[80:83], v[56:59], a[28:31]
    buffer_load_dwordx4 v16, s[12:15], s21 offen lds
    ds_read_b64_tr_b16 v[128:129], v151 offset:49152
    v_mfma_f32_16x16x32_bf16 a[44:47], v[80:83], v[60:63], a[44:47]
    ds_read_b64_tr_b16 v[130:131], v151 offset:50176
    v_mfma_f32_16x16x32_bf16 a[60:63], v[80:83], v[64:67], a[60:63]
    s_add_u32 s20, s20, 131072
    s_add_u32 s21, s21, 65536
    s_waitcnt vmcnt(12) lgkmcnt(12)
    s_barrier
    v_mfma_f32_16x16x32_bf16 a[0:3], v[100:103], v[84:87], a[0:3]
    ds_read_b128 v[36:39], v12 offset:0
    s_add_u32 m0, s22, 81920
    v_mfma_f32_16x16x32_bf16 a[16:19], v[100:103], v[88:91], a[16:19]
    buffer_load_dwordx4 v13, s[8:11], s20 offen lds
    ds_read_b64_tr_b16 v[20:21], v8 offset:0
    v_mfma_f32_16x16x32_bf16 a[32:35], v[100:103], v[92:95], a[32:35]
    ds_read_b64_tr_b16 v[22:23], v8 offset:1024
    v_mfma_f32_16x16x32_bf16 a[48:51], v[100:103], v[96:99], a[48:51]
    v_mfma_f32_16x16x32_bf16 a[4:7], v[104:107], v[84:87], a[4:7]
    ds_read_b128 v[40:43], v12 offset:1024
    s_add_u32 m0, s22, 82944
    v_mfma_f32_16x16x32_bf16 a[20:23], v[104:107], v[88:91], a[20:23]
    buffer_load_dwordx4 v14, s[8:11], s20 offen lds
    ds_read_b64_tr_b16 v[24:25], v9 offset:0
    v_mfma_f32_16x16x32_bf16 a[36:39], v[104:107], v[92:95], a[36:39]
    ds_read_b64_tr_b16 v[26:27], v9 offset:1024
    v_mfma_f32_16x16x32_bf16 a[52:55], v[104:107], v[96:99], a[52:55]
    v_mfma_f32_16x16x32_bf16 a[8:11], v[108:111], v[84:87], a[8:11]
    ds_read_b128 v[44:47], v12 offset:2048
    s_add_u32 m0, s23, 90112
    v_mfma_f32_16x16x32_bf16 a[24:27], v[108:111], v[88:91], a[24:27]
    buffer_load_dwordx4 v15, s[12:15], s21 offen lds
    ds_read_b64_tr_b16 v[28:29], v10 offset:0
    v_mfma_f32_16x16x32_bf16 a[40:43], v[108:111], v[92:95], a[40:43]
    ds_read_b64_tr_b16 v[30:31], v10 offset:1024
    v_mfma_f32_16x16x32_bf16 a[56:59], v[108:111], v[96:99], a[56:59]
    v_mfma_f32_16x16x32_bf16 a[12:15], v[112:115], v[84:87], a[12:15]
    ds_read_b128 v[48:51], v12 offset:3072
    s_add_u32 m0, s23, 91136
    v_mfma_f32_16x16x32_bf16 a[28:31], v[112:115], v[88:91], a[28:31]
    buffer_load_dwordx4 v16, s[12:15], s21 offen lds
    ds_read_b64_tr_b16 v[32:33], v11 offset:0
    v_mfma_f32_16x16x32_bf16 a[44:47], v[112:115], v[92:95], a[44:47]
    ds_read_b64_tr_b16 v[34:35], v11 offset:1024
    v_mfma_f32_16x16x32_bf16 a[60:63], v[112:115], v[96:99], a[60:63]
    s_add_u32 s20, s20, 131072
    s_add_u32 s21, s21, 65536
    s_waitcnt lgkmcnt(12)
    v_mfma_f32_16x16x32_bf16 a[0:3], v[132:135], v[116:119], a[0:3]
    ds_read_b128 v[68:71], v12 offset:16384
    s_add_u32 m0, s22, 98304
    v_mfma_f32_16x16x32_bf16 a[16:19], v[132:135], v[120:123], a[16:19]
    buffer_load_dwordx4 v13, s[8:11], s20 offen lds
    ds_read_b64_tr_b16 v[52:53], v8 offset:16384
    v_mfma_f32_16x16x32_bf16 a[32:35], v[132:135], v[124:127], a[32:35]
    ds_read_b64_tr_b16 v[54:55], v8 offset:17408
    v_mfma_f32_16x16x32_bf16 a[48:51], v[132:135], v[128:131], a[48:51]
    v_mfma_f32_16x16x32_bf16 a[4:7], v[136:139], v[116:119], a[4:7]
    ds_read_b128 v[72:75], v12 offset:17408
    s_add_u32 m0, s22, 99328
    v_mfma_f32_16x16x32_bf16 a[20:23], v[136:139], v[120:123], a[20:23]
    buffer_load_dwordx4 v14, s[8:11], s20 offen lds
    ds_read_b64_tr_b16 v[56:57], v9 offset:16384
    v_mfma_f32_16x16x32_bf16 a[36:39], v[136:139], v[124:127], a[36:39]
    ds_read_b64_tr_b16 v[58:59], v9 offset:17408
    v_mfma_f32_16x16x32_bf16 a[52:55], v[136:139], v[128:131], a[52:55]
    v_mfma_f32_16x16x32_bf16 a[8:11], v[140:143], v[116:119], a[8:11]
    ds_read_b128 v[76:79], v12 offset:18432
    s_add_u32 m0, s23, 106496
    v_mfma_f32_16x16x32_bf16 a[24:27], v[140:143], v[120:123], a[24:27]
    buffer_load_dwordx4 v15, s[12:15], s21 offen lds
    ds_read_b64_tr_b16 v[60:61], v10 offset:16384
    v_mfma_f32_16x16x32_bf16 a[40:43], v[140:143], v[124:127], a[40:43]
    ds_read_b64_tr_b16 v[62:63], v10 offset:17408
    v_mfma_f32_16x16x32_bf16 a[56:59], v[140:143], v[128:131], a[56:59]
    v_mfma_f32_16x16x32_bf16 a[12:15], v[144:147], v[116:119], a[12:15]
    ds_read_b128 v[80:83], v12 offset:19456
    s_add_u32 m0, s23, 107520
    v_mfma_f32_16x16x32_bf16 a[28:31], v[144:147], v[120:123], a[28:31]
    buffer_load_dwordx4 v16, s[12:15], s21 offen lds
    ds_read_b64_tr_b16 v[64:65], v11 offset:16384
    v_mfma_f32_16x16x32_bf16 a[44:47], v[144:147], v[124:127], a[44:47]
    ds_read_b64_tr_b16 v[66:67], v11 offset:17408
    v_mfma_f32_16x16x32_bf16 a[60:63], v[144:147], v[128:131], a[60:63]
    s_add_u32 s20, s20, 131072
    s_add_u32 s21, s21, 65536
    s_waitcnt vmcnt(12) lgkmcnt(12)
    s_barrier
    s_sub_u32 s24, s24, 1
    s_cmp_lg_u32 s24, 0
    s_cbranch_scc1 L_g2f_loop
    s_waitcnt vmcnt(0) lgkmcnt(0)
    v_and_b32 v1, 15, v0
    v_lshrrev_b32 v2, 4, v0
    v_and_b32 v3, 1, v2
    v_lshrrev_b32 v2, 1, v2
    v_lshlrev_b32 v3, 4, v3
    v_lshl_add_u32 v3, v2, 3, v3
    s_lshl_b32 s25, s5, 7
    s_lshr_b32 s26, s3, 1
    s_lshl_b32 s26, s26, 6
    s_add_u32 s25, s25, s26
    v_add_u32 v4, s25, v3
    s_lshl_b32 s58, s4, 7
    s_and_b32 s26, s3, 1
    s_lshl_b32 s26, s26, 6
    s_add_u32 s58, s58, s26
    s_lshl_b32 s26, s56, 5
    s_add_u32 s58, s58, s26
    v_add_u32 v5, s58, v1
    v_lshlrev_b32 v6, 11, v5
    v_lshl_add_u32 v6, v4, 1, v6
    v_lshlrev_b32 v7, 2, v4
    s_add_u32 s44, s6, 20480
    s_addc_u32 s45, s7, 0
    global_load_dwordx4 v[84:87], v7, s[44:45] offset:0
    global_load_dwordx4 v[88:91], v7, s[44:45] offset:16
    global_load_dwordx4 v[92:95], v7, s[44:45] offset:128
    global_load_dwordx4 v[96:99], v7, s[44:45] offset:144
    s_add_u32 s44, s6, 83886080
    s_addc_u32 s45, s7, 0
    v_lshlrev_b32 v9, 1, v5
    v_add_u32 v8, 0, v6
    global_load_dwordx4 v[132:135], v8, s[44:45] offset:0
    global_load_dwordx4 v[136:139], v8, s[44:45] offset:64
    global_load_ushort v120, v9, s[54:55] offset:0
    v_add_u32 v8, 32768, v6
    global_load_dwordx4 v[140:143], v8, s[44:45] offset:0
    global_load_dwordx4 v[144:147], v8, s[44:45] offset:64
    global_load_ushort v121, v9, s[54:55] offset:32
    s_lshl_b32 s25, s57, 1
    s_add_u32 s26, s25, s56
    s_lshl_b32 s26, s26, 2
    s_add_u32 s26, s26, s3
    s_lshl_b32 s26, s26, 13
    s_xor_b32 s27, s56, 1
    s_add_u32 s27, s25, s27
    s_lshl_b32 s27, s27, 2
    s_add_u32 s27, s27, s3
    s_lshl_b32 s27, s27, 13
    s_add_u32 s26, s26, 142606336
    s_add_u32 s27, s27, 142606336
    s_add_u32 s40, s6, s26
    s_addc_u32 s41, s7, 0
    s_add_u32 s42, s6, s27
    s_addc_u32 s43, s7, 0
    s_add_u32 s40, s40, 4096
    s_addc_u32 s41, s41, 0
    s_add_u32 s42, s42, 4096
    s_addc_u32 s43, s43, 0
    v_lshlrev_b32 v1, 4, v0
    s_cmp_lg_u32 s56, 0
    s_cbranch_scc1 L_g2fx_k1
    v_accvgpr_read_b32 v52, a32
    v_accvgpr_read_b32 v53, a33
    v_accvgpr_read_b32 v54, a34
    v_accvgpr_read_b32 v55, a35
    global_store_dwordx4 v1, v[52:55], s[40:41] offset:-4096 sc1
    v_accvgpr_read_b32 v56, a36
    v_accvgpr_read_b32 v57, a37
    v_accvgpr_read_b32 v58, a38
    v_accvgpr_read_b32 v59, a39
    global_store_dwordx4 v1, v[56:59], s[40:41] offset:-3072 sc1
    v_accvgpr_read_b32 v60, a40
    v_accvgpr_read_b32 v61, a41
    v_accvgpr_read_b32 v62, a42
    v_accvgpr_read_b32 v63, a43
    global_store_dwordx4 v1, v[60:63], s[40:41] offset:-2048 sc1
    v_accvgpr_read_b32 v64, a44
    v_accvgpr_read_b32 v65, a45
    v_accvgpr_read_b32 v66, a46
    v_accvgpr_read_b32 v67, a47
    global_store_dwordx4 v1, v[64:67], s[40:41] offset:-1024 sc1
    v_accvgpr_read_b32 v52, a48
    v_accvgpr_read_b32 v53, a49
    v_accvgpr_read_b32 v54, a50
    v_accvgpr_read_b32 v55, a51
    global_store_dwordx4 v1, v[52:55], s[40:41] offset:0 sc1
    v_accvgpr_read_b32 v56, a52
    v_accvgpr_read_b32 v57, a53
    v_accvgpr_read_b32 v58, a54
    v_accvgpr_read_b32 v59, a55
    global_store_dwordx4 v1, v[56:59], s[40:41] offset:1024 sc1
    v_accvgpr_read_b32 v60, a56
    v_accvgpr_read_b32 v61, a57
    v_accvgpr_read_b32 v62, a58
    v_accvgpr_read_b32 v63, a59
    global_store_dwordx4 v1, v[60:63], s[40:41] offset:2048 sc1
    v_accvgpr_read_b32 v64, a60
    v_accvgpr_read_b32 v65, a61
    v_accvgpr_read_b32 v66, a62
    v_accvgpr_read_b32 v67, a63
    global_store_dwordx4 v1, v[64:67], s[40:41] offset:3072 sc1
    v_accvgpr_read_b32 v20, a0
    v_accvgpr_read_b32 v21, a1
    v_accvgpr_read_b32 v22, a2
    v_accvgpr_read_b32 v23, a3
    v_accvgpr_read_b32 v24, a4
    v_accvgpr_read_b32 v25, a5
    v_accvgpr_read_b32 v26, a6
    v_accvgpr_read_b32 v27, a7
    v_accvgpr_read_b32 v28, a8
    v_accvgpr_read_b32 v29, a9
    v_accvgpr_read_b32 v30, a10
    v_accvgpr_read_b32 v31, a11
    v_accvgpr_read_b32 v32, a12
    v_accvgpr_read_b32 v33, a13
    v_accvgpr_read_b32 v34, a14
    v_accvgpr_read_b32 v35, a15
    v_accvgpr_read_b32 v36, a16
    v_accvgpr_read_b32 v37, a17
    v_accvgpr_read_b32 v38, a18
    v_accvgpr_read_b32 v39, a19
    v_accvgpr_read_b32 v40, a20
    v_accvgpr_read_b32 v41, a21
    v_accvgpr_read_b32 v42, a22
    v_accvgpr_read_b32 v43, a23
    v_accvgpr_read_b32 v44, a24
    v_accvgpr_read_b32 v45, a25
    v_accvgpr_read_b32 v46, a26
    v_accvgpr_read_b32 v47, a27
    v_accvgpr_read_b32 v48, a28
    v_accvgpr_read_b32 v49, a29
    v_accvgpr_read_b32 v50, a30
    v_accvgpr_read_b32 v51, a31
    s_branch L_g2fx_kd
L_g2fx_k1:
    v_accvgpr_read_b32 v52, a0
    v_accvgpr_read_b32 v53, a1
    v_accvgpr_read_b32 v54, a2
    v_accvgpr_read_b32 v55, a3
    global_store_dwordx4 v1, v[52:55], s[40:41] offset:-4096 sc1
    v_accvgpr_read_b32 v56, a4
    v_accvgpr_read_b32 v57, a5
    v_accvgpr_read_b32 v58, a6
    v_accvgpr_read_b32 v59, a7
    global_store_dwordx4 v1, v[56:59], s[40:41] offset:-3072 sc1
    v_accvgpr_read_b32 v60, a8
    v_accvgpr_read_b32 v61, a9
    v_accvgpr_read_b32 v62, a10
    v_accvgpr_read_b32 v63, a11
    global_store_dwordx4 v1, v[60:63], s[40:41] offset:-2048 sc1
    v_accvgpr_read_b32 v64, a12
    v_accvgpr_read_b32 v65, a13
    v_accvgpr_read_b32 v66, a14
    v_accvgpr_read_b32 v67, a15
    global_store_dwordx4 v1, v[64:67], s[40:41] offset:-1024 sc1
    v_accvgpr_read_b32 v52, a16
    v_accvgpr_read_b32 v53, a17
    v_accvgpr_read_b32 v54, a18
    v_accvgpr_read_b32 v55, a19
    global_store_dwordx4 v1, v[52:55], s[40:41] offset:0 sc1
    v_accvgpr_read_b32 v56, a20
    v_accvgpr_read_b32 v57, a21
    v_accvgpr_read_b32 v58, a22
    v_accvgpr_read_b32 v59, a23
    global_store_dwordx4 v1, v[56:59], s[40:41] offset:1024 sc1
    v_accvgpr_read_b32 v60, a24
    v_accvgpr_read_b32 v61, a25
    v_accvgpr_read_b32 v62, a26
    v_accvgpr_read_b32 v63, a27
    global_store_dwordx4 v1, v[60:63], s[40:41] offset:2048 sc1
    v_accvgpr_read_b32 v64, a28
    v_accvgpr_read_b32 v65, a29
    v_accvgpr_read_b32 v66, a30
    v_accvgpr_read_b32 v67, a31
    global_store_dwordx4 v1, v[64:67], s[40:41] offset:3072 sc1
    v_accvgpr_read_b32 v20, a32
    v_accvgpr_read_b32 v21, a33
    v_accvgpr_read_b32 v22, a34
    v_accvgpr_read_b32 v23, a35
    v_accvgpr_read_b32 v24, a36
    v_accvgpr_read_b32 v25, a37
    v_accvgpr_read_b32 v26, a38
    v_accvgpr_read_b32 v27, a39
    v_accvgpr_read_b32 v28, a40
    v_accvgpr_read_b32 v29, a41
    v_accvgpr_read_b32 v30, a42
    v_accvgpr_read_b32 v31, a43
    v_accvgpr_read_b32 v32, a44
    v_accvgpr_read_b32 v33, a45
    v_accvgpr_read_b32 v34, a46
    v_accvgpr_read_b32 v35, a47
    v_accvgpr_read_b32 v36, a48
    v_accvgpr_read_b32 v37, a49
    v_accvgpr_read_b32 v38, a50
    v_accvgpr_read_b32 v39, a51
    v_accvgpr_read_b32 v40, a52
    v_accvgpr_read_b32 v41, a53
    v_accvgpr_read_b32 v42, a54
    v_accvgpr_read_b32 v43, a55
    v_accvgpr_read_b32 v44, a56
    v_accvgpr_read_b32 v45, a57
    v_accvgpr_read_b32 v46, a58
    v_accvgpr_read_b32 v47, a59
    v_accvgpr_read_b32 v48, a60
    v_accvgpr_read_b32 v49, a61
    v_accvgpr_read_b32 v50, a62
    v_accvgpr_read_b32 v51, a63
L_g2fx_kd:
    s_mov_b32 s50, 0x200000
L_g2fx_sp:
    global_load_dwordx4 v[52:55], v1, s[42:43] offset:-4096 sc1
    global_load_dwordx4 v[56:59], v1, s[42:43] offset:-3072 sc1
    global_load_dwordx4 v[60:63], v1, s[42:43] offset:-2048 sc1
    global_load_dwordx4 v[64:67], v1, s[42:43] offset:-1024 sc1
    global_load_dwordx4 v[68:71], v1, s[42:43] offset:0 sc1
    global_load_dwordx4 v[72:75], v1, s[42:43] offset:1024 sc1
    global_load_dwordx4 v[76:79], v1, s[42:43] offset:2048 sc1
    global_load_dwordx4 v[80:83], v1, s[42:43] offset:3072 sc1
    s_waitcnt vmcnt(0)
    v_max3_u32 v2, v52, v53, v54
    v_max3_u32 v2, v2, v55, v56
    v_max3_u32 v2, v2, v57, v58
    v_max3_u32 v2, v2, v59, v60
    v_max3_u32 v2, v2, v61, v62
    v_max3_u32 v2, v2, v63, v64
    v_max3_u32 v2, v2, v65, v66
    v_max3_u32 v2, v2, v67, v68
    v_max3_u32 v2, v2, v69, v70
    v_max3_u32 v2, v2, v71, v72
    v_max3_u32 v2, v2, v73, v74
    v_max3_u32 v2, v2, v75, v76
    v_max3_u32 v2, v2, v77, v78
    v_max3_u32 v2, v2, v79, v80
    v_max3_u32 v2, v2, v81, v82
    v_max_u32 v2, v2, v83
    v_cmp_eq_u32 vcc, -1, v2
    s_cbranch_vccz L_g2fx_sok
    s_sub_u32 s50, s50, 1
    s_cbranch_scc0 L_g2fx_sp
L_g2fx_sok:
    v_add_f32 v20, v20, v52
    v_add_f32 v21, v21, v53
    v_add_f32 v22, v22, v54
    v_add_f32 v23, v23, v55
    v_add_f32 v24, v24, v56
    v_add_f32 v25, v25, v57
    v_add_f32 v26, v26, v58
    v_add_f32 v27, v27, v59
    v_add_f32 v28, v28, v60
    v_add_f32 v29, v29, v61
    v_add_f32 v30, v30, v62
    v_add_f32 v31, v31, v63
    v_add_f32 v32, v32, v64
    v_add_f32 v33, v33, v65
    v_add_f32 v34, v34, v66
    v_add_f32 v35, v35, v67
    v_add_f32 v36, v36, v68
    v_add_f32 v37, v37, v69
    v_add_f32 v38, v38, v70
    v_add_f32 v39, v39, v71
    v_add_f32 v40, v40, v72
    v_add_f32 v41, v41, v73
    v_add_f32 v42, v42, v74
    v_add_f32 v43, v43, v75
    v_add_f32 v44, v44, v76
    v_add_f32 v45, v45, v77
    v_add_f32 v46, v46, v78
    v_add_f32 v47, v47, v79
    v_add_f32 v48, v48, v80
    v_add_f32 v49, v49, v81
    v_add_f32 v50, v50, v82
    v_add_f32 v51, v51, v83
    v_permlane16_swap_b32 v20, v24
    v_permlane16_swap_b32 v21, v25
    v_permlane16_swap_b32 v22, v26
    v_permlane16_swap_b32 v23, v27
    v_permlane16_swap_b32 v28, v32
    v_permlane16_swap_b32 v29, v33
    v_permlane16_swap_b32 v30, v34
    v_permlane16_swap_b32 v31, v35
    v_permlane16_swap_b32 v36, v40
    v_permlane16_swap_b32 v37, v41
    v_permlane16_swap_b32 v38, v42
    v_permlane16_swap_b32 v39, v43
    v_permlane16_swap_b32 v44, v48
    v_permlane16_swap_b32 v45, v49
    v_permlane16_swap_b32 v46, v50
    v_permlane16_swap_b32 v47, v51
    s_waitcnt vmcnt(0)
    v_lshlrev_b32 v120, 16, v120
    v_add_u32 v8, 0, v6
    v_lshlrev_b32 v148, 16, v132
    v_and_b32 v149, 0xffff0000, v132
    v_lshlrev_b32 v150, 16, v133
    v_and_b32 v151, 0xffff0000, v133
    v_lshlrev_b32 v152, 16, v134
    v_and_b32 v153, 0xffff0000, v134
    v_lshlrev_b32 v154, 16, v135
    v_and_b32 v155, 0xffff0000, v135
    v_add_f32 v20, v20, v120
    v_add_f32 v21, v21, v120
    v_add_f32 v22, v22, v120
    v_add_f32 v23, v23, v120
    v_add_f32 v24, v24, v120
    v_add_f32 v25, v25, v120
    v_add_f32 v26, v26, v120
    v_add_f32 v27, v27, v120
    v_fma_f32 v20, v20, v84, v148
    v_fma_f32 v21, v21, v85, v149
    v_fma_f32 v22, v22, v86, v150
    v_fma_f32 v23, v23, v87, v151
    v_fma_f32 v24, v24, v88, v152
    v_fma_f32 v25, v25, v89, v153
    v_fma_f32 v26, v26, v90, v154
    v_fma_f32 v27, v27, v91, v155
    v_cvt_pk_bf16_f32 v132, v20, v21
    v_cvt_pk_bf16_f32 v133, v22, v23
    v_cvt_pk_bf16_f32 v134, v24, v25
    v_cvt_pk_bf16_f32 v135, v26, v27
    global_store_dwordx4 v8, v[132:135], s[60:61] offset:0
    v_lshlrev_b32 v148, 16, v136
    v_and_b32 v149, 0xffff0000, v136
    v_lshlrev_b32 v150, 16, v137
    v_and_b32 v151, 0xffff0000, v137
    v_lshlrev_b32 v152, 16, v138
    v_and_b32 v153, 0xffff0000, v138
    v_lshlrev_b32 v154, 16, v139
    v_and_b32 v155, 0xffff0000, v139
    v_add_f32 v28, v28, v120
    v_add_f32 v29, v29, v120
    v_add_f32 v30, v30, v120
    v_add_f32 v31, v31, v120
    v_add_f32 v32, v32, v120
    v_add_f32 v33, v33, v120
    v_add_f32 v34, v34, v120
    v_add_f32 v35, v35, v120
    v_fma_f32 v28, v28, v92, v148
    v_fma_f32 v29, v29, v93, v149
    v_fma_f32 v30, v30, v94, v150
    v_fma_f32 v31, v31, v95, v151
    v_fma_f32 v32, v32, v96, v152
    v_fma_f32 v33, v33, v97, v153
    v_fma_f32 v34, v34, v98, v154
    v_fma_f32 v35, v35, v99, v155
    v_cvt_pk_bf16_f32 v136, v28, v29
    v_cvt_pk_bf16_f32 v137, v30, v31
    v_cvt_pk_bf16_f32 v138, v32, v33
    v_cvt_pk_bf16_f32 v139, v34, v35
    global_store_dwordx4 v8, v[136:139], s[60:61] offset:64
    v_lshlrev_b32 v121, 16, v121
    v_add_u32 v8, 32768, v6
    v_lshlrev_b32 v148, 16, v140
    v_and_b32 v149, 0xffff0000, v140
    v_lshlrev_b32 v150, 16, v141
    v_and_b32 v151, 0xffff0000, v141
    v_lshlrev_b32 v152, 16, v142
    v_and_b32 v153, 0xffff0000, v142
    v_lshlrev_b32 v154, 16, v143
    v_and_b32 v155, 0xffff0000, v143
    v_add_f32 v36, v36, v121
    v_add_f32 v37, v37, v121
    v_add_f32 v38, v38, v121
    v_add_f32 v39, v39, v121
    v_add_f32 v40, v40, v121
    v_add_f32 v41, v41, v121
    v_add_f32 v42, v42, v121
    v_add_f32 v43, v43, v121
    v_fma_f32 v36, v36, v84, v148
    v_fma_f32 v37, v37, v85, v149
    v_fma_f32 v38, v38, v86, v150
    v_fma_f32 v39, v39, v87, v151
    v_fma_f32 v40, v40, v88, v152
    v_fma_f32 v41, v41, v89, v153
    v_fma_f32 v42, v42, v90, v154
    v_fma_f32 v43, v43, v91, v155
    v_cvt_pk_bf16_f32 v140, v36, v37
    v_cvt_pk_bf16_f32 v141, v38, v39
    v_cvt_pk_bf16_f32 v142, v40, v41
    v_cvt_pk_bf16_f32 v143, v42, v43
    global_store_dwordx4 v8, v[140:143], s[60:61] offset:0
    v_lshlrev_b32 v148, 16, v144
    v_and_b32 v149, 0xffff0000, v144
    v_lshlrev_b32 v150, 16, v145
    v_and_b32 v151, 0xffff0000, v145
    v_lshlrev_b32 v152, 16, v146
    v_and_b32 v153, 0xffff0000, v146
    v_lshlrev_b32 v154, 16, v147
    v_and_b32 v155, 0xffff0000, v147
    v_add_f32 v44, v44, v121
    v_add_f32 v45, v45, v121
    v_add_f32 v46, v46, v121
    v_add_f32 v47, v47, v121
    v_add_f32 v48, v48, v121
    v_add_f32 v49, v49, v121
    v_add_f32 v50, v50, v121
    v_add_f32 v51, v51, v121
    v_fma_f32 v44, v44, v92, v148
    v_fma_f32 v45, v45, v93, v149
    v_fma_f32 v46, v46, v94, v150
    v_fma_f32 v47, v47, v95, v151
    v_fma_f32 v48, v48, v96, v152
    v_fma_f32 v49, v49, v97, v153
    v_fma_f32 v50, v50, v98, v154
    v_fma_f32 v51, v51, v99, v155
    v_cvt_pk_bf16_f32 v144, v44, v45
    v_cvt_pk_bf16_f32 v145, v46, v47
    v_cvt_pk_bf16_f32 v146, v48, v49
    v_cvt_pk_bf16_f32 v147, v50, v51
    global_store_dwordx4 v8, v[144:147], s[60:61] offset:64
    s_waitcnt vmcnt(0)
    s_waitcnt vmcnt(0)
    s_endpgm
.section .rodata,"a"
.p2align 6
.amdhsa_kernel tail_kernel
  .amdhsa_next_free_vgpr 324
  .amdhsa_next_free_sgpr 102
  .amdhsa_accum_offset 196
  .amdhsa_group_segment_fixed_size 0
  .amdhsa_kernarg_size 136
  .amdhsa_user_sgpr_count 2
  .amdhsa_user_sgpr_kernarg_segment_ptr 1
  .amdhsa_system_sgpr_workgroup_id_x 1
.end_amdhsa_kernel
.text
```
